```python
import torch

def _softmax(x, axis=-1):
    return torch.softmax(x, dim=axis)
def _gelu(x):
    return torch.nn.functional.gelu(x, approximate="tanh")
def _silu(x):
    return torch.nn.functional.silu(x)
def _sigmoid(x):
    return torch.sigmoid(x)
def _layernorm(x, axis=-1, eps=1e-5):
    m = x.mean(dim=axis, keepdim=True)
    v = x.var(dim=axis, keepdim=True, unbiased=False)
    return (x - m) / torch.sqrt(v + eps)
def _scatter_add(tgt, idx, src, axis=0):
    return tgt.clone().index_add_(axis, idx, src)
def _segment_sum(src, seg, n):
    out = torch.zeros((n,) + src.shape[1:], dtype=src.dtype)
    return out.index_add_(0, seg, src)
def _pad(x, pw):
    flat = tuple(v for pair in reversed(pw) for v in pair)
    return torch.nn.functional.pad(x, flat)

kernel_name = 'interleave_layers__softmax_full_mha__mixer_channel_mlp__prompt'

def setup_inputs():

    _w = (lambda a: (lambda t: t.to(torch.bfloat16) if t.is_floating_point() else t)(torch.as_tensor(a)))
    def _A_setup():
        B, S, D = 1, 2048, 640
        return {
            "x": _w((lambda *s: torch.randn(*s, dtype=torch.bfloat16) * 0.05)(B, S, D)),
            "wqkv": _w((lambda *s: torch.randn(*s, dtype=torch.bfloat16) * 0.05)(D, 3 * D)),
            "wo": _w((lambda *s: torch.randn(*s, dtype=torch.bfloat16) * 0.05)(D, D)),
        }
    _A_in = _A_setup()

    def _B_setup():
        B, S, D, F = 1, 2048, 640, 1536
        return {
            "x": _w((lambda *s: torch.randn(*s, dtype=torch.bfloat16) * 0.05)(B, S, D)),
            "w1": _w((lambda *s: torch.randn(*s, dtype=torch.bfloat16) * 3.2)(D, F) * (D ** -0.5)),
            "b1": _w((lambda *s: torch.randn(*s, dtype=torch.bfloat16) * 0.8)(F)),
            "w2": _w((lambda *s: torch.randn(*s, dtype=torch.bfloat16) * 0.4)(F, D) * (F ** -0.5)),
            "b2": _w((lambda *s: torch.randn(*s, dtype=torch.bfloat16) * 0.4)(D)),
        }
    _B_in = _B_setup()

    return {
        "A_x": _A_in["x"],
        "A_wqkv": _A_in["wqkv"],
        "A_wo": _A_in["wo"],
        "B_x": _B_in["x"],
        "B_w1": _B_in["w1"],
        "B_b1": _B_in["b1"],
        "B_w2": _B_in["w2"],
        "B_b2": _B_in["b2"],
    }

def reference(A_x, A_wqkv, A_wo, B_x, B_w1, B_b1, B_w2, B_b2):
    def _A_ref(x, wqkv, wo):
        B, S, D = x.shape
        H = 32; Dh = D // H
        qkv = (lambda x, *d: x.permute(*d))((x @ wqkv).reshape(B, S, 3, H, Dh), 2, 0, 3, 1, 4)
        q, k, v = qkv[0], qkv[1], qkv[2]
        scale = Dh ** -0.5
        scores = torch.einsum("bhqd,bhkd->bhqk", q, k) * scale
        p = _softmax(scores, axis=-1)
        o = torch.einsum("bhqk,bhkd->bhqd", p, v)
        return (lambda x, *d: x.permute(*d))(o, 0, 2, 1, 3).reshape(B, S, D) @ wo

    def _B_ref(x, w1, b1, w2, b2):
        y = _layernorm(x, axis=-1)
        h = _gelu(torch.einsum("bsd,df->bsf", y, w1) + b1)
        return torch.einsum("bsf,fd->bsd", h, w2) + b2

    x = A_x
    x = x + _A_ref(_layernorm(x, axis=-1), A_wqkv, A_wo)
    x = x + _B_ref(_layernorm(x, axis=-1), B_w1, B_b1, B_w2, B_b2)
    x = x + _A_ref(_layernorm(x, axis=-1), A_wqkv, A_wo)
    x = x + _B_ref(_layernorm(x, axis=-1), B_w1, B_b1, B_w2, B_b2)
    return x
```

```asm
; @launch kernel=first_kernel grid=(256,1,1) block=(512,1,1) lds=163840
; @launch kernel=chain_kernel grid=(256,1,1) block=(512,1,1) lds=163840
.amdgcn_target "amdgcn-amd-amdhsa--gfx950"
.text
L_text_begin:
.globl first_kernel
.p2align 8
.type first_kernel,@function
first_kernel:
    s_cmp_ge_u32 s2, 256
    s_cbranch_scc1 L_end_first_kernel
    s_load_dwordx2 s[4:5], s[0:1], 80
    s_mov_b32 s6, 59768832
    s_mov_b32 s7, 0x00020000
    s_load_dwordx2 s[8:9], s[0:1], 0
    s_mov_b32 s10, 2621440
    s_mov_b32 s11, 0x00020000
    s_load_dwordx2 s[12:13], s[0:1], 8
    s_mov_b32 s14, 2457600
    s_mov_b32 s15, 0x00020000
    s_load_dwordx2 s[16:17], s[0:1], 16
    s_mov_b32 s18, 819200
    s_mov_b32 s19, 0x00020000
    s_load_dwordx2 s[36:37], s[0:1], 32
    s_mov_b32 s38, 1966080
    s_mov_b32 s39, 0x00020000
    s_load_dwordx2 s[40:41], s[0:1], 48
    s_mov_b32 s42, 1966080
    s_mov_b32 s43, 0x00020000
    v_lshrrev_b32 v1, 6, v0
    v_and_b32 v0, 63, v0
    v_readfirstlane_b32 s20, v1
    s_cmp_lg_u32 s20, 3
    s_cbranch_scc1 L_nocp_1
    s_lshr_b32 s26, s2, 3
    s_getpc_b64 s[22:23]
L_pc_2:
    s_sub_u32 s22, s22, L_pc_2-L_text_begin
    s_subb_u32 s23, s23, 0
    s_mul_i32 s24, s26, 128*((L_text_end-L_text_begin+4095)/4096)
    v_lshlrev_b32 v24, 7, v0
    v_add_u32 v24, s24, v24
    v_min_u32 v24, L_text_end-L_text_begin-4, v24
    v_cmp_gt_u32 vcc, (L_text_end-L_text_begin+4095)/4096, v0
    s_and_saveexec_b64 s[24:25], vcc
    global_load_dword v255, v24, s[22:23]
    s_mov_b64 exec, -1
L_nocp_1:
    s_and_b32 s22, s2, 7
    s_lshr_b32 s23, s2, 3
    s_lshr_b32 s24, s22, 1
    s_lshl_b32 s24, s24, 2
    s_lshr_b32 s25, s23, 3
    s_add_u32 s53, s24, s25
    s_and_b32 s27, s22, 1
    s_lshl_b32 s27, s27, 3
    s_and_b32 s23, s23, 7
    s_add_u32 s27, s27, s23
    s_and_b32 s29, s20, 3
    s_cmp_lt_u32 s20, 4
    s_cbranch_scc1 L_comp_4
    v_lshrrev_b32 v3, 4, v0
    v_lshlrev_b32 v4, 2, v3
    v_and_b32 v60, 15, v0
    v_xor_b32 v60, v60, v4
    v_lshlrev_b32 v60, 4, v60
    v_mul_u32_u24 v4, 3840, v3
    v_add_u32 v60, v60, v4
    v_lshrrev_b32 v5, 3, v0
    v_and_b32 v61, 7, v0
    v_xor_b32 v61, v61, v3
    v_mul_u32_u24 v5, 1280, v5
    v_xor_b32 v62, 4, v61
    v_lshl_add_u32 v61, v61, 4, v5
    v_lshl_add_u32 v62, v62, 4, v5
    s_mul_i32 s54, s29, 61440
    s_mul_i32 s22, s27, 240
    s_lshl_b32 s23, s27, 8
    s_sub_u32 s23, s23, 256
    s_cmp_ge_u32 s27, 11
    s_cselect_b32 s22, s23, s22
    s_add_u32 s54, s54, s22
    s_lshl_b32 s55, s53, 2
    s_add_u32 s55, s55, s29
    s_mul_i32 s55, s55, 40960
    s_lshl_b32 s56, s29, 12
    s_waitcnt lgkmcnt(0)
    s_add_u32 m0, s56, 0
    s_add_u32 s24, s54, 0
    buffer_load_dwordx4 v60, s[12:15], s24 offen lds
    s_add_u32 m0, s56, 65536
    s_add_u32 s24, s55, 0
    buffer_load_dwordx4 v61, s[8:11], s24 offen lds
    s_add_u32 m0, s56, 1024
    s_add_u32 s24, s54, 15360
    buffer_load_dwordx4 v60, s[12:15], s24 offen lds
    s_add_u32 m0, s56, 66560
    s_add_u32 s24, s55, 10240
    buffer_load_dwordx4 v62, s[8:11], s24 offen lds
    s_add_u32 m0, s56, 2048
    s_add_u32 s24, s54, 30720
    buffer_load_dwordx4 v60, s[12:15], s24 offen lds
    s_add_u32 m0, s56, 67584
    s_add_u32 s24, s55, 20480
    buffer_load_dwordx4 v61, s[8:11], s24 offen lds
    s_add_u32 m0, s56, 3072
    s_add_u32 s24, s54, 46080
    buffer_load_dwordx4 v60, s[12:15], s24 offen lds
    s_add_u32 m0, s56, 68608
    s_add_u32 s24, s55, 30720
    buffer_load_dwordx4 v62, s[8:11], s24 offen lds
    s_add_u32 m0, s56, 16384
    s_add_u32 s24, s54, 245760
    buffer_load_dwordx4 v60, s[12:15], s24 offen lds
    s_add_u32 m0, s56, 81920
    s_add_u32 s24, s55, 128
    buffer_load_dwordx4 v61, s[8:11], s24 offen lds
    s_add_u32 m0, s56, 17408
    s_add_u32 s24, s54, 261120
    buffer_load_dwordx4 v60, s[12:15], s24 offen lds
    s_add_u32 m0, s56, 82944
    s_add_u32 s24, s55, 10368
    buffer_load_dwordx4 v62, s[8:11], s24 offen lds
    s_add_u32 m0, s56, 18432
    s_add_u32 s24, s54, 276480
    buffer_load_dwordx4 v60, s[12:15], s24 offen lds
    s_add_u32 m0, s56, 83968
    s_add_u32 s24, s55, 20608
    buffer_load_dwordx4 v61, s[8:11], s24 offen lds
    s_add_u32 m0, s56, 19456
    s_add_u32 s24, s54, 291840
    buffer_load_dwordx4 v60, s[12:15], s24 offen lds
    s_add_u32 m0, s56, 84992
    s_add_u32 s24, s55, 30848
    buffer_load_dwordx4 v62, s[8:11], s24 offen lds
    s_setprio 2
    s_lshl_b32 s44, s29, 6
    s_mov_b32 s45, 32
    s_mov_b32 s46, 8
    s_cmp_ge_u32 s27, 11
    s_cbranch_scc1 L_vco_5
    s_mul_i32 s44, s29, 80
    s_cmp_eq_u32 s29, 3
    s_cselect_b32 s44, 32, s44
    s_cselect_b32 s45, 160, 40
    s_cselect_b32 s46, 40, 8
L_vco_5:
    v_bfe_u32 v24, v0, 2, 2
    v_lshrrev_b32 v25, 5, v0
    v_lshl_add_u32 v25, v25, 3, v24
    v_lshlrev_b32 v25, 8, v25
    v_lshlrev_b32 v24, 6, v24
    v_bfe_u32 v26, v0, 4, 1
    v_and_b32 v27, 3, v0
    v_mul_u32_u24 v28, s45, v26
    v_add_u32 v28, s44, v28
    v_mul_u32_u24 v8, s46, v27
    v_add_u32 v28, v28, v8
    v_and_b32 v28, 0xff, v28
    v_xor_b32 v28, v28, v24
    v_add_u32 v8, v28, v25
    v_and_b32 v5, 15, v0
    v_lshrrev_b32 v6, 4, v0
    v_xor_b32 v18, v5, v6
    v_and_b32 v18, 1, v18
    v_cmp_eq_u32 vcc, 0, v18
    v_mov_b32 v12, 0x3f803f80
    v_lshlrev_b32 v10, 4, v0
    v_cndmask_b32 v116, 0, v12, vcc
    v_cndmask_b32 v117, 0, v12, vcc
    v_cndmask_b32 v118, 0, v12, vcc
    v_cndmask_b32 v119, 0, v12, vcc
    v_lshl_add_u32 v11, v5, 2, v6
    v_lshlrev_b32 v11, 4, v11
    s_mul_i32 s32, s27, 163840
    s_lshl_b32 s22, s29, 10
    s_add_u32 s32, s32, s22
    s_add_u32 s32, s32, 4751360
    s_lshl_b32 s34, s2, 2
    s_add_u32 s34, s34, s29
    s_mul_i32 s35, s29, 5120
    s_add_u32 s35, s35, 131072
    s_lshr_b32 s30, s53, 2
    s_and_b32 s31, s53, 3
    s_lshl_b32 s22, s31, 12
    s_add_u32 s32, s32, s22
    v_add_u32 v9, s22, v8
    s_waitcnt vmcnt(8)
    s_barrier
    ds_read_b64_tr_b16 v[80:81], v8 offset:0
    ds_read_b64_tr_b16 v[82:83], v8 offset:1024
    ds_read_b64_tr_b16 v[84:85], v8 offset:4096
    ds_read_b64_tr_b16 v[86:87], v8 offset:5120
    ds_read_b64_tr_b16 v[88:89], v8 offset:8192
    ds_read_b64_tr_b16 v[90:91], v8 offset:9216
    ds_read_b64_tr_b16 v[92:93], v8 offset:12288
    ds_read_b64_tr_b16 v[94:95], v8 offset:13312
    s_cmp_lg_u32 s30, 0
    s_cbranch_scc1 L_nost_6
    ds_read_b64_tr_b16 v[96:97], v9 offset:0
    ds_read_b64_tr_b16 v[98:99], v9 offset:1024
    s_add_u32 s24, s32, 0
    s_waitcnt lgkmcnt(0)
    v_permlane32_swap_b32 v96, v98
    v_permlane32_swap_b32 v97, v99
    s_nop 1
    v_permlane16_swap_b32 v96, v97
    v_permlane16_swap_b32 v98, v99
    buffer_store_dwordx4 v[96:99], v11, s[4:7], s24 offen
L_nost_6:
    s_add_u32 m0, s56, 32768
    s_add_u32 s24, s54, 491520
    buffer_load_dwordx4 v60, s[12:15], s24 offen lds
    s_add_u32 m0, s56, 98304
    s_add_u32 s24, s55, 256
    buffer_load_dwordx4 v61, s[8:11], s24 offen lds
    s_waitcnt lgkmcnt(6)
    v_mfma_f32_16x16x32_bf16 v[56:59], v[80:83], v[116:119], 0
    s_add_u32 m0, s56, 33792
    s_add_u32 s24, s54, 506880
    buffer_load_dwordx4 v60, s[12:15], s24 offen lds
    s_add_u32 m0, s56, 99328
    s_add_u32 s24, s55, 10496
    buffer_load_dwordx4 v62, s[8:11], s24 offen lds
    s_waitcnt lgkmcnt(4)
    v_mfma_f32_16x16x32_bf16 v[56:59], v[84:87], v[116:119], v[56:59]
    s_add_u32 m0, s56, 34816
    s_add_u32 s24, s54, 522240
    buffer_load_dwordx4 v60, s[12:15], s24 offen lds
    s_add_u32 m0, s56, 100352
    s_add_u32 s24, s55, 20736
    buffer_load_dwordx4 v61, s[8:11], s24 offen lds
    s_waitcnt lgkmcnt(2)
    v_mfma_f32_16x16x32_bf16 v[56:59], v[88:91], v[116:119], v[56:59]
    s_add_u32 m0, s56, 35840
    s_add_u32 s24, s54, 537600
    buffer_load_dwordx4 v60, s[12:15], s24 offen lds
    s_add_u32 m0, s56, 101376
    s_add_u32 s24, s55, 30976
    buffer_load_dwordx4 v62, s[8:11], s24 offen lds
    s_waitcnt lgkmcnt(0)
    v_mfma_f32_16x16x32_bf16 v[56:59], v[92:95], v[116:119], v[56:59]
    s_waitcnt vmcnt(8)
    s_barrier
    ds_read_b64_tr_b16 v[80:81], v8 offset:16384
    ds_read_b64_tr_b16 v[82:83], v8 offset:17408
    ds_read_b64_tr_b16 v[84:85], v8 offset:20480
    ds_read_b64_tr_b16 v[86:87], v8 offset:21504
    ds_read_b64_tr_b16 v[88:89], v8 offset:24576
    ds_read_b64_tr_b16 v[90:91], v8 offset:25600
    ds_read_b64_tr_b16 v[92:93], v8 offset:28672
    ds_read_b64_tr_b16 v[94:95], v8 offset:29696
    s_cmp_lg_u32 s30, 1
    s_cbranch_scc1 L_nost_7
    ds_read_b64_tr_b16 v[96:97], v9 offset:16384
    ds_read_b64_tr_b16 v[98:99], v9 offset:17408
    s_add_u32 s24, s32, 16384
    s_waitcnt lgkmcnt(0)
    v_permlane32_swap_b32 v96, v98
    v_permlane32_swap_b32 v97, v99
    s_nop 1
    v_permlane16_swap_b32 v96, v97
    v_permlane16_swap_b32 v98, v99
    buffer_store_dwordx4 v[96:99], v11, s[4:7], s24 offen
L_nost_7:
    s_add_u32 m0, s56, 49152
    s_add_u32 s24, s54, 737280
    buffer_load_dwordx4 v60, s[12:15], s24 offen lds
    s_add_u32 m0, s56, 114688
    s_add_u32 s24, s55, 384
    buffer_load_dwordx4 v61, s[8:11], s24 offen lds
    s_waitcnt lgkmcnt(6)
    v_mfma_f32_16x16x32_bf16 v[56:59], v[80:83], v[116:119], v[56:59]
    s_add_u32 m0, s56, 50176
    s_add_u32 s24, s54, 752640
    buffer_load_dwordx4 v60, s[12:15], s24 offen lds
    s_add_u32 m0, s56, 115712
    s_add_u32 s24, s55, 10624
    buffer_load_dwordx4 v62, s[8:11], s24 offen lds
    s_waitcnt lgkmcnt(4)
    v_mfma_f32_16x16x32_bf16 v[56:59], v[84:87], v[116:119], v[56:59]
    s_add_u32 m0, s56, 51200
    s_add_u32 s24, s54, 768000
    buffer_load_dwordx4 v60, s[12:15], s24 offen lds
    s_add_u32 m0, s56, 116736
    s_add_u32 s24, s55, 20864
    buffer_load_dwordx4 v61, s[8:11], s24 offen lds
    s_waitcnt lgkmcnt(2)
    v_mfma_f32_16x16x32_bf16 v[56:59], v[88:91], v[116:119], v[56:59]
    s_add_u32 m0, s56, 52224
    s_add_u32 s24, s54, 783360
    buffer_load_dwordx4 v60, s[12:15], s24 offen lds
    s_add_u32 m0, s56, 117760
    s_add_u32 s24, s55, 31104
    buffer_load_dwordx4 v62, s[8:11], s24 offen lds
    s_waitcnt lgkmcnt(0)
    v_mfma_f32_16x16x32_bf16 v[56:59], v[92:95], v[116:119], v[56:59]
    s_waitcnt vmcnt(8)
    s_barrier
    ds_read_b64_tr_b16 v[80:81], v8 offset:32768
    ds_read_b64_tr_b16 v[82:83], v8 offset:33792
    ds_read_b64_tr_b16 v[84:85], v8 offset:36864
    ds_read_b64_tr_b16 v[86:87], v8 offset:37888
    ds_read_b64_tr_b16 v[88:89], v8 offset:40960
    ds_read_b64_tr_b16 v[90:91], v8 offset:41984
    ds_read_b64_tr_b16 v[92:93], v8 offset:45056
    ds_read_b64_tr_b16 v[94:95], v8 offset:46080
    s_cmp_lg_u32 s30, 2
    s_cbranch_scc1 L_nost_8
    ds_read_b64_tr_b16 v[96:97], v9 offset:32768
    ds_read_b64_tr_b16 v[98:99], v9 offset:33792
    s_add_u32 s24, s32, 32768
    s_waitcnt lgkmcnt(0)
    v_permlane32_swap_b32 v96, v98
    v_permlane32_swap_b32 v97, v99
    s_nop 1
    v_permlane16_swap_b32 v96, v97
    v_permlane16_swap_b32 v98, v99
    buffer_store_dwordx4 v[96:99], v11, s[4:7], s24 offen
L_nost_8:
    s_add_u32 m0, s56, 0
    s_add_u32 s24, s54, 983040
    buffer_load_dwordx4 v60, s[12:15], s24 offen lds
    s_add_u32 m0, s56, 65536
    s_add_u32 s24, s55, 512
    buffer_load_dwordx4 v61, s[8:11], s24 offen lds
    s_waitcnt lgkmcnt(6)
    v_mfma_f32_16x16x32_bf16 v[56:59], v[80:83], v[116:119], v[56:59]
    s_add_u32 m0, s56, 1024
    s_add_u32 s24, s54, 998400
    buffer_load_dwordx4 v60, s[12:15], s24 offen lds
    s_add_u32 m0, s56, 66560
    s_add_u32 s24, s55, 10752
    buffer_load_dwordx4 v62, s[8:11], s24 offen lds
    s_waitcnt lgkmcnt(4)
    v_mfma_f32_16x16x32_bf16 v[56:59], v[84:87], v[116:119], v[56:59]
    s_add_u32 m0, s56, 2048
    s_add_u32 s24, s54, 1013760
    buffer_load_dwordx4 v60, s[12:15], s24 offen lds
    s_add_u32 m0, s56, 67584
    s_add_u32 s24, s55, 20992
    buffer_load_dwordx4 v61, s[8:11], s24 offen lds
    s_waitcnt lgkmcnt(2)
    v_mfma_f32_16x16x32_bf16 v[56:59], v[88:91], v[116:119], v[56:59]
    s_add_u32 m0, s56, 3072
    s_add_u32 s24, s54, 1029120
    buffer_load_dwordx4 v60, s[12:15], s24 offen lds
    s_add_u32 m0, s56, 68608
    s_add_u32 s24, s55, 31232
    buffer_load_dwordx4 v62, s[8:11], s24 offen lds
    s_waitcnt lgkmcnt(0)
    v_mfma_f32_16x16x32_bf16 v[56:59], v[92:95], v[116:119], v[56:59]
    s_waitcnt vmcnt(8)
    s_barrier
    ds_read_b64_tr_b16 v[80:81], v8 offset:49152
    ds_read_b64_tr_b16 v[82:83], v8 offset:50176
    ds_read_b64_tr_b16 v[84:85], v8 offset:53248
    ds_read_b64_tr_b16 v[86:87], v8 offset:54272
    ds_read_b64_tr_b16 v[88:89], v8 offset:57344
    ds_read_b64_tr_b16 v[90:91], v8 offset:58368
    ds_read_b64_tr_b16 v[92:93], v8 offset:61440
    ds_read_b64_tr_b16 v[94:95], v8 offset:62464
    s_cmp_lg_u32 s30, 3
    s_cbranch_scc1 L_nost_9
    ds_read_b64_tr_b16 v[96:97], v9 offset:49152
    ds_read_b64_tr_b16 v[98:99], v9 offset:50176
    s_add_u32 s24, s32, 49152
    s_waitcnt lgkmcnt(0)
    v_permlane32_swap_b32 v96, v98
    v_permlane32_swap_b32 v97, v99
    s_nop 1
    v_permlane16_swap_b32 v96, v97
    v_permlane16_swap_b32 v98, v99
    buffer_store_dwordx4 v[96:99], v11, s[4:7], s24 offen
L_nost_9:
    s_add_u32 m0, s56, 16384
    s_add_u32 s24, s54, 1228800
    buffer_load_dwordx4 v60, s[12:15], s24 offen lds
    s_add_u32 m0, s56, 81920
    s_add_u32 s24, s55, 640
    buffer_load_dwordx4 v61, s[8:11], s24 offen lds
    s_waitcnt lgkmcnt(6)
    v_mfma_f32_16x16x32_bf16 v[56:59], v[80:83], v[116:119], v[56:59]
    s_add_u32 m0, s56, 17408
    s_add_u32 s24, s54, 1244160
    buffer_load_dwordx4 v60, s[12:15], s24 offen lds
    s_add_u32 m0, s56, 82944
    s_add_u32 s24, s55, 10880
    buffer_load_dwordx4 v62, s[8:11], s24 offen lds
    s_waitcnt lgkmcnt(4)
    v_mfma_f32_16x16x32_bf16 v[56:59], v[84:87], v[116:119], v[56:59]
    s_add_u32 m0, s56, 18432
    s_add_u32 s24, s54, 1259520
    buffer_load_dwordx4 v60, s[12:15], s24 offen lds
    s_add_u32 m0, s56, 83968
    s_add_u32 s24, s55, 21120
    buffer_load_dwordx4 v61, s[8:11], s24 offen lds
    s_waitcnt lgkmcnt(2)
    v_mfma_f32_16x16x32_bf16 v[56:59], v[88:91], v[116:119], v[56:59]
    s_add_u32 m0, s56, 19456
    s_add_u32 s24, s54, 1274880
    buffer_load_dwordx4 v60, s[12:15], s24 offen lds
    s_add_u32 m0, s56, 84992
    s_add_u32 s24, s55, 31360
    buffer_load_dwordx4 v62, s[8:11], s24 offen lds
    s_waitcnt lgkmcnt(0)
    v_mfma_f32_16x16x32_bf16 v[56:59], v[92:95], v[116:119], v[56:59]
    s_waitcnt vmcnt(8)
    s_barrier
    ds_read_b64_tr_b16 v[80:81], v8 offset:0
    ds_read_b64_tr_b16 v[82:83], v8 offset:1024
    ds_read_b64_tr_b16 v[84:85], v8 offset:4096
    ds_read_b64_tr_b16 v[86:87], v8 offset:5120
    ds_read_b64_tr_b16 v[88:89], v8 offset:8192
    ds_read_b64_tr_b16 v[90:91], v8 offset:9216
    ds_read_b64_tr_b16 v[92:93], v8 offset:12288
    ds_read_b64_tr_b16 v[94:95], v8 offset:13312
    s_cmp_lg_u32 s30, 0
    s_cbranch_scc1 L_nost_10
    ds_read_b64_tr_b16 v[96:97], v9 offset:0
    ds_read_b64_tr_b16 v[98:99], v9 offset:1024
    s_add_u32 s24, s32, 65536
    s_waitcnt lgkmcnt(0)
    buffer_store_dwordx4 v[96:99], v10, s[4:7], s24 offen
L_nost_10:
    s_add_u32 m0, s56, 32768
    s_add_u32 s24, s54, 1474560
    buffer_load_dwordx4 v60, s[12:15], s24 offen lds
    s_add_u32 m0, s56, 98304
    s_add_u32 s24, s55, 768
    buffer_load_dwordx4 v61, s[8:11], s24 offen lds
    s_waitcnt lgkmcnt(6)
    v_mfma_f32_16x16x32_bf16 v[56:59], v[80:83], v[116:119], v[56:59]
    s_add_u32 m0, s56, 33792
    s_add_u32 s24, s54, 1489920
    buffer_load_dwordx4 v60, s[12:15], s24 offen lds
    s_add_u32 m0, s56, 99328
    s_add_u32 s24, s55, 11008
    buffer_load_dwordx4 v62, s[8:11], s24 offen lds
    s_waitcnt lgkmcnt(4)
    v_mfma_f32_16x16x32_bf16 v[56:59], v[84:87], v[116:119], v[56:59]
    s_add_u32 m0, s56, 34816
    s_add_u32 s24, s54, 1505280
    buffer_load_dwordx4 v60, s[12:15], s24 offen lds
    s_add_u32 m0, s56, 100352
    s_add_u32 s24, s55, 21248
    buffer_load_dwordx4 v61, s[8:11], s24 offen lds
    s_waitcnt lgkmcnt(2)
    v_mfma_f32_16x16x32_bf16 v[56:59], v[88:91], v[116:119], v[56:59]
    s_add_u32 m0, s56, 35840
    s_add_u32 s24, s54, 1520640
    buffer_load_dwordx4 v60, s[12:15], s24 offen lds
    s_add_u32 m0, s56, 101376
    s_add_u32 s24, s55, 31488
    buffer_load_dwordx4 v62, s[8:11], s24 offen lds
    s_waitcnt lgkmcnt(0)
    v_mfma_f32_16x16x32_bf16 v[56:59], v[92:95], v[116:119], v[56:59]
    s_waitcnt vmcnt(8)
    s_barrier
    ds_read_b64_tr_b16 v[80:81], v8 offset:16384
    ds_read_b64_tr_b16 v[82:83], v8 offset:17408
    ds_read_b64_tr_b16 v[84:85], v8 offset:20480
    ds_read_b64_tr_b16 v[86:87], v8 offset:21504
    ds_read_b64_tr_b16 v[88:89], v8 offset:24576
    ds_read_b64_tr_b16 v[90:91], v8 offset:25600
    ds_read_b64_tr_b16 v[92:93], v8 offset:28672
    ds_read_b64_tr_b16 v[94:95], v8 offset:29696
    s_cmp_lg_u32 s30, 1
    s_cbranch_scc1 L_nost_11
    ds_read_b64_tr_b16 v[96:97], v9 offset:16384
    ds_read_b64_tr_b16 v[98:99], v9 offset:17408
    s_add_u32 s24, s32, 81920
    s_waitcnt lgkmcnt(0)
    buffer_store_dwordx4 v[96:99], v10, s[4:7], s24 offen
L_nost_11:
    s_add_u32 m0, s56, 49152
    s_add_u32 s24, s54, 1720320
    buffer_load_dwordx4 v60, s[12:15], s24 offen lds
    s_add_u32 m0, s56, 114688
    s_add_u32 s24, s55, 896
    buffer_load_dwordx4 v61, s[8:11], s24 offen lds
    s_waitcnt lgkmcnt(6)
    v_mfma_f32_16x16x32_bf16 v[56:59], v[80:83], v[116:119], v[56:59]
    s_add_u32 m0, s56, 50176
    s_add_u32 s24, s54, 1735680
    buffer_load_dwordx4 v60, s[12:15], s24 offen lds
    s_add_u32 m0, s56, 115712
    s_add_u32 s24, s55, 11136
    buffer_load_dwordx4 v62, s[8:11], s24 offen lds
    s_waitcnt lgkmcnt(4)
    v_mfma_f32_16x16x32_bf16 v[56:59], v[84:87], v[116:119], v[56:59]
    s_add_u32 m0, s56, 51200
    s_add_u32 s24, s54, 1751040
    buffer_load_dwordx4 v60, s[12:15], s24 offen lds
    s_add_u32 m0, s56, 116736
    s_add_u32 s24, s55, 21376
    buffer_load_dwordx4 v61, s[8:11], s24 offen lds
    s_waitcnt lgkmcnt(2)
    v_mfma_f32_16x16x32_bf16 v[56:59], v[88:91], v[116:119], v[56:59]
    s_add_u32 m0, s56, 52224
    s_add_u32 s24, s54, 1766400
    buffer_load_dwordx4 v60, s[12:15], s24 offen lds
    s_add_u32 m0, s56, 117760
    s_add_u32 s24, s55, 31616
    buffer_load_dwordx4 v62, s[8:11], s24 offen lds
    s_waitcnt lgkmcnt(0)
    v_mfma_f32_16x16x32_bf16 v[56:59], v[92:95], v[116:119], v[56:59]
    s_waitcnt vmcnt(8)
    s_barrier
    ds_read_b64_tr_b16 v[80:81], v8 offset:32768
    ds_read_b64_tr_b16 v[82:83], v8 offset:33792
    ds_read_b64_tr_b16 v[84:85], v8 offset:36864
    ds_read_b64_tr_b16 v[86:87], v8 offset:37888
    ds_read_b64_tr_b16 v[88:89], v8 offset:40960
    ds_read_b64_tr_b16 v[90:91], v8 offset:41984
    ds_read_b64_tr_b16 v[92:93], v8 offset:45056
    ds_read_b64_tr_b16 v[94:95], v8 offset:46080
    s_cmp_lg_u32 s30, 2
    s_cbranch_scc1 L_nost_12
    ds_read_b64_tr_b16 v[96:97], v9 offset:32768
    ds_read_b64_tr_b16 v[98:99], v9 offset:33792
    s_add_u32 s24, s32, 98304
    s_waitcnt lgkmcnt(0)
    buffer_store_dwordx4 v[96:99], v10, s[4:7], s24 offen
L_nost_12:
    s_add_u32 m0, s56, 0
    s_add_u32 s24, s54, 1966080
    buffer_load_dwordx4 v60, s[12:15], s24 offen lds
    s_add_u32 m0, s56, 65536
    s_add_u32 s24, s55, 1024
    buffer_load_dwordx4 v61, s[8:11], s24 offen lds
    s_waitcnt lgkmcnt(6)
    v_mfma_f32_16x16x32_bf16 v[56:59], v[80:83], v[116:119], v[56:59]
    s_add_u32 m0, s56, 1024
    s_add_u32 s24, s54, 1981440
    buffer_load_dwordx4 v60, s[12:15], s24 offen lds
    s_add_u32 m0, s56, 66560
    s_add_u32 s24, s55, 11264
    buffer_load_dwordx4 v62, s[8:11], s24 offen lds
    s_waitcnt lgkmcnt(4)
    v_mfma_f32_16x16x32_bf16 v[56:59], v[84:87], v[116:119], v[56:59]
    s_add_u32 m0, s56, 2048
    s_add_u32 s24, s54, 1996800
    buffer_load_dwordx4 v60, s[12:15], s24 offen lds
    s_add_u32 m0, s56, 67584
    s_add_u32 s24, s55, 21504
    buffer_load_dwordx4 v61, s[8:11], s24 offen lds
    s_waitcnt lgkmcnt(2)
    v_mfma_f32_16x16x32_bf16 v[56:59], v[88:91], v[116:119], v[56:59]
    s_add_u32 m0, s56, 3072
    s_add_u32 s24, s54, 2012160
    buffer_load_dwordx4 v60, s[12:15], s24 offen lds
    s_add_u32 m0, s56, 68608
    s_add_u32 s24, s55, 31744
    buffer_load_dwordx4 v62, s[8:11], s24 offen lds
    s_waitcnt lgkmcnt(0)
    v_mfma_f32_16x16x32_bf16 v[56:59], v[92:95], v[116:119], v[56:59]
    s_waitcnt vmcnt(8)
    s_barrier
    ds_read_b64_tr_b16 v[80:81], v8 offset:49152
    ds_read_b64_tr_b16 v[82:83], v8 offset:50176
    ds_read_b64_tr_b16 v[84:85], v8 offset:53248
    ds_read_b64_tr_b16 v[86:87], v8 offset:54272
    ds_read_b64_tr_b16 v[88:89], v8 offset:57344
    ds_read_b64_tr_b16 v[90:91], v8 offset:58368
    ds_read_b64_tr_b16 v[92:93], v8 offset:61440
    ds_read_b64_tr_b16 v[94:95], v8 offset:62464
    s_cmp_lg_u32 s30, 3
    s_cbranch_scc1 L_nost_13
    ds_read_b64_tr_b16 v[96:97], v9 offset:49152
    ds_read_b64_tr_b16 v[98:99], v9 offset:50176
    s_add_u32 s24, s32, 114688
    s_waitcnt lgkmcnt(0)
    buffer_store_dwordx4 v[96:99], v10, s[4:7], s24 offen
L_nost_13:
    s_add_u32 m0, s56, 16384
    s_add_u32 s24, s54, 2211840
    buffer_load_dwordx4 v60, s[12:15], s24 offen lds
    s_add_u32 m0, s56, 81920
    s_add_u32 s24, s55, 1152
    buffer_load_dwordx4 v61, s[8:11], s24 offen lds
    s_waitcnt lgkmcnt(6)
    v_mfma_f32_16x16x32_bf16 v[56:59], v[80:83], v[116:119], v[56:59]
    s_add_u32 m0, s56, 17408
    s_add_u32 s24, s54, 2227200
    buffer_load_dwordx4 v60, s[12:15], s24 offen lds
    s_add_u32 m0, s56, 82944
    s_add_u32 s24, s55, 11392
    buffer_load_dwordx4 v62, s[8:11], s24 offen lds
    s_waitcnt lgkmcnt(4)
    v_mfma_f32_16x16x32_bf16 v[56:59], v[84:87], v[116:119], v[56:59]
    s_add_u32 m0, s56, 18432
    s_add_u32 s24, s54, 2242560
    buffer_load_dwordx4 v60, s[12:15], s24 offen lds
    s_add_u32 m0, s56, 83968
    s_add_u32 s24, s55, 21632
    buffer_load_dwordx4 v61, s[8:11], s24 offen lds
    s_waitcnt lgkmcnt(2)
    v_mfma_f32_16x16x32_bf16 v[56:59], v[88:91], v[116:119], v[56:59]
    s_add_u32 m0, s56, 19456
    s_add_u32 s24, s54, 2257920
    buffer_load_dwordx4 v60, s[12:15], s24 offen lds
    s_add_u32 m0, s56, 84992
    s_add_u32 s24, s55, 31872
    buffer_load_dwordx4 v62, s[8:11], s24 offen lds
    s_waitcnt lgkmcnt(0)
    v_mfma_f32_16x16x32_bf16 v[56:59], v[92:95], v[116:119], v[56:59]
    s_waitcnt vmcnt(8)
    s_barrier
    ds_read_b64_tr_b16 v[80:81], v8 offset:0
    ds_read_b64_tr_b16 v[82:83], v8 offset:1024
    ds_read_b64_tr_b16 v[84:85], v8 offset:4096
    ds_read_b64_tr_b16 v[86:87], v8 offset:5120
    ds_read_b64_tr_b16 v[88:89], v8 offset:8192
    ds_read_b64_tr_b16 v[90:91], v8 offset:9216
    ds_read_b64_tr_b16 v[92:93], v8 offset:12288
    ds_read_b64_tr_b16 v[94:95], v8 offset:13312
    s_cmp_lg_u32 s30, 0
    s_cbranch_scc1 L_nost_14
    ds_read_b64_tr_b16 v[96:97], v9 offset:0
    ds_read_b64_tr_b16 v[98:99], v9 offset:1024
    s_add_u32 s24, s32, 131072
    s_waitcnt lgkmcnt(0)
    buffer_store_dwordx4 v[96:99], v10, s[4:7], s24 offen
L_nost_14:
    s_waitcnt lgkmcnt(6)
    v_mfma_f32_16x16x32_bf16 v[56:59], v[80:83], v[116:119], v[56:59]
    s_waitcnt lgkmcnt(4)
    v_mfma_f32_16x16x32_bf16 v[56:59], v[84:87], v[116:119], v[56:59]
    s_waitcnt lgkmcnt(2)
    v_mfma_f32_16x16x32_bf16 v[56:59], v[88:91], v[116:119], v[56:59]
    s_waitcnt lgkmcnt(0)
    v_mfma_f32_16x16x32_bf16 v[56:59], v[92:95], v[116:119], v[56:59]
    s_cmp_ge_u32 s34, 544
    s_cbranch_scc1 L_pw1_15
    s_lshr_b32 s25, s34, 3
    s_cmp_ge_u32 s34, 160
    s_cbranch_scc1 L_pw2_16
    s_mov_b64 s[40:41], s[16:17]
    s_mov_b32 s42, 819200
    s_cmp_ge_u32 s34, 128
    s_cbranch_scc1 L_phi_17
    s_mul_i32 s25, s25, 40
    s_mov_b32 s44, 4
    s_mov_b32 s45, 0
    s_mov_b32 s46, 0
    s_branch L_pgo_18
L_phi_17:
    s_mul_i32 s25, s25, 160
    s_sub_u32 s25, s25, 2544
    s_mov_b32 s44, 64
    s_mov_b32 s45, 36
    s_mov_b32 s46, 12
    s_branch L_pgo_18
L_pw2_16:
    s_sub_u32 s25, s25, 20
    s_lshl_b32 s25, s25, 5
    s_mov_b32 s44, 0
    s_mov_b32 s45, 0
    s_mov_b32 s46, 0
L_pgo_18:
    s_mul_i32 s25, s25, 1280
    s_and_b32 s26, s34, 7
    s_mul_i32 s26, s26, 160
    s_add_u32 s25, s25, s26
    v_add_u32 v20, 0, v0
    v_mul_u32_u24 v21, 205, v20
    v_lshrrev_b32 v21, 11, v21
    v_mul_u32_u24 v22, 10, v21
    v_sub_u32 v20, v20, v22
    v_lshrrev_b32 v22, 4, v21
    v_mad_u32_u24 v23, v22, s44, v21
    v_bfe_u32 v22, v21, 2, 1
    v_mad_u32_u24 v23, v22, s45, v23
    v_bfe_u32 v22, v21, 3, 1
    v_mad_u32_u24 v23, v22, s46, v23
    v_mul_u32_u24 v23, 1280, v23
    s_add_u32 m0, s35, 0
    v_lshl_add_u32 v20, v20, 4, v23
    buffer_load_dwordx4 v20, s[40:43], s25 offen lds
    v_add_u32 v20, 64, v0
    v_mul_u32_u24 v21, 205, v20
    v_lshrrev_b32 v21, 11, v21
    v_mul_u32_u24 v22, 10, v21
    v_sub_u32 v20, v20, v22
    v_lshrrev_b32 v22, 4, v21
    v_mad_u32_u24 v23, v22, s44, v21
    v_bfe_u32 v22, v21, 2, 1
    v_mad_u32_u24 v23, v22, s45, v23
    v_bfe_u32 v22, v21, 3, 1
    v_mad_u32_u24 v23, v22, s46, v23
    v_mul_u32_u24 v23, 1280, v23
    s_add_u32 m0, s35, 1024
    v_lshl_add_u32 v20, v20, 4, v23
    buffer_load_dwordx4 v20, s[40:43], s25 offen lds
    v_add_u32 v20, 128, v0
    v_mul_u32_u24 v21, 205, v20
    v_lshrrev_b32 v21, 11, v21
    v_mul_u32_u24 v22, 10, v21
    v_sub_u32 v20, v20, v22
    v_lshrrev_b32 v22, 4, v21
    v_mad_u32_u24 v23, v22, s44, v21
    v_bfe_u32 v22, v21, 2, 1
    v_mad_u32_u24 v23, v22, s45, v23
    v_bfe_u32 v22, v21, 3, 1
    v_mad_u32_u24 v23, v22, s46, v23
    v_mul_u32_u24 v23, 1280, v23
    s_add_u32 m0, s35, 2048
    v_lshl_add_u32 v20, v20, 4, v23
    buffer_load_dwordx4 v20, s[40:43], s25 offen lds
    v_add_u32 v20, 192, v0
    v_mul_u32_u24 v21, 205, v20
    v_lshrrev_b32 v21, 11, v21
    v_mul_u32_u24 v22, 10, v21
    v_sub_u32 v20, v20, v22
    v_lshrrev_b32 v22, 4, v21
    v_mad_u32_u24 v23, v22, s44, v21
    v_bfe_u32 v22, v21, 2, 1
    v_mad_u32_u24 v23, v22, s45, v23
    v_bfe_u32 v22, v21, 3, 1
    v_mad_u32_u24 v23, v22, s46, v23
    v_mul_u32_u24 v23, 1280, v23
    s_add_u32 m0, s35, 3072
    v_lshl_add_u32 v20, v20, 4, v23
    buffer_load_dwordx4 v20, s[40:43], s25 offen lds
    v_add_u32 v20, 256, v0
    v_mul_u32_u24 v21, 205, v20
    v_lshrrev_b32 v21, 11, v21
    v_mul_u32_u24 v22, 10, v21
    v_sub_u32 v20, v20, v22
    v_lshrrev_b32 v22, 4, v21
    v_mad_u32_u24 v23, v22, s44, v21
    v_bfe_u32 v22, v21, 2, 1
    v_mad_u32_u24 v23, v22, s45, v23
    v_bfe_u32 v22, v21, 3, 1
    v_mad_u32_u24 v23, v22, s46, v23
    v_mul_u32_u24 v23, 1280, v23
    s_add_u32 m0, s35, 4096
    v_lshl_add_u32 v20, v20, 4, v23
    buffer_load_dwordx4 v20, s[40:43], s25 offen lds
    s_branch L_pdn_19
L_pw1_15:
    s_sub_u32 s23, s34, 544
    s_mov_b32 s24, 178956971
    s_mul_hi_u32 s25, s23, s24
    s_mul_i32 s26, s25, 24
    s_sub_u32 s26, s23, s26
    s_mul_i32 s25, s25, 98304
    s_lshl_b32 s26, s26, 7
    s_add_u32 s25, s25, s26
    v_lshrrev_b32 v20, 3, v0
    v_and_b32 v21, 7, v0
    v_mul_u32_u24 v20, 3072, v20
    v_lshl_add_u32 v20, v21, 4, v20
    s_add_u32 m0, s35, 0
    s_add_u32 s24, s25, 0
    buffer_load_dwordx4 v20, s[36:39], s24 offen lds
    s_add_u32 m0, s35, 1024
    s_add_u32 s24, s25, 24576
    buffer_load_dwordx4 v20, s[36:39], s24 offen lds
    s_add_u32 m0, s35, 2048
    s_add_u32 s24, s25, 49152
    buffer_load_dwordx4 v20, s[36:39], s24 offen lds
    s_add_u32 m0, s35, 3072
    s_add_u32 s24, s25, 73728
    buffer_load_dwordx4 v20, s[36:39], s24 offen lds
    buffer_load_dword v21, v20, s[36:39], s24 offen
L_pdn_19:
    s_waitcnt vmcnt(5)
    s_barrier
    ds_read_b64_tr_b16 v[80:81], v8 offset:16384
    ds_read_b64_tr_b16 v[82:83], v8 offset:17408
    ds_read_b64_tr_b16 v[84:85], v8 offset:20480
    ds_read_b64_tr_b16 v[86:87], v8 offset:21504
    ds_read_b64_tr_b16 v[88:89], v8 offset:24576
    ds_read_b64_tr_b16 v[90:91], v8 offset:25600
    ds_read_b64_tr_b16 v[92:93], v8 offset:28672
    ds_read_b64_tr_b16 v[94:95], v8 offset:29696
    s_cmp_lg_u32 s30, 1
    s_cbranch_scc1 L_nost_20
    ds_read_b64_tr_b16 v[96:97], v9 offset:16384
    ds_read_b64_tr_b16 v[98:99], v9 offset:17408
    s_add_u32 s24, s32, 147456
    s_waitcnt lgkmcnt(0)
    buffer_store_dwordx4 v[96:99], v10, s[4:7], s24 offen
L_nost_20:
    s_waitcnt lgkmcnt(6)
    v_mfma_f32_16x16x32_bf16 v[56:59], v[80:83], v[116:119], v[56:59]
    s_waitcnt lgkmcnt(4)
    v_mfma_f32_16x16x32_bf16 v[56:59], v[84:87], v[116:119], v[56:59]
    s_waitcnt lgkmcnt(2)
    v_mfma_f32_16x16x32_bf16 v[56:59], v[88:91], v[116:119], v[56:59]
    s_waitcnt lgkmcnt(0)
    v_mfma_f32_16x16x32_bf16 v[56:59], v[92:95], v[116:119], v[56:59]
    v_lshlrev_b32 v3, 6, v5
    v_lshl_add_u32 v3, v6, 4, v3
    s_lshl_b32 s23, s29, 7
    s_add_u32 s22, s23, 151552
    v_add_u32 v4, s22, v3
    s_lshl_b32 s22, s27, 9
    s_add_u32 s22, s22, s23
    s_add_u32 s22, s22, 7372800
    s_mov_b32 exec_lo, 0x00030003
    s_mov_b32 exec_hi, 0x00030003
    ds_write_b128 v4, v[56:59]
    s_cmp_lg_u32 s53, 0
    s_cbranch_scc1 L_nocs_21
    buffer_store_dwordx4 v[56:59], v3, s[4:7], s22 offen
L_nocs_21:
    s_mov_b64 exec, -1
    s_waitcnt lgkmcnt(0)
    s_barrier
    s_waitcnt vmcnt(0)
    v_lshrrev_b32 v21, 4, v0
    v_bfe_u32 v22, v0, 2, 2
    v_and_b32 v23, 3, v0
    v_lshrrev_b32 v24, 1, v21
    v_and_b32 v25, 1, v21
    s_cmp_ge_u32 s34, 544
    s_cbranch_scc1 L_fw1_22
    v_lshlrev_b32 v24, 4, v24
    v_lshl_add_u32 v24, v25, 2, v24
    v_add_u32 v24, v24, v22
    v_mul_u32_u24 v24, 160, v24
    v_lshl_add_u32 v24, v23, 3, v24
    v_add_u32 v24, s35, v24
    ds_read_b64_tr_b16 v[28:29], v24 offset:0
    ds_read_b64_tr_b16 v[30:31], v24 offset:1280
    ds_read_b64_tr_b16 v[32:33], v24 offset:32
    ds_read_b64_tr_b16 v[34:35], v24 offset:1312
    ds_read_b64_tr_b16 v[36:37], v24 offset:64
    ds_read_b64_tr_b16 v[38:39], v24 offset:1344
    ds_read_b64_tr_b16 v[40:41], v24 offset:96
    ds_read_b64_tr_b16 v[42:43], v24 offset:1376
    ds_read_b64_tr_b16 v[44:45], v24 offset:128
    ds_read_b64_tr_b16 v[46:47], v24 offset:1408
    s_lshr_b32 s25, s34, 3
    s_and_b32 s26, s34, 7
    s_cmp_lt_u32 s34, 160
    s_cbranch_scc1 L_fwo_24
    s_mul_i32 s26, s26, 48
    s_add_u32 s25, s25, s26
    s_mul_i32 s25, s25, 5120
    s_add_u32 s25, s25, 2682880
    s_add_u32 s26, s25, 4096
    s_waitcnt lgkmcnt(8)
    v_permlane32_swap_b32 v28, v30
    v_permlane32_swap_b32 v29, v31
    s_nop 1
    v_permlane16_swap_b32 v28, v29
    v_permlane16_swap_b32 v30, v31
    buffer_store_dwordx4 v[28:31], v11, s[4:7], s25 offen offset:0
    s_waitcnt lgkmcnt(6)
    v_permlane32_swap_b32 v32, v34
    v_permlane32_swap_b32 v33, v35
    s_nop 1
    v_permlane16_swap_b32 v32, v33
    v_permlane16_swap_b32 v34, v35
    buffer_store_dwordx4 v[32:35], v11, s[4:7], s25 offen offset:1024
    s_waitcnt lgkmcnt(4)
    v_permlane32_swap_b32 v36, v38
    v_permlane32_swap_b32 v37, v39
    s_nop 1
    v_permlane16_swap_b32 v36, v37
    v_permlane16_swap_b32 v38, v39
    buffer_store_dwordx4 v[36:39], v11, s[4:7], s25 offen offset:2048
    s_waitcnt lgkmcnt(2)
    v_permlane32_swap_b32 v40, v42
    v_permlane32_swap_b32 v41, v43
    s_nop 1
    v_permlane16_swap_b32 v40, v41
    v_permlane16_swap_b32 v42, v43
    buffer_store_dwordx4 v[40:43], v11, s[4:7], s25 offen offset:3072
    s_waitcnt lgkmcnt(0)
    v_permlane32_swap_b32 v44, v46
    v_permlane32_swap_b32 v45, v47
    s_nop 1
    v_permlane16_swap_b32 v44, v45
    v_permlane16_swap_b32 v46, v47
    buffer_store_dwordx4 v[44:47], v11, s[4:7], s26 offen offset:0
    s_branch L_fdn_23
L_fwo_24:
    s_mul_i32 s26, s26, 20
    s_add_u32 s25, s25, s26
    s_mul_i32 s25, s25, 5120
    s_add_u32 s25, s25, 0
    s_add_u32 s26, s25, 4096
    s_waitcnt lgkmcnt(8)
    buffer_store_dwordx4 v[28:31], v10, s[4:7], s25 offen offset:0
    s_waitcnt lgkmcnt(6)
    buffer_store_dwordx4 v[32:35], v10, s[4:7], s25 offen offset:1024
    s_waitcnt lgkmcnt(4)
    buffer_store_dwordx4 v[36:39], v10, s[4:7], s25 offen offset:2048
    s_waitcnt lgkmcnt(2)
    buffer_store_dwordx4 v[40:43], v10, s[4:7], s25 offen offset:3072
    s_waitcnt lgkmcnt(0)
    buffer_store_dwordx4 v[44:47], v10, s[4:7], s26 offen offset:0
    s_branch L_fdn_23
L_fw1_22:
    v_lshl_add_u32 v24, v24, 3, v22
    v_lshlrev_b32 v24, 7, v24
    v_lshl_add_u32 v24, v23, 3, v24
    v_lshl_add_u32 v24, v25, 5, v24
    v_add_u32 v24, s35, v24
    ds_read_b64_tr_b16 v[28:29], v24 offset:0
    ds_read_b64_tr_b16 v[30:31], v24 offset:512
    ds_read_b64_tr_b16 v[32:33], v24 offset:2048
    ds_read_b64_tr_b16 v[34:35], v24 offset:2560
    ds_read_b64_tr_b16 v[36:37], v24 offset:64
    ds_read_b64_tr_b16 v[38:39], v24 offset:576
    ds_read_b64_tr_b16 v[40:41], v24 offset:2112
    ds_read_b64_tr_b16 v[42:43], v24 offset:2624
    s_sub_u32 s23, s34, 544
    s_mov_b32 s24, 178956971
    s_mul_hi_u32 s25, s23, s24
    s_mul_i32 s26, s25, 24
    s_sub_u32 s26, s23, s26
    s_lshl_b32 s23, s26, 1
    s_add_u32 s23, s23, 0
    s_lshl_b32 s28, s25, 1
    s_add_u32 s28, s28, 0
    s_mov_b32 s24, 1431655766
    s_mul_hi_u32 s24, s23, s24
    s_mul_i32 s22, s24, 3
    s_sub_u32 s23, s23, s22
    s_mul_i32 s24, s24, 40
    s_add_u32 s24, s24, s28
    s_mul_i32 s24, s24, 3
    s_add_u32 s24, s24, s23
    s_lshl_b32 s24, s24, 10
    s_add_u32 s24, s24, 819200
    s_waitcnt lgkmcnt(6)
    v_mfma_f32_16x16x32_bf16 v[48:51], v[28:31], v[116:119], 0
    v_permlane32_swap_b32 v28, v30
    v_permlane32_swap_b32 v29, v31
    s_nop 1
    v_permlane16_swap_b32 v28, v29
    v_permlane16_swap_b32 v30, v31
    buffer_store_dwordx4 v[28:31], v11, s[4:7], s24 offen
    s_lshl_b32 s23, s26, 1
    s_add_u32 s23, s23, 0
    s_lshl_b32 s28, s25, 1
    s_add_u32 s28, s28, 1
    s_mov_b32 s24, 1431655766
    s_mul_hi_u32 s24, s23, s24
    s_mul_i32 s22, s24, 3
    s_sub_u32 s23, s23, s22
    s_mul_i32 s24, s24, 40
    s_add_u32 s24, s24, s28
    s_mul_i32 s24, s24, 3
    s_add_u32 s24, s24, s23
    s_lshl_b32 s24, s24, 10
    s_add_u32 s24, s24, 819200
    s_waitcnt lgkmcnt(4)
    v_mfma_f32_16x16x32_bf16 v[48:51], v[32:35], v[116:119], v[48:51]
    v_permlane32_swap_b32 v32, v34
    v_permlane32_swap_b32 v33, v35
    s_nop 1
    v_permlane16_swap_b32 v32, v33
    v_permlane16_swap_b32 v34, v35
    buffer_store_dwordx4 v[32:35], v11, s[4:7], s24 offen
    s_lshl_b32 s23, s26, 1
    s_add_u32 s23, s23, 1
    s_lshl_b32 s28, s25, 1
    s_add_u32 s28, s28, 0
    s_mov_b32 s24, 1431655766
    s_mul_hi_u32 s24, s23, s24
    s_mul_i32 s22, s24, 3
    s_sub_u32 s23, s23, s22
    s_mul_i32 s24, s24, 40
    s_add_u32 s24, s24, s28
    s_mul_i32 s24, s24, 3
    s_add_u32 s24, s24, s23
    s_lshl_b32 s24, s24, 10
    s_add_u32 s24, s24, 819200
    s_waitcnt lgkmcnt(2)
    v_mfma_f32_16x16x32_bf16 v[52:55], v[36:39], v[116:119], 0
    v_permlane32_swap_b32 v36, v38
    v_permlane32_swap_b32 v37, v39
    s_nop 1
    v_permlane16_swap_b32 v36, v37
    v_permlane16_swap_b32 v38, v39
    buffer_store_dwordx4 v[36:39], v11, s[4:7], s24 offen
    s_lshl_b32 s23, s26, 1
    s_add_u32 s23, s23, 1
    s_lshl_b32 s28, s25, 1
    s_add_u32 s28, s28, 1
    s_mov_b32 s24, 1431655766
    s_mul_hi_u32 s24, s23, s24
    s_mul_i32 s22, s24, 3
    s_sub_u32 s23, s23, s22
    s_mul_i32 s24, s24, 40
    s_add_u32 s24, s24, s28
    s_mul_i32 s24, s24, 3
    s_add_u32 s24, s24, s23
    s_lshl_b32 s24, s24, 10
    s_add_u32 s24, s24, 819200
    s_waitcnt lgkmcnt(0)
    v_mfma_f32_16x16x32_bf16 v[52:55], v[40:43], v[116:119], v[52:55]
    v_permlane32_swap_b32 v40, v42
    v_permlane32_swap_b32 v41, v43
    s_nop 1
    v_permlane16_swap_b32 v40, v41
    v_permlane16_swap_b32 v42, v43
    buffer_store_dwordx4 v[40:43], v11, s[4:7], s24 offen
    s_mul_i32 s25, s25, 6144
    s_lshl_b32 s26, s26, 8
    s_add_u32 s25, s25, s26
    s_add_u32 s25, s25, 7380992
    s_mov_b32 exec_lo, 0x00030003
    s_mov_b32 exec_hi, 0x00030003
    buffer_store_dwordx4 v[48:51], v3, s[4:7], s25 offen
    buffer_store_dwordx4 v[52:55], v3, s[4:7], s25 offen offset:128
    s_mov_b64 exec, -1
L_fdn_23:
    s_branch L_fin_3
L_comp_4:
    s_waitcnt lgkmcnt(0)
    v_mov_b32 v4, 0
    s_lshl_b32 s22, s2, 2
    s_add_u32 s22, s22, s29
    s_lshl_b32 s22, s22, 6
    s_add_u32 s22, s22, 7503872
    buffer_store_byte v4, v0, s[4:7], s22 offen
    s_lshl_b32 s29, s53, 2
    s_add_u32 s29, s29, s20
    v_lshlrev_b32 v2, 4, v0
    v_and_b32 v5, 31, v0
    v_lshrrev_b32 v6, 5, v0
    s_lshr_b32 s33, s20, 1
    s_mul_i32 s32, s53, 491520
    s_add_u32 s32, s32, 10321920
    s_and_b32 s34, s29, 1
    s_cmp_ge_u32 s27, 11
    s_cbranch_scc1 L_vpath_25
    v_bfe_u32 v24, v0, 2, 2
    v_lshrrev_b32 v25, 5, v0
    v_lshl_add_u32 v25, v25, 3, v24
    v_lshlrev_b32 v25, 8, v25
    v_lshlrev_b32 v24, 6, v24
    v_bfe_u32 v26, v0, 4, 1
    v_and_b32 v27, 3, v0
    v_mul_u32_u24 v28, 40, v26
    v_add_u32 v28, 0, v28
    v_mul_u32_u24 v48, 8, v27
    v_add_u32 v28, v28, v48
    v_and_b32 v28, 0xff, v28
    v_xor_b32 v28, v28, v24
    v_add_u32 v48, v28, v25
    v_mul_u32_u24 v28, 40, v26
    v_add_u32 v28, 80, v28
    v_mul_u32_u24 v50, 8, v27
    v_add_u32 v28, v28, v50
    v_and_b32 v28, 0xff, v28
    v_xor_b32 v28, v28, v24
    v_add_u32 v50, v28, v25
    v_mul_u32_u24 v28, 40, v26
    v_add_u32 v28, 160, v28
    v_mul_u32_u24 v52, 8, v27
    v_add_u32 v28, v28, v52
    v_and_b32 v28, 0xff, v28
    v_xor_b32 v28, v28, v24
    v_add_u32 v52, v28, v25
    v_mul_u32_u24 v28, 160, v26
    v_add_u32 v28, 32, v28
    v_mul_u32_u24 v54, 40, v27
    v_add_u32 v28, v28, v54
    v_and_b32 v28, 0xff, v28
    v_xor_b32 v28, v28, v24
    v_add_u32 v54, v28, v25
    v_and_b32 v24, 31, v0
    v_bfe_u32 v25, v0, 1, 3
    v_lshrrev_b32 v26, 5, v0
    v_xor_b32 v25, v25, v26
    v_lshlrev_b32 v24, 7, v24
    s_lshl_b32 s22, s20, 12
    s_add_u32 s22, s22, 65536
    v_add_u32 v24, s22, v24
    v_xor_b32 v26, 0, v25
    v_lshl_add_u32 v56, v26, 4, v24
    v_xor_b32 v26, 2, v25
    v_lshl_add_u32 v57, v26, 4, v24
    v_xor_b32 v26, 4, v25
    v_lshl_add_u32 v58, v26, 4, v24
    v_xor_b32 v26, 6, v25
    v_lshl_add_u32 v59, v26, 4, v24
    v_and_b32 v24, 15, v0
    v_lshrrev_b32 v25, 4, v0
    v_bfe_u32 v60, v0, 1, 3
    v_xor_b32 v60, v60, v25
    v_xor_b32 v61, 4, v60
    v_lshlrev_b32 v24, 7, v24
    v_add_u32 v24, s22, v24
    v_lshl_add_u32 v60, v60, 4, v24
    v_lshl_add_u32 v61, v61, 4, v24
    v_mov_b32 v192, 0x3f803f80
    v_mov_b32 v193, 0x3f803f80
    v_mov_b32 v194, 0x3f803f80
    v_mov_b32 v195, 0x3f803f80
    v_mov_b32 v10, 0
    v_mov_b32 v11, 0
    v_mov_b32 v12, 0
    v_mov_b32 v13, 0
    v_mov_b32 v14, 0
    v_mov_b32 v15, 0
    v_lshlrev_b32 v16, 4, v6
    v_add_u32 v16, 151552, v16
    v_and_b32 v17, 0x13, v5
    v_bfe_u32 v18, v5, 2, 1
    v_lshl_add_u32 v17, v18, 3, v17
    v_bfe_u32 v18, v5, 3, 1
    v_lshl_add_u32 v17, v18, 2, v17
    v_lshlrev_b32 v32, 4, v17
    v_lshl_add_u32 v32, v6, 9, v32
    v_lshlrev_b32 v17, 3, v17
    s_mul_i32 s22, s33, 5120
    s_add_u32 s22, s22, s32
    s_sub_u32 s22, s22, 327680
    s_lshl_b32 s23, s34, 10
    s_add_u32 s35, s22, s23
    s_lshl_b32 s23, s34, 8
    s_add_u32 s36, s22, s23
    s_add_u32 s36, s36, 2048
    s_mul_i32 s37, s20, 1280
    s_add_u32 s37, s37, s32
    s_add_u32 s37, s37, 327680
    s_add_u32 s38, s37, 1024
    s_mul_i32 s22, s27, 6
    s_add_u32 s22, s22, 0
    s_movk_i32 s23, 5120
    s_cmp_ge_u32 s22, 32
    s_cselect_b32 s23, 10240, s23
    s_cselect_b32 s39, s35, s37
    s_cselect_b32 s41, s36, s38
    s_cselect_b32 s33, 1.0, 0x3ea52b5c
    s_mul_i32 s24, s22, s23
    s_cmp_ge_u32 s22, 64
    s_cselect_b32 s24, 0x80000000, s24
    s_add_u32 s39, s39, s24
    s_add_u32 s40, s39, s23
    s_add_u32 s41, s41, s24
    v_mad_u32_u24 v33, v6, s23, v17
    s_mul_i32 s22, s27, 6
    s_add_u32 s22, s22, 2
    s_movk_i32 s23, 5120
    s_cmp_ge_u32 s22, 32
    s_cselect_b32 s23, 10240, s23
    s_cselect_b32 s42, s35, s37
    s_cselect_b32 s44, s36, s38
    s_cselect_b32 s34, 1.0, 0x3ea52b5c
    s_mul_i32 s24, s22, s23
    s_cmp_ge_u32 s22, 64
    s_cselect_b32 s24, 0x80000000, s24
    s_add_u32 s42, s42, s24
    s_add_u32 s43, s42, s23
    s_add_u32 s44, s44, s24
    v_mad_u32_u24 v34, v6, s23, v17
    s_mul_i32 s22, s27, 6
    s_add_u32 s22, s22, 4
    s_movk_i32 s23, 5120
    s_cmp_ge_u32 s22, 32
    s_cselect_b32 s23, 10240, s23
    s_cselect_b32 s45, s35, s37
    s_cselect_b32 s47, s36, s38
    s_cselect_b32 s48, 1.0, 0x3ea52b5c
    s_mul_i32 s24, s22, s23
    s_cmp_ge_u32 s22, 64
    s_cselect_b32 s24, 0x80000000, s24
    s_add_u32 s45, s45, s24
    s_add_u32 s46, s45, s23
    s_add_u32 s47, s47, s24
    v_mad_u32_u24 v35, v6, s23, v17
    s_barrier
    ds_read_b128 v[160:163], v56 offset:0
    ds_read_b64_tr_b16 v[128:129], v48 offset:0
    ds_read_b64_tr_b16 v[130:131], v48 offset:1024
    ds_read_b64_tr_b16 v[132:133], v50 offset:0
    ds_read_b64_tr_b16 v[134:135], v50 offset:1024
    ds_read_b128 v[168:171], v60 offset:0
    ds_read_b64_tr_b16 v[136:137], v52 offset:0
    ds_read_b64_tr_b16 v[138:139], v52 offset:1024
    ds_read_b64_tr_b16 v[140:141], v54 offset:0
    ds_read_b64_tr_b16 v[142:143], v54 offset:1024
    s_waitcnt lgkmcnt(7)
    v_mfma_f32_32x32x16_bf16 v[64:79], v[128:131], v[160:163], 0
    ds_read_b128 v[164:167], v57 offset:0
    ds_read_b64_tr_b16 v[144:145], v48 offset:4096
    ds_read_b64_tr_b16 v[146:147], v48 offset:5120
    s_waitcnt lgkmcnt(8)
    v_mfma_f32_32x32x16_bf16 v[80:95], v[132:135], v[160:163], 0
    ds_read_b64_tr_b16 v[148:149], v50 offset:4096
    ds_read_b64_tr_b16 v[150:151], v50 offset:5120
    ds_read_b128 v[172:175], v60 offset:2048
    s_waitcnt lgkmcnt(8)
    v_mfma_f32_32x32x16_bf16 v[96:111], v[136:139], v[160:163], 0
    ds_read_b64_tr_b16 v[152:153], v52 offset:4096
    ds_read_b64_tr_b16 v[154:155], v52 offset:5120
    v_mfma_f32_16x16x32_bf16 v[176:179], v[192:195], v[168:171], 0
    s_waitcnt lgkmcnt(8)
    v_mfma_f32_32x32x16_bf16 v[112:127], v[140:143], v[160:163], 0
    ds_read_b64_tr_b16 v[156:157], v54 offset:4096
    ds_read_b64_tr_b16 v[158:159], v54 offset:5120
    v_mfma_f32_16x16x32_bf16 v[184:187], v[168:171], v[168:171], 0
    s_waitcnt lgkmcnt(7)
    v_mfma_f32_32x32x16_bf16 v[64:79], v[144:147], v[164:167], v[64:79]
    ds_read_b128 v[160:163], v58 offset:0
    ds_read_b64_tr_b16 v[128:129], v48 offset:8192
    ds_read_b64_tr_b16 v[130:131], v48 offset:9216
    s_waitcnt lgkmcnt(8)
    v_mfma_f32_32x32x16_bf16 v[80:95], v[148:151], v[164:167], v[80:95]
    ds_read_b64_tr_b16 v[132:133], v50 offset:8192
    ds_read_b64_tr_b16 v[134:135], v50 offset:9216
    ds_read_b128 v[168:171], v61 offset:0
    s_waitcnt lgkmcnt(8)
    v_mfma_f32_32x32x16_bf16 v[96:111], v[152:155], v[164:167], v[96:111]
    ds_read_b64_tr_b16 v[136:137], v52 offset:8192
    ds_read_b64_tr_b16 v[138:139], v52 offset:9216
    v_mfma_f32_16x16x32_bf16 v[180:183], v[192:195], v[172:175], 0
    s_waitcnt lgkmcnt(8)
    v_mfma_f32_32x32x16_bf16 v[112:127], v[156:159], v[164:167], v[112:127]
    ds_read_b64_tr_b16 v[140:141], v54 offset:8192
    ds_read_b64_tr_b16 v[142:143], v54 offset:9216
    v_mfma_f32_16x16x32_bf16 v[188:191], v[172:175], v[172:175], 0
    s_waitcnt lgkmcnt(7)
    v_mfma_f32_32x32x16_bf16 v[64:79], v[128:131], v[160:163], v[64:79]
    ds_read_b128 v[164:167], v59 offset:0
    ds_read_b64_tr_b16 v[144:145], v48 offset:12288
    ds_read_b64_tr_b16 v[146:147], v48 offset:13312
    s_waitcnt lgkmcnt(8)
    v_mfma_f32_32x32x16_bf16 v[80:95], v[132:135], v[160:163], v[80:95]
    ds_read_b64_tr_b16 v[148:149], v50 offset:12288
    ds_read_b64_tr_b16 v[150:151], v50 offset:13312
    ds_read_b128 v[172:175], v61 offset:2048
    s_waitcnt lgkmcnt(8)
    v_mfma_f32_32x32x16_bf16 v[96:111], v[136:139], v[160:163], v[96:111]
    ds_read_b64_tr_b16 v[152:153], v52 offset:12288
    ds_read_b64_tr_b16 v[154:155], v52 offset:13312
    v_mfma_f32_16x16x32_bf16 v[176:179], v[192:195], v[168:171], v[176:179]
    s_waitcnt lgkmcnt(8)
    v_mfma_f32_32x32x16_bf16 v[112:127], v[140:143], v[160:163], v[112:127]
    ds_read_b64_tr_b16 v[156:157], v54 offset:12288
    ds_read_b64_tr_b16 v[158:159], v54 offset:13312
    v_mfma_f32_16x16x32_bf16 v[184:187], v[168:171], v[168:171], v[184:187]
    s_waitcnt lgkmcnt(7)
    v_mfma_f32_32x32x16_bf16 v[64:79], v[144:147], v[164:167], v[64:79]
    s_barrier
    ds_read_b128 v[160:163], v56 offset:16384
    ds_read_b64_tr_b16 v[128:129], v48 offset:16384
    ds_read_b64_tr_b16 v[130:131], v48 offset:17408
    s_waitcnt lgkmcnt(8)
    v_mfma_f32_32x32x16_bf16 v[80:95], v[148:151], v[164:167], v[80:95]
    ds_read_b64_tr_b16 v[132:133], v50 offset:16384
    ds_read_b64_tr_b16 v[134:135], v50 offset:17408
    ds_read_b128 v[168:171], v60 offset:16384
    s_waitcnt lgkmcnt(8)
    v_mfma_f32_32x32x16_bf16 v[96:111], v[152:155], v[164:167], v[96:111]
    ds_read_b64_tr_b16 v[136:137], v52 offset:16384
    ds_read_b64_tr_b16 v[138:139], v52 offset:17408
    v_mfma_f32_16x16x32_bf16 v[180:183], v[192:195], v[172:175], v[180:183]
    s_waitcnt lgkmcnt(8)
    v_mfma_f32_32x32x16_bf16 v[112:127], v[156:159], v[164:167], v[112:127]
    ds_read_b64_tr_b16 v[140:141], v54 offset:16384
    ds_read_b64_tr_b16 v[142:143], v54 offset:17408
    v_mfma_f32_16x16x32_bf16 v[188:191], v[172:175], v[172:175], v[188:191]
    s_waitcnt lgkmcnt(7)
    v_mfma_f32_32x32x16_bf16 v[64:79], v[128:131], v[160:163], v[64:79]
    ds_read_b128 v[164:167], v57 offset:16384
    ds_read_b64_tr_b16 v[144:145], v48 offset:20480
    ds_read_b64_tr_b16 v[146:147], v48 offset:21504
    s_waitcnt lgkmcnt(8)
    v_mfma_f32_32x32x16_bf16 v[80:95], v[132:135], v[160:163], v[80:95]
    ds_read_b64_tr_b16 v[148:149], v50 offset:20480
    ds_read_b64_tr_b16 v[150:151], v50 offset:21504
    ds_read_b128 v[172:175], v60 offset:18432
    s_waitcnt lgkmcnt(8)
    v_mfma_f32_32x32x16_bf16 v[96:111], v[136:139], v[160:163], v[96:111]
    ds_read_b64_tr_b16 v[152:153], v52 offset:20480
    ds_read_b64_tr_b16 v[154:155], v52 offset:21504
    v_mfma_f32_16x16x32_bf16 v[176:179], v[192:195], v[168:171], v[176:179]
    s_waitcnt lgkmcnt(8)
    v_mfma_f32_32x32x16_bf16 v[112:127], v[140:143], v[160:163], v[112:127]
    ds_read_b64_tr_b16 v[156:157], v54 offset:20480
    ds_read_b64_tr_b16 v[158:159], v54 offset:21504
    v_mfma_f32_16x16x32_bf16 v[184:187], v[168:171], v[168:171], v[184:187]
    s_waitcnt lgkmcnt(7)
    v_mfma_f32_32x32x16_bf16 v[64:79], v[144:147], v[164:167], v[64:79]
    ds_read_b128 v[160:163], v58 offset:16384
    ds_read_b64_tr_b16 v[128:129], v48 offset:24576
    ds_read_b64_tr_b16 v[130:131], v48 offset:25600
    s_waitcnt lgkmcnt(8)
    v_mfma_f32_32x32x16_bf16 v[80:95], v[148:151], v[164:167], v[80:95]
    ds_read_b64_tr_b16 v[132:133], v50 offset:24576
    ds_read_b64_tr_b16 v[134:135], v50 offset:25600
    ds_read_b128 v[168:171], v61 offset:16384
    s_waitcnt lgkmcnt(8)
    v_mfma_f32_32x32x16_bf16 v[96:111], v[152:155], v[164:167], v[96:111]
    ds_read_b64_tr_b16 v[136:137], v52 offset:24576
    ds_read_b64_tr_b16 v[138:139], v52 offset:25600
    v_mfma_f32_16x16x32_bf16 v[180:183], v[192:195], v[172:175], v[180:183]
    s_waitcnt lgkmcnt(8)
    v_mfma_f32_32x32x16_bf16 v[112:127], v[156:159], v[164:167], v[112:127]
    ds_read_b64_tr_b16 v[140:141], v54 offset:24576
    ds_read_b64_tr_b16 v[142:143], v54 offset:25600
    v_mfma_f32_16x16x32_bf16 v[188:191], v[172:175], v[172:175], v[188:191]
    s_waitcnt lgkmcnt(7)
    v_mfma_f32_32x32x16_bf16 v[64:79], v[128:131], v[160:163], v[64:79]
    ds_read_b128 v[164:167], v59 offset:16384
    ds_read_b64_tr_b16 v[144:145], v48 offset:28672
    ds_read_b64_tr_b16 v[146:147], v48 offset:29696
    s_waitcnt lgkmcnt(8)
    v_mfma_f32_32x32x16_bf16 v[80:95], v[132:135], v[160:163], v[80:95]
    ds_read_b64_tr_b16 v[148:149], v50 offset:28672
    ds_read_b64_tr_b16 v[150:151], v50 offset:29696
    ds_read_b128 v[172:175], v61 offset:18432
    s_waitcnt lgkmcnt(8)
    v_mfma_f32_32x32x16_bf16 v[96:111], v[136:139], v[160:163], v[96:111]
    ds_read_b64_tr_b16 v[152:153], v52 offset:28672
    ds_read_b64_tr_b16 v[154:155], v52 offset:29696
    v_mfma_f32_16x16x32_bf16 v[176:179], v[192:195], v[168:171], v[176:179]
    s_waitcnt lgkmcnt(8)
    v_mfma_f32_32x32x16_bf16 v[112:127], v[140:143], v[160:163], v[112:127]
    ds_read_b64_tr_b16 v[156:157], v54 offset:28672
    ds_read_b64_tr_b16 v[158:159], v54 offset:29696
    v_mfma_f32_16x16x32_bf16 v[184:187], v[168:171], v[168:171], v[184:187]
    s_waitcnt lgkmcnt(7)
    v_mfma_f32_32x32x16_bf16 v[64:79], v[144:147], v[164:167], v[64:79]
    s_barrier
    ds_read_b128 v[160:163], v56 offset:32768
    ds_read_b64_tr_b16 v[128:129], v48 offset:32768
    ds_read_b64_tr_b16 v[130:131], v48 offset:33792
    s_waitcnt lgkmcnt(8)
    v_mfma_f32_32x32x16_bf16 v[80:95], v[148:151], v[164:167], v[80:95]
    ds_read_b64_tr_b16 v[132:133], v50 offset:32768
    ds_read_b64_tr_b16 v[134:135], v50 offset:33792
    ds_read_b128 v[168:171], v60 offset:32768
    s_waitcnt lgkmcnt(8)
    v_mfma_f32_32x32x16_bf16 v[96:111], v[152:155], v[164:167], v[96:111]
    ds_read_b64_tr_b16 v[136:137], v52 offset:32768
    ds_read_b64_tr_b16 v[138:139], v52 offset:33792
    v_mfma_f32_16x16x32_bf16 v[180:183], v[192:195], v[172:175], v[180:183]
    s_waitcnt lgkmcnt(8)
    v_mfma_f32_32x32x16_bf16 v[112:127], v[156:159], v[164:167], v[112:127]
    ds_read_b64_tr_b16 v[140:141], v54 offset:32768
    ds_read_b64_tr_b16 v[142:143], v54 offset:33792
    v_mfma_f32_16x16x32_bf16 v[188:191], v[172:175], v[172:175], v[188:191]
    s_waitcnt lgkmcnt(7)
    v_mfma_f32_32x32x16_bf16 v[64:79], v[128:131], v[160:163], v[64:79]
    ds_read_b128 v[164:167], v57 offset:32768
    ds_read_b64_tr_b16 v[144:145], v48 offset:36864
    ds_read_b64_tr_b16 v[146:147], v48 offset:37888
    s_waitcnt lgkmcnt(8)
    v_mfma_f32_32x32x16_bf16 v[80:95], v[132:135], v[160:163], v[80:95]
    ds_read_b64_tr_b16 v[148:149], v50 offset:36864
    ds_read_b64_tr_b16 v[150:151], v50 offset:37888
    ds_read_b128 v[172:175], v60 offset:34816
    s_waitcnt lgkmcnt(8)
    v_mfma_f32_32x32x16_bf16 v[96:111], v[136:139], v[160:163], v[96:111]
    ds_read_b64_tr_b16 v[152:153], v52 offset:36864
    ds_read_b64_tr_b16 v[154:155], v52 offset:37888
    v_mfma_f32_16x16x32_bf16 v[176:179], v[192:195], v[168:171], v[176:179]
    s_waitcnt lgkmcnt(8)
    v_mfma_f32_32x32x16_bf16 v[112:127], v[140:143], v[160:163], v[112:127]
    ds_read_b64_tr_b16 v[156:157], v54 offset:36864
    ds_read_b64_tr_b16 v[158:159], v54 offset:37888
    v_mfma_f32_16x16x32_bf16 v[184:187], v[168:171], v[168:171], v[184:187]
    s_waitcnt lgkmcnt(7)
    v_mfma_f32_32x32x16_bf16 v[64:79], v[144:147], v[164:167], v[64:79]
    ds_read_b128 v[160:163], v58 offset:32768
    ds_read_b64_tr_b16 v[128:129], v48 offset:40960
    ds_read_b64_tr_b16 v[130:131], v48 offset:41984
    s_waitcnt lgkmcnt(8)
    v_mfma_f32_32x32x16_bf16 v[80:95], v[148:151], v[164:167], v[80:95]
    ds_read_b64_tr_b16 v[132:133], v50 offset:40960
    ds_read_b64_tr_b16 v[134:135], v50 offset:41984
    ds_read_b128 v[168:171], v61 offset:32768
    s_waitcnt lgkmcnt(8)
    v_mfma_f32_32x32x16_bf16 v[96:111], v[152:155], v[164:167], v[96:111]
    ds_read_b64_tr_b16 v[136:137], v52 offset:40960
    ds_read_b64_tr_b16 v[138:139], v52 offset:41984
    v_mfma_f32_16x16x32_bf16 v[180:183], v[192:195], v[172:175], v[180:183]
    s_waitcnt lgkmcnt(8)
    v_mfma_f32_32x32x16_bf16 v[112:127], v[156:159], v[164:167], v[112:127]
    ds_read_b64_tr_b16 v[140:141], v54 offset:40960
    ds_read_b64_tr_b16 v[142:143], v54 offset:41984
    v_mfma_f32_16x16x32_bf16 v[188:191], v[172:175], v[172:175], v[188:191]
    s_waitcnt lgkmcnt(7)
    v_mfma_f32_32x32x16_bf16 v[64:79], v[128:131], v[160:163], v[64:79]
    ds_read_b128 v[164:167], v59 offset:32768
    ds_read_b64_tr_b16 v[144:145], v48 offset:45056
    ds_read_b64_tr_b16 v[146:147], v48 offset:46080
    s_waitcnt lgkmcnt(8)
    v_mfma_f32_32x32x16_bf16 v[80:95], v[132:135], v[160:163], v[80:95]
    ds_read_b64_tr_b16 v[148:149], v50 offset:45056
    ds_read_b64_tr_b16 v[150:151], v50 offset:46080
    ds_read_b128 v[172:175], v61 offset:34816
    s_waitcnt lgkmcnt(8)
    v_mfma_f32_32x32x16_bf16 v[96:111], v[136:139], v[160:163], v[96:111]
    ds_read_b64_tr_b16 v[152:153], v52 offset:45056
    ds_read_b64_tr_b16 v[154:155], v52 offset:46080
    v_mfma_f32_16x16x32_bf16 v[176:179], v[192:195], v[168:171], v[176:179]
    s_waitcnt lgkmcnt(8)
    v_mfma_f32_32x32x16_bf16 v[112:127], v[140:143], v[160:163], v[112:127]
    ds_read_b64_tr_b16 v[156:157], v54 offset:45056
    ds_read_b64_tr_b16 v[158:159], v54 offset:46080
    v_mfma_f32_16x16x32_bf16 v[184:187], v[168:171], v[168:171], v[184:187]
    s_waitcnt lgkmcnt(7)
    v_mfma_f32_32x32x16_bf16 v[64:79], v[144:147], v[164:167], v[64:79]
    s_barrier
    ds_read_b128 v[160:163], v56 offset:49152
    ds_read_b64_tr_b16 v[128:129], v48 offset:49152
    ds_read_b64_tr_b16 v[130:131], v48 offset:50176
    s_waitcnt lgkmcnt(8)
    v_mfma_f32_32x32x16_bf16 v[80:95], v[148:151], v[164:167], v[80:95]
    ds_read_b64_tr_b16 v[132:133], v50 offset:49152
    ds_read_b64_tr_b16 v[134:135], v50 offset:50176
    ds_read_b128 v[168:171], v60 offset:49152
    s_waitcnt lgkmcnt(8)
    v_mfma_f32_32x32x16_bf16 v[96:111], v[152:155], v[164:167], v[96:111]
    ds_read_b64_tr_b16 v[136:137], v52 offset:49152
    ds_read_b64_tr_b16 v[138:139], v52 offset:50176
    v_mfma_f32_16x16x32_bf16 v[180:183], v[192:195], v[172:175], v[180:183]
    s_waitcnt lgkmcnt(8)
    v_mfma_f32_32x32x16_bf16 v[112:127], v[156:159], v[164:167], v[112:127]
    ds_read_b64_tr_b16 v[140:141], v54 offset:49152
    ds_read_b64_tr_b16 v[142:143], v54 offset:50176
    v_mfma_f32_16x16x32_bf16 v[188:191], v[172:175], v[172:175], v[188:191]
    s_waitcnt lgkmcnt(7)
    v_mfma_f32_32x32x16_bf16 v[64:79], v[128:131], v[160:163], v[64:79]
    ds_read_b128 v[164:167], v57 offset:49152
    ds_read_b64_tr_b16 v[144:145], v48 offset:53248
    ds_read_b64_tr_b16 v[146:147], v48 offset:54272
    s_waitcnt lgkmcnt(8)
    v_mfma_f32_32x32x16_bf16 v[80:95], v[132:135], v[160:163], v[80:95]
    ds_read_b64_tr_b16 v[148:149], v50 offset:53248
    ds_read_b64_tr_b16 v[150:151], v50 offset:54272
    ds_read_b128 v[172:175], v60 offset:51200
    s_waitcnt lgkmcnt(8)
    v_mfma_f32_32x32x16_bf16 v[96:111], v[136:139], v[160:163], v[96:111]
    ds_read_b64_tr_b16 v[152:153], v52 offset:53248
    ds_read_b64_tr_b16 v[154:155], v52 offset:54272
    v_mfma_f32_16x16x32_bf16 v[176:179], v[192:195], v[168:171], v[176:179]
    s_waitcnt lgkmcnt(8)
    v_mfma_f32_32x32x16_bf16 v[112:127], v[140:143], v[160:163], v[112:127]
    ds_read_b64_tr_b16 v[156:157], v54 offset:53248
    ds_read_b64_tr_b16 v[158:159], v54 offset:54272
    v_mfma_f32_16x16x32_bf16 v[184:187], v[168:171], v[168:171], v[184:187]
    s_waitcnt lgkmcnt(7)
    v_mfma_f32_32x32x16_bf16 v[64:79], v[144:147], v[164:167], v[64:79]
    ds_read_b128 v[160:163], v58 offset:49152
    ds_read_b64_tr_b16 v[128:129], v48 offset:57344
    ds_read_b64_tr_b16 v[130:131], v48 offset:58368
    s_waitcnt lgkmcnt(8)
    v_mfma_f32_32x32x16_bf16 v[80:95], v[148:151], v[164:167], v[80:95]
    ds_read_b64_tr_b16 v[132:133], v50 offset:57344
    ds_read_b64_tr_b16 v[134:135], v50 offset:58368
    ds_read_b128 v[168:171], v61 offset:49152
    s_waitcnt lgkmcnt(8)
    v_mfma_f32_32x32x16_bf16 v[96:111], v[152:155], v[164:167], v[96:111]
    ds_read_b64_tr_b16 v[136:137], v52 offset:57344
    ds_read_b64_tr_b16 v[138:139], v52 offset:58368
    v_mfma_f32_16x16x32_bf16 v[180:183], v[192:195], v[172:175], v[180:183]
    s_waitcnt lgkmcnt(8)
    v_mfma_f32_32x32x16_bf16 v[112:127], v[156:159], v[164:167], v[112:127]
    ds_read_b64_tr_b16 v[140:141], v54 offset:57344
    ds_read_b64_tr_b16 v[142:143], v54 offset:58368
    v_mfma_f32_16x16x32_bf16 v[188:191], v[172:175], v[172:175], v[188:191]
    s_waitcnt lgkmcnt(7)
    v_mfma_f32_32x32x16_bf16 v[64:79], v[128:131], v[160:163], v[64:79]
    ds_read_b128 v[164:167], v59 offset:49152
    ds_read_b64_tr_b16 v[144:145], v48 offset:61440
    ds_read_b64_tr_b16 v[146:147], v48 offset:62464
    s_waitcnt lgkmcnt(8)
    v_mfma_f32_32x32x16_bf16 v[80:95], v[132:135], v[160:163], v[80:95]
    ds_read_b64_tr_b16 v[148:149], v50 offset:61440
    ds_read_b64_tr_b16 v[150:151], v50 offset:62464
    ds_read_b128 v[172:175], v61 offset:51200
    s_waitcnt lgkmcnt(8)
    v_mfma_f32_32x32x16_bf16 v[96:111], v[136:139], v[160:163], v[96:111]
    ds_read_b64_tr_b16 v[152:153], v52 offset:61440
    ds_read_b64_tr_b16 v[154:155], v52 offset:62464
    v_mfma_f32_16x16x32_bf16 v[176:179], v[192:195], v[168:171], v[176:179]
    s_waitcnt lgkmcnt(8)
    v_mfma_f32_32x32x16_bf16 v[112:127], v[140:143], v[160:163], v[112:127]
    ds_read_b64_tr_b16 v[156:157], v54 offset:61440
    ds_read_b64_tr_b16 v[158:159], v54 offset:62464
    v_mfma_f32_16x16x32_bf16 v[184:187], v[168:171], v[168:171], v[184:187]
    s_waitcnt lgkmcnt(7)
    v_mfma_f32_32x32x16_bf16 v[64:79], v[144:147], v[164:167], v[64:79]
    s_barrier
    ds_read_b128 v[160:163], v56 offset:0
    ds_read_b64_tr_b16 v[128:129], v48 offset:0
    ds_read_b64_tr_b16 v[130:131], v48 offset:1024
    s_waitcnt lgkmcnt(8)
    v_mfma_f32_32x32x16_bf16 v[80:95], v[148:151], v[164:167], v[80:95]
    ds_read_b64_tr_b16 v[132:133], v50 offset:0
    ds_read_b64_tr_b16 v[134:135], v50 offset:1024
    ds_read_b128 v[168:171], v60 offset:0
    s_waitcnt lgkmcnt(8)
    v_mfma_f32_32x32x16_bf16 v[96:111], v[152:155], v[164:167], v[96:111]
    ds_read_b64_tr_b16 v[136:137], v52 offset:0
    ds_read_b64_tr_b16 v[138:139], v52 offset:1024
    v_mfma_f32_16x16x32_bf16 v[180:183], v[192:195], v[172:175], v[180:183]
    s_waitcnt lgkmcnt(8)
    v_mfma_f32_32x32x16_bf16 v[112:127], v[156:159], v[164:167], v[112:127]
    ds_read_b64_tr_b16 v[140:141], v54 offset:0
    ds_read_b64_tr_b16 v[142:143], v54 offset:1024
    v_mfma_f32_16x16x32_bf16 v[188:191], v[172:175], v[172:175], v[188:191]
    s_waitcnt lgkmcnt(7)
    v_mfma_f32_32x32x16_bf16 v[64:79], v[128:131], v[160:163], v[64:79]
    ds_read_b128 v[164:167], v57 offset:0
    ds_read_b64_tr_b16 v[144:145], v48 offset:4096
    ds_read_b64_tr_b16 v[146:147], v48 offset:5120
    s_waitcnt lgkmcnt(8)
    v_mfma_f32_32x32x16_bf16 v[80:95], v[132:135], v[160:163], v[80:95]
    ds_read_b64_tr_b16 v[148:149], v50 offset:4096
    ds_read_b64_tr_b16 v[150:151], v50 offset:5120
    ds_read_b128 v[172:175], v60 offset:2048
    s_waitcnt lgkmcnt(8)
    v_mfma_f32_32x32x16_bf16 v[96:111], v[136:139], v[160:163], v[96:111]
    ds_read_b64_tr_b16 v[152:153], v52 offset:4096
    ds_read_b64_tr_b16 v[154:155], v52 offset:5120
    v_mfma_f32_16x16x32_bf16 v[176:179], v[192:195], v[168:171], v[176:179]
    s_waitcnt lgkmcnt(8)
    v_mfma_f32_32x32x16_bf16 v[112:127], v[140:143], v[160:163], v[112:127]
    ds_read_b64_tr_b16 v[156:157], v54 offset:4096
    ds_read_b64_tr_b16 v[158:159], v54 offset:5120
    v_mfma_f32_16x16x32_bf16 v[184:187], v[168:171], v[168:171], v[184:187]
    s_waitcnt lgkmcnt(7)
    v_mfma_f32_32x32x16_bf16 v[64:79], v[144:147], v[164:167], v[64:79]
    ds_read_b128 v[160:163], v58 offset:0
    ds_read_b64_tr_b16 v[128:129], v48 offset:8192
    ds_read_b64_tr_b16 v[130:131], v48 offset:9216
    s_waitcnt lgkmcnt(8)
    v_mfma_f32_32x32x16_bf16 v[80:95], v[148:151], v[164:167], v[80:95]
    ds_read_b64_tr_b16 v[132:133], v50 offset:8192
    ds_read_b64_tr_b16 v[134:135], v50 offset:9216
    ds_read_b128 v[168:171], v61 offset:0
    s_waitcnt lgkmcnt(8)
    v_mfma_f32_32x32x16_bf16 v[96:111], v[152:155], v[164:167], v[96:111]
    ds_read_b64_tr_b16 v[136:137], v52 offset:8192
    ds_read_b64_tr_b16 v[138:139], v52 offset:9216
    v_mfma_f32_16x16x32_bf16 v[180:183], v[192:195], v[172:175], v[180:183]
    s_waitcnt lgkmcnt(8)
    v_mfma_f32_32x32x16_bf16 v[112:127], v[156:159], v[164:167], v[112:127]
    ds_read_b64_tr_b16 v[140:141], v54 offset:8192
    ds_read_b64_tr_b16 v[142:143], v54 offset:9216
    v_mfma_f32_16x16x32_bf16 v[188:191], v[172:175], v[172:175], v[188:191]
    s_waitcnt lgkmcnt(7)
    v_mfma_f32_32x32x16_bf16 v[64:79], v[128:131], v[160:163], v[64:79]
    ds_read_b128 v[164:167], v59 offset:0
    ds_read_b64_tr_b16 v[144:145], v48 offset:12288
    ds_read_b64_tr_b16 v[146:147], v48 offset:13312
    s_waitcnt lgkmcnt(8)
    v_mfma_f32_32x32x16_bf16 v[80:95], v[132:135], v[160:163], v[80:95]
    ds_read_b64_tr_b16 v[148:149], v50 offset:12288
    ds_read_b64_tr_b16 v[150:151], v50 offset:13312
    ds_read_b128 v[172:175], v61 offset:2048
    s_waitcnt lgkmcnt(8)
    v_mfma_f32_32x32x16_bf16 v[96:111], v[136:139], v[160:163], v[96:111]
    ds_read_b64_tr_b16 v[152:153], v52 offset:12288
    ds_read_b64_tr_b16 v[154:155], v52 offset:13312
    v_mfma_f32_16x16x32_bf16 v[176:179], v[192:195], v[168:171], v[176:179]
    s_waitcnt lgkmcnt(8)
    v_mfma_f32_32x32x16_bf16 v[112:127], v[140:143], v[160:163], v[112:127]
    ds_read_b64_tr_b16 v[156:157], v54 offset:12288
    ds_read_b64_tr_b16 v[158:159], v54 offset:13312
    v_mfma_f32_16x16x32_bf16 v[184:187], v[168:171], v[168:171], v[184:187]
    s_waitcnt lgkmcnt(7)
    v_mfma_f32_32x32x16_bf16 v[64:79], v[144:147], v[164:167], v[64:79]
    s_barrier
    ds_read_b128 v[160:163], v56 offset:16384
    ds_read_b64_tr_b16 v[128:129], v48 offset:16384
    ds_read_b64_tr_b16 v[130:131], v48 offset:17408
    s_waitcnt lgkmcnt(8)
    v_mfma_f32_32x32x16_bf16 v[80:95], v[148:151], v[164:167], v[80:95]
    ds_read_b64_tr_b16 v[132:133], v50 offset:16384
    ds_read_b64_tr_b16 v[134:135], v50 offset:17408
    ds_read_b128 v[168:171], v60 offset:16384
    s_waitcnt lgkmcnt(8)
    v_mfma_f32_32x32x16_bf16 v[96:111], v[152:155], v[164:167], v[96:111]
    ds_read_b64_tr_b16 v[136:137], v52 offset:16384
    ds_read_b64_tr_b16 v[138:139], v52 offset:17408
    v_mfma_f32_16x16x32_bf16 v[180:183], v[192:195], v[172:175], v[180:183]
    s_waitcnt lgkmcnt(8)
    v_mfma_f32_32x32x16_bf16 v[112:127], v[156:159], v[164:167], v[112:127]
    ds_read_b64_tr_b16 v[140:141], v54 offset:16384
    ds_read_b64_tr_b16 v[142:143], v54 offset:17408
    v_mfma_f32_16x16x32_bf16 v[188:191], v[172:175], v[172:175], v[188:191]
    s_waitcnt lgkmcnt(7)
    v_mfma_f32_32x32x16_bf16 v[64:79], v[128:131], v[160:163], v[64:79]
    ds_read_b128 v[164:167], v57 offset:16384
    ds_read_b64_tr_b16 v[144:145], v48 offset:20480
    ds_read_b64_tr_b16 v[146:147], v48 offset:21504
    s_waitcnt lgkmcnt(8)
    v_mfma_f32_32x32x16_bf16 v[80:95], v[132:135], v[160:163], v[80:95]
    ds_read_b64_tr_b16 v[148:149], v50 offset:20480
    ds_read_b64_tr_b16 v[150:151], v50 offset:21504
    ds_read_b128 v[172:175], v60 offset:18432
    s_waitcnt lgkmcnt(8)
    v_mfma_f32_32x32x16_bf16 v[96:111], v[136:139], v[160:163], v[96:111]
    ds_read_b64_tr_b16 v[152:153], v52 offset:20480
    ds_read_b64_tr_b16 v[154:155], v52 offset:21504
    v_mfma_f32_16x16x32_bf16 v[176:179], v[192:195], v[168:171], v[176:179]
    s_waitcnt lgkmcnt(8)
    v_mfma_f32_32x32x16_bf16 v[112:127], v[140:143], v[160:163], v[112:127]
    ds_read_b64_tr_b16 v[156:157], v54 offset:20480
    ds_read_b64_tr_b16 v[158:159], v54 offset:21504
    v_mfma_f32_16x16x32_bf16 v[184:187], v[168:171], v[168:171], v[184:187]
    s_waitcnt lgkmcnt(7)
    v_mfma_f32_32x32x16_bf16 v[64:79], v[144:147], v[164:167], v[64:79]
    ds_read_b128 v[160:163], v58 offset:16384
    ds_read_b64_tr_b16 v[128:129], v48 offset:24576
    ds_read_b64_tr_b16 v[130:131], v48 offset:25600
    s_waitcnt lgkmcnt(8)
    v_mfma_f32_32x32x16_bf16 v[80:95], v[148:151], v[164:167], v[80:95]
    ds_read_b64_tr_b16 v[132:133], v50 offset:24576
    ds_read_b64_tr_b16 v[134:135], v50 offset:25600
    ds_read_b128 v[168:171], v61 offset:16384
    s_waitcnt lgkmcnt(8)
    v_mfma_f32_32x32x16_bf16 v[96:111], v[152:155], v[164:167], v[96:111]
    ds_read_b64_tr_b16 v[136:137], v52 offset:24576
    ds_read_b64_tr_b16 v[138:139], v52 offset:25600
    v_mfma_f32_16x16x32_bf16 v[180:183], v[192:195], v[172:175], v[180:183]
    s_waitcnt lgkmcnt(8)
    v_mfma_f32_32x32x16_bf16 v[112:127], v[156:159], v[164:167], v[112:127]
    ds_read_b64_tr_b16 v[140:141], v54 offset:24576
    ds_read_b64_tr_b16 v[142:143], v54 offset:25600
    v_mfma_f32_16x16x32_bf16 v[188:191], v[172:175], v[172:175], v[188:191]
    s_waitcnt lgkmcnt(7)
    v_mfma_f32_32x32x16_bf16 v[64:79], v[128:131], v[160:163], v[64:79]
    ds_read_b128 v[164:167], v59 offset:16384
    ds_read_b64_tr_b16 v[144:145], v48 offset:28672
    ds_read_b64_tr_b16 v[146:147], v48 offset:29696
    s_waitcnt lgkmcnt(8)
    v_mfma_f32_32x32x16_bf16 v[80:95], v[132:135], v[160:163], v[80:95]
    ds_read_b64_tr_b16 v[148:149], v50 offset:28672
    ds_read_b64_tr_b16 v[150:151], v50 offset:29696
    ds_read_b128 v[172:175], v61 offset:18432
    s_waitcnt lgkmcnt(8)
    v_mfma_f32_32x32x16_bf16 v[96:111], v[136:139], v[160:163], v[96:111]
    ds_read_b64_tr_b16 v[152:153], v52 offset:28672
    ds_read_b64_tr_b16 v[154:155], v52 offset:29696
    v_mfma_f32_16x16x32_bf16 v[176:179], v[192:195], v[168:171], v[176:179]
    s_waitcnt lgkmcnt(8)
    v_mfma_f32_32x32x16_bf16 v[112:127], v[140:143], v[160:163], v[112:127]
    ds_read_b64_tr_b16 v[156:157], v54 offset:28672
    ds_read_b64_tr_b16 v[158:159], v54 offset:29696
    v_mfma_f32_16x16x32_bf16 v[184:187], v[168:171], v[168:171], v[184:187]
    s_waitcnt lgkmcnt(7)
    v_mfma_f32_32x32x16_bf16 v[64:79], v[144:147], v[164:167], v[64:79]
    s_barrier
    ds_read_b128 v[160:163], v56 offset:32768
    ds_read_b64_tr_b16 v[128:129], v48 offset:32768
    ds_read_b64_tr_b16 v[130:131], v48 offset:33792
    s_waitcnt lgkmcnt(8)
    v_mfma_f32_32x32x16_bf16 v[80:95], v[148:151], v[164:167], v[80:95]
    ds_read_b64_tr_b16 v[132:133], v50 offset:32768
    ds_read_b64_tr_b16 v[134:135], v50 offset:33792
    ds_read_b128 v[168:171], v60 offset:32768
    s_waitcnt lgkmcnt(8)
    v_mfma_f32_32x32x16_bf16 v[96:111], v[152:155], v[164:167], v[96:111]
    ds_read_b64_tr_b16 v[136:137], v52 offset:32768
    ds_read_b64_tr_b16 v[138:139], v52 offset:33792
    v_mfma_f32_16x16x32_bf16 v[180:183], v[192:195], v[172:175], v[180:183]
    s_waitcnt lgkmcnt(8)
    v_mfma_f32_32x32x16_bf16 v[112:127], v[156:159], v[164:167], v[112:127]
    ds_read_b64_tr_b16 v[140:141], v54 offset:32768
    ds_read_b64_tr_b16 v[142:143], v54 offset:33792
    v_mfma_f32_16x16x32_bf16 v[188:191], v[172:175], v[172:175], v[188:191]
    s_waitcnt lgkmcnt(7)
    v_mfma_f32_32x32x16_bf16 v[64:79], v[128:131], v[160:163], v[64:79]
    ds_read_b128 v[164:167], v57 offset:32768
    ds_read_b64_tr_b16 v[144:145], v48 offset:36864
    ds_read_b64_tr_b16 v[146:147], v48 offset:37888
    s_waitcnt lgkmcnt(8)
    v_mfma_f32_32x32x16_bf16 v[80:95], v[132:135], v[160:163], v[80:95]
    ds_read_b64_tr_b16 v[148:149], v50 offset:36864
    ds_read_b64_tr_b16 v[150:151], v50 offset:37888
    ds_read_b128 v[172:175], v60 offset:34816
    s_waitcnt lgkmcnt(8)
    v_mfma_f32_32x32x16_bf16 v[96:111], v[136:139], v[160:163], v[96:111]
    ds_read_b64_tr_b16 v[152:153], v52 offset:36864
    ds_read_b64_tr_b16 v[154:155], v52 offset:37888
    v_mfma_f32_16x16x32_bf16 v[176:179], v[192:195], v[168:171], v[176:179]
    s_waitcnt lgkmcnt(8)
    v_mfma_f32_32x32x16_bf16 v[112:127], v[140:143], v[160:163], v[112:127]
    ds_read_b64_tr_b16 v[156:157], v54 offset:36864
    ds_read_b64_tr_b16 v[158:159], v54 offset:37888
    v_mfma_f32_16x16x32_bf16 v[184:187], v[168:171], v[168:171], v[184:187]
    s_waitcnt lgkmcnt(7)
    v_mfma_f32_32x32x16_bf16 v[64:79], v[144:147], v[164:167], v[64:79]
    ds_read_b128 v[160:163], v58 offset:32768
    ds_read_b64_tr_b16 v[128:129], v48 offset:40960
    ds_read_b64_tr_b16 v[130:131], v48 offset:41984
    s_waitcnt lgkmcnt(8)
    v_mfma_f32_32x32x16_bf16 v[80:95], v[148:151], v[164:167], v[80:95]
    ds_read_b64_tr_b16 v[132:133], v50 offset:40960
    ds_read_b64_tr_b16 v[134:135], v50 offset:41984
    ds_read_b128 v[168:171], v61 offset:32768
    s_waitcnt lgkmcnt(8)
    v_mfma_f32_32x32x16_bf16 v[96:111], v[152:155], v[164:167], v[96:111]
    ds_read_b64_tr_b16 v[136:137], v52 offset:40960
    ds_read_b64_tr_b16 v[138:139], v52 offset:41984
    v_mfma_f32_16x16x32_bf16 v[180:183], v[192:195], v[172:175], v[180:183]
    s_waitcnt lgkmcnt(8)
    v_mfma_f32_32x32x16_bf16 v[112:127], v[156:159], v[164:167], v[112:127]
    ds_read_b64_tr_b16 v[140:141], v54 offset:40960
    ds_read_b64_tr_b16 v[142:143], v54 offset:41984
    v_mfma_f32_16x16x32_bf16 v[188:191], v[172:175], v[172:175], v[188:191]
    s_waitcnt lgkmcnt(7)
    v_mfma_f32_32x32x16_bf16 v[64:79], v[128:131], v[160:163], v[64:79]
    ds_read_b128 v[164:167], v59 offset:32768
    ds_read_b64_tr_b16 v[144:145], v48 offset:45056
    ds_read_b64_tr_b16 v[146:147], v48 offset:46080
    s_waitcnt lgkmcnt(8)
    v_mfma_f32_32x32x16_bf16 v[80:95], v[132:135], v[160:163], v[80:95]
    ds_read_b64_tr_b16 v[148:149], v50 offset:45056
    ds_read_b64_tr_b16 v[150:151], v50 offset:46080
    ds_read_b128 v[172:175], v61 offset:34816
    s_waitcnt lgkmcnt(8)
    v_mfma_f32_32x32x16_bf16 v[96:111], v[136:139], v[160:163], v[96:111]
    ds_read_b64_tr_b16 v[152:153], v52 offset:45056
    ds_read_b64_tr_b16 v[154:155], v52 offset:46080
    v_mfma_f32_16x16x32_bf16 v[176:179], v[192:195], v[168:171], v[176:179]
    s_waitcnt lgkmcnt(8)
    v_mfma_f32_32x32x16_bf16 v[112:127], v[140:143], v[160:163], v[112:127]
    ds_read_b64_tr_b16 v[156:157], v54 offset:45056
    ds_read_b64_tr_b16 v[158:159], v54 offset:46080
    v_mfma_f32_16x16x32_bf16 v[184:187], v[168:171], v[168:171], v[184:187]
    s_waitcnt lgkmcnt(7)
    v_mfma_f32_32x32x16_bf16 v[64:79], v[144:147], v[164:167], v[64:79]
    s_barrier
    ds_read_b128 v[160:163], v56 offset:49152
    ds_read_b64_tr_b16 v[128:129], v48 offset:49152
    ds_read_b64_tr_b16 v[130:131], v48 offset:50176
    s_waitcnt lgkmcnt(8)
    v_mfma_f32_32x32x16_bf16 v[80:95], v[148:151], v[164:167], v[80:95]
    ds_read_b64_tr_b16 v[132:133], v50 offset:49152
    ds_read_b64_tr_b16 v[134:135], v50 offset:50176
    ds_read_b128 v[168:171], v60 offset:49152
    s_waitcnt lgkmcnt(8)
    v_mfma_f32_32x32x16_bf16 v[96:111], v[152:155], v[164:167], v[96:111]
    ds_read_b64_tr_b16 v[136:137], v52 offset:49152
    ds_read_b64_tr_b16 v[138:139], v52 offset:50176
    v_mfma_f32_16x16x32_bf16 v[180:183], v[192:195], v[172:175], v[180:183]
    s_waitcnt lgkmcnt(8)
    v_mfma_f32_32x32x16_bf16 v[112:127], v[156:159], v[164:167], v[112:127]
    ds_read_b64_tr_b16 v[140:141], v54 offset:49152
    ds_read_b64_tr_b16 v[142:143], v54 offset:50176
    v_mfma_f32_16x16x32_bf16 v[188:191], v[172:175], v[172:175], v[188:191]
    s_waitcnt lgkmcnt(7)
    v_mfma_f32_32x32x16_bf16 v[64:79], v[128:131], v[160:163], v[64:79]
    ds_read_b128 v[164:167], v57 offset:49152
    ds_read_b64_tr_b16 v[144:145], v48 offset:53248
    ds_read_b64_tr_b16 v[146:147], v48 offset:54272
    s_waitcnt lgkmcnt(8)
    v_mfma_f32_32x32x16_bf16 v[80:95], v[132:135], v[160:163], v[80:95]
    ds_read_b64_tr_b16 v[148:149], v50 offset:53248
    ds_read_b64_tr_b16 v[150:151], v50 offset:54272
    ds_read_b128 v[172:175], v60 offset:51200
    s_waitcnt lgkmcnt(8)
    v_mfma_f32_32x32x16_bf16 v[96:111], v[136:139], v[160:163], v[96:111]
    ds_read_b64_tr_b16 v[152:153], v52 offset:53248
    ds_read_b64_tr_b16 v[154:155], v52 offset:54272
    v_mfma_f32_16x16x32_bf16 v[176:179], v[192:195], v[168:171], v[176:179]
    s_waitcnt lgkmcnt(8)
    v_mfma_f32_32x32x16_bf16 v[112:127], v[140:143], v[160:163], v[112:127]
    ds_read_b64_tr_b16 v[156:157], v54 offset:53248
    ds_read_b64_tr_b16 v[158:159], v54 offset:54272
    v_mfma_f32_16x16x32_bf16 v[184:187], v[168:171], v[168:171], v[184:187]
    s_waitcnt lgkmcnt(7)
    v_mfma_f32_32x32x16_bf16 v[64:79], v[144:147], v[164:167], v[64:79]
    ds_read_b128 v[160:163], v58 offset:49152
    ds_read_b64_tr_b16 v[128:129], v48 offset:57344
    ds_read_b64_tr_b16 v[130:131], v48 offset:58368
    s_waitcnt lgkmcnt(8)
    v_mfma_f32_32x32x16_bf16 v[80:95], v[148:151], v[164:167], v[80:95]
    ds_read_b64_tr_b16 v[132:133], v50 offset:57344
    ds_read_b64_tr_b16 v[134:135], v50 offset:58368
    ds_read_b128 v[168:171], v61 offset:49152
    s_waitcnt lgkmcnt(8)
    v_mfma_f32_32x32x16_bf16 v[96:111], v[152:155], v[164:167], v[96:111]
    ds_read_b64_tr_b16 v[136:137], v52 offset:57344
    ds_read_b64_tr_b16 v[138:139], v52 offset:58368
    v_mfma_f32_16x16x32_bf16 v[180:183], v[192:195], v[172:175], v[180:183]
    s_waitcnt lgkmcnt(8)
    v_mfma_f32_32x32x16_bf16 v[112:127], v[156:159], v[164:167], v[112:127]
    ds_read_b64_tr_b16 v[140:141], v54 offset:57344
    ds_read_b64_tr_b16 v[142:143], v54 offset:58368
    v_mfma_f32_16x16x32_bf16 v[188:191], v[172:175], v[172:175], v[188:191]
    s_waitcnt lgkmcnt(7)
    v_mfma_f32_32x32x16_bf16 v[64:79], v[128:131], v[160:163], v[64:79]
    ds_read_b128 v[164:167], v59 offset:49152
    ds_read_b64_tr_b16 v[144:145], v48 offset:61440
    ds_read_b64_tr_b16 v[146:147], v48 offset:62464
    s_waitcnt lgkmcnt(8)
    v_mfma_f32_32x32x16_bf16 v[80:95], v[132:135], v[160:163], v[80:95]
    ds_read_b64_tr_b16 v[148:149], v50 offset:61440
    ds_read_b64_tr_b16 v[150:151], v50 offset:62464
    ds_read_b128 v[172:175], v61 offset:51200
    s_waitcnt lgkmcnt(8)
    v_mfma_f32_32x32x16_bf16 v[96:111], v[136:139], v[160:163], v[96:111]
    ds_read_b64_tr_b16 v[152:153], v52 offset:61440
    ds_read_b64_tr_b16 v[154:155], v52 offset:62464
    v_mfma_f32_16x16x32_bf16 v[176:179], v[192:195], v[168:171], v[176:179]
    s_waitcnt lgkmcnt(8)
    v_mfma_f32_32x32x16_bf16 v[112:127], v[140:143], v[160:163], v[112:127]
    ds_read_b64_tr_b16 v[156:157], v54 offset:61440
    ds_read_b64_tr_b16 v[158:159], v54 offset:62464
    v_mfma_f32_16x16x32_bf16 v[184:187], v[168:171], v[168:171], v[184:187]
    s_waitcnt lgkmcnt(7)
    v_mfma_f32_32x32x16_bf16 v[64:79], v[144:147], v[164:167], v[64:79]
    s_barrier
    ds_read_b128 v[160:163], v56 offset:0
    ds_read_b64_tr_b16 v[128:129], v48 offset:0
    ds_read_b64_tr_b16 v[130:131], v48 offset:1024
    s_waitcnt lgkmcnt(8)
    v_mfma_f32_32x32x16_bf16 v[80:95], v[148:151], v[164:167], v[80:95]
    ds_read_b64_tr_b16 v[132:133], v50 offset:0
    ds_read_b64_tr_b16 v[134:135], v50 offset:1024
    ds_read_b128 v[168:171], v60 offset:0
    s_waitcnt lgkmcnt(8)
    v_mfma_f32_32x32x16_bf16 v[96:111], v[152:155], v[164:167], v[96:111]
    ds_read_b64_tr_b16 v[136:137], v52 offset:0
    ds_read_b64_tr_b16 v[138:139], v52 offset:1024
    v_mfma_f32_16x16x32_bf16 v[180:183], v[192:195], v[172:175], v[180:183]
    s_waitcnt lgkmcnt(8)
    v_mfma_f32_32x32x16_bf16 v[112:127], v[156:159], v[164:167], v[112:127]
    ds_read_b64_tr_b16 v[140:141], v54 offset:0
    ds_read_b64_tr_b16 v[142:143], v54 offset:1024
    v_mfma_f32_16x16x32_bf16 v[188:191], v[172:175], v[172:175], v[188:191]
    s_waitcnt lgkmcnt(7)
    v_mfma_f32_32x32x16_bf16 v[64:79], v[128:131], v[160:163], v[64:79]
    ds_read_b128 v[164:167], v57 offset:0
    ds_read_b64_tr_b16 v[144:145], v48 offset:4096
    ds_read_b64_tr_b16 v[146:147], v48 offset:5120
    s_waitcnt lgkmcnt(8)
    v_mfma_f32_32x32x16_bf16 v[80:95], v[132:135], v[160:163], v[80:95]
    ds_read_b64_tr_b16 v[148:149], v50 offset:4096
    ds_read_b64_tr_b16 v[150:151], v50 offset:5120
    ds_read_b128 v[172:175], v60 offset:2048
    s_waitcnt lgkmcnt(8)
    v_mfma_f32_32x32x16_bf16 v[96:111], v[136:139], v[160:163], v[96:111]
    ds_read_b64_tr_b16 v[152:153], v52 offset:4096
    ds_read_b64_tr_b16 v[154:155], v52 offset:5120
    v_mfma_f32_16x16x32_bf16 v[176:179], v[192:195], v[168:171], v[176:179]
    s_waitcnt lgkmcnt(8)
    v_mfma_f32_32x32x16_bf16 v[112:127], v[140:143], v[160:163], v[112:127]
    ds_read_b64_tr_b16 v[156:157], v54 offset:4096
    ds_read_b64_tr_b16 v[158:159], v54 offset:5120
    v_mfma_f32_16x16x32_bf16 v[184:187], v[168:171], v[168:171], v[184:187]
    s_waitcnt lgkmcnt(7)
    v_mfma_f32_32x32x16_bf16 v[64:79], v[144:147], v[164:167], v[64:79]
    ds_read_b128 v[160:163], v58 offset:0
    ds_read_b64_tr_b16 v[128:129], v48 offset:8192
    ds_read_b64_tr_b16 v[130:131], v48 offset:9216
    s_waitcnt lgkmcnt(8)
    v_mfma_f32_32x32x16_bf16 v[80:95], v[148:151], v[164:167], v[80:95]
    ds_read_b64_tr_b16 v[132:133], v50 offset:8192
    ds_read_b64_tr_b16 v[134:135], v50 offset:9216
    ds_read_b128 v[168:171], v61 offset:0
    s_waitcnt lgkmcnt(8)
    v_mfma_f32_32x32x16_bf16 v[96:111], v[152:155], v[164:167], v[96:111]
    ds_read_b64_tr_b16 v[136:137], v52 offset:8192
    ds_read_b64_tr_b16 v[138:139], v52 offset:9216
    v_mfma_f32_16x16x32_bf16 v[180:183], v[192:195], v[172:175], v[180:183]
    s_waitcnt lgkmcnt(8)
    v_mfma_f32_32x32x16_bf16 v[112:127], v[156:159], v[164:167], v[112:127]
    ds_read_b64_tr_b16 v[140:141], v54 offset:8192
    ds_read_b64_tr_b16 v[142:143], v54 offset:9216
    v_mfma_f32_16x16x32_bf16 v[188:191], v[172:175], v[172:175], v[188:191]
    s_waitcnt lgkmcnt(7)
    v_mfma_f32_32x32x16_bf16 v[64:79], v[128:131], v[160:163], v[64:79]
    ds_read_b128 v[164:167], v59 offset:0
    ds_read_b64_tr_b16 v[144:145], v48 offset:12288
    ds_read_b64_tr_b16 v[146:147], v48 offset:13312
    s_waitcnt lgkmcnt(8)
    v_mfma_f32_32x32x16_bf16 v[80:95], v[132:135], v[160:163], v[80:95]
    ds_read_b64_tr_b16 v[148:149], v50 offset:12288
    ds_read_b64_tr_b16 v[150:151], v50 offset:13312
    ds_read_b128 v[172:175], v61 offset:2048
    s_waitcnt lgkmcnt(8)
    v_mfma_f32_32x32x16_bf16 v[96:111], v[136:139], v[160:163], v[96:111]
    ds_read_b64_tr_b16 v[152:153], v52 offset:12288
    ds_read_b64_tr_b16 v[154:155], v52 offset:13312
    v_mfma_f32_16x16x32_bf16 v[176:179], v[192:195], v[168:171], v[176:179]
    s_waitcnt lgkmcnt(8)
    v_mfma_f32_32x32x16_bf16 v[112:127], v[140:143], v[160:163], v[112:127]
    ds_read_b64_tr_b16 v[156:157], v54 offset:12288
    ds_read_b64_tr_b16 v[158:159], v54 offset:13312
    v_mfma_f32_16x16x32_bf16 v[184:187], v[168:171], v[168:171], v[184:187]
    s_waitcnt lgkmcnt(7)
    v_mfma_f32_32x32x16_bf16 v[64:79], v[144:147], v[164:167], v[64:79]
    s_barrier
    ds_read_b128 v[160:163], v56 offset:16384
    ds_read_b64_tr_b16 v[128:129], v48 offset:16384
    ds_read_b64_tr_b16 v[130:131], v48 offset:17408
    s_waitcnt lgkmcnt(8)
    v_mfma_f32_32x32x16_bf16 v[80:95], v[148:151], v[164:167], v[80:95]
    ds_read_b64_tr_b16 v[132:133], v50 offset:16384
    ds_read_b64_tr_b16 v[134:135], v50 offset:17408
    ds_read_b128 v[168:171], v60 offset:16384
    s_waitcnt lgkmcnt(8)
    v_mfma_f32_32x32x16_bf16 v[96:111], v[152:155], v[164:167], v[96:111]
    ds_read_b64_tr_b16 v[136:137], v52 offset:16384
    ds_read_b64_tr_b16 v[138:139], v52 offset:17408
    v_mfma_f32_16x16x32_bf16 v[180:183], v[192:195], v[172:175], v[180:183]
    s_waitcnt lgkmcnt(8)
    v_mfma_f32_32x32x16_bf16 v[112:127], v[156:159], v[164:167], v[112:127]
    ds_read_b64_tr_b16 v[140:141], v54 offset:16384
    ds_read_b64_tr_b16 v[142:143], v54 offset:17408
    v_mfma_f32_16x16x32_bf16 v[188:191], v[172:175], v[172:175], v[188:191]
    s_waitcnt lgkmcnt(7)
    v_mfma_f32_32x32x16_bf16 v[64:79], v[128:131], v[160:163], v[64:79]
    ds_read_b128 v[164:167], v57 offset:16384
    ds_read_b64_tr_b16 v[144:145], v48 offset:20480
    ds_read_b64_tr_b16 v[146:147], v48 offset:21504
    s_waitcnt lgkmcnt(8)
    v_mfma_f32_32x32x16_bf16 v[80:95], v[132:135], v[160:163], v[80:95]
    ds_read_b64_tr_b16 v[148:149], v50 offset:20480
    ds_read_b64_tr_b16 v[150:151], v50 offset:21504
    ds_read_b128 v[172:175], v60 offset:18432
    s_waitcnt lgkmcnt(8)
    v_mfma_f32_32x32x16_bf16 v[96:111], v[136:139], v[160:163], v[96:111]
    ds_read_b64_tr_b16 v[152:153], v52 offset:20480
    ds_read_b64_tr_b16 v[154:155], v52 offset:21504
    v_mfma_f32_16x16x32_bf16 v[176:179], v[192:195], v[168:171], v[176:179]
    s_waitcnt lgkmcnt(8)
    v_mfma_f32_32x32x16_bf16 v[112:127], v[140:143], v[160:163], v[112:127]
    ds_read_b64_tr_b16 v[156:157], v54 offset:20480
    ds_read_b64_tr_b16 v[158:159], v54 offset:21504
    v_mfma_f32_16x16x32_bf16 v[184:187], v[168:171], v[168:171], v[184:187]
    s_waitcnt lgkmcnt(7)
    v_mfma_f32_32x32x16_bf16 v[64:79], v[144:147], v[164:167], v[64:79]
    ds_read_b128 v[160:163], v58 offset:16384
    ds_read_b64_tr_b16 v[128:129], v48 offset:24576
    ds_read_b64_tr_b16 v[130:131], v48 offset:25600
    s_waitcnt lgkmcnt(8)
    v_mfma_f32_32x32x16_bf16 v[80:95], v[148:151], v[164:167], v[80:95]
    ds_read_b64_tr_b16 v[132:133], v50 offset:24576
    ds_read_b64_tr_b16 v[134:135], v50 offset:25600
    ds_read_b128 v[168:171], v61 offset:16384
    s_waitcnt lgkmcnt(8)
    v_mfma_f32_32x32x16_bf16 v[96:111], v[152:155], v[164:167], v[96:111]
    ds_read_b64_tr_b16 v[136:137], v52 offset:24576
    ds_read_b64_tr_b16 v[138:139], v52 offset:25600
    v_mfma_f32_16x16x32_bf16 v[180:183], v[192:195], v[172:175], v[180:183]
    s_waitcnt lgkmcnt(8)
    v_mfma_f32_32x32x16_bf16 v[112:127], v[156:159], v[164:167], v[112:127]
    ds_read_b64_tr_b16 v[140:141], v54 offset:24576
    ds_read_b64_tr_b16 v[142:143], v54 offset:25600
    v_mfma_f32_16x16x32_bf16 v[188:191], v[172:175], v[172:175], v[188:191]
    s_waitcnt lgkmcnt(7)
    v_mfma_f32_32x32x16_bf16 v[64:79], v[128:131], v[160:163], v[64:79]
    ds_read_b128 v[164:167], v59 offset:16384
    ds_read_b64_tr_b16 v[144:145], v48 offset:28672
    ds_read_b64_tr_b16 v[146:147], v48 offset:29696
    s_waitcnt lgkmcnt(8)
    v_mfma_f32_32x32x16_bf16 v[80:95], v[132:135], v[160:163], v[80:95]
    ds_read_b64_tr_b16 v[148:149], v50 offset:28672
    ds_read_b64_tr_b16 v[150:151], v50 offset:29696
    ds_read_b128 v[172:175], v61 offset:18432
    s_waitcnt lgkmcnt(8)
    v_mfma_f32_32x32x16_bf16 v[96:111], v[136:139], v[160:163], v[96:111]
    ds_read_b64_tr_b16 v[152:153], v52 offset:28672
    ds_read_b64_tr_b16 v[154:155], v52 offset:29696
    v_mfma_f32_16x16x32_bf16 v[176:179], v[192:195], v[168:171], v[176:179]
    s_waitcnt lgkmcnt(8)
    v_mfma_f32_32x32x16_bf16 v[112:127], v[140:143], v[160:163], v[112:127]
    ds_read_b64_tr_b16 v[156:157], v54 offset:28672
    ds_read_b64_tr_b16 v[158:159], v54 offset:29696
    v_mfma_f32_16x16x32_bf16 v[184:187], v[168:171], v[168:171], v[184:187]
    s_waitcnt lgkmcnt(7)
    v_mfma_f32_32x32x16_bf16 v[64:79], v[144:147], v[164:167], v[64:79]
    s_waitcnt lgkmcnt(5)
    v_mfma_f32_32x32x16_bf16 v[80:95], v[148:151], v[164:167], v[80:95]
    s_waitcnt lgkmcnt(2)
    v_mfma_f32_32x32x16_bf16 v[96:111], v[152:155], v[164:167], v[96:111]
    v_mfma_f32_16x16x32_bf16 v[180:183], v[192:195], v[172:175], v[180:183]
    s_waitcnt lgkmcnt(0)
    v_mfma_f32_32x32x16_bf16 v[112:127], v[156:159], v[164:167], v[112:127]
    v_mfma_f32_16x16x32_bf16 v[188:191], v[172:175], v[172:175], v[188:191]
    v_and_b32 v25, 3, v0
    v_and_b32 v26, 15, v0
    s_lshl_b32 s22, s20, 8
    s_add_u32 s22, s22, 152576
    v_lshlrev_b32 v26, 3, v26
    v_add_u32 v26, s22, v26
    v_lshlrev_b32 v24, 3, v5
    v_add_u32 v24, s22, v24
    v_cmp_eq_u32 vcc, 1, v25
    s_nop 1
    v_cndmask_b32 v184, v184, v185, vcc
    v_cndmask_b32 v188, v188, v189, vcc
    v_cmp_eq_u32 vcc, 2, v25
    s_nop 1
    v_cndmask_b32 v184, v184, v186, vcc
    v_cndmask_b32 v188, v188, v190, vcc
    v_cmp_eq_u32 vcc, 3, v25
    s_nop 1
    v_cndmask_b32 v184, v184, v187, vcc
    v_cndmask_b32 v188, v188, v191, vcc
    v_mov_b32 v177, v184
    v_mov_b32 v181, v188
    s_mov_b32 exec_lo, 0x00f0000f
    s_mov_b32 exec_hi, 0xf0000f00
    ds_write_b64 v26, v[176:177]
    ds_write_b64 v26, v[180:181] offset:128
    s_mov_b64 exec, -1
    ds_read_b64 v[8:9], v24
    s_barrier
    s_waitcnt lgkmcnt(0)
    v_mul_f32 v8, 0.5, v8
    v_mul_f32 v9, 0.5, v9
    ds_read_b128 v[188:191], v16 offset:0
    ds_read_b128 v[192:195], v16 offset:32
    ds_read_b128 v[196:199], v16 offset:64
    ds_read_b128 v[200:203], v16 offset:96
    ds_read_b128 v[204:207], v16 offset:128
    ds_read_b128 v[208:211], v16 offset:160
    ds_read_b128 v[212:215], v16 offset:192
    ds_read_b128 v[216:219], v16 offset:224
    ds_read_b128 v[220:223], v16 offset:256
    ds_read_b128 v[224:227], v16 offset:288
    ds_read_b128 v[228:231], v16 offset:320
    ds_read_b128 v[232:235], v16 offset:352
    ds_read_b128 v[236:239], v16 offset:384
    ds_read_b128 v[240:243], v16 offset:416
    ds_read_b128 v[244:247], v16 offset:448
    v_add_f32 v8, v8, v10
    v_add_f32 v9, v9, v11
    v_add_f32 v12, v12, v14
    v_add_f32 v13, v13, v15
    v_add_f32 v8, v8, v12
    v_add_f32 v9, v9, v13
    v_mov_b32 v10, v8
    s_nop 1
    v_permlane32_swap_b32 v8, v10
    v_add_f32 v8, v8, v10
    v_mov_b32 v11, v9
    s_nop 1
    v_permlane32_swap_b32 v9, v11
    v_add_f32 v9, v9, v11
    v_mul_f32 v8, 0x3acccccd, v8
    v_mul_f32 v9, 0x3acccccd, v9
    v_fma_f32 v9, -v8, v8, v9
    v_max_f32 v9, 0, v9
    v_add_f32 v10, 0x3727c5ac, v9
    v_rsq_f32 v10, v10
    s_nop 0
    v_mov_b32 v9, v10
    v_mul_f32 v36, s33, v9
    v_mul_f32 v42, -v8, v36
    v_mul_f32 v38, s34, v9
    v_mul_f32 v44, -v8, v38
    v_mul_f32 v40, s48, v9
    v_mul_f32 v46, -v8, v40
    s_waitcnt lgkmcnt(0)
    v_pk_mul_f32 v[188:189], v[188:189], v[42:43] op_sel_hi:[1,0]
    v_pk_mul_f32 v[190:191], v[190:191], v[42:43] op_sel_hi:[1,0]
    v_pk_mul_f32 v[192:193], v[192:193], v[42:43] op_sel_hi:[1,0]
    v_pk_mul_f32 v[194:195], v[194:195], v[42:43] op_sel_hi:[1,0]
    v_pk_mul_f32 v[196:197], v[196:197], v[42:43] op_sel_hi:[1,0]
    v_pk_mul_f32 v[198:199], v[198:199], v[42:43] op_sel_hi:[1,0]
    v_pk_mul_f32 v[200:201], v[200:201], v[42:43] op_sel_hi:[1,0]
    v_pk_mul_f32 v[202:203], v[202:203], v[42:43] op_sel_hi:[1,0]
    v_pk_mul_f32 v[204:205], v[204:205], v[44:45] op_sel_hi:[1,0]
    v_pk_mul_f32 v[206:207], v[206:207], v[44:45] op_sel_hi:[1,0]
    v_pk_mul_f32 v[208:209], v[208:209], v[44:45] op_sel_hi:[1,0]
    v_pk_mul_f32 v[210:211], v[210:211], v[44:45] op_sel_hi:[1,0]
    v_pk_mul_f32 v[212:213], v[212:213], v[44:45] op_sel_hi:[1,0]
    v_pk_mul_f32 v[214:215], v[214:215], v[44:45] op_sel_hi:[1,0]
    v_pk_mul_f32 v[216:217], v[216:217], v[44:45] op_sel_hi:[1,0]
    v_pk_mul_f32 v[218:219], v[218:219], v[44:45] op_sel_hi:[1,0]
    v_pk_mul_f32 v[220:221], v[220:221], v[46:47] op_sel_hi:[1,0]
    v_pk_mul_f32 v[222:223], v[222:223], v[46:47] op_sel_hi:[1,0]
    v_pk_mul_f32 v[224:225], v[224:225], v[46:47] op_sel_hi:[1,0]
    v_pk_mul_f32 v[226:227], v[226:227], v[46:47] op_sel_hi:[1,0]
    v_pk_mul_f32 v[228:229], v[228:229], v[46:47] op_sel_hi:[1,0]
    v_pk_mul_f32 v[230:231], v[230:231], v[46:47] op_sel_hi:[1,0]
    v_pk_mul_f32 v[232:233], v[232:233], v[46:47] op_sel_hi:[1,0]
    v_pk_mul_f32 v[234:235], v[234:235], v[46:47] op_sel_hi:[1,0]
    v_pk_mul_f32 v[236:237], v[236:237], v[42:43] op_sel_hi:[1,0]
    v_pk_mul_f32 v[238:239], v[238:239], v[42:43] op_sel_hi:[1,0]
    v_pk_mul_f32 v[240:241], v[240:241], v[44:45] op_sel_hi:[1,0]
    v_pk_mul_f32 v[242:243], v[242:243], v[44:45] op_sel_hi:[1,0]
    v_pk_mul_f32 v[244:245], v[244:245], v[46:47] op_sel_hi:[1,0]
    v_pk_mul_f32 v[246:247], v[246:247], v[46:47] op_sel_hi:[1,0]
    v_pk_fma_f32 v[64:65], v[64:65], v[36:37], v[188:189] op_sel_hi:[1,0,1]
    v_pk_fma_f32 v[66:67], v[66:67], v[36:37], v[190:191] op_sel_hi:[1,0,1]
    v_cvt_pk_bf16_f32 v64, v64, v65
    v_cvt_pk_bf16_f32 v65, v66, v67
    v_pk_fma_f32 v[68:69], v[68:69], v[36:37], v[192:193] op_sel_hi:[1,0,1]
    v_pk_fma_f32 v[70:71], v[70:71], v[36:37], v[194:195] op_sel_hi:[1,0,1]
    v_cvt_pk_bf16_f32 v66, v68, v69
    v_cvt_pk_bf16_f32 v67, v70, v71
    buffer_store_dwordx4 v[64:67], v32, s[4:7], s39 offen
    v_pk_fma_f32 v[72:73], v[72:73], v[36:37], v[196:197] op_sel_hi:[1,0,1]
    v_pk_fma_f32 v[74:75], v[74:75], v[36:37], v[198:199] op_sel_hi:[1,0,1]
    v_cvt_pk_bf16_f32 v72, v72, v73
    v_cvt_pk_bf16_f32 v73, v74, v75
    v_pk_fma_f32 v[76:77], v[76:77], v[36:37], v[200:201] op_sel_hi:[1,0,1]
    v_pk_fma_f32 v[78:79], v[78:79], v[36:37], v[202:203] op_sel_hi:[1,0,1]
    v_cvt_pk_bf16_f32 v74, v76, v77
    v_cvt_pk_bf16_f32 v75, v78, v79
    buffer_store_dwordx4 v[72:75], v32, s[4:7], s40 offen
    v_pk_fma_f32 v[80:81], v[80:81], v[38:39], v[204:205] op_sel_hi:[1,0,1]
    v_pk_fma_f32 v[82:83], v[82:83], v[38:39], v[206:207] op_sel_hi:[1,0,1]
    v_cvt_pk_bf16_f32 v80, v80, v81
    v_cvt_pk_bf16_f32 v81, v82, v83
    v_pk_fma_f32 v[84:85], v[84:85], v[38:39], v[208:209] op_sel_hi:[1,0,1]
    v_pk_fma_f32 v[86:87], v[86:87], v[38:39], v[210:211] op_sel_hi:[1,0,1]
    v_cvt_pk_bf16_f32 v82, v84, v85
    v_cvt_pk_bf16_f32 v83, v86, v87
    buffer_store_dwordx4 v[80:83], v32, s[4:7], s42 offen
    v_pk_fma_f32 v[88:89], v[88:89], v[38:39], v[212:213] op_sel_hi:[1,0,1]
    v_pk_fma_f32 v[90:91], v[90:91], v[38:39], v[214:215] op_sel_hi:[1,0,1]
    v_cvt_pk_bf16_f32 v88, v88, v89
    v_cvt_pk_bf16_f32 v89, v90, v91
    v_pk_fma_f32 v[92:93], v[92:93], v[38:39], v[216:217] op_sel_hi:[1,0,1]
    v_pk_fma_f32 v[94:95], v[94:95], v[38:39], v[218:219] op_sel_hi:[1,0,1]
    v_cvt_pk_bf16_f32 v90, v92, v93
    v_cvt_pk_bf16_f32 v91, v94, v95
    buffer_store_dwordx4 v[88:91], v32, s[4:7], s43 offen
    v_pk_fma_f32 v[96:97], v[96:97], v[40:41], v[220:221] op_sel_hi:[1,0,1]
    v_pk_fma_f32 v[98:99], v[98:99], v[40:41], v[222:223] op_sel_hi:[1,0,1]
    v_cvt_pk_bf16_f32 v96, v96, v97
    v_cvt_pk_bf16_f32 v97, v98, v99
    v_pk_fma_f32 v[100:101], v[100:101], v[40:41], v[224:225] op_sel_hi:[1,0,1]
    v_pk_fma_f32 v[102:103], v[102:103], v[40:41], v[226:227] op_sel_hi:[1,0,1]
    v_cvt_pk_bf16_f32 v98, v100, v101
    v_cvt_pk_bf16_f32 v99, v102, v103
    buffer_store_dwordx4 v[96:99], v32, s[4:7], s45 offen
    v_pk_fma_f32 v[104:105], v[104:105], v[40:41], v[228:229] op_sel_hi:[1,0,1]
    v_pk_fma_f32 v[106:107], v[106:107], v[40:41], v[230:231] op_sel_hi:[1,0,1]
    v_cvt_pk_bf16_f32 v104, v104, v105
    v_cvt_pk_bf16_f32 v105, v106, v107
    v_pk_fma_f32 v[108:109], v[108:109], v[40:41], v[232:233] op_sel_hi:[1,0,1]
    v_pk_fma_f32 v[110:111], v[110:111], v[40:41], v[234:235] op_sel_hi:[1,0,1]
    v_cvt_pk_bf16_f32 v106, v108, v109
    v_cvt_pk_bf16_f32 v107, v110, v111
    buffer_store_dwordx4 v[104:107], v32, s[4:7], s46 offen
    v_pk_fma_f32 v[112:113], v[112:113], v[36:37], v[236:237] op_sel_hi:[1,0,1]
    v_pk_fma_f32 v[114:115], v[114:115], v[36:37], v[238:239] op_sel_hi:[1,0,1]
    v_cvt_pk_bf16_f32 v112, v112, v113
    v_cvt_pk_bf16_f32 v113, v114, v115
    buffer_store_dwordx2 v[112:113], v33, s[4:7], s41 offen
    v_pk_fma_f32 v[116:117], v[116:117], v[38:39], v[240:241] op_sel_hi:[1,0,1]
    v_pk_fma_f32 v[118:119], v[118:119], v[38:39], v[242:243] op_sel_hi:[1,0,1]
    v_cvt_pk_bf16_f32 v116, v116, v117
    v_cvt_pk_bf16_f32 v117, v118, v119
    buffer_store_dwordx2 v[116:117], v34, s[4:7], s44 offen
    v_pk_fma_f32 v[120:121], v[120:121], v[40:41], v[244:245] op_sel_hi:[1,0,1]
    v_pk_fma_f32 v[122:123], v[122:123], v[40:41], v[246:247] op_sel_hi:[1,0,1]
    v_cvt_pk_bf16_f32 v120, v120, v121
    v_cvt_pk_bf16_f32 v121, v122, v123
    buffer_store_dwordx2 v[120:121], v35, s[4:7], s47 offen
    s_branch L_fin_3
L_vpath_25:
    v_bfe_u32 v24, v0, 2, 2
    v_lshrrev_b32 v25, 5, v0
    v_lshl_add_u32 v25, v25, 3, v24
    v_lshlrev_b32 v25, 8, v25
    v_lshlrev_b32 v24, 6, v24
    v_bfe_u32 v26, v0, 4, 1
    v_and_b32 v27, 3, v0
    v_mul_u32_u24 v28, 32, v26
    v_add_u32 v28, 0, v28
    v_mul_u32_u24 v48, 8, v27
    v_add_u32 v28, v28, v48
    v_and_b32 v28, 0xff, v28
    v_xor_b32 v28, v28, v24
    v_add_u32 v48, v28, v25
    v_mul_u32_u24 v28, 32, v26
    v_add_u32 v28, 64, v28
    v_mul_u32_u24 v50, 8, v27
    v_add_u32 v28, v28, v50
    v_and_b32 v28, 0xff, v28
    v_xor_b32 v28, v28, v24
    v_add_u32 v50, v28, v25
    v_mul_u32_u24 v28, 32, v26
    v_add_u32 v28, 128, v28
    v_mul_u32_u24 v52, 8, v27
    v_add_u32 v28, v28, v52
    v_and_b32 v28, 0xff, v28
    v_xor_b32 v28, v28, v24
    v_add_u32 v52, v28, v25
    v_mul_u32_u24 v28, 32, v26
    v_add_u32 v28, 192, v28
    v_mul_u32_u24 v54, 8, v27
    v_add_u32 v28, v28, v54
    v_and_b32 v28, 0xff, v28
    v_xor_b32 v28, v28, v24
    v_add_u32 v54, v28, v25
    v_and_b32 v24, 31, v0
    v_bfe_u32 v25, v0, 1, 3
    v_lshrrev_b32 v26, 5, v0
    v_xor_b32 v25, v25, v26
    v_lshlrev_b32 v24, 7, v24
    s_lshl_b32 s22, s20, 12
    s_add_u32 s22, s22, 65536
    v_add_u32 v24, s22, v24
    v_xor_b32 v26, 0, v25
    v_lshl_add_u32 v56, v26, 4, v24
    v_xor_b32 v26, 2, v25
    v_lshl_add_u32 v57, v26, 4, v24
    v_xor_b32 v26, 4, v25
    v_lshl_add_u32 v58, v26, 4, v24
    v_xor_b32 v26, 6, v25
    v_lshl_add_u32 v59, v26, 4, v24
    v_and_b32 v24, 15, v0
    v_lshrrev_b32 v25, 4, v0
    v_bfe_u32 v60, v0, 1, 3
    v_xor_b32 v60, v60, v25
    v_xor_b32 v61, 4, v60
    v_lshlrev_b32 v24, 7, v24
    v_add_u32 v24, s22, v24
    v_lshl_add_u32 v60, v60, 4, v24
    v_lshl_add_u32 v61, v61, 4, v24
    v_mov_b32 v192, 0x3f803f80
    v_mov_b32 v193, 0x3f803f80
    v_mov_b32 v194, 0x3f803f80
    v_mov_b32 v195, 0x3f803f80
    v_mov_b32 v10, 0
    v_mov_b32 v11, 0
    v_mov_b32 v12, 0
    v_mov_b32 v13, 0
    v_mov_b32 v14, 0
    v_mov_b32 v15, 0
    v_lshlrev_b32 v16, 2, v5
    v_add_u32 v23, 151552, v16
    s_sub_u32 s35, s27, 11
    s_lshl_b32 s46, s35, 7
    s_mul_i32 s42, s33, 5120
    s_mul_i32 s43, s34, 1280
    s_add_u32 s42, s42, s43
    s_add_u32 s42, s42, s32
    s_add_u32 s42, s42, 2560
    s_mov_b32 s47, 52429
    s_movk_i32 s36, 10240
    v_mul_u32_u24 v17, 320, v6
    s_add_u32 s48, s46, 0
    v_add_u32 v20, s48, v5
    v_mul_u32_u24 v21, s47, v20
    v_lshrrev_b32 v21, 20, v21
    v_mul_u32_u24 v22, 20, v21
    v_sub_u32 v22, v20, v22
    v_mul_u32_u24 v21, s36, v21
    v_lshl_add_u32 v21, v22, 4, v21
    v_add_u32 v32, v21, v17
    s_add_u32 s48, s46, 32
    v_add_u32 v20, s48, v5
    v_mul_u32_u24 v21, s47, v20
    v_lshrrev_b32 v21, 20, v21
    v_mul_u32_u24 v22, 20, v21
    v_sub_u32 v22, v20, v22
    v_mul_u32_u24 v21, s36, v21
    v_lshl_add_u32 v21, v22, 4, v21
    v_add_u32 v33, v21, v17
    s_add_u32 s48, s46, 64
    v_add_u32 v20, s48, v5
    v_mul_u32_u24 v21, s47, v20
    v_lshrrev_b32 v21, 20, v21
    v_mul_u32_u24 v22, 20, v21
    v_sub_u32 v22, v20, v22
    v_mul_u32_u24 v21, s36, v21
    v_lshl_add_u32 v21, v22, 4, v21
    v_add_u32 v34, v21, v17
    s_add_u32 s48, s46, 96
    v_add_u32 v20, s48, v5
    v_mul_u32_u24 v21, s47, v20
    v_lshrrev_b32 v21, 20, v21
    v_mul_u32_u24 v22, 20, v21
    v_sub_u32 v22, v20, v22
    v_mul_u32_u24 v21, s36, v21
    v_lshl_add_u32 v21, v22, 4, v21
    v_add_u32 v35, v21, v17
    s_lshl_b32 s49, s20, 8
    s_add_u32 s49, s49, 155648
    v_add_u32 v18, s49, v16
    v_lshlrev_b32 v19, 4, v6
    v_add_u32 v19, s49, v19
    s_barrier
    ds_read_b128 v[160:163], v56 offset:0
    ds_read_b64_tr_b16 v[128:129], v48 offset:0
    ds_read_b64_tr_b16 v[130:131], v48 offset:1024
    ds_read_b64_tr_b16 v[132:133], v50 offset:0
    ds_read_b64_tr_b16 v[134:135], v50 offset:1024
    ds_read_b128 v[168:171], v60 offset:0
    ds_read_b64_tr_b16 v[136:137], v52 offset:0
    ds_read_b64_tr_b16 v[138:139], v52 offset:1024
    ds_read_b64_tr_b16 v[140:141], v54 offset:0
    ds_read_b64_tr_b16 v[142:143], v54 offset:1024
    s_waitcnt lgkmcnt(7)
    v_mfma_f32_32x32x16_bf16 v[64:79], v[160:163], v[128:131], 0
    ds_read_b128 v[164:167], v57 offset:0
    ds_read_b64_tr_b16 v[144:145], v48 offset:4096
    ds_read_b64_tr_b16 v[146:147], v48 offset:5120
    s_waitcnt lgkmcnt(8)
    v_mfma_f32_32x32x16_bf16 v[80:95], v[160:163], v[132:135], 0
    ds_read_b64_tr_b16 v[148:149], v50 offset:4096
    ds_read_b64_tr_b16 v[150:151], v50 offset:5120
    ds_read_b128 v[172:175], v60 offset:2048
    s_waitcnt lgkmcnt(8)
    v_mfma_f32_32x32x16_bf16 v[96:111], v[160:163], v[136:139], 0
    ds_read_b64_tr_b16 v[152:153], v52 offset:4096
    ds_read_b64_tr_b16 v[154:155], v52 offset:5120
    v_mfma_f32_16x16x32_bf16 v[176:179], v[192:195], v[168:171], 0
    s_waitcnt lgkmcnt(8)
    v_mfma_f32_32x32x16_bf16 v[112:127], v[160:163], v[140:143], 0
    ds_read_b64_tr_b16 v[156:157], v54 offset:4096
    ds_read_b64_tr_b16 v[158:159], v54 offset:5120
    v_mfma_f32_16x16x32_bf16 v[184:187], v[168:171], v[168:171], 0
    s_waitcnt lgkmcnt(7)
    v_mfma_f32_32x32x16_bf16 v[64:79], v[164:167], v[144:147], v[64:79]
    ds_read_b128 v[160:163], v58 offset:0
    ds_read_b64_tr_b16 v[128:129], v48 offset:8192
    ds_read_b64_tr_b16 v[130:131], v48 offset:9216
    s_waitcnt lgkmcnt(8)
    v_mfma_f32_32x32x16_bf16 v[80:95], v[164:167], v[148:151], v[80:95]
    ds_read_b64_tr_b16 v[132:133], v50 offset:8192
    ds_read_b64_tr_b16 v[134:135], v50 offset:9216
    ds_read_b128 v[168:171], v61 offset:0
    s_waitcnt lgkmcnt(8)
    v_mfma_f32_32x32x16_bf16 v[96:111], v[164:167], v[152:155], v[96:111]
    ds_read_b64_tr_b16 v[136:137], v52 offset:8192
    ds_read_b64_tr_b16 v[138:139], v52 offset:9216
    v_mfma_f32_16x16x32_bf16 v[180:183], v[192:195], v[172:175], 0
    s_waitcnt lgkmcnt(8)
    v_mfma_f32_32x32x16_bf16 v[112:127], v[164:167], v[156:159], v[112:127]
    ds_read_b64_tr_b16 v[140:141], v54 offset:8192
    ds_read_b64_tr_b16 v[142:143], v54 offset:9216
    v_mfma_f32_16x16x32_bf16 v[188:191], v[172:175], v[172:175], 0
    s_waitcnt lgkmcnt(7)
    v_mfma_f32_32x32x16_bf16 v[64:79], v[160:163], v[128:131], v[64:79]
    ds_read_b128 v[164:167], v59 offset:0
    ds_read_b64_tr_b16 v[144:145], v48 offset:12288
    ds_read_b64_tr_b16 v[146:147], v48 offset:13312
    s_waitcnt lgkmcnt(8)
    v_mfma_f32_32x32x16_bf16 v[80:95], v[160:163], v[132:135], v[80:95]
    ds_read_b64_tr_b16 v[148:149], v50 offset:12288
    ds_read_b64_tr_b16 v[150:151], v50 offset:13312
    ds_read_b128 v[172:175], v61 offset:2048
    s_waitcnt lgkmcnt(8)
    v_mfma_f32_32x32x16_bf16 v[96:111], v[160:163], v[136:139], v[96:111]
    ds_read_b64_tr_b16 v[152:153], v52 offset:12288
    ds_read_b64_tr_b16 v[154:155], v52 offset:13312
    v_mfma_f32_16x16x32_bf16 v[176:179], v[192:195], v[168:171], v[176:179]
    s_waitcnt lgkmcnt(8)
    v_mfma_f32_32x32x16_bf16 v[112:127], v[160:163], v[140:143], v[112:127]
    ds_read_b64_tr_b16 v[156:157], v54 offset:12288
    ds_read_b64_tr_b16 v[158:159], v54 offset:13312
    v_mfma_f32_16x16x32_bf16 v[184:187], v[168:171], v[168:171], v[184:187]
    s_waitcnt lgkmcnt(7)
    v_mfma_f32_32x32x16_bf16 v[64:79], v[164:167], v[144:147], v[64:79]
    s_barrier
    ds_read_b128 v[160:163], v56 offset:16384
    ds_read_b64_tr_b16 v[128:129], v48 offset:16384
    ds_read_b64_tr_b16 v[130:131], v48 offset:17408
    s_waitcnt lgkmcnt(8)
    v_mfma_f32_32x32x16_bf16 v[80:95], v[164:167], v[148:151], v[80:95]
    ds_read_b64_tr_b16 v[132:133], v50 offset:16384
    ds_read_b64_tr_b16 v[134:135], v50 offset:17408
    ds_read_b128 v[168:171], v60 offset:16384
    s_waitcnt lgkmcnt(8)
    v_mfma_f32_32x32x16_bf16 v[96:111], v[164:167], v[152:155], v[96:111]
    ds_read_b64_tr_b16 v[136:137], v52 offset:16384
    ds_read_b64_tr_b16 v[138:139], v52 offset:17408
    v_mfma_f32_16x16x32_bf16 v[180:183], v[192:195], v[172:175], v[180:183]
    s_waitcnt lgkmcnt(8)
    v_mfma_f32_32x32x16_bf16 v[112:127], v[164:167], v[156:159], v[112:127]
    ds_read_b64_tr_b16 v[140:141], v54 offset:16384
    ds_read_b64_tr_b16 v[142:143], v54 offset:17408
    v_mfma_f32_16x16x32_bf16 v[188:191], v[172:175], v[172:175], v[188:191]
    s_waitcnt lgkmcnt(7)
    v_mfma_f32_32x32x16_bf16 v[64:79], v[160:163], v[128:131], v[64:79]
    ds_read_b128 v[164:167], v57 offset:16384
    ds_read_b64_tr_b16 v[144:145], v48 offset:20480
    ds_read_b64_tr_b16 v[146:147], v48 offset:21504
    s_waitcnt lgkmcnt(8)
    v_mfma_f32_32x32x16_bf16 v[80:95], v[160:163], v[132:135], v[80:95]
    ds_read_b64_tr_b16 v[148:149], v50 offset:20480
    ds_read_b64_tr_b16 v[150:151], v50 offset:21504
    ds_read_b128 v[172:175], v60 offset:18432
    s_waitcnt lgkmcnt(8)
    v_mfma_f32_32x32x16_bf16 v[96:111], v[160:163], v[136:139], v[96:111]
    ds_read_b64_tr_b16 v[152:153], v52 offset:20480
    ds_read_b64_tr_b16 v[154:155], v52 offset:21504
    v_mfma_f32_16x16x32_bf16 v[176:179], v[192:195], v[168:171], v[176:179]
    s_waitcnt lgkmcnt(8)
    v_mfma_f32_32x32x16_bf16 v[112:127], v[160:163], v[140:143], v[112:127]
    ds_read_b64_tr_b16 v[156:157], v54 offset:20480
    ds_read_b64_tr_b16 v[158:159], v54 offset:21504
    v_mfma_f32_16x16x32_bf16 v[184:187], v[168:171], v[168:171], v[184:187]
    s_waitcnt lgkmcnt(7)
    v_mfma_f32_32x32x16_bf16 v[64:79], v[164:167], v[144:147], v[64:79]
    ds_read_b128 v[160:163], v58 offset:16384
    ds_read_b64_tr_b16 v[128:129], v48 offset:24576
    ds_read_b64_tr_b16 v[130:131], v48 offset:25600
    s_waitcnt lgkmcnt(8)
    v_mfma_f32_32x32x16_bf16 v[80:95], v[164:167], v[148:151], v[80:95]
    ds_read_b64_tr_b16 v[132:133], v50 offset:24576
    ds_read_b64_tr_b16 v[134:135], v50 offset:25600
    ds_read_b128 v[168:171], v61 offset:16384
    s_waitcnt lgkmcnt(8)
    v_mfma_f32_32x32x16_bf16 v[96:111], v[164:167], v[152:155], v[96:111]
    ds_read_b64_tr_b16 v[136:137], v52 offset:24576
    ds_read_b64_tr_b16 v[138:139], v52 offset:25600
    v_mfma_f32_16x16x32_bf16 v[180:183], v[192:195], v[172:175], v[180:183]
    s_waitcnt lgkmcnt(8)
    v_mfma_f32_32x32x16_bf16 v[112:127], v[164:167], v[156:159], v[112:127]
    ds_read_b64_tr_b16 v[140:141], v54 offset:24576
    ds_read_b64_tr_b16 v[142:143], v54 offset:25600
    v_mfma_f32_16x16x32_bf16 v[188:191], v[172:175], v[172:175], v[188:191]
    s_waitcnt lgkmcnt(7)
    v_mfma_f32_32x32x16_bf16 v[64:79], v[160:163], v[128:131], v[64:79]
    ds_read_b128 v[164:167], v59 offset:16384
    ds_read_b64_tr_b16 v[144:145], v48 offset:28672
    ds_read_b64_tr_b16 v[146:147], v48 offset:29696
    s_waitcnt lgkmcnt(8)
    v_mfma_f32_32x32x16_bf16 v[80:95], v[160:163], v[132:135], v[80:95]
    ds_read_b64_tr_b16 v[148:149], v50 offset:28672
    ds_read_b64_tr_b16 v[150:151], v50 offset:29696
    ds_read_b128 v[172:175], v61 offset:18432
    s_waitcnt lgkmcnt(8)
    v_mfma_f32_32x32x16_bf16 v[96:111], v[160:163], v[136:139], v[96:111]
    ds_read_b64_tr_b16 v[152:153], v52 offset:28672
    ds_read_b64_tr_b16 v[154:155], v52 offset:29696
    v_mfma_f32_16x16x32_bf16 v[176:179], v[192:195], v[168:171], v[176:179]
    s_waitcnt lgkmcnt(8)
    v_mfma_f32_32x32x16_bf16 v[112:127], v[160:163], v[140:143], v[112:127]
    ds_read_b64_tr_b16 v[156:157], v54 offset:28672
    ds_read_b64_tr_b16 v[158:159], v54 offset:29696
    v_mfma_f32_16x16x32_bf16 v[184:187], v[168:171], v[168:171], v[184:187]
    s_waitcnt lgkmcnt(7)
    v_mfma_f32_32x32x16_bf16 v[64:79], v[164:167], v[144:147], v[64:79]
    s_barrier
    ds_read_b128 v[160:163], v56 offset:32768
    ds_read_b64_tr_b16 v[128:129], v48 offset:32768
    ds_read_b64_tr_b16 v[130:131], v48 offset:33792
    s_waitcnt lgkmcnt(8)
    v_mfma_f32_32x32x16_bf16 v[80:95], v[164:167], v[148:151], v[80:95]
    ds_read_b64_tr_b16 v[132:133], v50 offset:32768
    ds_read_b64_tr_b16 v[134:135], v50 offset:33792
    ds_read_b128 v[168:171], v60 offset:32768
    s_waitcnt lgkmcnt(8)
    v_mfma_f32_32x32x16_bf16 v[96:111], v[164:167], v[152:155], v[96:111]
    ds_read_b64_tr_b16 v[136:137], v52 offset:32768
    ds_read_b64_tr_b16 v[138:139], v52 offset:33792
    v_mfma_f32_16x16x32_bf16 v[180:183], v[192:195], v[172:175], v[180:183]
    s_waitcnt lgkmcnt(8)
    v_mfma_f32_32x32x16_bf16 v[112:127], v[164:167], v[156:159], v[112:127]
    ds_read_b64_tr_b16 v[140:141], v54 offset:32768
    ds_read_b64_tr_b16 v[142:143], v54 offset:33792
    v_mfma_f32_16x16x32_bf16 v[188:191], v[172:175], v[172:175], v[188:191]
    s_waitcnt lgkmcnt(7)
    v_mfma_f32_32x32x16_bf16 v[64:79], v[160:163], v[128:131], v[64:79]
    ds_read_b128 v[164:167], v57 offset:32768
    ds_read_b64_tr_b16 v[144:145], v48 offset:36864
    ds_read_b64_tr_b16 v[146:147], v48 offset:37888
    s_waitcnt lgkmcnt(8)
    v_mfma_f32_32x32x16_bf16 v[80:95], v[160:163], v[132:135], v[80:95]
    ds_read_b64_tr_b16 v[148:149], v50 offset:36864
    ds_read_b64_tr_b16 v[150:151], v50 offset:37888
    ds_read_b128 v[172:175], v60 offset:34816
    s_waitcnt lgkmcnt(8)
    v_mfma_f32_32x32x16_bf16 v[96:111], v[160:163], v[136:139], v[96:111]
    ds_read_b64_tr_b16 v[152:153], v52 offset:36864
    ds_read_b64_tr_b16 v[154:155], v52 offset:37888
    v_mfma_f32_16x16x32_bf16 v[176:179], v[192:195], v[168:171], v[176:179]
    s_waitcnt lgkmcnt(8)
    v_mfma_f32_32x32x16_bf16 v[112:127], v[160:163], v[140:143], v[112:127]
    ds_read_b64_tr_b16 v[156:157], v54 offset:36864
    ds_read_b64_tr_b16 v[158:159], v54 offset:37888
    v_mfma_f32_16x16x32_bf16 v[184:187], v[168:171], v[168:171], v[184:187]
    s_waitcnt lgkmcnt(7)
    v_mfma_f32_32x32x16_bf16 v[64:79], v[164:167], v[144:147], v[64:79]
    ds_read_b128 v[160:163], v58 offset:32768
    ds_read_b64_tr_b16 v[128:129], v48 offset:40960
    ds_read_b64_tr_b16 v[130:131], v48 offset:41984
    s_waitcnt lgkmcnt(8)
    v_mfma_f32_32x32x16_bf16 v[80:95], v[164:167], v[148:151], v[80:95]
    ds_read_b64_tr_b16 v[132:133], v50 offset:40960
    ds_read_b64_tr_b16 v[134:135], v50 offset:41984
    ds_read_b128 v[168:171], v61 offset:32768
    s_waitcnt lgkmcnt(8)
    v_mfma_f32_32x32x16_bf16 v[96:111], v[164:167], v[152:155], v[96:111]
    ds_read_b64_tr_b16 v[136:137], v52 offset:40960
    ds_read_b64_tr_b16 v[138:139], v52 offset:41984
    v_mfma_f32_16x16x32_bf16 v[180:183], v[192:195], v[172:175], v[180:183]
    s_waitcnt lgkmcnt(8)
    v_mfma_f32_32x32x16_bf16 v[112:127], v[164:167], v[156:159], v[112:127]
    ds_read_b64_tr_b16 v[140:141], v54 offset:40960
    ds_read_b64_tr_b16 v[142:143], v54 offset:41984
    v_mfma_f32_16x16x32_bf16 v[188:191], v[172:175], v[172:175], v[188:191]
    s_waitcnt lgkmcnt(7)
    v_mfma_f32_32x32x16_bf16 v[64:79], v[160:163], v[128:131], v[64:79]
    ds_read_b128 v[164:167], v59 offset:32768
    ds_read_b64_tr_b16 v[144:145], v48 offset:45056
    ds_read_b64_tr_b16 v[146:147], v48 offset:46080
    s_waitcnt lgkmcnt(8)
    v_mfma_f32_32x32x16_bf16 v[80:95], v[160:163], v[132:135], v[80:95]
    ds_read_b64_tr_b16 v[148:149], v50 offset:45056
    ds_read_b64_tr_b16 v[150:151], v50 offset:46080
    ds_read_b128 v[172:175], v61 offset:34816
    s_waitcnt lgkmcnt(8)
    v_mfma_f32_32x32x16_bf16 v[96:111], v[160:163], v[136:139], v[96:111]
    ds_read_b64_tr_b16 v[152:153], v52 offset:45056
    ds_read_b64_tr_b16 v[154:155], v52 offset:46080
    v_mfma_f32_16x16x32_bf16 v[176:179], v[192:195], v[168:171], v[176:179]
    s_waitcnt lgkmcnt(8)
    v_mfma_f32_32x32x16_bf16 v[112:127], v[160:163], v[140:143], v[112:127]
    ds_read_b64_tr_b16 v[156:157], v54 offset:45056
    ds_read_b64_tr_b16 v[158:159], v54 offset:46080
    v_mfma_f32_16x16x32_bf16 v[184:187], v[168:171], v[168:171], v[184:187]
    s_waitcnt lgkmcnt(7)
    v_mfma_f32_32x32x16_bf16 v[64:79], v[164:167], v[144:147], v[64:79]
    s_barrier
    ds_read_b128 v[160:163], v56 offset:49152
    ds_read_b64_tr_b16 v[128:129], v48 offset:49152
    ds_read_b64_tr_b16 v[130:131], v48 offset:50176
    s_waitcnt lgkmcnt(8)
    v_mfma_f32_32x32x16_bf16 v[80:95], v[164:167], v[148:151], v[80:95]
    ds_read_b64_tr_b16 v[132:133], v50 offset:49152
    ds_read_b64_tr_b16 v[134:135], v50 offset:50176
    ds_read_b128 v[168:171], v60 offset:49152
    s_waitcnt lgkmcnt(8)
    v_mfma_f32_32x32x16_bf16 v[96:111], v[164:167], v[152:155], v[96:111]
    ds_read_b64_tr_b16 v[136:137], v52 offset:49152
    ds_read_b64_tr_b16 v[138:139], v52 offset:50176
    v_mfma_f32_16x16x32_bf16 v[180:183], v[192:195], v[172:175], v[180:183]
    s_waitcnt lgkmcnt(8)
    v_mfma_f32_32x32x16_bf16 v[112:127], v[164:167], v[156:159], v[112:127]
    ds_read_b64_tr_b16 v[140:141], v54 offset:49152
    ds_read_b64_tr_b16 v[142:143], v54 offset:50176
    v_mfma_f32_16x16x32_bf16 v[188:191], v[172:175], v[172:175], v[188:191]
    s_waitcnt lgkmcnt(7)
    v_mfma_f32_32x32x16_bf16 v[64:79], v[160:163], v[128:131], v[64:79]
    ds_read_b128 v[164:167], v57 offset:49152
    ds_read_b64_tr_b16 v[144:145], v48 offset:53248
    ds_read_b64_tr_b16 v[146:147], v48 offset:54272
    s_waitcnt lgkmcnt(8)
    v_mfma_f32_32x32x16_bf16 v[80:95], v[160:163], v[132:135], v[80:95]
    ds_read_b64_tr_b16 v[148:149], v50 offset:53248
    ds_read_b64_tr_b16 v[150:151], v50 offset:54272
    ds_read_b128 v[172:175], v60 offset:51200
    s_waitcnt lgkmcnt(8)
    v_mfma_f32_32x32x16_bf16 v[96:111], v[160:163], v[136:139], v[96:111]
    ds_read_b64_tr_b16 v[152:153], v52 offset:53248
    ds_read_b64_tr_b16 v[154:155], v52 offset:54272
    v_mfma_f32_16x16x32_bf16 v[176:179], v[192:195], v[168:171], v[176:179]
    s_waitcnt lgkmcnt(8)
    v_mfma_f32_32x32x16_bf16 v[112:127], v[160:163], v[140:143], v[112:127]
    ds_read_b64_tr_b16 v[156:157], v54 offset:53248
    ds_read_b64_tr_b16 v[158:159], v54 offset:54272
    v_mfma_f32_16x16x32_bf16 v[184:187], v[168:171], v[168:171], v[184:187]
    s_waitcnt lgkmcnt(7)
    v_mfma_f32_32x32x16_bf16 v[64:79], v[164:167], v[144:147], v[64:79]
    ds_read_b128 v[160:163], v58 offset:49152
    ds_read_b64_tr_b16 v[128:129], v48 offset:57344
    ds_read_b64_tr_b16 v[130:131], v48 offset:58368
    s_waitcnt lgkmcnt(8)
    v_mfma_f32_32x32x16_bf16 v[80:95], v[164:167], v[148:151], v[80:95]
    ds_read_b64_tr_b16 v[132:133], v50 offset:57344
    ds_read_b64_tr_b16 v[134:135], v50 offset:58368
    ds_read_b128 v[168:171], v61 offset:49152
    s_waitcnt lgkmcnt(8)
    v_mfma_f32_32x32x16_bf16 v[96:111], v[164:167], v[152:155], v[96:111]
    ds_read_b64_tr_b16 v[136:137], v52 offset:57344
    ds_read_b64_tr_b16 v[138:139], v52 offset:58368
    v_mfma_f32_16x16x32_bf16 v[180:183], v[192:195], v[172:175], v[180:183]
    s_waitcnt lgkmcnt(8)
    v_mfma_f32_32x32x16_bf16 v[112:127], v[164:167], v[156:159], v[112:127]
    ds_read_b64_tr_b16 v[140:141], v54 offset:57344
    ds_read_b64_tr_b16 v[142:143], v54 offset:58368
    v_mfma_f32_16x16x32_bf16 v[188:191], v[172:175], v[172:175], v[188:191]
    s_waitcnt lgkmcnt(7)
    v_mfma_f32_32x32x16_bf16 v[64:79], v[160:163], v[128:131], v[64:79]
    ds_read_b128 v[164:167], v59 offset:49152
    ds_read_b64_tr_b16 v[144:145], v48 offset:61440
    ds_read_b64_tr_b16 v[146:147], v48 offset:62464
    s_waitcnt lgkmcnt(8)
    v_mfma_f32_32x32x16_bf16 v[80:95], v[160:163], v[132:135], v[80:95]
    ds_read_b64_tr_b16 v[148:149], v50 offset:61440
    ds_read_b64_tr_b16 v[150:151], v50 offset:62464
    ds_read_b128 v[172:175], v61 offset:51200
    s_waitcnt lgkmcnt(8)
    v_mfma_f32_32x32x16_bf16 v[96:111], v[160:163], v[136:139], v[96:111]
    ds_read_b64_tr_b16 v[152:153], v52 offset:61440
    ds_read_b64_tr_b16 v[154:155], v52 offset:62464
    v_mfma_f32_16x16x32_bf16 v[176:179], v[192:195], v[168:171], v[176:179]
    s_waitcnt lgkmcnt(8)
    v_mfma_f32_32x32x16_bf16 v[112:127], v[160:163], v[140:143], v[112:127]
    ds_read_b64_tr_b16 v[156:157], v54 offset:61440
    ds_read_b64_tr_b16 v[158:159], v54 offset:62464
    v_mfma_f32_16x16x32_bf16 v[184:187], v[168:171], v[168:171], v[184:187]
    s_waitcnt lgkmcnt(7)
    v_mfma_f32_32x32x16_bf16 v[64:79], v[164:167], v[144:147], v[64:79]
    s_barrier
    ds_read_b128 v[160:163], v56 offset:0
    ds_read_b64_tr_b16 v[128:129], v48 offset:0
    ds_read_b64_tr_b16 v[130:131], v48 offset:1024
    s_waitcnt lgkmcnt(8)
    v_mfma_f32_32x32x16_bf16 v[80:95], v[164:167], v[148:151], v[80:95]
    ds_read_b64_tr_b16 v[132:133], v50 offset:0
    ds_read_b64_tr_b16 v[134:135], v50 offset:1024
    ds_read_b128 v[168:171], v60 offset:0
    s_waitcnt lgkmcnt(8)
    v_mfma_f32_32x32x16_bf16 v[96:111], v[164:167], v[152:155], v[96:111]
    ds_read_b64_tr_b16 v[136:137], v52 offset:0
    ds_read_b64_tr_b16 v[138:139], v52 offset:1024
    v_mfma_f32_16x16x32_bf16 v[180:183], v[192:195], v[172:175], v[180:183]
    s_waitcnt lgkmcnt(8)
    v_mfma_f32_32x32x16_bf16 v[112:127], v[164:167], v[156:159], v[112:127]
    ds_read_b64_tr_b16 v[140:141], v54 offset:0
    ds_read_b64_tr_b16 v[142:143], v54 offset:1024
    v_mfma_f32_16x16x32_bf16 v[188:191], v[172:175], v[172:175], v[188:191]
    s_waitcnt lgkmcnt(7)
    v_mfma_f32_32x32x16_bf16 v[64:79], v[160:163], v[128:131], v[64:79]
    ds_read_b128 v[164:167], v57 offset:0
    ds_read_b64_tr_b16 v[144:145], v48 offset:4096
    ds_read_b64_tr_b16 v[146:147], v48 offset:5120
    s_waitcnt lgkmcnt(8)
    v_mfma_f32_32x32x16_bf16 v[80:95], v[160:163], v[132:135], v[80:95]
    ds_read_b64_tr_b16 v[148:149], v50 offset:4096
    ds_read_b64_tr_b16 v[150:151], v50 offset:5120
    ds_read_b128 v[172:175], v60 offset:2048
    s_waitcnt lgkmcnt(8)
    v_mfma_f32_32x32x16_bf16 v[96:111], v[160:163], v[136:139], v[96:111]
    ds_read_b64_tr_b16 v[152:153], v52 offset:4096
    ds_read_b64_tr_b16 v[154:155], v52 offset:5120
    v_mfma_f32_16x16x32_bf16 v[176:179], v[192:195], v[168:171], v[176:179]
    s_waitcnt lgkmcnt(8)
    v_mfma_f32_32x32x16_bf16 v[112:127], v[160:163], v[140:143], v[112:127]
    ds_read_b64_tr_b16 v[156:157], v54 offset:4096
    ds_read_b64_tr_b16 v[158:159], v54 offset:5120
    v_mfma_f32_16x16x32_bf16 v[184:187], v[168:171], v[168:171], v[184:187]
    s_waitcnt lgkmcnt(7)
    v_mfma_f32_32x32x16_bf16 v[64:79], v[164:167], v[144:147], v[64:79]
    ds_read_b128 v[160:163], v58 offset:0
    ds_read_b64_tr_b16 v[128:129], v48 offset:8192
    ds_read_b64_tr_b16 v[130:131], v48 offset:9216
    s_waitcnt lgkmcnt(8)
    v_mfma_f32_32x32x16_bf16 v[80:95], v[164:167], v[148:151], v[80:95]
    ds_read_b64_tr_b16 v[132:133], v50 offset:8192
    ds_read_b64_tr_b16 v[134:135], v50 offset:9216
    ds_read_b128 v[168:171], v61 offset:0
    s_waitcnt lgkmcnt(8)
    v_mfma_f32_32x32x16_bf16 v[96:111], v[164:167], v[152:155], v[96:111]
    ds_read_b64_tr_b16 v[136:137], v52 offset:8192
    ds_read_b64_tr_b16 v[138:139], v52 offset:9216
    v_mfma_f32_16x16x32_bf16 v[180:183], v[192:195], v[172:175], v[180:183]
    s_waitcnt lgkmcnt(8)
    v_mfma_f32_32x32x16_bf16 v[112:127], v[164:167], v[156:159], v[112:127]
    ds_read_b64_tr_b16 v[140:141], v54 offset:8192
    ds_read_b64_tr_b16 v[142:143], v54 offset:9216
    v_mfma_f32_16x16x32_bf16 v[188:191], v[172:175], v[172:175], v[188:191]
    s_waitcnt lgkmcnt(7)
    v_mfma_f32_32x32x16_bf16 v[64:79], v[160:163], v[128:131], v[64:79]
    ds_read_b128 v[164:167], v59 offset:0
    ds_read_b64_tr_b16 v[144:145], v48 offset:12288
    ds_read_b64_tr_b16 v[146:147], v48 offset:13312
    s_waitcnt lgkmcnt(8)
    v_mfma_f32_32x32x16_bf16 v[80:95], v[160:163], v[132:135], v[80:95]
    ds_read_b64_tr_b16 v[148:149], v50 offset:12288
    ds_read_b64_tr_b16 v[150:151], v50 offset:13312
    ds_read_b128 v[172:175], v61 offset:2048
    s_waitcnt lgkmcnt(8)
    v_mfma_f32_32x32x16_bf16 v[96:111], v[160:163], v[136:139], v[96:111]
    ds_read_b64_tr_b16 v[152:153], v52 offset:12288
    ds_read_b64_tr_b16 v[154:155], v52 offset:13312
    v_mfma_f32_16x16x32_bf16 v[176:179], v[192:195], v[168:171], v[176:179]
    s_waitcnt lgkmcnt(8)
    v_mfma_f32_32x32x16_bf16 v[112:127], v[160:163], v[140:143], v[112:127]
    ds_read_b64_tr_b16 v[156:157], v54 offset:12288
    ds_read_b64_tr_b16 v[158:159], v54 offset:13312
    v_mfma_f32_16x16x32_bf16 v[184:187], v[168:171], v[168:171], v[184:187]
    s_waitcnt lgkmcnt(7)
    v_mfma_f32_32x32x16_bf16 v[64:79], v[164:167], v[144:147], v[64:79]
    s_barrier
    ds_read_b128 v[160:163], v56 offset:16384
    ds_read_b64_tr_b16 v[128:129], v48 offset:16384
    ds_read_b64_tr_b16 v[130:131], v48 offset:17408
    s_waitcnt lgkmcnt(8)
    v_mfma_f32_32x32x16_bf16 v[80:95], v[164:167], v[148:151], v[80:95]
    ds_read_b64_tr_b16 v[132:133], v50 offset:16384
    ds_read_b64_tr_b16 v[134:135], v50 offset:17408
    ds_read_b128 v[168:171], v60 offset:16384
    s_waitcnt lgkmcnt(8)
    v_mfma_f32_32x32x16_bf16 v[96:111], v[164:167], v[152:155], v[96:111]
    ds_read_b64_tr_b16 v[136:137], v52 offset:16384
    ds_read_b64_tr_b16 v[138:139], v52 offset:17408
    v_mfma_f32_16x16x32_bf16 v[180:183], v[192:195], v[172:175], v[180:183]
    s_waitcnt lgkmcnt(8)
    v_mfma_f32_32x32x16_bf16 v[112:127], v[164:167], v[156:159], v[112:127]
    ds_read_b64_tr_b16 v[140:141], v54 offset:16384
    ds_read_b64_tr_b16 v[142:143], v54 offset:17408
    v_mfma_f32_16x16x32_bf16 v[188:191], v[172:175], v[172:175], v[188:191]
    s_waitcnt lgkmcnt(7)
    v_mfma_f32_32x32x16_bf16 v[64:79], v[160:163], v[128:131], v[64:79]
    ds_read_b128 v[164:167], v57 offset:16384
    ds_read_b64_tr_b16 v[144:145], v48 offset:20480
    ds_read_b64_tr_b16 v[146:147], v48 offset:21504
    s_waitcnt lgkmcnt(8)
    v_mfma_f32_32x32x16_bf16 v[80:95], v[160:163], v[132:135], v[80:95]
    ds_read_b64_tr_b16 v[148:149], v50 offset:20480
    ds_read_b64_tr_b16 v[150:151], v50 offset:21504
    ds_read_b128 v[172:175], v60 offset:18432
    s_waitcnt lgkmcnt(8)
    v_mfma_f32_32x32x16_bf16 v[96:111], v[160:163], v[136:139], v[96:111]
    ds_read_b64_tr_b16 v[152:153], v52 offset:20480
    ds_read_b64_tr_b16 v[154:155], v52 offset:21504
    v_mfma_f32_16x16x32_bf16 v[176:179], v[192:195], v[168:171], v[176:179]
    s_waitcnt lgkmcnt(8)
    v_mfma_f32_32x32x16_bf16 v[112:127], v[160:163], v[140:143], v[112:127]
    ds_read_b64_tr_b16 v[156:157], v54 offset:20480
    ds_read_b64_tr_b16 v[158:159], v54 offset:21504
    v_mfma_f32_16x16x32_bf16 v[184:187], v[168:171], v[168:171], v[184:187]
    s_waitcnt lgkmcnt(7)
    v_mfma_f32_32x32x16_bf16 v[64:79], v[164:167], v[144:147], v[64:79]
    ds_read_b128 v[160:163], v58 offset:16384
    ds_read_b64_tr_b16 v[128:129], v48 offset:24576
    ds_read_b64_tr_b16 v[130:131], v48 offset:25600
    s_waitcnt lgkmcnt(8)
    v_mfma_f32_32x32x16_bf16 v[80:95], v[164:167], v[148:151], v[80:95]
    ds_read_b64_tr_b16 v[132:133], v50 offset:24576
    ds_read_b64_tr_b16 v[134:135], v50 offset:25600
    ds_read_b128 v[168:171], v61 offset:16384
    s_waitcnt lgkmcnt(8)
    v_mfma_f32_32x32x16_bf16 v[96:111], v[164:167], v[152:155], v[96:111]
    ds_read_b64_tr_b16 v[136:137], v52 offset:24576
    ds_read_b64_tr_b16 v[138:139], v52 offset:25600
    v_mfma_f32_16x16x32_bf16 v[180:183], v[192:195], v[172:175], v[180:183]
    s_waitcnt lgkmcnt(8)
    v_mfma_f32_32x32x16_bf16 v[112:127], v[164:167], v[156:159], v[112:127]
    ds_read_b64_tr_b16 v[140:141], v54 offset:24576
    ds_read_b64_tr_b16 v[142:143], v54 offset:25600
    v_mfma_f32_16x16x32_bf16 v[188:191], v[172:175], v[172:175], v[188:191]
    s_waitcnt lgkmcnt(7)
    v_mfma_f32_32x32x16_bf16 v[64:79], v[160:163], v[128:131], v[64:79]
    ds_read_b128 v[164:167], v59 offset:16384
    ds_read_b64_tr_b16 v[144:145], v48 offset:28672
    ds_read_b64_tr_b16 v[146:147], v48 offset:29696
    s_waitcnt lgkmcnt(8)
    v_mfma_f32_32x32x16_bf16 v[80:95], v[160:163], v[132:135], v[80:95]
    ds_read_b64_tr_b16 v[148:149], v50 offset:28672
    ds_read_b64_tr_b16 v[150:151], v50 offset:29696
    ds_read_b128 v[172:175], v61 offset:18432
    s_waitcnt lgkmcnt(8)
    v_mfma_f32_32x32x16_bf16 v[96:111], v[160:163], v[136:139], v[96:111]
    ds_read_b64_tr_b16 v[152:153], v52 offset:28672
    ds_read_b64_tr_b16 v[154:155], v52 offset:29696
    v_mfma_f32_16x16x32_bf16 v[176:179], v[192:195], v[168:171], v[176:179]
    s_waitcnt lgkmcnt(8)
    v_mfma_f32_32x32x16_bf16 v[112:127], v[160:163], v[140:143], v[112:127]
    ds_read_b64_tr_b16 v[156:157], v54 offset:28672
    ds_read_b64_tr_b16 v[158:159], v54 offset:29696
    v_mfma_f32_16x16x32_bf16 v[184:187], v[168:171], v[168:171], v[184:187]
    s_waitcnt lgkmcnt(7)
    v_mfma_f32_32x32x16_bf16 v[64:79], v[164:167], v[144:147], v[64:79]
    s_barrier
    ds_read_b128 v[160:163], v56 offset:32768
    ds_read_b64_tr_b16 v[128:129], v48 offset:32768
    ds_read_b64_tr_b16 v[130:131], v48 offset:33792
    s_waitcnt lgkmcnt(8)
    v_mfma_f32_32x32x16_bf16 v[80:95], v[164:167], v[148:151], v[80:95]
    ds_read_b64_tr_b16 v[132:133], v50 offset:32768
    ds_read_b64_tr_b16 v[134:135], v50 offset:33792
    ds_read_b128 v[168:171], v60 offset:32768
    s_waitcnt lgkmcnt(8)
    v_mfma_f32_32x32x16_bf16 v[96:111], v[164:167], v[152:155], v[96:111]
    ds_read_b64_tr_b16 v[136:137], v52 offset:32768
    ds_read_b64_tr_b16 v[138:139], v52 offset:33792
    v_mfma_f32_16x16x32_bf16 v[180:183], v[192:195], v[172:175], v[180:183]
    s_waitcnt lgkmcnt(8)
    v_mfma_f32_32x32x16_bf16 v[112:127], v[164:167], v[156:159], v[112:127]
    ds_read_b64_tr_b16 v[140:141], v54 offset:32768
    ds_read_b64_tr_b16 v[142:143], v54 offset:33792
    v_mfma_f32_16x16x32_bf16 v[188:191], v[172:175], v[172:175], v[188:191]
    s_waitcnt lgkmcnt(7)
    v_mfma_f32_32x32x16_bf16 v[64:79], v[160:163], v[128:131], v[64:79]
    ds_read_b128 v[164:167], v57 offset:32768
    ds_read_b64_tr_b16 v[144:145], v48 offset:36864
    ds_read_b64_tr_b16 v[146:147], v48 offset:37888
    s_waitcnt lgkmcnt(8)
    v_mfma_f32_32x32x16_bf16 v[80:95], v[160:163], v[132:135], v[80:95]
    ds_read_b64_tr_b16 v[148:149], v50 offset:36864
    ds_read_b64_tr_b16 v[150:151], v50 offset:37888
    ds_read_b128 v[172:175], v60 offset:34816
    s_waitcnt lgkmcnt(8)
    v_mfma_f32_32x32x16_bf16 v[96:111], v[160:163], v[136:139], v[96:111]
    ds_read_b64_tr_b16 v[152:153], v52 offset:36864
    ds_read_b64_tr_b16 v[154:155], v52 offset:37888
    v_mfma_f32_16x16x32_bf16 v[176:179], v[192:195], v[168:171], v[176:179]
    s_waitcnt lgkmcnt(8)
    v_mfma_f32_32x32x16_bf16 v[112:127], v[160:163], v[140:143], v[112:127]
    ds_read_b64_tr_b16 v[156:157], v54 offset:36864
    ds_read_b64_tr_b16 v[158:159], v54 offset:37888
    v_mfma_f32_16x16x32_bf16 v[184:187], v[168:171], v[168:171], v[184:187]
    s_waitcnt lgkmcnt(7)
    v_mfma_f32_32x32x16_bf16 v[64:79], v[164:167], v[144:147], v[64:79]
    ds_read_b128 v[160:163], v58 offset:32768
    ds_read_b64_tr_b16 v[128:129], v48 offset:40960
    ds_read_b64_tr_b16 v[130:131], v48 offset:41984
    s_waitcnt lgkmcnt(8)
    v_mfma_f32_32x32x16_bf16 v[80:95], v[164:167], v[148:151], v[80:95]
    ds_read_b64_tr_b16 v[132:133], v50 offset:40960
    ds_read_b64_tr_b16 v[134:135], v50 offset:41984
    ds_read_b128 v[168:171], v61 offset:32768
    s_waitcnt lgkmcnt(8)
    v_mfma_f32_32x32x16_bf16 v[96:111], v[164:167], v[152:155], v[96:111]
    ds_read_b64_tr_b16 v[136:137], v52 offset:40960
    ds_read_b64_tr_b16 v[138:139], v52 offset:41984
    v_mfma_f32_16x16x32_bf16 v[180:183], v[192:195], v[172:175], v[180:183]
    s_waitcnt lgkmcnt(8)
    v_mfma_f32_32x32x16_bf16 v[112:127], v[164:167], v[156:159], v[112:127]
    ds_read_b64_tr_b16 v[140:141], v54 offset:40960
    ds_read_b64_tr_b16 v[142:143], v54 offset:41984
    v_mfma_f32_16x16x32_bf16 v[188:191], v[172:175], v[172:175], v[188:191]
    s_waitcnt lgkmcnt(7)
    v_mfma_f32_32x32x16_bf16 v[64:79], v[160:163], v[128:131], v[64:79]
    ds_read_b128 v[164:167], v59 offset:32768
    ds_read_b64_tr_b16 v[144:145], v48 offset:45056
    ds_read_b64_tr_b16 v[146:147], v48 offset:46080
    s_waitcnt lgkmcnt(8)
    v_mfma_f32_32x32x16_bf16 v[80:95], v[160:163], v[132:135], v[80:95]
    ds_read_b64_tr_b16 v[148:149], v50 offset:45056
    ds_read_b64_tr_b16 v[150:151], v50 offset:46080
    ds_read_b128 v[172:175], v61 offset:34816
    s_waitcnt lgkmcnt(8)
    v_mfma_f32_32x32x16_bf16 v[96:111], v[160:163], v[136:139], v[96:111]
    ds_read_b64_tr_b16 v[152:153], v52 offset:45056
    ds_read_b64_tr_b16 v[154:155], v52 offset:46080
    v_mfma_f32_16x16x32_bf16 v[176:179], v[192:195], v[168:171], v[176:179]
    s_waitcnt lgkmcnt(8)
    v_mfma_f32_32x32x16_bf16 v[112:127], v[160:163], v[140:143], v[112:127]
    ds_read_b64_tr_b16 v[156:157], v54 offset:45056
    ds_read_b64_tr_b16 v[158:159], v54 offset:46080
    v_mfma_f32_16x16x32_bf16 v[184:187], v[168:171], v[168:171], v[184:187]
    s_waitcnt lgkmcnt(7)
    v_mfma_f32_32x32x16_bf16 v[64:79], v[164:167], v[144:147], v[64:79]
    s_barrier
    ds_read_b128 v[160:163], v56 offset:49152
    ds_read_b64_tr_b16 v[128:129], v48 offset:49152
    ds_read_b64_tr_b16 v[130:131], v48 offset:50176
    s_waitcnt lgkmcnt(8)
    v_mfma_f32_32x32x16_bf16 v[80:95], v[164:167], v[148:151], v[80:95]
    ds_read_b64_tr_b16 v[132:133], v50 offset:49152
    ds_read_b64_tr_b16 v[134:135], v50 offset:50176
    ds_read_b128 v[168:171], v60 offset:49152
    s_waitcnt lgkmcnt(8)
    v_mfma_f32_32x32x16_bf16 v[96:111], v[164:167], v[152:155], v[96:111]
    ds_read_b64_tr_b16 v[136:137], v52 offset:49152
    ds_read_b64_tr_b16 v[138:139], v52 offset:50176
    v_mfma_f32_16x16x32_bf16 v[180:183], v[192:195], v[172:175], v[180:183]
    s_waitcnt lgkmcnt(8)
    v_mfma_f32_32x32x16_bf16 v[112:127], v[164:167], v[156:159], v[112:127]
    ds_read_b64_tr_b16 v[140:141], v54 offset:49152
    ds_read_b64_tr_b16 v[142:143], v54 offset:50176
    v_mfma_f32_16x16x32_bf16 v[188:191], v[172:175], v[172:175], v[188:191]
    s_waitcnt lgkmcnt(7)
    v_mfma_f32_32x32x16_bf16 v[64:79], v[160:163], v[128:131], v[64:79]
    ds_read_b128 v[164:167], v57 offset:49152
    ds_read_b64_tr_b16 v[144:145], v48 offset:53248
    ds_read_b64_tr_b16 v[146:147], v48 offset:54272
    s_waitcnt lgkmcnt(8)
    v_mfma_f32_32x32x16_bf16 v[80:95], v[160:163], v[132:135], v[80:95]
    ds_read_b64_tr_b16 v[148:149], v50 offset:53248
    ds_read_b64_tr_b16 v[150:151], v50 offset:54272
    ds_read_b128 v[172:175], v60 offset:51200
    s_waitcnt lgkmcnt(8)
    v_mfma_f32_32x32x16_bf16 v[96:111], v[160:163], v[136:139], v[96:111]
    ds_read_b64_tr_b16 v[152:153], v52 offset:53248
    ds_read_b64_tr_b16 v[154:155], v52 offset:54272
    v_mfma_f32_16x16x32_bf16 v[176:179], v[192:195], v[168:171], v[176:179]
    s_waitcnt lgkmcnt(8)
    v_mfma_f32_32x32x16_bf16 v[112:127], v[160:163], v[140:143], v[112:127]
    ds_read_b64_tr_b16 v[156:157], v54 offset:53248
    ds_read_b64_tr_b16 v[158:159], v54 offset:54272
    v_mfma_f32_16x16x32_bf16 v[184:187], v[168:171], v[168:171], v[184:187]
    s_waitcnt lgkmcnt(7)
    v_mfma_f32_32x32x16_bf16 v[64:79], v[164:167], v[144:147], v[64:79]
    ds_read_b128 v[160:163], v58 offset:49152
    ds_read_b64_tr_b16 v[128:129], v48 offset:57344
    ds_read_b64_tr_b16 v[130:131], v48 offset:58368
    s_waitcnt lgkmcnt(8)
    v_mfma_f32_32x32x16_bf16 v[80:95], v[164:167], v[148:151], v[80:95]
    ds_read_b64_tr_b16 v[132:133], v50 offset:57344
    ds_read_b64_tr_b16 v[134:135], v50 offset:58368
    ds_read_b128 v[168:171], v61 offset:49152
    s_waitcnt lgkmcnt(8)
    v_mfma_f32_32x32x16_bf16 v[96:111], v[164:167], v[152:155], v[96:111]
    ds_read_b64_tr_b16 v[136:137], v52 offset:57344
    ds_read_b64_tr_b16 v[138:139], v52 offset:58368
    v_mfma_f32_16x16x32_bf16 v[180:183], v[192:195], v[172:175], v[180:183]
    s_waitcnt lgkmcnt(8)
    v_mfma_f32_32x32x16_bf16 v[112:127], v[164:167], v[156:159], v[112:127]
    ds_read_b64_tr_b16 v[140:141], v54 offset:57344
    ds_read_b64_tr_b16 v[142:143], v54 offset:58368
    v_mfma_f32_16x16x32_bf16 v[188:191], v[172:175], v[172:175], v[188:191]
    s_waitcnt lgkmcnt(7)
    v_mfma_f32_32x32x16_bf16 v[64:79], v[160:163], v[128:131], v[64:79]
    ds_read_b128 v[164:167], v59 offset:49152
    ds_read_b64_tr_b16 v[144:145], v48 offset:61440
    ds_read_b64_tr_b16 v[146:147], v48 offset:62464
    s_waitcnt lgkmcnt(8)
    v_mfma_f32_32x32x16_bf16 v[80:95], v[160:163], v[132:135], v[80:95]
    ds_read_b64_tr_b16 v[148:149], v50 offset:61440
    ds_read_b64_tr_b16 v[150:151], v50 offset:62464
    ds_read_b128 v[172:175], v61 offset:51200
    s_waitcnt lgkmcnt(8)
    v_mfma_f32_32x32x16_bf16 v[96:111], v[160:163], v[136:139], v[96:111]
    ds_read_b64_tr_b16 v[152:153], v52 offset:61440
    ds_read_b64_tr_b16 v[154:155], v52 offset:62464
    v_mfma_f32_16x16x32_bf16 v[176:179], v[192:195], v[168:171], v[176:179]
    s_waitcnt lgkmcnt(8)
    v_mfma_f32_32x32x16_bf16 v[112:127], v[160:163], v[140:143], v[112:127]
    ds_read_b64_tr_b16 v[156:157], v54 offset:61440
    ds_read_b64_tr_b16 v[158:159], v54 offset:62464
    v_mfma_f32_16x16x32_bf16 v[184:187], v[168:171], v[168:171], v[184:187]
    s_waitcnt lgkmcnt(7)
    v_mfma_f32_32x32x16_bf16 v[64:79], v[164:167], v[144:147], v[64:79]
    s_barrier
    ds_read_b128 v[160:163], v56 offset:0
    ds_read_b64_tr_b16 v[128:129], v48 offset:0
    ds_read_b64_tr_b16 v[130:131], v48 offset:1024
    s_waitcnt lgkmcnt(8)
    v_mfma_f32_32x32x16_bf16 v[80:95], v[164:167], v[148:151], v[80:95]
    ds_read_b64_tr_b16 v[132:133], v50 offset:0
    ds_read_b64_tr_b16 v[134:135], v50 offset:1024
    ds_read_b128 v[168:171], v60 offset:0
    s_waitcnt lgkmcnt(8)
    v_mfma_f32_32x32x16_bf16 v[96:111], v[164:167], v[152:155], v[96:111]
    ds_read_b64_tr_b16 v[136:137], v52 offset:0
    ds_read_b64_tr_b16 v[138:139], v52 offset:1024
    v_mfma_f32_16x16x32_bf16 v[180:183], v[192:195], v[172:175], v[180:183]
    s_waitcnt lgkmcnt(8)
    v_mfma_f32_32x32x16_bf16 v[112:127], v[164:167], v[156:159], v[112:127]
    ds_read_b64_tr_b16 v[140:141], v54 offset:0
    ds_read_b64_tr_b16 v[142:143], v54 offset:1024
    v_mfma_f32_16x16x32_bf16 v[188:191], v[172:175], v[172:175], v[188:191]
    s_waitcnt lgkmcnt(7)
    v_mfma_f32_32x32x16_bf16 v[64:79], v[160:163], v[128:131], v[64:79]
    ds_read_b128 v[164:167], v57 offset:0
    ds_read_b64_tr_b16 v[144:145], v48 offset:4096
    ds_read_b64_tr_b16 v[146:147], v48 offset:5120
    s_waitcnt lgkmcnt(8)
    v_mfma_f32_32x32x16_bf16 v[80:95], v[160:163], v[132:135], v[80:95]
    ds_read_b64_tr_b16 v[148:149], v50 offset:4096
    ds_read_b64_tr_b16 v[150:151], v50 offset:5120
    ds_read_b128 v[172:175], v60 offset:2048
    s_waitcnt lgkmcnt(8)
    v_mfma_f32_32x32x16_bf16 v[96:111], v[160:163], v[136:139], v[96:111]
    ds_read_b64_tr_b16 v[152:153], v52 offset:4096
    ds_read_b64_tr_b16 v[154:155], v52 offset:5120
    v_mfma_f32_16x16x32_bf16 v[176:179], v[192:195], v[168:171], v[176:179]
    s_waitcnt lgkmcnt(8)
    v_mfma_f32_32x32x16_bf16 v[112:127], v[160:163], v[140:143], v[112:127]
    ds_read_b64_tr_b16 v[156:157], v54 offset:4096
    ds_read_b64_tr_b16 v[158:159], v54 offset:5120
    v_mfma_f32_16x16x32_bf16 v[184:187], v[168:171], v[168:171], v[184:187]
    s_waitcnt lgkmcnt(7)
    v_mfma_f32_32x32x16_bf16 v[64:79], v[164:167], v[144:147], v[64:79]
    ds_read_b128 v[160:163], v58 offset:0
    ds_read_b64_tr_b16 v[128:129], v48 offset:8192
    ds_read_b64_tr_b16 v[130:131], v48 offset:9216
    s_waitcnt lgkmcnt(8)
    v_mfma_f32_32x32x16_bf16 v[80:95], v[164:167], v[148:151], v[80:95]
    ds_read_b64_tr_b16 v[132:133], v50 offset:8192
    ds_read_b64_tr_b16 v[134:135], v50 offset:9216
    ds_read_b128 v[168:171], v61 offset:0
    s_waitcnt lgkmcnt(8)
    v_mfma_f32_32x32x16_bf16 v[96:111], v[164:167], v[152:155], v[96:111]
    ds_read_b64_tr_b16 v[136:137], v52 offset:8192
    ds_read_b64_tr_b16 v[138:139], v52 offset:9216
    v_mfma_f32_16x16x32_bf16 v[180:183], v[192:195], v[172:175], v[180:183]
    s_waitcnt lgkmcnt(8)
    v_mfma_f32_32x32x16_bf16 v[112:127], v[164:167], v[156:159], v[112:127]
    ds_read_b64_tr_b16 v[140:141], v54 offset:8192
    ds_read_b64_tr_b16 v[142:143], v54 offset:9216
    v_mfma_f32_16x16x32_bf16 v[188:191], v[172:175], v[172:175], v[188:191]
    s_waitcnt lgkmcnt(7)
    v_mfma_f32_32x32x16_bf16 v[64:79], v[160:163], v[128:131], v[64:79]
    ds_read_b128 v[164:167], v59 offset:0
    ds_read_b64_tr_b16 v[144:145], v48 offset:12288
    ds_read_b64_tr_b16 v[146:147], v48 offset:13312
    s_waitcnt lgkmcnt(8)
    v_mfma_f32_32x32x16_bf16 v[80:95], v[160:163], v[132:135], v[80:95]
    ds_read_b64_tr_b16 v[148:149], v50 offset:12288
    ds_read_b64_tr_b16 v[150:151], v50 offset:13312
    ds_read_b128 v[172:175], v61 offset:2048
    s_waitcnt lgkmcnt(8)
    v_mfma_f32_32x32x16_bf16 v[96:111], v[160:163], v[136:139], v[96:111]
    ds_read_b64_tr_b16 v[152:153], v52 offset:12288
    ds_read_b64_tr_b16 v[154:155], v52 offset:13312
    v_mfma_f32_16x16x32_bf16 v[176:179], v[192:195], v[168:171], v[176:179]
    s_waitcnt lgkmcnt(8)
    v_mfma_f32_32x32x16_bf16 v[112:127], v[160:163], v[140:143], v[112:127]
    ds_read_b64_tr_b16 v[156:157], v54 offset:12288
    ds_read_b64_tr_b16 v[158:159], v54 offset:13312
    v_mfma_f32_16x16x32_bf16 v[184:187], v[168:171], v[168:171], v[184:187]
    s_waitcnt lgkmcnt(7)
    v_mfma_f32_32x32x16_bf16 v[64:79], v[164:167], v[144:147], v[64:79]
    s_barrier
    ds_read_b128 v[160:163], v56 offset:16384
    ds_read_b64_tr_b16 v[128:129], v48 offset:16384
    ds_read_b64_tr_b16 v[130:131], v48 offset:17408
    s_waitcnt lgkmcnt(8)
    v_mfma_f32_32x32x16_bf16 v[80:95], v[164:167], v[148:151], v[80:95]
    ds_read_b64_tr_b16 v[132:133], v50 offset:16384
    ds_read_b64_tr_b16 v[134:135], v50 offset:17408
    ds_read_b128 v[168:171], v60 offset:16384
    s_waitcnt lgkmcnt(8)
    v_mfma_f32_32x32x16_bf16 v[96:111], v[164:167], v[152:155], v[96:111]
    ds_read_b64_tr_b16 v[136:137], v52 offset:16384
    ds_read_b64_tr_b16 v[138:139], v52 offset:17408
    v_mfma_f32_16x16x32_bf16 v[180:183], v[192:195], v[172:175], v[180:183]
    s_waitcnt lgkmcnt(8)
    v_mfma_f32_32x32x16_bf16 v[112:127], v[164:167], v[156:159], v[112:127]
    ds_read_b64_tr_b16 v[140:141], v54 offset:16384
    ds_read_b64_tr_b16 v[142:143], v54 offset:17408
    v_mfma_f32_16x16x32_bf16 v[188:191], v[172:175], v[172:175], v[188:191]
    s_waitcnt lgkmcnt(7)
    v_mfma_f32_32x32x16_bf16 v[64:79], v[160:163], v[128:131], v[64:79]
    ds_read_b128 v[164:167], v57 offset:16384
    ds_read_b64_tr_b16 v[144:145], v48 offset:20480
    ds_read_b64_tr_b16 v[146:147], v48 offset:21504
    s_waitcnt lgkmcnt(8)
    v_mfma_f32_32x32x16_bf16 v[80:95], v[160:163], v[132:135], v[80:95]
    ds_read_b64_tr_b16 v[148:149], v50 offset:20480
    ds_read_b64_tr_b16 v[150:151], v50 offset:21504
    ds_read_b128 v[172:175], v60 offset:18432
    s_waitcnt lgkmcnt(8)
    v_mfma_f32_32x32x16_bf16 v[96:111], v[160:163], v[136:139], v[96:111]
    ds_read_b64_tr_b16 v[152:153], v52 offset:20480
    ds_read_b64_tr_b16 v[154:155], v52 offset:21504
    v_mfma_f32_16x16x32_bf16 v[176:179], v[192:195], v[168:171], v[176:179]
    s_waitcnt lgkmcnt(8)
    v_mfma_f32_32x32x16_bf16 v[112:127], v[160:163], v[140:143], v[112:127]
    ds_read_b64_tr_b16 v[156:157], v54 offset:20480
    ds_read_b64_tr_b16 v[158:159], v54 offset:21504
    v_mfma_f32_16x16x32_bf16 v[184:187], v[168:171], v[168:171], v[184:187]
    s_waitcnt lgkmcnt(7)
    v_mfma_f32_32x32x16_bf16 v[64:79], v[164:167], v[144:147], v[64:79]
    ds_read_b128 v[160:163], v58 offset:16384
    ds_read_b64_tr_b16 v[128:129], v48 offset:24576
    ds_read_b64_tr_b16 v[130:131], v48 offset:25600
    s_waitcnt lgkmcnt(8)
    v_mfma_f32_32x32x16_bf16 v[80:95], v[164:167], v[148:151], v[80:95]
    ds_read_b64_tr_b16 v[132:133], v50 offset:24576
    ds_read_b64_tr_b16 v[134:135], v50 offset:25600
    ds_read_b128 v[168:171], v61 offset:16384
    s_waitcnt lgkmcnt(8)
    v_mfma_f32_32x32x16_bf16 v[96:111], v[164:167], v[152:155], v[96:111]
    ds_read_b64_tr_b16 v[136:137], v52 offset:24576
    ds_read_b64_tr_b16 v[138:139], v52 offset:25600
    v_mfma_f32_16x16x32_bf16 v[180:183], v[192:195], v[172:175], v[180:183]
    s_waitcnt lgkmcnt(8)
    v_mfma_f32_32x32x16_bf16 v[112:127], v[164:167], v[156:159], v[112:127]
    ds_read_b64_tr_b16 v[140:141], v54 offset:24576
    ds_read_b64_tr_b16 v[142:143], v54 offset:25600
    v_mfma_f32_16x16x32_bf16 v[188:191], v[172:175], v[172:175], v[188:191]
    s_waitcnt lgkmcnt(7)
    v_mfma_f32_32x32x16_bf16 v[64:79], v[160:163], v[128:131], v[64:79]
    ds_read_b128 v[164:167], v59 offset:16384
    ds_read_b64_tr_b16 v[144:145], v48 offset:28672
    ds_read_b64_tr_b16 v[146:147], v48 offset:29696
    s_waitcnt lgkmcnt(8)
    v_mfma_f32_32x32x16_bf16 v[80:95], v[160:163], v[132:135], v[80:95]
    ds_read_b64_tr_b16 v[148:149], v50 offset:28672
    ds_read_b64_tr_b16 v[150:151], v50 offset:29696
    ds_read_b128 v[172:175], v61 offset:18432
    s_waitcnt lgkmcnt(8)
    v_mfma_f32_32x32x16_bf16 v[96:111], v[160:163], v[136:139], v[96:111]
    ds_read_b64_tr_b16 v[152:153], v52 offset:28672
    ds_read_b64_tr_b16 v[154:155], v52 offset:29696
    v_mfma_f32_16x16x32_bf16 v[176:179], v[192:195], v[168:171], v[176:179]
    s_waitcnt lgkmcnt(8)
    v_mfma_f32_32x32x16_bf16 v[112:127], v[160:163], v[140:143], v[112:127]
    ds_read_b64_tr_b16 v[156:157], v54 offset:28672
    ds_read_b64_tr_b16 v[158:159], v54 offset:29696
    v_mfma_f32_16x16x32_bf16 v[184:187], v[168:171], v[168:171], v[184:187]
    s_waitcnt lgkmcnt(7)
    v_mfma_f32_32x32x16_bf16 v[64:79], v[164:167], v[144:147], v[64:79]
    s_waitcnt lgkmcnt(5)
    v_mfma_f32_32x32x16_bf16 v[80:95], v[164:167], v[148:151], v[80:95]
    s_waitcnt lgkmcnt(2)
    v_mfma_f32_32x32x16_bf16 v[96:111], v[164:167], v[152:155], v[96:111]
    v_mfma_f32_16x16x32_bf16 v[180:183], v[192:195], v[172:175], v[180:183]
    s_waitcnt lgkmcnt(0)
    v_mfma_f32_32x32x16_bf16 v[112:127], v[164:167], v[156:159], v[112:127]
    v_mfma_f32_16x16x32_bf16 v[188:191], v[172:175], v[172:175], v[188:191]
    v_and_b32 v25, 3, v0
    v_and_b32 v26, 15, v0
    s_lshl_b32 s22, s20, 8
    s_add_u32 s22, s22, 152576
    v_lshlrev_b32 v26, 3, v26
    v_add_u32 v26, s22, v26
    v_lshlrev_b32 v24, 3, v5
    v_add_u32 v24, s22, v24
    v_cmp_eq_u32 vcc, 1, v25
    s_nop 1
    v_cndmask_b32 v184, v184, v185, vcc
    v_cndmask_b32 v188, v188, v189, vcc
    v_cmp_eq_u32 vcc, 2, v25
    s_nop 1
    v_cndmask_b32 v184, v184, v186, vcc
    v_cndmask_b32 v188, v188, v190, vcc
    v_cmp_eq_u32 vcc, 3, v25
    s_nop 1
    v_cndmask_b32 v184, v184, v187, vcc
    v_cndmask_b32 v188, v188, v191, vcc
    v_mov_b32 v177, v184
    v_mov_b32 v181, v188
    s_mov_b32 exec_lo, 0x00f0000f
    s_mov_b32 exec_hi, 0xf0000f00
    ds_write_b64 v26, v[176:177]
    ds_write_b64 v26, v[180:181] offset:128
    s_mov_b64 exec, -1
    ds_read_b64 v[8:9], v24
    s_barrier
    s_waitcnt lgkmcnt(0)
    v_mul_f32 v8, 0.5, v8
    v_mul_f32 v9, 0.5, v9
    ds_read_b32 v40, v23 offset:0
    ds_read_b32 v42, v23 offset:128
    ds_read_b32 v44, v23 offset:256
    ds_read_b32 v46, v23 offset:384
    v_add_f32 v8, v8, v10
    v_add_f32 v9, v9, v11
    v_add_f32 v12, v12, v14
    v_add_f32 v13, v13, v15
    v_add_f32 v8, v8, v12
    v_add_f32 v9, v9, v13
    v_mov_b32 v10, v8
    s_nop 1
    v_permlane32_swap_b32 v8, v10
    v_add_f32 v8, v8, v10
    v_mov_b32 v11, v9
    s_nop 1
    v_permlane32_swap_b32 v9, v11
    v_add_f32 v9, v9, v11
    v_mul_f32 v8, 0x3acccccd, v8
    v_mul_f32 v9, 0x3acccccd, v9
    v_fma_f32 v9, -v8, v8, v9
    v_max_f32 v9, 0, v9
    v_add_f32 v10, 0x3727c5ac, v9
    v_rsq_f32 v10, v10
    s_nop 0
    v_mov_b32 v9, v10
    v_mul_f32 v8, -v8, v9
    ds_write_b32 v18, v9
    ds_write_b32 v18, v8 offset:128
    ds_read_b128 v[216:219], v19 offset:0
    ds_read_b128 v[232:235], v19 offset:128
    ds_read_b128 v[220:223], v19 offset:32
    ds_read_b128 v[236:239], v19 offset:160
    ds_read_b128 v[224:227], v19 offset:64
    ds_read_b128 v[240:243], v19 offset:192
    ds_read_b128 v[228:231], v19 offset:96
    ds_read_b128 v[244:247], v19 offset:224
    s_waitcnt lgkmcnt(0)
    v_pk_mul_f32 v[64:65], v[64:65], v[216:217]
    v_pk_mul_f32 v[66:67], v[66:67], v[218:219]
    v_pk_mul_f32 v[68:69], v[68:69], v[220:221]
    v_pk_mul_f32 v[70:71], v[70:71], v[222:223]
    v_pk_mul_f32 v[72:73], v[72:73], v[224:225]
    v_pk_mul_f32 v[74:75], v[74:75], v[226:227]
    v_pk_mul_f32 v[76:77], v[76:77], v[228:229]
    v_pk_mul_f32 v[78:79], v[78:79], v[230:231]
    v_pk_fma_f32 v[64:65], v[232:233], v[40:41], v[64:65] op_sel_hi:[1,0,1]
    v_pk_fma_f32 v[66:67], v[234:235], v[40:41], v[66:67] op_sel_hi:[1,0,1]
    v_pk_fma_f32 v[68:69], v[236:237], v[40:41], v[68:69] op_sel_hi:[1,0,1]
    v_pk_fma_f32 v[70:71], v[238:239], v[40:41], v[70:71] op_sel_hi:[1,0,1]
    v_pk_fma_f32 v[72:73], v[240:241], v[40:41], v[72:73] op_sel_hi:[1,0,1]
    v_pk_fma_f32 v[74:75], v[242:243], v[40:41], v[74:75] op_sel_hi:[1,0,1]
    v_pk_fma_f32 v[76:77], v[244:245], v[40:41], v[76:77] op_sel_hi:[1,0,1]
    v_pk_fma_f32 v[78:79], v[246:247], v[40:41], v[78:79] op_sel_hi:[1,0,1]
    v_cvt_pk_bf16_f32 v64, v64, v65
    v_cvt_pk_bf16_f32 v65, v66, v67
    v_cvt_pk_bf16_f32 v66, v68, v69
    v_cvt_pk_bf16_f32 v67, v70, v71
    v_cvt_pk_bf16_f32 v68, v72, v73
    v_cvt_pk_bf16_f32 v69, v74, v75
    v_cvt_pk_bf16_f32 v70, v76, v77
    v_cvt_pk_bf16_f32 v71, v78, v79
    buffer_store_dwordx4 v[64:67], v32, s[4:7], s42 offen
    buffer_store_dwordx4 v[68:71], v32, s[4:7], s42 offen offset:640
    v_pk_mul_f32 v[80:81], v[80:81], v[216:217]
    v_pk_mul_f32 v[82:83], v[82:83], v[218:219]
    v_pk_mul_f32 v[84:85], v[84:85], v[220:221]
    v_pk_mul_f32 v[86:87], v[86:87], v[222:223]
    v_pk_mul_f32 v[88:89], v[88:89], v[224:225]
    v_pk_mul_f32 v[90:91], v[90:91], v[226:227]
    v_pk_mul_f32 v[92:93], v[92:93], v[228:229]
    v_pk_mul_f32 v[94:95], v[94:95], v[230:231]
    v_pk_fma_f32 v[80:81], v[232:233], v[42:43], v[80:81] op_sel_hi:[1,0,1]
    v_pk_fma_f32 v[82:83], v[234:235], v[42:43], v[82:83] op_sel_hi:[1,0,1]
    v_pk_fma_f32 v[84:85], v[236:237], v[42:43], v[84:85] op_sel_hi:[1,0,1]
    v_pk_fma_f32 v[86:87], v[238:239], v[42:43], v[86:87] op_sel_hi:[1,0,1]
    v_pk_fma_f32 v[88:89], v[240:241], v[42:43], v[88:89] op_sel_hi:[1,0,1]
    v_pk_fma_f32 v[90:91], v[242:243], v[42:43], v[90:91] op_sel_hi:[1,0,1]
    v_pk_fma_f32 v[92:93], v[244:245], v[42:43], v[92:93] op_sel_hi:[1,0,1]
    v_pk_fma_f32 v[94:95], v[246:247], v[42:43], v[94:95] op_sel_hi:[1,0,1]
    v_cvt_pk_bf16_f32 v80, v80, v81
    v_cvt_pk_bf16_f32 v81, v82, v83
    v_cvt_pk_bf16_f32 v82, v84, v85
    v_cvt_pk_bf16_f32 v83, v86, v87
    v_cvt_pk_bf16_f32 v84, v88, v89
    v_cvt_pk_bf16_f32 v85, v90, v91
    v_cvt_pk_bf16_f32 v86, v92, v93
    v_cvt_pk_bf16_f32 v87, v94, v95
    buffer_store_dwordx4 v[80:83], v33, s[4:7], s42 offen
    buffer_store_dwordx4 v[84:87], v33, s[4:7], s42 offen offset:640
    v_pk_mul_f32 v[96:97], v[96:97], v[216:217]
    v_pk_mul_f32 v[98:99], v[98:99], v[218:219]
    v_pk_mul_f32 v[100:101], v[100:101], v[220:221]
    v_pk_mul_f32 v[102:103], v[102:103], v[222:223]
    v_pk_mul_f32 v[104:105], v[104:105], v[224:225]
    v_pk_mul_f32 v[106:107], v[106:107], v[226:227]
    v_pk_mul_f32 v[108:109], v[108:109], v[228:229]
    v_pk_mul_f32 v[110:111], v[110:111], v[230:231]
    v_pk_fma_f32 v[96:97], v[232:233], v[44:45], v[96:97] op_sel_hi:[1,0,1]
    v_pk_fma_f32 v[98:99], v[234:235], v[44:45], v[98:99] op_sel_hi:[1,0,1]
    v_pk_fma_f32 v[100:101], v[236:237], v[44:45], v[100:101] op_sel_hi:[1,0,1]
    v_pk_fma_f32 v[102:103], v[238:239], v[44:45], v[102:103] op_sel_hi:[1,0,1]
    v_pk_fma_f32 v[104:105], v[240:241], v[44:45], v[104:105] op_sel_hi:[1,0,1]
    v_pk_fma_f32 v[106:107], v[242:243], v[44:45], v[106:107] op_sel_hi:[1,0,1]
    v_pk_fma_f32 v[108:109], v[244:245], v[44:45], v[108:109] op_sel_hi:[1,0,1]
    v_pk_fma_f32 v[110:111], v[246:247], v[44:45], v[110:111] op_sel_hi:[1,0,1]
    v_cvt_pk_bf16_f32 v96, v96, v97
    v_cvt_pk_bf16_f32 v97, v98, v99
    v_cvt_pk_bf16_f32 v98, v100, v101
    v_cvt_pk_bf16_f32 v99, v102, v103
    v_cvt_pk_bf16_f32 v100, v104, v105
    v_cvt_pk_bf16_f32 v101, v106, v107
    v_cvt_pk_bf16_f32 v102, v108, v109
    v_cvt_pk_bf16_f32 v103, v110, v111
    buffer_store_dwordx4 v[96:99], v34, s[4:7], s42 offen
    buffer_store_dwordx4 v[100:103], v34, s[4:7], s42 offen offset:640
    v_pk_mul_f32 v[112:113], v[112:113], v[216:217]
    v_pk_mul_f32 v[114:115], v[114:115], v[218:219]
    v_pk_mul_f32 v[116:117], v[116:117], v[220:221]
    v_pk_mul_f32 v[118:119], v[118:119], v[222:223]
    v_pk_mul_f32 v[120:121], v[120:121], v[224:225]
    v_pk_mul_f32 v[122:123], v[122:123], v[226:227]
    v_pk_mul_f32 v[124:125], v[124:125], v[228:229]
    v_pk_mul_f32 v[126:127], v[126:127], v[230:231]
    v_pk_fma_f32 v[112:113], v[232:233], v[46:47], v[112:113] op_sel_hi:[1,0,1]
    v_pk_fma_f32 v[114:115], v[234:235], v[46:47], v[114:115] op_sel_hi:[1,0,1]
    v_pk_fma_f32 v[116:117], v[236:237], v[46:47], v[116:117] op_sel_hi:[1,0,1]
    v_pk_fma_f32 v[118:119], v[238:239], v[46:47], v[118:119] op_sel_hi:[1,0,1]
    v_pk_fma_f32 v[120:121], v[240:241], v[46:47], v[120:121] op_sel_hi:[1,0,1]
    v_pk_fma_f32 v[122:123], v[242:243], v[46:47], v[122:123] op_sel_hi:[1,0,1]
    v_pk_fma_f32 v[124:125], v[244:245], v[46:47], v[124:125] op_sel_hi:[1,0,1]
    v_pk_fma_f32 v[126:127], v[246:247], v[46:47], v[126:127] op_sel_hi:[1,0,1]
    v_cvt_pk_bf16_f32 v112, v112, v113
    v_cvt_pk_bf16_f32 v113, v114, v115
    v_cvt_pk_bf16_f32 v114, v116, v117
    v_cvt_pk_bf16_f32 v115, v118, v119
    v_cvt_pk_bf16_f32 v116, v120, v121
    v_cvt_pk_bf16_f32 v117, v122, v123
    v_cvt_pk_bf16_f32 v118, v124, v125
    v_cvt_pk_bf16_f32 v119, v126, v127
    buffer_store_dwordx4 v[112:115], v35, s[4:7], s42 offen
    buffer_store_dwordx4 v[116:119], v35, s[4:7], s42 offen offset:640
L_fin_3:
L_end_first_kernel:
    s_endpgm
.globl chain_kernel
.p2align 8
.type chain_kernel,@function
chain_kernel:
    s_mov_b32 s50, 0
    s_cmp_ge_u32 s2, 256
    s_cbranch_scc1 L_end_chain
    s_load_dwordx2 s[4:5], s[0:1], 80
    s_mov_b32 s6, 59768832
    s_mov_b32 s7, 0x00020000
    s_load_dwordx2 s[8:9], s[0:1], 0
    s_mov_b32 s10, 2621440
    s_mov_b32 s11, 0x00020000
    s_load_dwordx2 s[12:13], s[0:1], 64
    s_mov_b32 s14, 2621440
    s_mov_b32 s15, 0x00020000
    s_load_dwordx2 s[16:17], s[0:1], 56
    s_mov_b32 s18, 1280
    s_mov_b32 s19, 0x00020000
    s_load_dwordx2 s[56:57], s[0:1], 72
    s_mov_b32 s58, 256
    s_mov_b32 s59, 0x00020000
    s_load_dwordx2 s[88:89], s[0:1], 40
    s_mov_b32 s90, 3072
    s_mov_b32 s91, 0x00020000
    v_lshrrev_b32 v1, 6, v0
    v_and_b32 v0, 63, v0
    v_readfirstlane_b32 s20, v1
    s_and_b32 s21, s2, 7
    s_lshr_b32 s51, s2, 3
    s_lshr_b32 s22, s51, 4
    s_lshl_b32 s53, s21, 1
    s_add_u32 s53, s53, s22
    s_mov_b32 s52, 7503872
    s_mul_i32 s3, s21, 344064
    s_add_u32 s3, s3, 7569408
L_layer:
    s_lshr_b32 s48, s51, 3
    s_lshl_b32 s22, s21, 2
    s_add_u32 s48, s48, s22
    s_and_b32 s49, s51, 7
    s_mul_i32 s26, s48, 10240
    s_add_u32 s26, s26, 10321920
    v_lshlrev_b32 v2, 4, v0
    s_and_b32 s29, s20, 3
    s_lshr_b32 s33, s20, 2
    s_lshl_b32 s27, s29, 1
    s_lshl_b32 s22, s49, 1
    s_lshr_b32 s23, s29, 1
    s_add_u32 s22, s22, s23
    s_mul_i32 s22, s22, 491520
    s_mul_i32 s28, s48, 5120
    s_add_u32 s28, s28, s22
    s_and_b32 s22, s29, 1
    s_mul_i32 s22, s22, 2560
    s_add_u32 s28, s28, s22
    s_add_u32 s28, s28, 10649600
    s_mul_i32 s22, s33, 1280
    s_add_u32 s36, s28, s22
    s_sub_u32 s37, s28, s22
    v_and_b32 v5, 31, v0
    v_lshrrev_b32 v6, 5, v0
    v_xor_b32 v7, s33, v6
    v_mul_u32_u24 v7, 1280, v7
    v_lshl_add_u32 v7, v5, 3, v7
    s_cmp_lg_u32 s50, 0
    s_cbranch_scc1 L_l1st_26
    s_waitcnt lgkmcnt(0)
    s_lshl_b32 s30, s20, 10
    s_add_u32 m0, s30, 102400
    s_add_u32 s31, s26, s30
    buffer_load_dwordx4 v2, s[4:7], s31 offen sc1 lds
    buffer_load_dwordx4 v[152:155], v2, s[4:7], s36 offen sc1
    buffer_load_dwordx4 v[156:159], v2, s[4:7], s37 offen offset:1280 sc1
    buffer_load_dwordx2 v[150:151], v7, s[4:7], s28 offen offset:1024 sc1
    s_cmp_lt_u32 s20, 4
    s_cbranch_scc1 L_nl_27
    s_and_b32 s30, s29, 1
    s_lshl_b32 s30, s30, 10
    s_add_u32 s31, s26, s30
    s_add_u32 m0, s30, 110592
    s_add_u32 s24, s31, 8192
    buffer_load_dwordx4 v2, s[4:7], s24 offen offset:0 sc1 lds
L_nl_27:
L_l1st_26:
    v_mov_b32 v31, 0
    s_mul_i32 s22, s48, 43
    s_add_u32 s22, s22, 0
    s_lshr_b32 s22, s22, 8
    s_add_u32 s22, s22, 0
    s_lshl_b32 s22, s22, 8
    v_writelane_b32 v31, s22, 0
    s_mul_i32 s22, s48, 43
    s_add_u32 s22, s22, 1376
    s_lshr_b32 s22, s22, 8
    s_add_u32 s22, s22, 0
    s_lshl_b32 s22, s22, 8
    v_writelane_b32 v31, s22, 1
    s_mul_i32 s22, s48, 20
    s_add_u32 s22, s22, 0
    s_lshr_b32 s22, s22, 7
    s_add_u32 s22, s22, 11
    s_lshl_b32 s22, s22, 8
    v_writelane_b32 v31, s22, 2
    s_mul_i32 s22, s48, 20
    s_add_u32 s22, s22, 19
    s_lshr_b32 s22, s22, 7
    s_add_u32 s22, s22, 11
    s_lshl_b32 s22, s22, 8
    v_writelane_b32 v31, s22, 3
    s_add_u32 s27, s27, s33
    s_mov_b32 s34, 0
    s_lshl_b32 s22, s33, 10
    s_add_u32 s22, s22, 102400
    v_add_u32 v11, s22, v2
    s_lshl_b32 s22, s33, 8
    s_add_u32 s22, s22, 104448
    v_mul_u32_u24 v3, 5120, v6
    v_lshl_add_u32 v3, v5, 3, v3
    v_add_u32 v3, s22, v3
    s_mul_i32 s22, s33, 1280
    s_add_u32 s22, s22, 104960
    v_mul_u32_u24 v4, 320, v6
    v_lshl_add_u32 v4, v5, 4, v4
    v_add_u32 v4, s22, v4
    v_mov_b32 v30, 0xdddddddd
    v_mov_b32 v8, 0x3f803f80
    v_cmp_eq_u32 vcc, 20, v5
    s_mov_b32 s40, 0x000fffff
    s_mov_b32 s41, 0x000fffff
    v_cndmask_b32 v128, 0, v8, vcc
    v_cndmask_b32 v129, 0, v8, vcc
    v_cndmask_b32 v130, 0, v8, vcc
    v_cndmask_b32 v131, 0, v8, vcc
    v_cndmask_b32 v132, 0, v8, vcc
    v_cndmask_b32 v133, 0, v8, vcc
    v_cndmask_b32 v134, 0, v8, vcc
    v_cndmask_b32 v135, 0, v8, vcc
    v_cndmask_b32 v136, 0, v8, vcc
    v_cndmask_b32 v137, 0, v8, vcc
    v_cndmask_b32 v138, 0, v8, vcc
    v_cndmask_b32 v139, 0, v8, vcc
    v_cndmask_b32 v140, 0, v8, vcc
    v_cndmask_b32 v141, 0, v8, vcc
    v_cndmask_b32 v142, 0, v8, vcc
    v_cndmask_b32 v143, 0, v8, vcc
    v_mov_b32 v96, 0
    v_mov_b32 v97, 0
    v_mov_b32 v98, 0
    v_mov_b32 v99, 0
    v_mov_b32 v100, 0
    v_mov_b32 v101, 0
    v_mov_b32 v102, 0
    v_mov_b32 v103, 0
    v_mov_b32 v104, 0
    v_mov_b32 v105, 0
    v_mov_b32 v106, 0
    v_mov_b32 v107, 0
    v_mov_b32 v108, 0
    v_mov_b32 v109, 0
    v_mov_b32 v110, 0
    v_mov_b32 v111, 0
    v_mov_b32 v112, 0
    v_mov_b32 v113, 0
    v_mov_b32 v114, 0
    v_mov_b32 v115, 0
    v_mov_b32 v116, 0
    v_mov_b32 v117, 0
    v_mov_b32 v118, 0
    v_mov_b32 v119, 0
    v_mov_b32 v120, 0
    v_mov_b32 v121, 0
    v_mov_b32 v122, 0
    v_mov_b32 v123, 0
    v_mov_b32 v124, 0
    v_mov_b32 v125, 0
    v_mov_b32 v126, 0
    v_mov_b32 v127, 0
    s_and_b32 s39, s51, 15
    s_mul_i32 s39, s39, 122880
    s_mul_i32 s22, s29, 3072
    s_add_u32 s39, s39, s22
    s_getreg_b32 s55, hwreg(HW_REG_XCC_ID)
    s_and_b32 s55, s55, 7
    s_mul_i32 s22, s55, s55
    s_lshl_b32 s22, s22, 8
    s_add_u32 s22, s22, s55
    s_lshl_b32 s22, s22, 8
    s_add_u32 s55, s22, 1
    s_lshl_b32 s22, s21, 5
    v_mov_b32 v26, s22
    s_xor_b32 s24, s20, 0
    s_mul_i32 s22, s24, 3072
    s_cmp_ge_u32 s24, 6
    s_cselect_b32 s24, 22528, 0
    s_add_u32 s22, s22, s24
    s_add_u32 s22, s22, 102400
    v_add_u32 v12, s22, v2
    s_xor_b32 s24, s20, 4
    s_mul_i32 s22, s24, 3072
    s_cmp_ge_u32 s24, 6
    s_cselect_b32 s24, 22528, 0
    s_add_u32 s22, s22, s24
    s_add_u32 s22, s22, 102400
    v_add_u32 v13, s22, v2
    s_lshl_b32 s22, s20, 2
    s_add_u32 s22, s22, 162880
    v_mov_b32 v23, s22
    v_and_b32 v24, 7, v0
    v_lshlrev_b32 v24, 2, v24
    v_add_u32 v24, 162880, v24
    v_mov_b32 v25, 0x5f800000
    v_lshlrev_b32 v29, 7, v0
    v_lshrrev_b32 v9, 4, v5
    v_mul_u32_u24 v9, 20480, v9
    v_and_b32 v10, 3, v5
    v_bfe_u32 v17, v5, 2, 1
    v_lshl_add_u32 v10, v17, 3, v10
    v_bfe_u32 v17, v5, 3, 1
    v_lshl_add_u32 v10, v17, 2, v10
    v_lshl_add_u32 v20, v10, 4, v9
    v_lshl_add_u32 v20, v6, 8, v20
    s_lshl_b32 s22, s48, 9
    v_add_u32 v20, s22, v20
    v_lshl_add_u32 v21, v10, 3, v9
    s_lshl_b32 s22, s48, 7
    s_add_u32 s22, s22, 16384
    v_add_u32 v21, s22, v21
    s_mul_i32 s38, s27, 40960
    s_mul_i32 s22, s49, 344064
    s_add_u32 s38, s38, s22
    s_add_u32 s38, s38, 7569408
    v_mov_b32 v16, 0
    v_mov_b32 v17, 0
    v_mov_b32 v18, 0
    v_mov_b32 v19, 0
    s_cmp_ge_u32 s20, 4
    s_cbranch_scc1 L_roleb_29
    v_and_b32 v172, 15, v0
    v_min_u32 v172, 11, v172
    v_lshrrev_b32 v173, 4, v0
    v_mul_u32_u24 v173, 30720, v173
    v_lshl_add_u32 v173, v172, 3, v173
    v_lshlrev_b32 v174, 2, v172
    s_mul_i32 s22, s29, 96
    s_add_u32 s22, s22, 161792
    v_lshl_add_u32 v172, v172, 3, s22
    s_lshr_b32 s22, s51, 3
    s_lshl_b32 s22, s22, 2
    s_and_b32 s23, s20, 1
    s_lshl_b32 s23, s23, 1
    s_add_u32 s22, s22, s23
    s_lshr_b32 s23, s20, 1
    s_add_u32 s45, s22, s23
    s_lshr_b32 s46, s45, 1
    s_mul_i32 s46, s46, 40960
    s_and_b32 s22, s45, 1
    s_lshl_b32 s22, s22, 8
    s_add_u32 s46, s46, s22
    s_and_b32 s23, s51, 7
    s_mul_i32 s22, s23, 5120
    s_add_u32 s46, s46, s22
    s_mul_i32 s22, s21, 327680
    s_add_u32 s46, s46, s22
    s_lshl_b32 s47, s21, 4
    s_add_u32 s47, s47, s45
    s_mul_i32 s47, s47, 20480
    s_mul_i32 s22, s23, 160
    s_add_u32 s47, s47, s22
    v_and_b32 v234, 15, v0
    v_lshrrev_b32 v235, 4, v0
    v_lshrrev_b32 v236, 5, v0
    v_lshlrev_b32 v236, 9, v236
    v_lshl_add_u32 v232, v234, 4, v236
    v_and_b32 v236, 1, v235
    v_lshl_add_u32 v232, v236, 3, v232
    v_mul_u32_u24 v233, 1280, v234
    v_lshl_add_u32 v233, v235, 3, v233
    s_cmp_eq_u32 s50, 0
    s_cbranch_scc1 L_nos1_30
    v_mov_b32 v8, 162824
    v_mov_b32 v9, 1
    s_and_b32 s22, s51, 15
    s_lshl_b32 s22, s22, 8
    s_add_u32 s22, s22, 7561216
    s_mov_b64 exec, 1
    s_waitcnt vmcnt(0)
    ds_add_rtn_u32 v10, v8, v9
    v_mov_b32 v8, 0
    s_waitcnt lgkmcnt(0)
    v_cmp_ne_u32 vcc, 3, v10
    s_cbranch_vccnz L_nsig1_31
    buffer_atomic_add v9, v8, s[4:7], s22 offen sc1
L_nsig1_31:
    s_mov_b64 exec, -1
    s_barrier
    s_barrier
    s_lshl_b32 s30, s20, 10
    s_add_u32 m0, s30, 102400
    s_add_u32 s31, s26, s30
    buffer_load_dwordx4 v2, s[4:7], s31 offen sc1 lds
    buffer_load_dwordx4 v[152:155], v2, s[4:7], s36 offen sc1
    buffer_load_dwordx4 v[156:159], v2, s[4:7], s37 offen offset:1280 sc1
    buffer_load_dwordx2 v[150:151], v7, s[4:7], s28 offen offset:1024 sc1
    s_cmp_lt_u32 s20, 4
    s_cbranch_scc1 L_nl_32
    s_and_b32 s30, s29, 1
    s_lshl_b32 s30, s30, 10
    s_add_u32 s31, s26, s30
    s_add_u32 m0, s30, 110592
    s_add_u32 s24, s31, 8192
    buffer_load_dwordx4 v2, s[4:7], s24 offen offset:0 sc1 lds
L_nl_32:
L_nos1_30:
    s_waitcnt vmcnt(0)
    s_barrier
    ds_read_b64 v[148:149], v3 offset:0
    ds_read_b128 v[144:147], v11 offset:0
    s_mov_b64 exec, s[40:41]
    ds_read_b128 v[128:131], v4 offset:0
    ds_read_b128 v[132:135], v4 offset:640
    s_mov_b64 exec, -1
    s_waitcnt lgkmcnt(2)
    v_mfma_f32_32x32x4_2b_bf16 v[32:63], v[148:149], v[150:151], 0 cbsz:1 abid:0
    s_nop 15
    s_nop 1
    v_mfma_f32_32x32x16_bf16 v[32:47], v[144:147], v[152:155], v[32:47]
    v_mfma_f32_32x32x16_bf16 v[48:63], v[144:147], v[156:159], v[48:63]
    s_barrier
    ds_read_b64 v[148:149], v3 offset:0
    ds_read_b128 v[144:147], v11 offset:5120
    s_nop 8
    s_setprio 0
    v_exp_f32 v32, v32
    v_exp_f32 v33, v33
    v_exp_f32 v34, v34
    s_mov_b64 exec, s[40:41]
    ds_read_b128 v[136:139], v4 offset:5120
    ds_read_b128 v[140:143], v4 offset:5760
    s_mov_b64 exec, -1
    v_exp_f32 v35, v35
    v_exp_f32 v36, v36
    s_waitcnt lgkmcnt(2)
    v_mfma_f32_32x32x4_2b_bf16 v[64:95], v[148:149], v[150:151], 0 cbsz:1 abid:1
    v_exp_f32 v37, v37
    v_exp_f32 v38, v38
    v_exp_f32 v39, v39
    v_exp_f32 v40, v40
    v_exp_f32 v41, v41
    v_exp_f32 v42, v42
    v_exp_f32 v43, v43
    v_exp_f32 v44, v44
    v_smfmac_f32_32x32x32_bf16 v[96:111], v[128:131], v[32:39], v30
    v_exp_f32 v45, v45
    s_mul_i32 s30, s29, 5120
    s_and_b32 s32, s51, 7
    s_mul_i32 s32, s32, 102400
    s_add_u32 s32, s32, s30
    s_lshl_b32 s42, s51, 2
    s_add_u32 s42, s42, s29
    s_lshl_b32 s44, s42, 7
    s_add_u32 s44, s44, s3
    s_add_u32 s44, s44, 327680
    s_lshl_b32 s22, s21, 7
    s_add_u32 s42, s42, s22
    s_mul_i32 s42, s42, 2560
    s_lshl_b32 s22, s50, 31
    s_or_b32 s42, s42, s22
    s_or_b32 s44, s44, s22
    v_exp_f32 v46, v46
    v_exp_f32 v47, v47
    v_exp_f32 v48, v48
    v_exp_f32 v49, v49
    v_smfmac_f32_32x32x32_bf16 v[96:111], v[132:135], v[40:47], v30
    v_exp_f32 v50, v50
    v_exp_f32 v51, v51
    v_exp_f32 v52, v52
    v_mfma_f32_32x32x16_bf16 v[64:79], v[144:147], v[152:155], v[64:79]
    v_exp_f32 v53, v53
    v_exp_f32 v54, v54
    v_exp_f32 v55, v55
    v_mfma_f32_32x32x16_bf16 v[80:95], v[144:147], v[156:159], v[80:95]
    v_exp_f32 v56, v56
    s_barrier
    ds_read_b64 v[148:149], v3 offset:10240
    ds_read_b128 v[144:147], v11 offset:10240
    v_exp_f32 v57, v57
    v_exp_f32 v58, v58
    v_smfmac_f32_32x32x32_bf16 v[112:127], v[128:131], v[48:55], v30
    v_exp_f32 v59, v59
    v_exp_f32 v60, v60
    v_exp_f32 v61, v61
    v_exp_f32 v62, v62
    v_exp_f32 v63, v63
    s_setprio 1
    v_exp_f32 v64, v64
    v_exp_f32 v65, v65
    v_smfmac_f32_32x32x32_bf16 v[112:127], v[132:135], v[56:63], v30
    v_exp_f32 v66, v66
    s_mov_b64 exec, s[40:41]
    ds_read_b128 v[128:131], v4 offset:10240
    ds_read_b128 v[132:135], v4 offset:10880
    s_mov_b64 exec, -1
    v_exp_f32 v67, v67
    v_exp_f32 v68, v68
    s_waitcnt lgkmcnt(2)
    v_mfma_f32_32x32x4_2b_bf16 v[32:63], v[148:149], v[150:151], 0 cbsz:1 abid:0
    v_exp_f32 v69, v69
    v_exp_f32 v70, v70
    v_exp_f32 v71, v71
    v_exp_f32 v72, v72
    v_exp_f32 v73, v73
    v_exp_f32 v74, v74
    v_exp_f32 v75, v75
    v_exp_f32 v76, v76
    v_smfmac_f32_32x32x32_bf16 v[96:111], v[136:139], v[64:71], v30
    v_exp_f32 v77, v77
    s_add_u32 m0, s30, 0
    s_add_u32 s24, s32, 0
    buffer_load_dwordx4 v2, s[4:7], s24 offen offset:0  lds
    buffer_load_dwordx4 v2, s[4:7], s24 offen offset:1024  lds
    v_exp_f32 v78, v78
    v_exp_f32 v79, v79
    v_exp_f32 v80, v80
    v_exp_f32 v81, v81
    v_smfmac_f32_32x32x32_bf16 v[96:111], v[140:143], v[72:79], v30
    v_exp_f32 v82, v82
    v_exp_f32 v83, v83
    v_exp_f32 v84, v84
    v_mfma_f32_32x32x16_bf16 v[32:47], v[144:147], v[152:155], v[32:47]
    v_exp_f32 v85, v85
    v_exp_f32 v86, v86
    v_exp_f32 v87, v87
    v_mfma_f32_32x32x16_bf16 v[48:63], v[144:147], v[156:159], v[48:63]
    v_exp_f32 v88, v88
    ds_read_b128 v[144:147], v11 offset:15360
    s_add_u32 m0, s30, 2048
    s_add_u32 s24, s32, 2048
    buffer_load_dwordx4 v2, s[4:7], s24 offen offset:0  lds
    v_exp_f32 v89, v89
    v_exp_f32 v90, v90
    v_smfmac_f32_32x32x32_bf16 v[112:127], v[136:139], v[80:87], v30
    v_exp_f32 v91, v91
    v_exp_f32 v92, v92
    v_exp_f32 v93, v93
    v_exp_f32 v94, v94
    v_exp_f32 v95, v95
    s_setprio 0
    v_exp_f32 v32, v32
    v_exp_f32 v33, v33
    v_smfmac_f32_32x32x32_bf16 v[112:127], v[140:143], v[88:95], v30
    v_exp_f32 v34, v34
    s_mov_b64 exec, s[40:41]
    ds_read_b128 v[136:139], v4 offset:15360
    ds_read_b128 v[140:143], v4 offset:16000
    s_mov_b64 exec, -1
    v_exp_f32 v35, v35
    v_exp_f32 v36, v36
    s_waitcnt lgkmcnt(2)
    v_mfma_f32_32x32x4_2b_bf16 v[64:95], v[148:149], v[150:151], 0 cbsz:1 abid:1
    v_exp_f32 v37, v37
    v_exp_f32 v38, v38
    v_exp_f32 v39, v39
    v_exp_f32 v40, v40
    v_exp_f32 v41, v41
    v_exp_f32 v42, v42
    v_exp_f32 v43, v43
    v_exp_f32 v44, v44
    v_smfmac_f32_32x32x32_bf16 v[96:111], v[128:131], v[32:39], v30
    v_exp_f32 v45, v45
    s_add_u32 m0, s30, 3072
    s_add_u32 s24, s32, 3072
    buffer_load_dwordx4 v2, s[4:7], s24 offen offset:0  lds
    buffer_load_dwordx4 v2, s[4:7], s24 offen offset:1024  lds
    v_exp_f32 v46, v46
    v_exp_f32 v47, v47
    v_exp_f32 v48, v48
    v_exp_f32 v49, v49
    v_smfmac_f32_32x32x32_bf16 v[96:111], v[132:135], v[40:47], v30
    v_exp_f32 v50, v50
    v_exp_f32 v51, v51
    v_exp_f32 v52, v52
    v_mfma_f32_32x32x16_bf16 v[64:79], v[144:147], v[152:155], v[64:79]
    v_exp_f32 v53, v53
    v_exp_f32 v54, v54
    v_exp_f32 v55, v55
    v_mfma_f32_32x32x16_bf16 v[80:95], v[144:147], v[156:159], v[80:95]
    v_exp_f32 v56, v56
    s_waitcnt lgkmcnt(0)
    s_barrier
    ds_read_b64 v[148:149], v3 offset:20480
    ds_read_b128 v[144:147], v11 offset:20480
    v_exp_f32 v57, v57
    v_exp_f32 v58, v58
    v_smfmac_f32_32x32x32_bf16 v[112:127], v[128:131], v[48:55], v30
    v_exp_f32 v59, v59
    v_exp_f32 v60, v60
    v_exp_f32 v61, v61
    v_exp_f32 v62, v62
    v_exp_f32 v63, v63
    s_setprio 1
    v_exp_f32 v64, v64
    v_exp_f32 v65, v65
    v_smfmac_f32_32x32x32_bf16 v[112:127], v[132:135], v[56:63], v30
    v_exp_f32 v66, v66
    s_mov_b64 exec, s[40:41]
    ds_read_b128 v[128:131], v4 offset:20480
    ds_read_b128 v[132:135], v4 offset:21120
    s_mov_b64 exec, -1
    v_exp_f32 v67, v67
    v_exp_f32 v68, v68
    s_waitcnt lgkmcnt(2)
    v_mfma_f32_32x32x4_2b_bf16 v[32:63], v[148:149], v[150:151], 0 cbsz:1 abid:0
    v_exp_f32 v69, v69
    v_exp_f32 v70, v70
    v_exp_f32 v71, v71
    v_exp_f32 v72, v72
    v_exp_f32 v73, v73
    v_exp_f32 v74, v74
    v_exp_f32 v75, v75
    v_exp_f32 v76, v76
    v_smfmac_f32_32x32x32_bf16 v[96:111], v[136:139], v[64:71], v30
    v_exp_f32 v77, v77
    s_add_u32 m0, s30, 20480
    s_add_u32 s24, s32, 20480
    buffer_load_dwordx4 v2, s[4:7], s24 offen offset:0  lds
    buffer_load_dwordx4 v2, s[4:7], s24 offen offset:1024  lds
    v_exp_f32 v78, v78
    v_exp_f32 v79, v79
    v_exp_f32 v80, v80
    v_exp_f32 v81, v81
    v_smfmac_f32_32x32x32_bf16 v[96:111], v[140:143], v[72:79], v30
    v_exp_f32 v82, v82
    v_exp_f32 v83, v83
    v_exp_f32 v84, v84
    v_mfma_f32_32x32x16_bf16 v[32:47], v[144:147], v[152:155], v[32:47]
    v_exp_f32 v85, v85
    v_exp_f32 v86, v86
    v_exp_f32 v87, v87
    v_mfma_f32_32x32x16_bf16 v[48:63], v[144:147], v[156:159], v[48:63]
    v_exp_f32 v88, v88
    ds_read_b128 v[144:147], v11 offset:25600
    s_add_u32 m0, s30, 22528
    s_add_u32 s24, s32, 22528
    buffer_load_dwordx4 v2, s[4:7], s24 offen offset:0  lds
    s_lshl_b32 s24, s50, 31
    s_or_b32 s24, s24, s38
    buffer_store_dwordx4 v[16:19], v20, s[4:7], s24 offen sc1
    buffer_store_dwordx2 v[16:17], v21, s[4:7], s24 offen sc1
    v_exp_f32 v89, v89
    v_exp_f32 v90, v90
    v_smfmac_f32_32x32x32_bf16 v[112:127], v[136:139], v[80:87], v30
    v_exp_f32 v91, v91
    v_exp_f32 v92, v92
    v_exp_f32 v93, v93
    v_exp_f32 v94, v94
    v_exp_f32 v95, v95
    s_setprio 0
    v_exp_f32 v32, v32
    v_exp_f32 v33, v33
    v_smfmac_f32_32x32x32_bf16 v[112:127], v[140:143], v[88:95], v30
    v_exp_f32 v34, v34
    s_mov_b64 exec, s[40:41]
    ds_read_b128 v[136:139], v4 offset:25600
    ds_read_b128 v[140:143], v4 offset:26240
    s_mov_b64 exec, -1
    v_exp_f32 v35, v35
    v_exp_f32 v36, v36
    s_waitcnt lgkmcnt(2)
    v_mfma_f32_32x32x4_2b_bf16 v[64:95], v[148:149], v[150:151], 0 cbsz:1 abid:1
    v_exp_f32 v37, v37
    v_exp_f32 v38, v38
    v_exp_f32 v39, v39
    v_exp_f32 v40, v40
    v_exp_f32 v41, v41
    v_exp_f32 v42, v42
    v_exp_f32 v43, v43
    v_exp_f32 v44, v44
    v_smfmac_f32_32x32x32_bf16 v[96:111], v[128:131], v[32:39], v30
    v_exp_f32 v45, v45
    s_add_u32 m0, s30, 23552
    s_add_u32 s24, s32, 23552
    buffer_load_dwordx4 v2, s[4:7], s24 offen offset:0  lds
    buffer_load_dwordx4 v2, s[4:7], s24 offen offset:1024  lds
    v_exp_f32 v46, v46
    v_exp_f32 v47, v47
    v_exp_f32 v48, v48
    v_exp_f32 v49, v49
    v_smfmac_f32_32x32x32_bf16 v[96:111], v[132:135], v[40:47], v30
    v_exp_f32 v50, v50
    v_exp_f32 v51, v51
    v_exp_f32 v52, v52
    v_mfma_f32_32x32x16_bf16 v[64:79], v[144:147], v[152:155], v[64:79]
    v_exp_f32 v53, v53
    v_exp_f32 v54, v54
    v_exp_f32 v55, v55
    v_mfma_f32_32x32x16_bf16 v[80:95], v[144:147], v[156:159], v[80:95]
    v_exp_f32 v56, v56
    s_barrier
    ds_read_b64 v[148:149], v3 offset:30720
    ds_read_b128 v[144:147], v11 offset:30720
    v_exp_f32 v57, v57
    v_exp_f32 v58, v58
    v_smfmac_f32_32x32x32_bf16 v[112:127], v[128:131], v[48:55], v30
    v_exp_f32 v59, v59
    v_exp_f32 v60, v60
    v_exp_f32 v61, v61
    v_exp_f32 v62, v62
    v_exp_f32 v63, v63
    s_setprio 1
    v_exp_f32 v64, v64
    v_exp_f32 v65, v65
    v_smfmac_f32_32x32x32_bf16 v[112:127], v[132:135], v[56:63], v30
    v_exp_f32 v66, v66
    s_mov_b64 exec, s[40:41]
    ds_read_b128 v[128:131], v4 offset:30720
    ds_read_b128 v[132:135], v4 offset:31360
    s_mov_b64 exec, -1
    v_exp_f32 v67, v67
    v_exp_f32 v68, v68
    s_waitcnt lgkmcnt(2)
    v_mfma_f32_32x32x4_2b_bf16 v[32:63], v[148:149], v[150:151], 0 cbsz:1 abid:0
    v_exp_f32 v69, v69
    v_exp_f32 v70, v70
    v_exp_f32 v71, v71
    v_exp_f32 v72, v72
    v_exp_f32 v73, v73
    v_exp_f32 v74, v74
    v_exp_f32 v75, v75
    v_exp_f32 v76, v76
    v_smfmac_f32_32x32x32_bf16 v[96:111], v[136:139], v[64:71], v30
    v_exp_f32 v77, v77
    s_add_u32 m0, s30, 40960
    s_add_u32 s24, s32, 40960
    buffer_load_dwordx4 v2, s[4:7], s24 offen offset:0  lds
    buffer_load_dwordx4 v2, s[4:7], s24 offen offset:1024  lds
    v_exp_f32 v78, v78
    v_exp_f32 v79, v79
    v_exp_f32 v80, v80
    v_exp_f32 v81, v81
    v_smfmac_f32_32x32x32_bf16 v[96:111], v[140:143], v[72:79], v30
    v_exp_f32 v82, v82
    v_exp_f32 v83, v83
    v_exp_f32 v84, v84
    v_mfma_f32_32x32x16_bf16 v[32:47], v[144:147], v[152:155], v[32:47]
    v_exp_f32 v85, v85
    v_exp_f32 v86, v86
    v_exp_f32 v87, v87
    v_mfma_f32_32x32x16_bf16 v[48:63], v[144:147], v[156:159], v[48:63]
    v_exp_f32 v88, v88
    ds_read_b128 v[144:147], v11 offset:35840
    s_add_u32 m0, s30, 43008
    s_add_u32 s24, s32, 43008
    buffer_load_dwordx4 v2, s[4:7], s24 offen offset:0  lds
    v_exp_f32 v89, v89
    v_exp_f32 v90, v90
    v_smfmac_f32_32x32x32_bf16 v[112:127], v[136:139], v[80:87], v30
    v_exp_f32 v91, v91
    v_exp_f32 v92, v92
    v_exp_f32 v93, v93
    v_exp_f32 v94, v94
    v_exp_f32 v95, v95
    s_setprio 0
    v_exp_f32 v32, v32
    v_exp_f32 v33, v33
    v_smfmac_f32_32x32x32_bf16 v[112:127], v[140:143], v[88:95], v30
    v_exp_f32 v34, v34
    s_mov_b64 exec, s[40:41]
    ds_read_b128 v[136:139], v4 offset:35840
    ds_read_b128 v[140:143], v4 offset:36480
    s_mov_b64 exec, -1
    v_exp_f32 v35, v35
    v_exp_f32 v36, v36
    s_waitcnt lgkmcnt(2)
    v_mfma_f32_32x32x4_2b_bf16 v[64:95], v[148:149], v[150:151], 0 cbsz:1 abid:1
    v_exp_f32 v37, v37
    v_exp_f32 v38, v38
    v_exp_f32 v39, v39
    v_exp_f32 v40, v40
    v_exp_f32 v41, v41
    v_exp_f32 v42, v42
    v_exp_f32 v43, v43
    v_exp_f32 v44, v44
    v_smfmac_f32_32x32x32_bf16 v[96:111], v[128:131], v[32:39], v30
    v_exp_f32 v45, v45
    s_add_u32 m0, s30, 44032
    s_add_u32 s24, s32, 44032
    buffer_load_dwordx4 v2, s[4:7], s24 offen offset:0  lds
    buffer_load_dwordx4 v2, s[4:7], s24 offen offset:1024  lds
    v_exp_f32 v46, v46
    v_exp_f32 v47, v47
    v_exp_f32 v48, v48
    v_exp_f32 v49, v49
    v_smfmac_f32_32x32x32_bf16 v[96:111], v[132:135], v[40:47], v30
    v_exp_f32 v50, v50
    v_exp_f32 v51, v51
    v_exp_f32 v52, v52
    v_mfma_f32_32x32x16_bf16 v[64:79], v[144:147], v[152:155], v[64:79]
    v_exp_f32 v53, v53
    v_exp_f32 v54, v54
    v_exp_f32 v55, v55
    v_mfma_f32_32x32x16_bf16 v[80:95], v[144:147], v[156:159], v[80:95]
    v_exp_f32 v56, v56
    s_waitcnt lgkmcnt(0)
    s_barrier
    ds_read_b64 v[148:149], v3 offset:40960
    ds_read_b128 v[144:147], v11 offset:40960
    buffer_store_dwordx4 v[16:19], v2, s[12:15], s42 offen offset:0 sc1
    v_exp_f32 v57, v57
    v_exp_f32 v58, v58
    v_smfmac_f32_32x32x32_bf16 v[112:127], v[128:131], v[48:55], v30
    v_exp_f32 v59, v59
    v_exp_f32 v60, v60
    v_exp_f32 v61, v61
    v_exp_f32 v62, v62
    v_exp_f32 v63, v63
    s_setprio 3
    v_exp_f32 v64, v64
    v_exp_f32 v65, v65
    v_smfmac_f32_32x32x32_bf16 v[112:127], v[132:135], v[56:63], v30
    v_exp_f32 v66, v66
    s_mov_b64 exec, s[40:41]
    ds_read_b128 v[128:131], v4 offset:40960
    ds_read_b128 v[132:135], v4 offset:41600
    s_mov_b64 exec, -1
    v_exp_f32 v67, v67
    v_exp_f32 v68, v68
    s_waitcnt lgkmcnt(2)
    v_mfma_f32_32x32x4_2b_bf16 v[32:63], v[148:149], v[150:151], 0 cbsz:1 abid:0
    v_exp_f32 v69, v69
    v_exp_f32 v70, v70
    v_exp_f32 v71, v71
    v_exp_f32 v72, v72
    v_exp_f32 v73, v73
    v_exp_f32 v74, v74
    v_exp_f32 v75, v75
    v_exp_f32 v76, v76
    v_smfmac_f32_32x32x32_bf16 v[96:111], v[136:139], v[64:71], v30
    v_exp_f32 v77, v77
    s_add_u32 m0, s30, 61440
    s_add_u32 s24, s32, 61440
    buffer_load_dwordx4 v2, s[4:7], s24 offen offset:0  lds
    buffer_load_dwordx4 v2, s[4:7], s24 offen offset:1024  lds
    v_exp_f32 v78, v78
    v_exp_f32 v79, v79
    v_exp_f32 v80, v80
    v_exp_f32 v81, v81
    v_smfmac_f32_32x32x32_bf16 v[96:111], v[140:143], v[72:79], v30
    v_exp_f32 v82, v82
    v_exp_f32 v83, v83
    v_exp_f32 v84, v84
    v_mfma_f32_32x32x16_bf16 v[32:47], v[144:147], v[152:155], v[32:47]
    v_exp_f32 v85, v85
    v_exp_f32 v86, v86
    v_exp_f32 v87, v87
    v_mfma_f32_32x32x16_bf16 v[48:63], v[144:147], v[156:159], v[48:63]
    v_exp_f32 v88, v88
    ds_read_b128 v[144:147], v11 offset:46080
    s_add_u32 m0, s30, 63488
    s_add_u32 s24, s32, 63488
    buffer_load_dwordx4 v2, s[4:7], s24 offen offset:0  lds
    v_exp_f32 v89, v89
    v_exp_f32 v90, v90
    v_smfmac_f32_32x32x32_bf16 v[112:127], v[136:139], v[80:87], v30
    v_exp_f32 v91, v91
    v_exp_f32 v92, v92
    v_exp_f32 v93, v93
    v_exp_f32 v94, v94
    v_exp_f32 v95, v95
    s_setprio 2
    v_exp_f32 v32, v32
    v_exp_f32 v33, v33
    v_smfmac_f32_32x32x32_bf16 v[112:127], v[140:143], v[88:95], v30
    v_exp_f32 v34, v34
    s_mov_b64 exec, s[40:41]
    ds_read_b128 v[136:139], v4 offset:46080
    ds_read_b128 v[140:143], v4 offset:46720
    s_mov_b64 exec, -1
    v_exp_f32 v35, v35
    v_exp_f32 v36, v36
    s_waitcnt lgkmcnt(2)
    v_mfma_f32_32x32x4_2b_bf16 v[64:95], v[148:149], v[150:151], 0 cbsz:1 abid:1
    v_exp_f32 v37, v37
    v_exp_f32 v38, v38
    v_exp_f32 v39, v39
    v_exp_f32 v40, v40
    v_exp_f32 v41, v41
    v_exp_f32 v42, v42
    v_exp_f32 v43, v43
    v_exp_f32 v44, v44
    v_smfmac_f32_32x32x32_bf16 v[96:111], v[128:131], v[32:39], v30
    v_exp_f32 v45, v45
    s_add_u32 m0, s30, 64512
    s_add_u32 s24, s32, 64512
    buffer_load_dwordx4 v2, s[4:7], s24 offen offset:0  lds
    buffer_load_dwordx4 v2, s[4:7], s24 offen offset:1024  lds
    v_exp_f32 v46, v46
    v_exp_f32 v47, v47
    v_exp_f32 v48, v48
    v_exp_f32 v49, v49
    v_smfmac_f32_32x32x32_bf16 v[96:111], v[132:135], v[40:47], v30
    v_exp_f32 v50, v50
    v_exp_f32 v51, v51
    v_exp_f32 v52, v52
    v_mfma_f32_32x32x16_bf16 v[64:79], v[144:147], v[152:155], v[64:79]
    v_exp_f32 v53, v53
    v_exp_f32 v54, v54
    v_exp_f32 v55, v55
    v_mfma_f32_32x32x16_bf16 v[80:95], v[144:147], v[156:159], v[80:95]
    v_exp_f32 v56, v56
    ds_read_b64 v[148:149], v3 offset:51200
    ds_read_b128 v[144:147], v11 offset:51200
    buffer_store_dwordx4 v[16:19], v2, s[12:15], s42 offen offset:1024 sc1
    v_exp_f32 v57, v57
    v_exp_f32 v58, v58
    v_smfmac_f32_32x32x32_bf16 v[112:127], v[128:131], v[48:55], v30
    v_exp_f32 v59, v59
    v_exp_f32 v60, v60
    v_exp_f32 v61, v61
    v_exp_f32 v62, v62
    v_exp_f32 v63, v63
    s_setprio 1
    v_exp_f32 v64, v64
    v_exp_f32 v65, v65
    v_smfmac_f32_32x32x32_bf16 v[112:127], v[132:135], v[56:63], v30
    v_exp_f32 v66, v66
    s_mov_b64 exec, s[40:41]
    ds_read_b128 v[128:131], v4 offset:51200
    ds_read_b128 v[132:135], v4 offset:51840
    s_mov_b64 exec, -1
    v_exp_f32 v67, v67
    v_exp_f32 v68, v68
    s_waitcnt lgkmcnt(2)
    v_mfma_f32_32x32x4_2b_bf16 v[32:63], v[148:149], v[150:151], 0 cbsz:1 abid:0
    v_exp_f32 v69, v69
    v_exp_f32 v70, v70
    v_exp_f32 v71, v71
    v_exp_f32 v72, v72
    v_exp_f32 v73, v73
    v_exp_f32 v74, v74
    v_exp_f32 v75, v75
    v_exp_f32 v76, v76
    v_smfmac_f32_32x32x32_bf16 v[96:111], v[136:139], v[64:71], v30
    v_exp_f32 v77, v77
    s_add_u32 m0, s30, 81920
    s_add_u32 s24, s32, 81920
    buffer_load_dwordx4 v2, s[4:7], s24 offen offset:0  lds
    buffer_load_dwordx4 v2, s[4:7], s24 offen offset:1024  lds
    v_exp_f32 v78, v78
    v_exp_f32 v79, v79
    v_exp_f32 v80, v80
    v_exp_f32 v81, v81
    v_smfmac_f32_32x32x32_bf16 v[96:111], v[140:143], v[72:79], v30
    v_exp_f32 v82, v82
    v_exp_f32 v83, v83
    v_exp_f32 v84, v84
    v_mfma_f32_32x32x16_bf16 v[32:47], v[144:147], v[152:155], v[32:47]
    v_exp_f32 v85, v85
    v_exp_f32 v86, v86
    v_exp_f32 v87, v87
    v_mfma_f32_32x32x16_bf16 v[48:63], v[144:147], v[156:159], v[48:63]
    v_exp_f32 v88, v88
    ds_read_b128 v[144:147], v11 offset:56320
    s_add_u32 m0, s30, 83968
    s_add_u32 s24, s32, 83968
    buffer_load_dwordx4 v2, s[4:7], s24 offen offset:0  lds
    v_exp_f32 v89, v89
    v_exp_f32 v90, v90
    v_smfmac_f32_32x32x32_bf16 v[112:127], v[136:139], v[80:87], v30
    v_exp_f32 v91, v91
    v_exp_f32 v92, v92
    v_exp_f32 v93, v93
    v_exp_f32 v94, v94
    v_exp_f32 v95, v95
    s_setprio 0
    v_exp_f32 v32, v32
    v_exp_f32 v33, v33
    v_smfmac_f32_32x32x32_bf16 v[112:127], v[140:143], v[88:95], v30
    v_exp_f32 v34, v34
    s_mov_b64 exec, s[40:41]
    ds_read_b128 v[136:139], v4 offset:56320
    ds_read_b128 v[140:143], v4 offset:56960
    s_mov_b64 exec, -1
    v_exp_f32 v35, v35
    v_exp_f32 v36, v36
    s_waitcnt lgkmcnt(2)
    v_mfma_f32_32x32x4_2b_bf16 v[64:95], v[148:149], v[150:151], 0 cbsz:1 abid:1
    v_exp_f32 v37, v37
    v_exp_f32 v38, v38
    v_exp_f32 v39, v39
    v_exp_f32 v40, v40
    v_exp_f32 v41, v41
    v_exp_f32 v42, v42
    v_exp_f32 v43, v43
    v_exp_f32 v44, v44
    v_smfmac_f32_32x32x32_bf16 v[96:111], v[128:131], v[32:39], v30
    v_exp_f32 v45, v45
    s_add_u32 m0, s30, 84992
    s_add_u32 s24, s32, 84992
    buffer_load_dwordx4 v2, s[4:7], s24 offen offset:0  lds
    buffer_load_dwordx4 v2, s[4:7], s24 offen offset:1024  lds
    v_exp_f32 v46, v46
    v_exp_f32 v47, v47
    v_exp_f32 v48, v48
    v_exp_f32 v49, v49
    v_smfmac_f32_32x32x32_bf16 v[96:111], v[132:135], v[40:47], v30
    v_exp_f32 v50, v50
    v_exp_f32 v51, v51
    v_exp_f32 v52, v52
    v_mfma_f32_32x32x16_bf16 v[64:79], v[144:147], v[152:155], v[64:79]
    v_exp_f32 v53, v53
    v_exp_f32 v54, v54
    v_exp_f32 v55, v55
    v_mfma_f32_32x32x16_bf16 v[80:95], v[144:147], v[156:159], v[80:95]
    v_exp_f32 v56, v56
    s_waitcnt lgkmcnt(0)
    s_barrier
    ds_read_b64 v[148:149], v3 offset:0
    ds_read_b128 v[144:147], v11 offset:0
    s_mov_b32 exec_hi, 0
    buffer_store_dwordx4 v[16:19], v2, s[12:15], s42 offen offset:2048 sc1
    s_mov_b64 exec, -1
    v_exp_f32 v57, v57
    v_exp_f32 v58, v58
    v_smfmac_f32_32x32x32_bf16 v[112:127], v[128:131], v[48:55], v30
    v_exp_f32 v59, v59
    v_exp_f32 v60, v60
    v_exp_f32 v61, v61
    v_exp_f32 v62, v62
    v_exp_f32 v63, v63
    s_setprio 3
    v_exp_f32 v64, v64
    v_exp_f32 v65, v65
    v_smfmac_f32_32x32x32_bf16 v[112:127], v[132:135], v[56:63], v30
    v_exp_f32 v66, v66
    s_mov_b64 exec, s[40:41]
    ds_read_b128 v[128:131], v4 offset:0
    ds_read_b128 v[132:135], v4 offset:640
    s_mov_b64 exec, -1
    v_exp_f32 v67, v67
    v_exp_f32 v68, v68
    s_waitcnt lgkmcnt(2)
    v_mfma_f32_32x32x4_2b_bf16 v[32:63], v[148:149], v[150:151], 0 cbsz:1 abid:0
    v_exp_f32 v69, v69
    v_exp_f32 v70, v70
    v_exp_f32 v71, v71
    v_exp_f32 v72, v72
    v_exp_f32 v73, v73
    v_exp_f32 v74, v74
    v_exp_f32 v75, v75
    v_exp_f32 v76, v76
    v_smfmac_f32_32x32x32_bf16 v[96:111], v[136:139], v[64:71], v30
    v_exp_f32 v77, v77
    v_exp_f32 v78, v78
    v_exp_f32 v79, v79
    v_exp_f32 v80, v80
    v_exp_f32 v81, v81
    v_smfmac_f32_32x32x32_bf16 v[96:111], v[140:143], v[72:79], v30
    v_exp_f32 v82, v82
    v_exp_f32 v83, v83
    v_exp_f32 v84, v84
    v_mfma_f32_32x32x16_bf16 v[32:47], v[144:147], v[152:155], v[32:47]
    v_exp_f32 v85, v85
    v_exp_f32 v86, v86
    v_exp_f32 v87, v87
    v_mfma_f32_32x32x16_bf16 v[48:63], v[144:147], v[156:159], v[48:63]
    v_exp_f32 v88, v88
    ds_read_b128 v[144:147], v11 offset:5120
    v_exp_f32 v89, v89
    v_exp_f32 v90, v90
    v_smfmac_f32_32x32x32_bf16 v[112:127], v[136:139], v[80:87], v30
    v_exp_f32 v91, v91
    v_exp_f32 v92, v92
    v_exp_f32 v93, v93
    v_exp_f32 v94, v94
    v_exp_f32 v95, v95
    s_setprio 2
    v_exp_f32 v32, v32
    v_exp_f32 v33, v33
    v_smfmac_f32_32x32x32_bf16 v[112:127], v[140:143], v[88:95], v30
    v_exp_f32 v34, v34
    s_mov_b64 exec, s[40:41]
    ds_read_b128 v[136:139], v4 offset:5120
    ds_read_b128 v[140:143], v4 offset:5760
    s_mov_b64 exec, -1
    v_exp_f32 v35, v35
    v_exp_f32 v36, v36
    s_waitcnt lgkmcnt(2)
    v_mfma_f32_32x32x4_2b_bf16 v[64:95], v[148:149], v[150:151], 0 cbsz:1 abid:1
    v_exp_f32 v37, v37
    v_exp_f32 v38, v38
    v_exp_f32 v39, v39
    v_exp_f32 v40, v40
    v_exp_f32 v41, v41
    v_exp_f32 v42, v42
    v_exp_f32 v43, v43
    v_exp_f32 v44, v44
    v_smfmac_f32_32x32x32_bf16 v[96:111], v[128:131], v[32:39], v30
    v_exp_f32 v45, v45
    s_add_u32 s24, s39, 819200
    buffer_load_dwordx4 v[208:211], v2, s[4:7], s24 offen offset:0
    buffer_load_dwordx4 v[212:215], v2, s[4:7], s24 offen offset:1024
    buffer_load_dwordx4 v[216:219], v2, s[4:7], s24 offen offset:2048
    v_exp_f32 v46, v46
    v_exp_f32 v47, v47
    v_exp_f32 v48, v48
    v_exp_f32 v49, v49
    v_smfmac_f32_32x32x32_bf16 v[96:111], v[132:135], v[40:47], v30
    v_exp_f32 v50, v50
    v_exp_f32 v51, v51
    v_exp_f32 v52, v52
    v_mfma_f32_32x32x16_bf16 v[64:79], v[144:147], v[152:155], v[64:79]
    v_exp_f32 v53, v53
    v_exp_f32 v54, v54
    v_exp_f32 v55, v55
    v_mfma_f32_32x32x16_bf16 v[80:95], v[144:147], v[156:159], v[80:95]
    v_exp_f32 v56, v56
    ds_read_b64 v[148:149], v3 offset:10240
    ds_read_b128 v[144:147], v11 offset:10240
    s_mov_b64 exec, 0xff
    buffer_store_dwordx4 v[16:19], v2, s[4:7], s44 offen sc1
    s_mov_b64 exec, -1
    v_exp_f32 v57, v57
    v_exp_f32 v58, v58
    v_smfmac_f32_32x32x32_bf16 v[112:127], v[128:131], v[48:55], v30
    v_exp_f32 v59, v59
    v_exp_f32 v60, v60
    v_exp_f32 v61, v61
    v_exp_f32 v62, v62
    v_exp_f32 v63, v63
    s_setprio 1
    v_exp_f32 v64, v64
    v_exp_f32 v65, v65
    v_smfmac_f32_32x32x32_bf16 v[112:127], v[132:135], v[56:63], v30
    v_exp_f32 v66, v66
    s_mov_b64 exec, s[40:41]
    ds_read_b128 v[128:131], v4 offset:10240
    ds_read_b128 v[132:135], v4 offset:10880
    s_mov_b64 exec, -1
    v_exp_f32 v67, v67
    v_exp_f32 v68, v68
    s_waitcnt lgkmcnt(2)
    v_mfma_f32_32x32x4_2b_bf16 v[32:63], v[148:149], v[150:151], 0 cbsz:1 abid:0
    v_exp_f32 v69, v69
    v_exp_f32 v70, v70
    v_exp_f32 v71, v71
    v_exp_f32 v72, v72
    v_exp_f32 v73, v73
    v_exp_f32 v74, v74
    v_exp_f32 v75, v75
    v_exp_f32 v76, v76
    v_smfmac_f32_32x32x32_bf16 v[96:111], v[136:139], v[64:71], v30
    v_exp_f32 v77, v77
    v_exp_f32 v78, v78
    v_exp_f32 v79, v79
    v_exp_f32 v80, v80
    v_exp_f32 v81, v81
    v_smfmac_f32_32x32x32_bf16 v[96:111], v[140:143], v[72:79], v30
    v_exp_f32 v82, v82
    v_exp_f32 v83, v83
    v_exp_f32 v84, v84
    v_mfma_f32_32x32x16_bf16 v[32:47], v[144:147], v[152:155], v[32:47]
    v_exp_f32 v85, v85
    v_exp_f32 v86, v86
    v_exp_f32 v87, v87
    v_mfma_f32_32x32x16_bf16 v[48:63], v[144:147], v[156:159], v[48:63]
    v_exp_f32 v88, v88
    ds_read_b128 v[144:147], v11 offset:15360
    v_exp_f32 v89, v89
    v_exp_f32 v90, v90
    v_smfmac_f32_32x32x32_bf16 v[112:127], v[136:139], v[80:87], v30
    v_exp_f32 v91, v91
    v_exp_f32 v92, v92
    v_exp_f32 v93, v93
    v_exp_f32 v94, v94
    v_exp_f32 v95, v95
    s_setprio 0
    v_exp_f32 v32, v32
    v_exp_f32 v33, v33
    v_smfmac_f32_32x32x32_bf16 v[112:127], v[140:143], v[88:95], v30
    v_exp_f32 v34, v34
    s_mov_b64 exec, s[40:41]
    ds_read_b128 v[136:139], v4 offset:15360
    ds_read_b128 v[140:143], v4 offset:16000
    s_mov_b64 exec, -1
    v_exp_f32 v35, v35
    v_exp_f32 v36, v36
    s_waitcnt lgkmcnt(2)
    v_mfma_f32_32x32x4_2b_bf16 v[64:95], v[148:149], v[150:151], 0 cbsz:1 abid:1
    v_exp_f32 v37, v37
    v_exp_f32 v38, v38
    v_exp_f32 v39, v39
    v_exp_f32 v40, v40
    v_exp_f32 v41, v41
    v_exp_f32 v42, v42
    v_exp_f32 v43, v43
    v_exp_f32 v44, v44
    v_smfmac_f32_32x32x32_bf16 v[96:111], v[128:131], v[32:39], v30
    v_exp_f32 v45, v45
    s_add_u32 s24, s39, 831488
    buffer_load_dwordx4 v[220:223], v2, s[4:7], s24 offen offset:0
    buffer_load_dwordx4 v[224:227], v2, s[4:7], s24 offen offset:1024
    buffer_load_dwordx4 v[228:231], v2, s[4:7], s24 offen offset:2048
    v_exp_f32 v46, v46
    v_exp_f32 v47, v47
    v_exp_f32 v48, v48
    v_exp_f32 v49, v49
    v_smfmac_f32_32x32x32_bf16 v[96:111], v[132:135], v[40:47], v30
    v_exp_f32 v50, v50
    v_exp_f32 v51, v51
    v_exp_f32 v52, v52
    v_mfma_f32_32x32x16_bf16 v[64:79], v[144:147], v[152:155], v[64:79]
    v_exp_f32 v53, v53
    v_exp_f32 v54, v54
    v_exp_f32 v55, v55
    v_mfma_f32_32x32x16_bf16 v[80:95], v[144:147], v[156:159], v[80:95]
    v_exp_f32 v56, v56
    s_waitcnt lgkmcnt(0)
    s_barrier
    ds_read_b64 v[148:149], v3 offset:20480
    ds_read_b128 v[144:147], v11 offset:20480
    v_exp_f32 v57, v57
    v_exp_f32 v58, v58
    v_smfmac_f32_32x32x32_bf16 v[112:127], v[128:131], v[48:55], v30
    v_exp_f32 v59, v59
    v_exp_f32 v60, v60
    v_exp_f32 v61, v61
    v_exp_f32 v62, v62
    v_exp_f32 v63, v63
    s_setprio 3
    v_exp_f32 v64, v64
    v_exp_f32 v65, v65
    v_smfmac_f32_32x32x32_bf16 v[112:127], v[132:135], v[56:63], v30
    v_exp_f32 v66, v66
    s_mov_b64 exec, s[40:41]
    ds_read_b128 v[128:131], v4 offset:20480
    ds_read_b128 v[132:135], v4 offset:21120
    s_mov_b64 exec, -1
    v_exp_f32 v67, v67
    v_exp_f32 v68, v68
    s_waitcnt lgkmcnt(2)
    v_mfma_f32_32x32x4_2b_bf16 v[32:63], v[148:149], v[150:151], 0 cbsz:1 abid:0
    v_exp_f32 v69, v69
    v_exp_f32 v70, v70
    v_exp_f32 v71, v71
    v_exp_f32 v72, v72
    v_exp_f32 v73, v73
    v_exp_f32 v74, v74
    v_exp_f32 v75, v75
    v_exp_f32 v76, v76
    v_smfmac_f32_32x32x32_bf16 v[96:111], v[136:139], v[64:71], v30
    v_exp_f32 v77, v77
    v_exp_f32 v78, v78
    v_exp_f32 v79, v79
    v_exp_f32 v80, v80
    v_exp_f32 v81, v81
    v_smfmac_f32_32x32x32_bf16 v[96:111], v[140:143], v[72:79], v30
    v_exp_f32 v82, v82
    v_exp_f32 v83, v83
    v_exp_f32 v84, v84
    v_mfma_f32_32x32x16_bf16 v[32:47], v[144:147], v[152:155], v[32:47]
    v_exp_f32 v85, v85
    v_exp_f32 v86, v86
    v_exp_f32 v87, v87
    v_mfma_f32_32x32x16_bf16 v[48:63], v[144:147], v[156:159], v[48:63]
    v_exp_f32 v88, v88
    ds_read_b128 v[144:147], v11 offset:25600
    v_exp_f32 v89, v89
    v_exp_f32 v90, v90
    v_smfmac_f32_32x32x32_bf16 v[112:127], v[136:139], v[80:87], v30
    v_exp_f32 v91, v91
    v_exp_f32 v92, v92
    v_exp_f32 v93, v93
    v_exp_f32 v94, v94
    v_exp_f32 v95, v95
    s_setprio 2
    v_exp_f32 v32, v32
    v_exp_f32 v33, v33
    v_smfmac_f32_32x32x32_bf16 v[112:127], v[140:143], v[88:95], v30
    v_exp_f32 v34, v34
    s_mov_b64 exec, s[40:41]
    ds_read_b128 v[136:139], v4 offset:25600
    ds_read_b128 v[140:143], v4 offset:26240
    s_mov_b64 exec, -1
    v_exp_f32 v35, v35
    v_exp_f32 v36, v36
    s_waitcnt lgkmcnt(2)
    v_mfma_f32_32x32x4_2b_bf16 v[64:95], v[148:149], v[150:151], 0 cbsz:1 abid:1
    v_exp_f32 v37, v37
    v_exp_f32 v38, v38
    v_exp_f32 v39, v39
    v_exp_f32 v40, v40
    v_exp_f32 v41, v41
    v_exp_f32 v42, v42
    v_exp_f32 v43, v43
    v_exp_f32 v44, v44
    v_smfmac_f32_32x32x32_bf16 v[96:111], v[128:131], v[32:39], v30
    v_exp_f32 v45, v45
    s_cmp_lg_u32 s50, 0
    s_cbranch_scc1 L_res1_33
    buffer_load_dwordx2 v[240:241], v233, s[8:11], s47 offen offset:0
    buffer_load_dwordx2 v[242:243], v233, s[8:11], s47 offen offset:32
    buffer_load_dwordx2 v[244:245], v233, s[8:11], s47 offen offset:64
    buffer_load_dwordx2 v[246:247], v233, s[8:11], s47 offen offset:96
    buffer_load_dwordx2 v[248:249], v233, s[8:11], s47 offen offset:128
    s_branch L_resj_34
L_res1_33:
    s_add_u32 s24, s46, 0
    buffer_load_dwordx2 v[240:241], v232, s[12:15], s24 offen sc1
    s_add_u32 s24, s46, 1024
    buffer_load_dwordx2 v[242:243], v232, s[12:15], s24 offen sc1
    s_add_u32 s24, s46, 2048
    buffer_load_dwordx2 v[244:245], v232, s[12:15], s24 offen sc1
    s_add_u32 s24, s46, 3072
    buffer_load_dwordx2 v[246:247], v232, s[12:15], s24 offen sc1
    s_add_u32 s24, s46, 4096
    buffer_load_dwordx2 v[248:249], v232, s[12:15], s24 offen sc1
L_resj_34:
    v_exp_f32 v46, v46
    v_exp_f32 v47, v47
    v_exp_f32 v48, v48
    v_exp_f32 v49, v49
    v_smfmac_f32_32x32x32_bf16 v[96:111], v[132:135], v[40:47], v30
    v_exp_f32 v50, v50
    v_exp_f32 v51, v51
    v_exp_f32 v52, v52
    v_mfma_f32_32x32x16_bf16 v[64:79], v[144:147], v[152:155], v[64:79]
    v_exp_f32 v53, v53
    v_exp_f32 v54, v54
    v_exp_f32 v55, v55
    v_mfma_f32_32x32x16_bf16 v[80:95], v[144:147], v[156:159], v[80:95]
    v_exp_f32 v56, v56
    ds_read_b64 v[148:149], v3 offset:30720
    ds_read_b128 v[144:147], v11 offset:30720
    v_exp_f32 v57, v57
    v_exp_f32 v58, v58
    v_smfmac_f32_32x32x32_bf16 v[112:127], v[128:131], v[48:55], v30
    v_exp_f32 v59, v59
    v_exp_f32 v60, v60
    v_exp_f32 v61, v61
    v_exp_f32 v62, v62
    v_exp_f32 v63, v63
    s_setprio 1
    v_exp_f32 v64, v64
    v_exp_f32 v65, v65
    v_smfmac_f32_32x32x32_bf16 v[112:127], v[132:135], v[56:63], v30
    v_exp_f32 v66, v66
    s_mov_b64 exec, s[40:41]
    ds_read_b128 v[128:131], v4 offset:30720
    ds_read_b128 v[132:135], v4 offset:31360
    s_mov_b64 exec, -1
    v_exp_f32 v67, v67
    v_exp_f32 v68, v68
    s_waitcnt lgkmcnt(2)
    v_mfma_f32_32x32x4_2b_bf16 v[32:63], v[148:149], v[150:151], 0 cbsz:1 abid:0
    v_exp_f32 v69, v69
    v_exp_f32 v70, v70
    v_exp_f32 v71, v71
    v_exp_f32 v72, v72
    v_exp_f32 v73, v73
    v_exp_f32 v74, v74
    v_exp_f32 v75, v75
    v_exp_f32 v76, v76
    v_smfmac_f32_32x32x32_bf16 v[96:111], v[136:139], v[64:71], v30
    v_exp_f32 v77, v77
    v_exp_f32 v78, v78
    v_exp_f32 v79, v79
    v_exp_f32 v80, v80
    v_exp_f32 v81, v81
    v_smfmac_f32_32x32x32_bf16 v[96:111], v[140:143], v[72:79], v30
    v_exp_f32 v82, v82
    v_exp_f32 v83, v83
    v_exp_f32 v84, v84
    v_mfma_f32_32x32x16_bf16 v[32:47], v[144:147], v[152:155], v[32:47]
    v_exp_f32 v85, v85
    v_exp_f32 v86, v86
    v_exp_f32 v87, v87
    v_mfma_f32_32x32x16_bf16 v[48:63], v[144:147], v[156:159], v[48:63]
    v_exp_f32 v88, v88
    ds_read_b128 v[144:147], v11 offset:35840
    s_and_b32 s22, s51, 15
    s_lshl_b32 s22, s22, 2
    s_add_u32 s22, s22, s29
    s_mul_i32 s23, s22, 48
    s_mul_i32 s22, s22, 96
    buffer_load_dword v170, v174, s[88:91], s23 offen
    s_add_u32 s24, s22, 7380992
    buffer_load_dwordx2 v[160:161], v173, s[4:7], s24 offen
    s_add_u32 s24, s22, 7387136
    buffer_load_dwordx2 v[162:163], v173, s[4:7], s24 offen
    s_add_u32 s24, s22, 7393280
    buffer_load_dwordx2 v[164:165], v173, s[4:7], s24 offen
    s_add_u32 s24, s22, 7399424
    buffer_load_dwordx2 v[166:167], v173, s[4:7], s24 offen
    s_add_u32 s24, s22, 7405568
    buffer_load_dwordx2 v[168:169], v173, s[4:7], s24 offen
    v_exp_f32 v89, v89
    v_exp_f32 v90, v90
    v_smfmac_f32_32x32x32_bf16 v[112:127], v[136:139], v[80:87], v30
    v_exp_f32 v91, v91
    v_exp_f32 v92, v92
    v_exp_f32 v93, v93
    v_exp_f32 v94, v94
    v_exp_f32 v95, v95
    s_setprio 0
    v_exp_f32 v32, v32
    v_exp_f32 v33, v33
    v_smfmac_f32_32x32x32_bf16 v[112:127], v[140:143], v[88:95], v30
    v_exp_f32 v34, v34
    s_mov_b64 exec, s[40:41]
    ds_read_b128 v[136:139], v4 offset:35840
    ds_read_b128 v[140:143], v4 offset:36480
    s_mov_b64 exec, -1
    v_exp_f32 v35, v35
    v_exp_f32 v36, v36
    s_waitcnt lgkmcnt(2)
    v_mfma_f32_32x32x4_2b_bf16 v[64:95], v[148:149], v[150:151], 0 cbsz:1 abid:1
    v_exp_f32 v37, v37
    v_exp_f32 v38, v38
    v_exp_f32 v39, v39
    v_exp_f32 v40, v40
    v_exp_f32 v41, v41
    v_exp_f32 v42, v42
    v_exp_f32 v43, v43
    v_exp_f32 v44, v44
    v_smfmac_f32_32x32x32_bf16 v[96:111], v[128:131], v[32:39], v30
    v_exp_f32 v45, v45
    s_lshl_b32 s43, s51, 2
    s_add_u32 s43, s43, s29
    s_mul_i32 s43, s43, 15360
    s_add_u32 s24, s43, 2785280
    s_mov_b64 exec, 0xfff
    buffer_load_dword v28, v29, s[4:7], s24 offen
    s_mov_b64 exec, -1
    v_exp_f32 v46, v46
    v_exp_f32 v47, v47
    v_exp_f32 v48, v48
    v_exp_f32 v49, v49
    v_smfmac_f32_32x32x32_bf16 v[96:111], v[132:135], v[40:47], v30
    v_exp_f32 v50, v50
    v_exp_f32 v51, v51
    v_exp_f32 v52, v52
    v_mfma_f32_32x32x16_bf16 v[64:79], v[144:147], v[152:155], v[64:79]
    v_exp_f32 v53, v53
    v_exp_f32 v54, v54
    v_exp_f32 v55, v55
    v_mfma_f32_32x32x16_bf16 v[80:95], v[144:147], v[156:159], v[80:95]
    v_exp_f32 v56, v56
    s_waitcnt lgkmcnt(0)
    s_barrier
    ds_read_b64 v[148:149], v3 offset:40960
    ds_read_b128 v[144:147], v11 offset:40960
    v_exp_f32 v57, v57
    v_exp_f32 v58, v58
    v_smfmac_f32_32x32x32_bf16 v[112:127], v[128:131], v[48:55], v30
    v_exp_f32 v59, v59
    v_exp_f32 v60, v60
    v_exp_f32 v61, v61
    v_exp_f32 v62, v62
    v_exp_f32 v63, v63
    s_setprio 3
    v_exp_f32 v64, v64
    v_exp_f32 v65, v65
    v_smfmac_f32_32x32x32_bf16 v[112:127], v[132:135], v[56:63], v30
    v_exp_f32 v66, v66
    s_mov_b64 exec, s[40:41]
    ds_read_b128 v[128:131], v4 offset:40960
    ds_read_b128 v[132:135], v4 offset:41600
    s_mov_b64 exec, -1
    v_exp_f32 v67, v67
    v_exp_f32 v68, v68
    s_waitcnt lgkmcnt(2)
    v_mfma_f32_32x32x4_2b_bf16 v[32:63], v[148:149], v[150:151], 0 cbsz:1 abid:0
    v_exp_f32 v69, v69
    v_exp_f32 v70, v70
    v_exp_f32 v71, v71
    v_exp_f32 v72, v72
    v_exp_f32 v73, v73
    v_exp_f32 v74, v74
    v_exp_f32 v75, v75
    v_exp_f32 v76, v76
    v_smfmac_f32_32x32x32_bf16 v[96:111], v[136:139], v[64:71], v30
    v_exp_f32 v77, v77
    s_add_u32 s24, s43, 2786816
    s_mov_b64 exec, 0xfff
    buffer_load_dword v28, v29, s[4:7], s24 offen
    s_mov_b64 exec, -1
    v_exp_f32 v78, v78
    v_exp_f32 v79, v79
    v_exp_f32 v80, v80
    v_exp_f32 v81, v81
    v_smfmac_f32_32x32x32_bf16 v[96:111], v[140:143], v[72:79], v30
    v_exp_f32 v82, v82
    v_exp_f32 v83, v83
    v_exp_f32 v84, v84
    v_mfma_f32_32x32x16_bf16 v[32:47], v[144:147], v[152:155], v[32:47]
    v_exp_f32 v85, v85
    v_exp_f32 v86, v86
    v_exp_f32 v87, v87
    v_mfma_f32_32x32x16_bf16 v[48:63], v[144:147], v[156:159], v[48:63]
    v_exp_f32 v88, v88
    ds_read_b128 v[144:147], v11 offset:46080
    v_exp_f32 v89, v89
    v_exp_f32 v90, v90
    v_smfmac_f32_32x32x32_bf16 v[112:127], v[136:139], v[80:87], v30
    v_exp_f32 v91, v91
    v_exp_f32 v92, v92
    v_exp_f32 v93, v93
    v_exp_f32 v94, v94
    v_exp_f32 v95, v95
    s_setprio 2
    v_exp_f32 v32, v32
    v_exp_f32 v33, v33
    v_smfmac_f32_32x32x32_bf16 v[112:127], v[140:143], v[88:95], v30
    v_exp_f32 v34, v34
    s_mov_b64 exec, s[40:41]
    ds_read_b128 v[136:139], v4 offset:46080
    ds_read_b128 v[140:143], v4 offset:46720
    s_mov_b64 exec, -1
    v_exp_f32 v35, v35
    v_exp_f32 v36, v36
    s_waitcnt lgkmcnt(2)
    v_mfma_f32_32x32x4_2b_bf16 v[64:95], v[148:149], v[150:151], 0 cbsz:1 abid:1
    v_exp_f32 v37, v37
    v_exp_f32 v38, v38
    v_exp_f32 v39, v39
    v_exp_f32 v40, v40
    v_exp_f32 v41, v41
    v_exp_f32 v42, v42
    v_exp_f32 v43, v43
    v_exp_f32 v44, v44
    v_smfmac_f32_32x32x32_bf16 v[96:111], v[128:131], v[32:39], v30
    v_exp_f32 v45, v45
    s_add_u32 s24, s43, 2788352
    s_mov_b64 exec, 0xfff
    buffer_load_dword v28, v29, s[4:7], s24 offen
    s_mov_b64 exec, -1
    v_exp_f32 v46, v46
    v_exp_f32 v47, v47
    v_exp_f32 v48, v48
    v_exp_f32 v49, v49
    v_smfmac_f32_32x32x32_bf16 v[96:111], v[132:135], v[40:47], v30
    v_exp_f32 v50, v50
    v_exp_f32 v51, v51
    v_exp_f32 v52, v52
    v_mfma_f32_32x32x16_bf16 v[64:79], v[144:147], v[152:155], v[64:79]
    v_exp_f32 v53, v53
    v_exp_f32 v54, v54
    v_exp_f32 v55, v55
    v_mfma_f32_32x32x16_bf16 v[80:95], v[144:147], v[156:159], v[80:95]
    v_exp_f32 v56, v56
    ds_read_b64 v[148:149], v3 offset:51200
    ds_read_b128 v[144:147], v11 offset:51200
    v_exp_f32 v57, v57
    v_exp_f32 v58, v58
    v_smfmac_f32_32x32x32_bf16 v[112:127], v[128:131], v[48:55], v30
    v_exp_f32 v59, v59
    v_exp_f32 v60, v60
    v_exp_f32 v61, v61
    v_exp_f32 v62, v62
    v_exp_f32 v63, v63
    s_setprio 1
    v_exp_f32 v64, v64
    v_exp_f32 v65, v65
    v_smfmac_f32_32x32x32_bf16 v[112:127], v[132:135], v[56:63], v30
    v_exp_f32 v66, v66
    s_mov_b64 exec, s[40:41]
    ds_read_b128 v[128:131], v4 offset:51200
    ds_read_b128 v[132:135], v4 offset:51840
    s_mov_b64 exec, -1
    v_exp_f32 v67, v67
    v_exp_f32 v68, v68
    s_waitcnt lgkmcnt(2)
    v_mfma_f32_32x32x4_2b_bf16 v[32:63], v[148:149], v[150:151], 0 cbsz:1 abid:0
    v_exp_f32 v69, v69
    v_exp_f32 v70, v70
    v_exp_f32 v71, v71
    v_exp_f32 v72, v72
    v_exp_f32 v73, v73
    v_exp_f32 v74, v74
    v_exp_f32 v75, v75
    v_exp_f32 v76, v76
    v_smfmac_f32_32x32x32_bf16 v[96:111], v[136:139], v[64:71], v30
    v_exp_f32 v77, v77
    s_add_u32 s24, s43, 2789888
    s_mov_b64 exec, 0xfff
    buffer_load_dword v28, v29, s[4:7], s24 offen
    s_mov_b64 exec, -1
    v_exp_f32 v78, v78
    v_exp_f32 v79, v79
    v_exp_f32 v80, v80
    v_exp_f32 v81, v81
    v_smfmac_f32_32x32x32_bf16 v[96:111], v[140:143], v[72:79], v30
    v_exp_f32 v82, v82
    v_exp_f32 v83, v83
    v_exp_f32 v84, v84
    v_mfma_f32_32x32x16_bf16 v[32:47], v[144:147], v[152:155], v[32:47]
    v_exp_f32 v85, v85
    v_exp_f32 v86, v86
    v_exp_f32 v87, v87
    v_mfma_f32_32x32x16_bf16 v[48:63], v[144:147], v[156:159], v[48:63]
    v_exp_f32 v88, v88
    ds_read_b128 v[144:147], v11 offset:56320
    v_exp_f32 v89, v89
    v_exp_f32 v90, v90
    v_smfmac_f32_32x32x32_bf16 v[112:127], v[136:139], v[80:87], v30
    v_exp_f32 v91, v91
    v_exp_f32 v92, v92
    v_exp_f32 v93, v93
    v_exp_f32 v94, v94
    v_exp_f32 v95, v95
    s_setprio 0
    v_exp_f32 v32, v32
    v_exp_f32 v33, v33
    v_smfmac_f32_32x32x32_bf16 v[112:127], v[140:143], v[88:95], v30
    v_exp_f32 v34, v34
    s_mov_b64 exec, s[40:41]
    ds_read_b128 v[136:139], v4 offset:56320
    ds_read_b128 v[140:143], v4 offset:56960
    s_mov_b64 exec, -1
    v_exp_f32 v35, v35
    v_exp_f32 v36, v36
    s_waitcnt lgkmcnt(2)
    v_mfma_f32_32x32x4_2b_bf16 v[64:95], v[148:149], v[150:151], 0 cbsz:1 abid:1
    v_exp_f32 v37, v37
    v_exp_f32 v38, v38
    v_exp_f32 v39, v39
    v_exp_f32 v40, v40
    v_exp_f32 v41, v41
    v_exp_f32 v42, v42
    v_exp_f32 v43, v43
    v_exp_f32 v44, v44
    v_smfmac_f32_32x32x32_bf16 v[96:111], v[128:131], v[32:39], v30
    v_exp_f32 v45, v45
    s_add_u32 s24, s43, 2791424
    s_mov_b64 exec, 0xfff
    buffer_load_dword v28, v29, s[4:7], s24 offen
    s_mov_b64 exec, -1
    v_exp_f32 v46, v46
    v_exp_f32 v47, v47
    v_exp_f32 v48, v48
    v_exp_f32 v49, v49
    v_smfmac_f32_32x32x32_bf16 v[96:111], v[132:135], v[40:47], v30
    v_exp_f32 v50, v50
    v_exp_f32 v51, v51
    v_exp_f32 v52, v52
    v_mfma_f32_32x32x16_bf16 v[64:79], v[144:147], v[152:155], v[64:79]
    v_exp_f32 v53, v53
    v_exp_f32 v54, v54
    v_exp_f32 v55, v55
    v_mfma_f32_32x32x16_bf16 v[80:95], v[144:147], v[156:159], v[80:95]
    v_exp_f32 v56, v56
    s_waitcnt vmcnt(19)
    s_waitcnt lgkmcnt(0)
    s_barrier
    s_or_b32 s22, s20, s50
    s_cbranch_scc1 L_nopub_35
    v_mov_b32 v8, s55
    s_mov_b64 exec, 1
    buffer_atomic_add v8, v26, s[56:59], 0 offen sc1
    s_mov_b64 exec, -1
L_nopub_35:
    ds_read_b64 v[148:149], v3 offset:0
    ds_read_b128 v[144:147], v11 offset:0
    v_exp_f32 v57, v57
    v_exp_f32 v58, v58
    v_smfmac_f32_32x32x32_bf16 v[112:127], v[128:131], v[48:55], v30
    v_exp_f32 v59, v59
    v_exp_f32 v60, v60
    v_exp_f32 v61, v61
    v_exp_f32 v62, v62
    v_exp_f32 v63, v63
    s_setprio 3
    v_exp_f32 v64, v64
    v_exp_f32 v65, v65
    v_smfmac_f32_32x32x32_bf16 v[112:127], v[132:135], v[56:63], v30
    v_exp_f32 v66, v66
    s_mov_b64 exec, s[40:41]
    ds_read_b128 v[128:131], v4 offset:0
    ds_read_b128 v[132:135], v4 offset:640
    s_mov_b64 exec, -1
    v_exp_f32 v67, v67
    v_exp_f32 v68, v68
    s_waitcnt lgkmcnt(2)
    v_mfma_f32_32x32x4_2b_bf16 v[32:63], v[148:149], v[150:151], 0 cbsz:1 abid:0
    v_exp_f32 v69, v69
    v_exp_f32 v70, v70
    v_exp_f32 v71, v71
    v_exp_f32 v72, v72
    v_exp_f32 v73, v73
    v_exp_f32 v74, v74
    v_exp_f32 v75, v75
    v_exp_f32 v76, v76
    v_smfmac_f32_32x32x32_bf16 v[96:111], v[136:139], v[64:71], v30
    v_exp_f32 v77, v77
    s_add_u32 s24, s43, 2792960
    s_mov_b64 exec, 0xfff
    buffer_load_dword v28, v29, s[4:7], s24 offen
    s_mov_b64 exec, -1
    v_exp_f32 v78, v78
    v_exp_f32 v79, v79
    v_exp_f32 v80, v80
    v_exp_f32 v81, v81
    v_smfmac_f32_32x32x32_bf16 v[96:111], v[140:143], v[72:79], v30
    v_exp_f32 v82, v82
    v_exp_f32 v83, v83
    v_exp_f32 v84, v84
    v_mfma_f32_32x32x16_bf16 v[32:47], v[144:147], v[152:155], v[32:47]
    v_exp_f32 v85, v85
    v_exp_f32 v86, v86
    v_exp_f32 v87, v87
    v_mfma_f32_32x32x16_bf16 v[48:63], v[144:147], v[156:159], v[48:63]
    v_exp_f32 v88, v88
    ds_read_b128 v[144:147], v11 offset:5120
    v_exp_f32 v89, v89
    v_exp_f32 v90, v90
    v_smfmac_f32_32x32x32_bf16 v[112:127], v[136:139], v[80:87], v30
    v_exp_f32 v91, v91
    v_exp_f32 v92, v92
    v_exp_f32 v93, v93
    v_exp_f32 v94, v94
    v_exp_f32 v95, v95
    s_setprio 2
    v_exp_f32 v32, v32
    v_exp_f32 v33, v33
    v_smfmac_f32_32x32x32_bf16 v[112:127], v[140:143], v[88:95], v30
    v_exp_f32 v34, v34
    s_mov_b64 exec, s[40:41]
    ds_read_b128 v[136:139], v4 offset:5120
    ds_read_b128 v[140:143], v4 offset:5760
    s_mov_b64 exec, -1
    v_exp_f32 v35, v35
    v_exp_f32 v36, v36
    s_waitcnt lgkmcnt(2)
    v_mfma_f32_32x32x4_2b_bf16 v[64:95], v[148:149], v[150:151], 0 cbsz:1 abid:1
    v_exp_f32 v37, v37
    v_exp_f32 v38, v38
    v_exp_f32 v39, v39
    v_exp_f32 v40, v40
    v_exp_f32 v41, v41
    v_exp_f32 v42, v42
    v_exp_f32 v43, v43
    v_exp_f32 v44, v44
    v_smfmac_f32_32x32x32_bf16 v[96:111], v[128:131], v[32:39], v30
    v_exp_f32 v45, v45
    s_add_u32 s24, s43, 2794496
    s_mov_b64 exec, 0xfff
    buffer_load_dword v28, v29, s[4:7], s24 offen
    s_mov_b64 exec, -1
    v_exp_f32 v46, v46
    v_exp_f32 v47, v47
    v_exp_f32 v48, v48
    v_exp_f32 v49, v49
    v_smfmac_f32_32x32x32_bf16 v[96:111], v[132:135], v[40:47], v30
    v_exp_f32 v50, v50
    v_exp_f32 v51, v51
    v_exp_f32 v52, v52
    v_mfma_f32_32x32x16_bf16 v[64:79], v[144:147], v[152:155], v[64:79]
    v_exp_f32 v53, v53
    v_exp_f32 v54, v54
    v_exp_f32 v55, v55
    v_mfma_f32_32x32x16_bf16 v[80:95], v[144:147], v[156:159], v[80:95]
    v_exp_f32 v56, v56
    ds_read_b64 v[148:149], v3 offset:10240
    ds_read_b128 v[144:147], v11 offset:10240
    s_cmp_lg_u32 s20, 3
    s_cbranch_scc1 L_ncp_36
    s_getpc_b64 s[22:23]
L_pc_37:
    s_sub_u32 s22, s22, L_pc_37-L_text_begin
    s_subb_u32 s23, s23, 0
    s_mul_i32 s24, s51, 128*((L_text_end-L_text_begin+4095)/4096)
    v_lshlrev_b32 v31, 7, v0
    v_add_u32 v31, s24, v31
    v_min_u32 v31, L_text_end-L_text_begin-4, v31
    v_cmp_gt_u32 vcc, (L_text_end-L_text_begin+4095)/4096, v0
    s_and_saveexec_b64 s[24:25], vcc
    global_load_dword v28, v31, s[22:23]
    s_mov_b64 exec, -1
L_ncp_36:
    v_exp_f32 v57, v57
    v_exp_f32 v58, v58
    v_smfmac_f32_32x32x32_bf16 v[112:127], v[128:131], v[48:55], v30
    v_exp_f32 v59, v59
    v_exp_f32 v60, v60
    v_exp_f32 v61, v61
    v_exp_f32 v62, v62
    v_exp_f32 v63, v63
    s_setprio 1
    v_exp_f32 v64, v64
    v_exp_f32 v65, v65
    v_smfmac_f32_32x32x32_bf16 v[112:127], v[132:135], v[56:63], v30
    v_exp_f32 v66, v66
    s_mov_b64 exec, s[40:41]
    ds_read_b128 v[128:131], v4 offset:10240
    ds_read_b128 v[132:135], v4 offset:10880
    s_mov_b64 exec, -1
    v_exp_f32 v67, v67
    v_exp_f32 v68, v68
    s_waitcnt lgkmcnt(2)
    v_mfma_f32_32x32x4_2b_bf16 v[32:63], v[148:149], v[150:151], 0 cbsz:1 abid:0
    v_exp_f32 v69, v69
    v_exp_f32 v70, v70
    v_exp_f32 v71, v71
    v_exp_f32 v72, v72
    v_exp_f32 v73, v73
    v_exp_f32 v74, v74
    v_exp_f32 v75, v75
    v_exp_f32 v76, v76
    v_smfmac_f32_32x32x32_bf16 v[96:111], v[136:139], v[64:71], v30
    v_exp_f32 v77, v77
    s_add_u32 s24, s43, 2796032
    s_mov_b64 exec, 0xfff
    buffer_load_dword v28, v29, s[4:7], s24 offen
    s_mov_b64 exec, -1
    v_exp_f32 v78, v78
    v_exp_f32 v79, v79
    v_exp_f32 v80, v80
    v_exp_f32 v81, v81
    v_smfmac_f32_32x32x32_bf16 v[96:111], v[140:143], v[72:79], v30
    v_exp_f32 v82, v82
    v_exp_f32 v83, v83
    v_exp_f32 v84, v84
    v_mfma_f32_32x32x16_bf16 v[32:47], v[144:147], v[152:155], v[32:47]
    v_exp_f32 v85, v85
    v_exp_f32 v86, v86
    v_exp_f32 v87, v87
    v_mfma_f32_32x32x16_bf16 v[48:63], v[144:147], v[156:159], v[48:63]
    v_exp_f32 v88, v88
    ds_read_b128 v[144:147], v11 offset:15360
    v_exp_f32 v89, v89
    v_exp_f32 v90, v90
    v_smfmac_f32_32x32x32_bf16 v[112:127], v[136:139], v[80:87], v30
    v_exp_f32 v91, v91
    v_exp_f32 v92, v92
    v_exp_f32 v93, v93
    v_exp_f32 v94, v94
    v_exp_f32 v95, v95
    s_setprio 0
    v_exp_f32 v32, v32
    v_exp_f32 v33, v33
    v_smfmac_f32_32x32x32_bf16 v[112:127], v[140:143], v[88:95], v30
    v_exp_f32 v34, v34
    s_mov_b64 exec, s[40:41]
    ds_read_b128 v[136:139], v4 offset:15360
    ds_read_b128 v[140:143], v4 offset:16000
    s_mov_b64 exec, -1
    v_exp_f32 v35, v35
    v_exp_f32 v36, v36
    s_waitcnt lgkmcnt(2)
    v_mfma_f32_32x32x4_2b_bf16 v[64:95], v[148:149], v[150:151], 0 cbsz:1 abid:1
    v_exp_f32 v37, v37
    v_exp_f32 v38, v38
    v_exp_f32 v39, v39
    v_exp_f32 v40, v40
    v_exp_f32 v41, v41
    v_exp_f32 v42, v42
    v_exp_f32 v43, v43
    v_exp_f32 v44, v44
    v_smfmac_f32_32x32x32_bf16 v[96:111], v[128:131], v[32:39], v30
    v_exp_f32 v45, v45
    s_add_u32 s24, s43, 2797568
    s_mov_b64 exec, 0xfff
    buffer_load_dword v28, v29, s[4:7], s24 offen
    s_mov_b64 exec, -1
    v_exp_f32 v46, v46
    v_exp_f32 v47, v47
    v_exp_f32 v48, v48
    v_exp_f32 v49, v49
    v_smfmac_f32_32x32x32_bf16 v[96:111], v[132:135], v[40:47], v30
    v_exp_f32 v50, v50
    v_exp_f32 v51, v51
    v_exp_f32 v52, v52
    v_mfma_f32_32x32x16_bf16 v[64:79], v[144:147], v[152:155], v[64:79]
    v_exp_f32 v53, v53
    v_exp_f32 v54, v54
    v_exp_f32 v55, v55
    v_mfma_f32_32x32x16_bf16 v[80:95], v[144:147], v[156:159], v[80:95]
    v_exp_f32 v56, v56
    s_waitcnt lgkmcnt(0)
    s_barrier
    ds_read_b64 v[148:149], v3 offset:20480
    ds_read_b128 v[144:147], v11 offset:20480
    v_exp_f32 v57, v57
    v_exp_f32 v58, v58
    v_smfmac_f32_32x32x32_bf16 v[112:127], v[128:131], v[48:55], v30
    v_exp_f32 v59, v59
    v_exp_f32 v60, v60
    v_exp_f32 v61, v61
    v_exp_f32 v62, v62
    v_exp_f32 v63, v63
    s_setprio 3
    v_exp_f32 v64, v64
    v_exp_f32 v65, v65
    v_smfmac_f32_32x32x32_bf16 v[112:127], v[132:135], v[56:63], v30
    v_exp_f32 v66, v66
    s_mov_b64 exec, s[40:41]
    ds_read_b128 v[128:131], v4 offset:20480
    ds_read_b128 v[132:135], v4 offset:21120
    s_mov_b64 exec, -1
    v_exp_f32 v67, v67
    v_exp_f32 v68, v68
    s_waitcnt lgkmcnt(2)
    v_mfma_f32_32x32x4_2b_bf16 v[32:63], v[148:149], v[150:151], 0 cbsz:1 abid:0
    v_exp_f32 v69, v69
    v_exp_f32 v70, v70
    v_exp_f32 v71, v71
    v_exp_f32 v72, v72
    v_exp_f32 v73, v73
    v_exp_f32 v74, v74
    v_exp_f32 v75, v75
    v_exp_f32 v76, v76
    v_smfmac_f32_32x32x32_bf16 v[96:111], v[136:139], v[64:71], v30
    v_exp_f32 v77, v77
    s_waitcnt vmcnt(9)
    v_add_f32 v160, v160, v162
    v_add_f32 v161, v161, v163
    v_add_f32 v160, v160, v164
    v_add_f32 v161, v161, v165
    v_add_f32 v160, v160, v166
    v_add_f32 v161, v161, v167
    v_add_f32 v160, v160, v168
    v_add_f32 v161, v161, v169
    v_and_b32 v171, 0xffff0000, v170
    v_lshlrev_b32 v170, 16, v170
    v_mov_b32 v162, v160
    v_mov_b32 v163, v161
    s_nop 0
    v_permlane16_swap_b32 v160, v162
    v_permlane16_swap_b32 v161, v163
    v_add_f32 v160, v160, v162
    v_add_f32 v161, v161, v163
    v_mov_b32 v162, v160
    v_mov_b32 v163, v161
    s_nop 0
    v_permlane32_swap_b32 v160, v162
    v_permlane32_swap_b32 v161, v163
    v_add_f32 v160, v160, v162
    v_add_f32 v161, v161, v163
    ds_write_b64 v172, v[160:161]
    ds_write_b64 v172, v[170:171] offset:384
    s_waitcnt lgkmcnt(0)
    s_add_u32 s24, s43, 2799104
    s_mov_b64 exec, 0xfff
    buffer_load_dword v28, v29, s[4:7], s24 offen
    s_mov_b64 exec, -1
    v_exp_f32 v78, v78
    v_exp_f32 v79, v79
    v_exp_f32 v80, v80
    v_exp_f32 v81, v81
    v_smfmac_f32_32x32x32_bf16 v[96:111], v[140:143], v[72:79], v30
    v_exp_f32 v82, v82
    v_exp_f32 v83, v83
    v_exp_f32 v84, v84
    v_mfma_f32_32x32x16_bf16 v[32:47], v[144:147], v[152:155], v[32:47]
    v_exp_f32 v85, v85
    v_exp_f32 v86, v86
    v_exp_f32 v87, v87
    v_mfma_f32_32x32x16_bf16 v[48:63], v[144:147], v[156:159], v[48:63]
    v_exp_f32 v88, v88
    ds_read_b128 v[144:147], v11 offset:25600
    v_exp_f32 v89, v89
    v_exp_f32 v90, v90
    v_smfmac_f32_32x32x32_bf16 v[112:127], v[136:139], v[80:87], v30
    v_exp_f32 v91, v91
    v_exp_f32 v92, v92
    v_exp_f32 v93, v93
    v_exp_f32 v94, v94
    v_exp_f32 v95, v95
    s_setprio 2
    v_exp_f32 v32, v32
    v_exp_f32 v33, v33
    v_smfmac_f32_32x32x32_bf16 v[112:127], v[140:143], v[88:95], v30
    v_exp_f32 v34, v34
    s_mov_b64 exec, s[40:41]
    ds_read_b128 v[136:139], v4 offset:25600
    ds_read_b128 v[140:143], v4 offset:26240
    s_mov_b64 exec, -1
    v_exp_f32 v35, v35
    v_exp_f32 v36, v36
    s_waitcnt lgkmcnt(2)
    v_mfma_f32_32x32x4_2b_bf16 v[64:95], v[148:149], v[150:151], 0 cbsz:1 abid:1
    v_exp_f32 v37, v37
    v_exp_f32 v38, v38
    v_exp_f32 v39, v39
    v_exp_f32 v40, v40
    v_exp_f32 v41, v41
    v_exp_f32 v42, v42
    v_exp_f32 v43, v43
    v_exp_f32 v44, v44
    v_smfmac_f32_32x32x32_bf16 v[96:111], v[128:131], v[32:39], v30
    v_exp_f32 v45, v45
    v_exp_f32 v46, v46
    v_exp_f32 v47, v47
    v_exp_f32 v48, v48
    v_exp_f32 v49, v49
    v_smfmac_f32_32x32x32_bf16 v[96:111], v[132:135], v[40:47], v30
    v_exp_f32 v50, v50
    v_exp_f32 v51, v51
    v_exp_f32 v52, v52
    v_mfma_f32_32x32x16_bf16 v[64:79], v[144:147], v[152:155], v[64:79]
    v_exp_f32 v53, v53
    v_exp_f32 v54, v54
    v_exp_f32 v55, v55
    v_mfma_f32_32x32x16_bf16 v[80:95], v[144:147], v[156:159], v[80:95]
    v_exp_f32 v56, v56
    ds_read_b64 v[148:149], v3 offset:30720
    ds_read_b128 v[144:147], v11 offset:30720
    v_exp_f32 v57, v57
    v_exp_f32 v58, v58
    v_smfmac_f32_32x32x32_bf16 v[112:127], v[128:131], v[48:55], v30
    v_exp_f32 v59, v59
    v_exp_f32 v60, v60
    v_exp_f32 v61, v61
    v_exp_f32 v62, v62
    v_exp_f32 v63, v63
    s_setprio 1
    v_exp_f32 v64, v64
    v_exp_f32 v65, v65
    v_smfmac_f32_32x32x32_bf16 v[112:127], v[132:135], v[56:63], v30
    v_exp_f32 v66, v66
    s_mov_b64 exec, s[40:41]
    ds_read_b128 v[128:131], v4 offset:30720
    ds_read_b128 v[132:135], v4 offset:31360
    s_mov_b64 exec, -1
    v_exp_f32 v67, v67
    v_exp_f32 v68, v68
    s_waitcnt lgkmcnt(2)
    v_mfma_f32_32x32x4_2b_bf16 v[32:63], v[148:149], v[150:151], 0 cbsz:1 abid:0
    v_exp_f32 v69, v69
    v_exp_f32 v70, v70
    v_exp_f32 v71, v71
    v_exp_f32 v72, v72
    v_exp_f32 v73, v73
    v_exp_f32 v74, v74
    v_exp_f32 v75, v75
    v_exp_f32 v76, v76
    v_smfmac_f32_32x32x32_bf16 v[96:111], v[136:139], v[64:71], v30
    v_exp_f32 v77, v77
    v_lshrrev_b32 v31, 2, v0
    v_lshlrev_b32 v31, 13, v31
    v_and_b32 v27, 3, v0
    v_lshl_add_u32 v31, v27, 7, v31
    s_lshl_b32 s24, s21, 9
    s_add_u32 s24, s24, s52
    s_add_u32 s24, s24, 12288
    s_mov_b64 exec, 0xfff
    buffer_load_dword v28, v31, s[4:7], s24 offen sc1
    s_mov_b64 exec, -1
    v_exp_f32 v78, v78
    v_exp_f32 v79, v79
    v_exp_f32 v80, v80
    v_exp_f32 v81, v81
    v_smfmac_f32_32x32x32_bf16 v[96:111], v[140:143], v[72:79], v30
    v_exp_f32 v82, v82
    v_exp_f32 v83, v83
    v_exp_f32 v84, v84
    v_mfma_f32_32x32x16_bf16 v[32:47], v[144:147], v[152:155], v[32:47]
    v_exp_f32 v85, v85
    v_exp_f32 v86, v86
    v_exp_f32 v87, v87
    v_mfma_f32_32x32x16_bf16 v[48:63], v[144:147], v[156:159], v[48:63]
    v_exp_f32 v88, v88
    ds_read_b128 v[144:147], v11 offset:35840
    buffer_load_dword v27, v26, s[56:59], 0 offen sc1
    v_exp_f32 v89, v89
    v_exp_f32 v90, v90
    v_smfmac_f32_32x32x32_bf16 v[112:127], v[136:139], v[80:87], v30
    v_exp_f32 v91, v91
    v_exp_f32 v92, v92
    v_exp_f32 v93, v93
    v_exp_f32 v94, v94
    v_exp_f32 v95, v95
    s_setprio 0
    v_exp_f32 v32, v32
    v_exp_f32 v33, v33
    v_smfmac_f32_32x32x32_bf16 v[112:127], v[140:143], v[88:95], v30
    v_exp_f32 v34, v34
    s_mov_b64 exec, s[40:41]
    ds_read_b128 v[136:139], v4 offset:35840
    ds_read_b128 v[140:143], v4 offset:36480
    s_mov_b64 exec, -1
    v_exp_f32 v35, v35
    v_exp_f32 v36, v36
    s_waitcnt lgkmcnt(2)
    v_mfma_f32_32x32x4_2b_bf16 v[64:95], v[148:149], v[150:151], 0 cbsz:1 abid:1
    v_exp_f32 v37, v37
    v_exp_f32 v38, v38
    v_exp_f32 v39, v39
    v_exp_f32 v40, v40
    v_exp_f32 v41, v41
    v_exp_f32 v42, v42
    v_exp_f32 v43, v43
    v_exp_f32 v44, v44
    v_smfmac_f32_32x32x32_bf16 v[96:111], v[128:131], v[32:39], v30
    v_exp_f32 v45, v45
    v_exp_f32 v46, v46
    v_exp_f32 v47, v47
    v_exp_f32 v48, v48
    v_exp_f32 v49, v49
    v_smfmac_f32_32x32x32_bf16 v[96:111], v[132:135], v[40:47], v30
    v_exp_f32 v50, v50
    v_exp_f32 v51, v51
    v_exp_f32 v52, v52
    v_mfma_f32_32x32x16_bf16 v[80:95], v[144:147], v[156:159], v[80:95]
    v_exp_f32 v53, v53
    v_exp_f32 v54, v54
    v_exp_f32 v55, v55
    v_mfma_f32_32x32x16_bf16 v[64:79], v[144:147], v[152:155], v[64:79]
    v_exp_f32 v56, v56
    v_exp_f32 v57, v57
    v_exp_f32 v58, v58
    v_smfmac_f32_32x32x32_bf16 v[112:127], v[128:131], v[48:55], v30
    v_exp_f32 v59, v59
    v_exp_f32 v60, v60
    v_exp_f32 v61, v61
    v_exp_f32 v62, v62
    v_exp_f32 v63, v63
    s_setprio 3
    v_exp_f32 v80, v80
    v_exp_f32 v81, v81
    v_smfmac_f32_32x32x32_bf16 v[112:127], v[132:135], v[56:63], v30
    v_exp_f32 v82, v82
    v_exp_f32 v83, v83
    v_exp_f32 v84, v84
    v_exp_f32 v85, v85
    v_exp_f32 v86, v86
    v_exp_f32 v87, v87
    v_exp_f32 v88, v88
    v_exp_f32 v89, v89
    v_exp_f32 v90, v90
    v_exp_f32 v91, v91
    v_exp_f32 v92, v92
    s_waitcnt lgkmcnt(0)
    v_smfmac_f32_32x32x32_bf16 v[112:127], v[136:139], v[80:87], v30
    v_exp_f32 v93, v93
    v_exp_f32 v94, v94
    v_exp_f32 v95, v95
    v_exp_f32 v64, v64
    v_exp_f32 v65, v65
    v_smfmac_f32_32x32x32_bf16 v[112:127], v[140:143], v[88:95], v30
    v_exp_f32 v66, v66
    v_exp_f32 v67, v67
    v_exp_f32 v68, v68
    v_exp_f32 v69, v69
    v_exp_f32 v70, v70
    v_exp_f32 v71, v71
    v_exp_f32 v72, v72
    v_exp_f32 v73, v73
    v_exp_f32 v74, v74
    v_smfmac_f32_32x32x32_bf16 v[96:111], v[136:139], v[64:71], v30
    v_exp_f32 v75, v75
    v_exp_f32 v76, v76
    v_exp_f32 v77, v77
    ds_write_b128 v12, v[112:115] offset:0
    ds_write_b128 v12, v[116:119] offset:1024
    ds_write_b128 v12, v[120:123] offset:2048
    v_exp_f32 v78, v78
    v_exp_f32 v79, v79
    v_cmp_nle_f32 vcc, 0x1f800000, v120
    v_cmp_nle_f32 s[36:37], v120, v25
    v_smfmac_f32_32x32x32_bf16 v[96:111], v[140:143], v[72:79], v30
    s_setprio 0
    s_branch L_red_28
L_roleb_29:
    s_cmp_eq_u32 s50, 0
    s_cbranch_scc1 L_nos1_38
    s_barrier
    s_cmp_lg_u32 s29, 0
    s_cbranch_scc1 L_nopoll1_39
    s_mov_b32 s23, 200000
    s_mov_b32 s22, 7561216
    s_mov_b64 exec, 15
L_poll1_40:
    buffer_load_dword v10, v31, s[4:7], s22 offen sc1
    s_sub_u32 s23, s23, 1
    s_cbranch_scc1 L_nopoll1_39
    s_waitcnt vmcnt(0)
    v_cmp_gt_u32 vcc, 16, v10
    s_cbranch_vccnz L_poll1_40
L_nopoll1_39:
    s_mov_b64 exec, -1
    s_barrier
    s_lshl_b32 s30, s20, 10
    s_add_u32 m0, s30, 102400
    s_add_u32 s31, s26, s30
    buffer_load_dwordx4 v2, s[4:7], s31 offen sc1 lds
    buffer_load_dwordx4 v[152:155], v2, s[4:7], s36 offen sc1
    buffer_load_dwordx4 v[156:159], v2, s[4:7], s37 offen offset:1280 sc1
    buffer_load_dwordx2 v[150:151], v7, s[4:7], s28 offen offset:1024 sc1
    s_cmp_lt_u32 s20, 4
    s_cbranch_scc1 L_nl_41
    s_and_b32 s30, s29, 1
    s_lshl_b32 s30, s30, 10
    s_add_u32 s31, s26, s30
    s_add_u32 m0, s30, 110592
    s_add_u32 s24, s31, 8192
    buffer_load_dwordx4 v2, s[4:7], s24 offen offset:0 sc1 lds
L_nl_41:
L_nos1_38:
    s_waitcnt vmcnt(1)
    s_barrier
    ds_read_b64 v[148:149], v3 offset:0
    ds_read_b128 v[144:147], v11 offset:0
    s_mov_b64 exec, s[40:41]
    ds_read_b128 v[128:131], v4 offset:0
    ds_read_b128 v[132:135], v4 offset:640
    s_mov_b64 exec, -1
    s_lshl_b32 s30, s29, 10
    s_add_u32 s31, s26, s30
    s_add_u32 m0, s30, 112640
    s_add_u32 s24, s31, 491520
    buffer_load_dwordx4 v2, s[4:7], s24 offen offset:0 sc1 lds
    s_lshl_b32 s30, s29, 10
    s_add_u32 s31, s26, s30
    s_add_u32 m0, s30, 116736
    s_add_u32 s24, s31, 495616
    buffer_load_dwordx4 v2, s[4:7], s24 offen offset:0 sc1 lds
    s_and_b32 s30, s29, 1
    s_lshl_b32 s30, s30, 10
    s_add_u32 s31, s26, s30
    s_add_u32 m0, s30, 120832
    s_add_u32 s24, s31, 499712
    buffer_load_dwordx4 v2, s[4:7], s24 offen offset:0 sc1 lds
    s_waitcnt lgkmcnt(2)
    v_mfma_f32_32x32x4_2b_bf16 v[32:63], v[148:149], v[150:151], 0 cbsz:1 abid:0
    s_nop 15
    s_nop 1
    v_mfma_f32_32x32x16_bf16 v[32:47], v[144:147], v[152:155], v[32:47]
    v_mfma_f32_32x32x16_bf16 v[48:63], v[144:147], v[156:159], v[48:63]
    s_waitcnt vmcnt(3)
    s_barrier
    ds_read_b64 v[148:149], v3 offset:0
    ds_read_b128 v[144:147], v11 offset:5120
    s_lshl_b32 s30, s29, 10
    s_add_u32 s31, s26, s30
    s_add_u32 m0, s30, 122880
    s_add_u32 s24, s31, 983040
    buffer_load_dwordx4 v2, s[4:7], s24 offen offset:0 sc1 lds
    s_lshl_b32 s30, s29, 10
    s_add_u32 s31, s26, s30
    s_add_u32 m0, s30, 126976
    s_add_u32 s24, s31, 987136
    buffer_load_dwordx4 v2, s[4:7], s24 offen offset:0 sc1 lds
    s_and_b32 s30, s29, 1
    s_lshl_b32 s30, s30, 10
    s_add_u32 s31, s26, s30
    s_add_u32 m0, s30, 131072
    s_add_u32 s24, s31, 991232
    buffer_load_dwordx4 v2, s[4:7], s24 offen offset:0 sc1 lds
    s_nop 8
    s_setprio 0
    v_exp_f32 v32, v32
    v_exp_f32 v33, v33
    v_exp_f32 v34, v34
    s_mov_b64 exec, s[40:41]
    ds_read_b128 v[136:139], v4 offset:5120
    ds_read_b128 v[140:143], v4 offset:5760
    s_mov_b64 exec, -1
    v_exp_f32 v35, v35
    v_exp_f32 v36, v36
    s_waitcnt lgkmcnt(2)
    v_mfma_f32_32x32x4_2b_bf16 v[64:95], v[148:149], v[150:151], 0 cbsz:1 abid:1
    v_exp_f32 v37, v37
    v_exp_f32 v38, v38
    v_exp_f32 v39, v39
    v_exp_f32 v40, v40
    v_exp_f32 v41, v41
    v_exp_f32 v42, v42
    v_exp_f32 v43, v43
    v_exp_f32 v44, v44
    v_smfmac_f32_32x32x32_bf16 v[96:111], v[128:131], v[32:39], v30
    v_exp_f32 v45, v45
    v_exp_f32 v46, v46
    v_exp_f32 v47, v47
    v_exp_f32 v48, v48
    v_exp_f32 v49, v49
    v_smfmac_f32_32x32x32_bf16 v[96:111], v[132:135], v[40:47], v30
    v_exp_f32 v50, v50
    v_exp_f32 v51, v51
    v_exp_f32 v52, v52
    v_mfma_f32_32x32x16_bf16 v[64:79], v[144:147], v[152:155], v[64:79]
    v_exp_f32 v53, v53
    v_exp_f32 v54, v54
    v_exp_f32 v55, v55
    v_mfma_f32_32x32x16_bf16 v[80:95], v[144:147], v[156:159], v[80:95]
    v_exp_f32 v56, v56
    s_waitcnt vmcnt(3)
    s_barrier
    ds_read_b64 v[148:149], v3 offset:10240
    ds_read_b128 v[144:147], v11 offset:10240
    s_lshl_b32 s30, s29, 10
    s_add_u32 s31, s26, s30
    s_add_u32 m0, s30, 133120
    s_add_u32 s24, s31, 1474560
    buffer_load_dwordx4 v2, s[4:7], s24 offen offset:0 sc1 lds
    s_lshl_b32 s30, s29, 10
    s_add_u32 s31, s26, s30
    s_add_u32 m0, s30, 137216
    s_add_u32 s24, s31, 1478656
    buffer_load_dwordx4 v2, s[4:7], s24 offen offset:0 sc1 lds
    s_and_b32 s30, s29, 1
    s_lshl_b32 s30, s30, 10
    s_add_u32 s31, s26, s30
    s_add_u32 m0, s30, 141312
    s_add_u32 s24, s31, 1482752
    buffer_load_dwordx4 v2, s[4:7], s24 offen offset:0 sc1 lds
    v_exp_f32 v57, v57
    v_exp_f32 v58, v58
    v_smfmac_f32_32x32x32_bf16 v[112:127], v[128:131], v[48:55], v30
    v_exp_f32 v59, v59
    v_exp_f32 v60, v60
    v_exp_f32 v61, v61
    v_exp_f32 v62, v62
    v_exp_f32 v63, v63
    s_setprio 1
    v_exp_f32 v64, v64
    v_exp_f32 v65, v65
    v_smfmac_f32_32x32x32_bf16 v[112:127], v[132:135], v[56:63], v30
    v_exp_f32 v66, v66
    s_mov_b64 exec, s[40:41]
    ds_read_b128 v[128:131], v4 offset:10240
    ds_read_b128 v[132:135], v4 offset:10880
    s_mov_b64 exec, -1
    v_exp_f32 v67, v67
    v_exp_f32 v68, v68
    s_waitcnt lgkmcnt(2)
    v_mfma_f32_32x32x4_2b_bf16 v[32:63], v[148:149], v[150:151], 0 cbsz:1 abid:0
    v_exp_f32 v69, v69
    v_exp_f32 v70, v70
    v_exp_f32 v71, v71
    v_exp_f32 v72, v72
    v_exp_f32 v73, v73
    v_exp_f32 v74, v74
    v_exp_f32 v75, v75
    v_exp_f32 v76, v76
    v_smfmac_f32_32x32x32_bf16 v[96:111], v[136:139], v[64:71], v30
    v_exp_f32 v77, v77
    s_lshr_b32 s30, s29, 1
    s_mul_i32 s31, s30, 491520
    s_and_b32 s30, s29, 1
    s_mul_i32 s30, s30, 5120
    s_add_u32 s31, s31, s30
    s_add_u32 s31, s31, s26
    s_mul_i32 s30, s29, 5120
    s_add_u32 m0, s30, 143360
    s_add_u32 s24, s31, 1966080
    buffer_load_dwordx4 v2, s[4:7], s24 offen offset:0 sc1 lds
    buffer_load_dwordx4 v2, s[4:7], s24 offen offset:1024 sc1 lds
    buffer_load_dwordx4 v2, s[4:7], s24 offen offset:2048 sc1 lds
    v_exp_f32 v78, v78
    v_exp_f32 v79, v79
    v_exp_f32 v80, v80
    v_exp_f32 v81, v81
    v_smfmac_f32_32x32x32_bf16 v[96:111], v[140:143], v[72:79], v30
    v_exp_f32 v82, v82
    v_exp_f32 v83, v83
    v_exp_f32 v84, v84
    v_mfma_f32_32x32x16_bf16 v[32:47], v[144:147], v[152:155], v[32:47]
    v_exp_f32 v85, v85
    v_exp_f32 v86, v86
    v_exp_f32 v87, v87
    v_mfma_f32_32x32x16_bf16 v[48:63], v[144:147], v[156:159], v[48:63]
    v_exp_f32 v88, v88
    ds_read_b128 v[144:147], v11 offset:15360
    s_add_u32 m0, s30, 146432
    s_add_u32 s24, s31, 1969152
    buffer_load_dwordx4 v2, s[4:7], s24 offen offset:0 sc1 lds
    buffer_load_dwordx4 v2, s[4:7], s24 offen offset:1024 sc1 lds
    v_exp_f32 v89, v89
    v_exp_f32 v90, v90
    v_smfmac_f32_32x32x32_bf16 v[112:127], v[136:139], v[80:87], v30
    v_exp_f32 v91, v91
    v_exp_f32 v92, v92
    v_exp_f32 v93, v93
    v_exp_f32 v94, v94
    v_exp_f32 v95, v95
    s_setprio 0
    v_exp_f32 v32, v32
    v_exp_f32 v33, v33
    v_smfmac_f32_32x32x32_bf16 v[112:127], v[140:143], v[88:95], v30
    v_exp_f32 v34, v34
    s_mov_b64 exec, s[40:41]
    ds_read_b128 v[136:139], v4 offset:15360
    ds_read_b128 v[140:143], v4 offset:16000
    s_mov_b64 exec, -1
    v_exp_f32 v35, v35
    v_exp_f32 v36, v36
    s_waitcnt lgkmcnt(2)
    v_mfma_f32_32x32x4_2b_bf16 v[64:95], v[148:149], v[150:151], 0 cbsz:1 abid:1
    v_exp_f32 v37, v37
    v_exp_f32 v38, v38
    v_exp_f32 v39, v39
    v_exp_f32 v40, v40
    v_exp_f32 v41, v41
    v_exp_f32 v42, v42
    v_exp_f32 v43, v43
    v_exp_f32 v44, v44
    v_smfmac_f32_32x32x32_bf16 v[96:111], v[128:131], v[32:39], v30
    v_exp_f32 v45, v45
    v_exp_f32 v46, v46
    v_exp_f32 v47, v47
    v_exp_f32 v48, v48
    v_exp_f32 v49, v49
    v_smfmac_f32_32x32x32_bf16 v[96:111], v[132:135], v[40:47], v30
    v_exp_f32 v50, v50
    v_exp_f32 v51, v51
    v_exp_f32 v52, v52
    v_mfma_f32_32x32x16_bf16 v[64:79], v[144:147], v[152:155], v[64:79]
    v_exp_f32 v53, v53
    v_exp_f32 v54, v54
    v_exp_f32 v55, v55
    v_mfma_f32_32x32x16_bf16 v[80:95], v[144:147], v[156:159], v[80:95]
    v_exp_f32 v56, v56
    s_waitcnt vmcnt(8)
    s_waitcnt lgkmcnt(0)
    s_barrier
    ds_read_b64 v[148:149], v3 offset:20480
    ds_read_b128 v[144:147], v11 offset:20480
    s_add_u32 m0, s30, 102400
    s_add_u32 s24, s31, 2949120
    buffer_load_dwordx4 v2, s[4:7], s24 offen offset:0 sc1 lds
    buffer_load_dwordx4 v2, s[4:7], s24 offen offset:1024 sc1 lds
    buffer_load_dwordx4 v2, s[4:7], s24 offen offset:2048 sc1 lds
    v_exp_f32 v57, v57
    v_exp_f32 v58, v58
    v_smfmac_f32_32x32x32_bf16 v[112:127], v[128:131], v[48:55], v30
    v_exp_f32 v59, v59
    v_exp_f32 v60, v60
    v_exp_f32 v61, v61
    v_exp_f32 v62, v62
    v_exp_f32 v63, v63
    s_setprio 1
    v_exp_f32 v64, v64
    v_exp_f32 v65, v65
    v_smfmac_f32_32x32x32_bf16 v[112:127], v[132:135], v[56:63], v30
    v_exp_f32 v66, v66
    s_mov_b64 exec, s[40:41]
    ds_read_b128 v[128:131], v4 offset:20480
    ds_read_b128 v[132:135], v4 offset:21120
    s_mov_b64 exec, -1
    v_exp_f32 v67, v67
    v_exp_f32 v68, v68
    s_waitcnt lgkmcnt(2)
    v_mfma_f32_32x32x4_2b_bf16 v[32:63], v[148:149], v[150:151], 0 cbsz:1 abid:0
    v_exp_f32 v69, v69
    v_exp_f32 v70, v70
    v_exp_f32 v71, v71
    v_exp_f32 v72, v72
    v_exp_f32 v73, v73
    v_exp_f32 v74, v74
    v_exp_f32 v75, v75
    v_exp_f32 v76, v76
    v_smfmac_f32_32x32x32_bf16 v[96:111], v[136:139], v[64:71], v30
    v_exp_f32 v77, v77
    s_add_u32 m0, s30, 105472
    s_add_u32 s24, s31, 2952192
    buffer_load_dwordx4 v2, s[4:7], s24 offen offset:0 sc1 lds
    buffer_load_dwordx4 v2, s[4:7], s24 offen offset:1024 sc1 lds
    v_exp_f32 v78, v78
    v_exp_f32 v79, v79
    v_exp_f32 v80, v80
    v_exp_f32 v81, v81
    v_smfmac_f32_32x32x32_bf16 v[96:111], v[140:143], v[72:79], v30
    v_exp_f32 v82, v82
    v_exp_f32 v83, v83
    v_exp_f32 v84, v84
    v_mfma_f32_32x32x16_bf16 v[32:47], v[144:147], v[152:155], v[32:47]
    v_exp_f32 v85, v85
    v_exp_f32 v86, v86
    v_exp_f32 v87, v87
    v_mfma_f32_32x32x16_bf16 v[48:63], v[144:147], v[156:159], v[48:63]
    v_exp_f32 v88, v88
    ds_read_b128 v[144:147], v11 offset:25600
    s_lshl_b32 s24, s50, 31
    s_or_b32 s24, s24, s38
    buffer_store_dwordx4 v[16:19], v20, s[4:7], s24 offen sc1
    buffer_store_dwordx2 v[16:17], v21, s[4:7], s24 offen sc1
    v_exp_f32 v89, v89
    v_exp_f32 v90, v90
    v_smfmac_f32_32x32x32_bf16 v[112:127], v[136:139], v[80:87], v30
    v_exp_f32 v91, v91
    v_exp_f32 v92, v92
    v_exp_f32 v93, v93
    v_exp_f32 v94, v94
    v_exp_f32 v95, v95
    s_setprio 0
    v_exp_f32 v32, v32
    v_exp_f32 v33, v33
    v_smfmac_f32_32x32x32_bf16 v[112:127], v[140:143], v[88:95], v30
    v_exp_f32 v34, v34
    s_mov_b64 exec, s[40:41]
    ds_read_b128 v[136:139], v4 offset:25600
    ds_read_b128 v[140:143], v4 offset:26240
    s_mov_b64 exec, -1
    v_exp_f32 v35, v35
    v_exp_f32 v36, v36
    s_waitcnt lgkmcnt(2)
    v_mfma_f32_32x32x4_2b_bf16 v[64:95], v[148:149], v[150:151], 0 cbsz:1 abid:1
    v_exp_f32 v37, v37
    v_exp_f32 v38, v38
    v_exp_f32 v39, v39
    v_exp_f32 v40, v40
    v_exp_f32 v41, v41
    v_exp_f32 v42, v42
    v_exp_f32 v43, v43
    v_exp_f32 v44, v44
    v_smfmac_f32_32x32x32_bf16 v[96:111], v[128:131], v[32:39], v30
    v_exp_f32 v45, v45
    s_add_u32 s24, s39, 843776
    buffer_load_dwordx4 v[160:163], v2, s[4:7], s24 offen offset:0
    buffer_load_dwordx4 v[164:167], v2, s[4:7], s24 offen offset:1024
    buffer_load_dwordx4 v[168:171], v2, s[4:7], s24 offen offset:2048
    v_exp_f32 v46, v46
    v_exp_f32 v47, v47
    v_exp_f32 v48, v48
    v_exp_f32 v49, v49
    v_smfmac_f32_32x32x32_bf16 v[96:111], v[132:135], v[40:47], v30
    v_exp_f32 v50, v50
    v_exp_f32 v51, v51
    v_exp_f32 v52, v52
    v_mfma_f32_32x32x16_bf16 v[64:79], v[144:147], v[152:155], v[64:79]
    v_exp_f32 v53, v53
    v_exp_f32 v54, v54
    v_exp_f32 v55, v55
    v_mfma_f32_32x32x16_bf16 v[80:95], v[144:147], v[156:159], v[80:95]
    v_exp_f32 v56, v56
    s_waitcnt vmcnt(15)
    s_barrier
    ds_read_b64 v[148:149], v3 offset:30720
    ds_read_b128 v[144:147], v11 offset:30720
    v_exp_f32 v57, v57
    v_exp_f32 v58, v58
    v_smfmac_f32_32x32x32_bf16 v[112:127], v[128:131], v[48:55], v30
    v_exp_f32 v59, v59
    v_exp_f32 v60, v60
    v_exp_f32 v61, v61
    v_exp_f32 v62, v62
    v_exp_f32 v63, v63
    s_setprio 1
    v_exp_f32 v64, v64
    v_exp_f32 v65, v65
    v_smfmac_f32_32x32x32_bf16 v[112:127], v[132:135], v[56:63], v30
    v_exp_f32 v66, v66
    s_mov_b64 exec, s[40:41]
    ds_read_b128 v[128:131], v4 offset:30720
    ds_read_b128 v[132:135], v4 offset:31360
    s_mov_b64 exec, -1
    v_exp_f32 v67, v67
    v_exp_f32 v68, v68
    s_waitcnt lgkmcnt(2)
    v_mfma_f32_32x32x4_2b_bf16 v[32:63], v[148:149], v[150:151], 0 cbsz:1 abid:0
    v_exp_f32 v69, v69
    v_exp_f32 v70, v70
    v_exp_f32 v71, v71
    v_exp_f32 v72, v72
    v_exp_f32 v73, v73
    v_exp_f32 v74, v74
    v_exp_f32 v75, v75
    v_exp_f32 v76, v76
    v_smfmac_f32_32x32x32_bf16 v[96:111], v[136:139], v[64:71], v30
    v_exp_f32 v77, v77
    s_add_u32 s24, s39, 856064
    buffer_load_dwordx4 v[172:175], v2, s[4:7], s24 offen offset:0
    buffer_load_dwordx4 v[176:179], v2, s[4:7], s24 offen offset:1024
    buffer_load_dwordx4 v[180:183], v2, s[4:7], s24 offen offset:2048
    v_exp_f32 v78, v78
    v_exp_f32 v79, v79
    v_exp_f32 v80, v80
    v_exp_f32 v81, v81
    v_smfmac_f32_32x32x32_bf16 v[96:111], v[140:143], v[72:79], v30
    v_exp_f32 v82, v82
    v_exp_f32 v83, v83
    v_exp_f32 v84, v84
    v_mfma_f32_32x32x16_bf16 v[32:47], v[144:147], v[152:155], v[32:47]
    v_exp_f32 v85, v85
    v_exp_f32 v86, v86
    v_exp_f32 v87, v87
    v_mfma_f32_32x32x16_bf16 v[48:63], v[144:147], v[156:159], v[48:63]
    v_exp_f32 v88, v88
    ds_read_b128 v[144:147], v11 offset:35840
    v_exp_f32 v89, v89
    v_exp_f32 v90, v90
    v_smfmac_f32_32x32x32_bf16 v[112:127], v[136:139], v[80:87], v30
    v_exp_f32 v91, v91
    v_exp_f32 v92, v92
    v_exp_f32 v93, v93
    v_exp_f32 v94, v94
    v_exp_f32 v95, v95
    s_setprio 0
    v_exp_f32 v32, v32
    v_exp_f32 v33, v33
    v_smfmac_f32_32x32x32_bf16 v[112:127], v[140:143], v[88:95], v30
    v_exp_f32 v34, v34
    s_mov_b64 exec, s[40:41]
    ds_read_b128 v[136:139], v4 offset:35840
    ds_read_b128 v[140:143], v4 offset:36480
    s_mov_b64 exec, -1
    v_exp_f32 v35, v35
    v_exp_f32 v36, v36
    s_waitcnt lgkmcnt(2)
    v_mfma_f32_32x32x4_2b_bf16 v[64:95], v[148:149], v[150:151], 0 cbsz:1 abid:1
    v_exp_f32 v37, v37
    v_exp_f32 v38, v38
    v_exp_f32 v39, v39
    v_exp_f32 v40, v40
    v_exp_f32 v41, v41
    v_exp_f32 v42, v42
    v_exp_f32 v43, v43
    v_exp_f32 v44, v44
    v_smfmac_f32_32x32x32_bf16 v[96:111], v[128:131], v[32:39], v30
    v_exp_f32 v45, v45
    v_exp_f32 v46, v46
    v_exp_f32 v47, v47
    v_exp_f32 v48, v48
    v_exp_f32 v49, v49
    v_smfmac_f32_32x32x32_bf16 v[96:111], v[132:135], v[40:47], v30
    v_exp_f32 v50, v50
    v_exp_f32 v51, v51
    v_exp_f32 v52, v52
    v_mfma_f32_32x32x16_bf16 v[64:79], v[144:147], v[152:155], v[64:79]
    v_exp_f32 v53, v53
    v_exp_f32 v54, v54
    v_exp_f32 v55, v55
    v_mfma_f32_32x32x16_bf16 v[80:95], v[144:147], v[156:159], v[80:95]
    v_exp_f32 v56, v56
    s_waitcnt vmcnt(13)
    s_waitcnt lgkmcnt(0)
    s_barrier
    ds_read_b64 v[148:149], v3 offset:40960
    ds_read_b128 v[144:147], v11 offset:40960
    s_add_u32 m0, s30, 122880
    s_add_u32 s24, s31, 3932160
    buffer_load_dwordx4 v2, s[4:7], s24 offen offset:0 sc1 lds
    buffer_load_dwordx4 v2, s[4:7], s24 offen offset:1024 sc1 lds
    buffer_load_dwordx4 v2, s[4:7], s24 offen offset:2048 sc1 lds
    v_exp_f32 v57, v57
    v_exp_f32 v58, v58
    v_smfmac_f32_32x32x32_bf16 v[112:127], v[128:131], v[48:55], v30
    v_exp_f32 v59, v59
    v_exp_f32 v60, v60
    v_exp_f32 v61, v61
    v_exp_f32 v62, v62
    v_exp_f32 v63, v63
    s_setprio 3
    v_exp_f32 v64, v64
    v_exp_f32 v65, v65
    v_smfmac_f32_32x32x32_bf16 v[112:127], v[132:135], v[56:63], v30
    v_exp_f32 v66, v66
    s_mov_b64 exec, s[40:41]
    ds_read_b128 v[128:131], v4 offset:40960
    ds_read_b128 v[132:135], v4 offset:41600
    s_mov_b64 exec, -1
    v_exp_f32 v67, v67
    v_exp_f32 v68, v68
    s_waitcnt lgkmcnt(2)
    v_mfma_f32_32x32x4_2b_bf16 v[32:63], v[148:149], v[150:151], 0 cbsz:1 abid:0
    v_exp_f32 v69, v69
    v_exp_f32 v70, v70
    v_exp_f32 v71, v71
    v_exp_f32 v72, v72
    v_exp_f32 v73, v73
    v_exp_f32 v74, v74
    v_exp_f32 v75, v75
    v_exp_f32 v76, v76
    v_smfmac_f32_32x32x32_bf16 v[96:111], v[136:139], v[64:71], v30
    v_exp_f32 v77, v77
    s_add_u32 m0, s30, 125952
    s_add_u32 s24, s31, 3935232
    buffer_load_dwordx4 v2, s[4:7], s24 offen offset:0 sc1 lds
    buffer_load_dwordx4 v2, s[4:7], s24 offen offset:1024 sc1 lds
    v_exp_f32 v78, v78
    v_exp_f32 v79, v79
    v_exp_f32 v80, v80
    v_exp_f32 v81, v81
    v_smfmac_f32_32x32x32_bf16 v[96:111], v[140:143], v[72:79], v30
    v_exp_f32 v82, v82
    v_exp_f32 v83, v83
    v_exp_f32 v84, v84
    v_mfma_f32_32x32x16_bf16 v[32:47], v[144:147], v[152:155], v[32:47]
    v_exp_f32 v85, v85
    v_exp_f32 v86, v86
    v_exp_f32 v87, v87
    v_mfma_f32_32x32x16_bf16 v[48:63], v[144:147], v[156:159], v[48:63]
    v_exp_f32 v88, v88
    ds_read_b128 v[144:147], v11 offset:46080
    v_exp_f32 v89, v89
    v_exp_f32 v90, v90
    v_smfmac_f32_32x32x32_bf16 v[112:127], v[136:139], v[80:87], v30
    v_exp_f32 v91, v91
    v_exp_f32 v92, v92
    v_exp_f32 v93, v93
    v_exp_f32 v94, v94
    v_exp_f32 v95, v95
    s_setprio 2
    v_exp_f32 v32, v32
    v_exp_f32 v33, v33
    v_smfmac_f32_32x32x32_bf16 v[112:127], v[140:143], v[88:95], v30
    v_exp_f32 v34, v34
    s_mov_b64 exec, s[40:41]
    ds_read_b128 v[136:139], v4 offset:46080
    ds_read_b128 v[140:143], v4 offset:46720
    s_mov_b64 exec, -1
    v_exp_f32 v35, v35
    v_exp_f32 v36, v36
    s_waitcnt lgkmcnt(2)
    v_mfma_f32_32x32x4_2b_bf16 v[64:95], v[148:149], v[150:151], 0 cbsz:1 abid:1
    v_exp_f32 v37, v37
    v_exp_f32 v38, v38
    v_exp_f32 v39, v39
    v_exp_f32 v40, v40
    v_exp_f32 v41, v41
    v_exp_f32 v42, v42
    v_exp_f32 v43, v43
    v_exp_f32 v44, v44
    v_smfmac_f32_32x32x32_bf16 v[96:111], v[128:131], v[32:39], v30
    v_exp_f32 v45, v45
    s_add_u32 s24, s39, 868352
    buffer_load_dwordx4 v[184:187], v2, s[4:7], s24 offen offset:0
    buffer_load_dwordx4 v[188:191], v2, s[4:7], s24 offen offset:1024
    buffer_load_dwordx4 v[192:195], v2, s[4:7], s24 offen offset:2048
    v_exp_f32 v46, v46
    v_exp_f32 v47, v47
    v_exp_f32 v48, v48
    v_exp_f32 v49, v49
    v_smfmac_f32_32x32x32_bf16 v[96:111], v[132:135], v[40:47], v30
    v_exp_f32 v50, v50
    v_exp_f32 v51, v51
    v_exp_f32 v52, v52
    v_mfma_f32_32x32x16_bf16 v[64:79], v[144:147], v[152:155], v[64:79]
    v_exp_f32 v53, v53
    v_exp_f32 v54, v54
    v_exp_f32 v55, v55
    v_mfma_f32_32x32x16_bf16 v[80:95], v[144:147], v[156:159], v[80:95]
    v_exp_f32 v56, v56
    ds_read_b64 v[148:149], v3 offset:51200
    ds_read_b128 v[144:147], v11 offset:51200
    v_exp_f32 v57, v57
    v_exp_f32 v58, v58
    v_smfmac_f32_32x32x32_bf16 v[112:127], v[128:131], v[48:55], v30
    v_exp_f32 v59, v59
    v_exp_f32 v60, v60
    v_exp_f32 v61, v61
    v_exp_f32 v62, v62
    v_exp_f32 v63, v63
    s_setprio 1
    v_exp_f32 v64, v64
    v_exp_f32 v65, v65
    v_smfmac_f32_32x32x32_bf16 v[112:127], v[132:135], v[56:63], v30
    v_exp_f32 v66, v66
    s_mov_b64 exec, s[40:41]
    ds_read_b128 v[128:131], v4 offset:51200
    ds_read_b128 v[132:135], v4 offset:51840
    s_mov_b64 exec, -1
    v_exp_f32 v67, v67
    v_exp_f32 v68, v68
    s_waitcnt lgkmcnt(2)
    v_mfma_f32_32x32x4_2b_bf16 v[32:63], v[148:149], v[150:151], 0 cbsz:1 abid:0
    v_exp_f32 v69, v69
    v_exp_f32 v70, v70
    v_exp_f32 v71, v71
    v_exp_f32 v72, v72
    v_exp_f32 v73, v73
    v_exp_f32 v74, v74
    v_exp_f32 v75, v75
    v_exp_f32 v76, v76
    v_smfmac_f32_32x32x32_bf16 v[96:111], v[136:139], v[64:71], v30
    v_exp_f32 v77, v77
    s_add_u32 s24, s39, 880640
    buffer_load_dwordx4 v[196:199], v2, s[4:7], s24 offen offset:0
    buffer_load_dwordx4 v[200:203], v2, s[4:7], s24 offen offset:1024
    buffer_load_dwordx4 v[204:207], v2, s[4:7], s24 offen offset:2048
    v_exp_f32 v78, v78
    v_exp_f32 v79, v79
    v_exp_f32 v80, v80
    v_exp_f32 v81, v81
    v_smfmac_f32_32x32x32_bf16 v[96:111], v[140:143], v[72:79], v30
    v_exp_f32 v82, v82
    v_exp_f32 v83, v83
    v_exp_f32 v84, v84
    v_mfma_f32_32x32x16_bf16 v[32:47], v[144:147], v[152:155], v[32:47]
    v_exp_f32 v85, v85
    v_exp_f32 v86, v86
    v_exp_f32 v87, v87
    v_mfma_f32_32x32x16_bf16 v[48:63], v[144:147], v[156:159], v[48:63]
    v_exp_f32 v88, v88
    ds_read_b128 v[144:147], v11 offset:56320
    v_exp_f32 v89, v89
    v_exp_f32 v90, v90
    v_smfmac_f32_32x32x32_bf16 v[112:127], v[136:139], v[80:87], v30
    v_exp_f32 v91, v91
    v_exp_f32 v92, v92
    v_exp_f32 v93, v93
    v_exp_f32 v94, v94
    v_exp_f32 v95, v95
    s_setprio 0
    v_exp_f32 v32, v32
    v_exp_f32 v33, v33
    v_smfmac_f32_32x32x32_bf16 v[112:127], v[140:143], v[88:95], v30
    v_exp_f32 v34, v34
    s_mov_b64 exec, s[40:41]
    ds_read_b128 v[136:139], v4 offset:56320
    ds_read_b128 v[140:143], v4 offset:56960
    s_mov_b64 exec, -1
    v_exp_f32 v35, v35
    v_exp_f32 v36, v36
    s_waitcnt lgkmcnt(2)
    v_mfma_f32_32x32x4_2b_bf16 v[64:95], v[148:149], v[150:151], 0 cbsz:1 abid:1
    v_exp_f32 v37, v37
    v_exp_f32 v38, v38
    v_exp_f32 v39, v39
    v_exp_f32 v40, v40
    v_exp_f32 v41, v41
    v_exp_f32 v42, v42
    v_exp_f32 v43, v43
    v_exp_f32 v44, v44
    v_smfmac_f32_32x32x32_bf16 v[96:111], v[128:131], v[32:39], v30
    v_exp_f32 v45, v45
    v_exp_f32 v46, v46
    v_exp_f32 v47, v47
    v_exp_f32 v48, v48
    v_exp_f32 v49, v49
    v_smfmac_f32_32x32x32_bf16 v[96:111], v[132:135], v[40:47], v30
    v_exp_f32 v50, v50
    v_exp_f32 v51, v51
    v_exp_f32 v52, v52
    v_mfma_f32_32x32x16_bf16 v[64:79], v[144:147], v[152:155], v[64:79]
    v_exp_f32 v53, v53
    v_exp_f32 v54, v54
    v_exp_f32 v55, v55
    v_mfma_f32_32x32x16_bf16 v[80:95], v[144:147], v[156:159], v[80:95]
    v_exp_f32 v56, v56
    s_waitcnt vmcnt(19)
    s_waitcnt lgkmcnt(0)
    s_barrier
    ds_read_b64 v[148:149], v3 offset:0
    ds_read_b128 v[144:147], v11 offset:0
    s_add_u32 m0, s30, 143360
    s_add_u32 s24, s31, 4915200
    buffer_load_dwordx4 v2, s[4:7], s24 offen offset:0 sc1 lds
    buffer_load_dwordx4 v2, s[4:7], s24 offen offset:1024 sc1 lds
    buffer_load_dwordx4 v2, s[4:7], s24 offen offset:2048 sc1 lds
    v_exp_f32 v57, v57
    v_exp_f32 v58, v58
    v_smfmac_f32_32x32x32_bf16 v[112:127], v[128:131], v[48:55], v30
    v_exp_f32 v59, v59
    v_exp_f32 v60, v60
    v_exp_f32 v61, v61
    v_exp_f32 v62, v62
    v_exp_f32 v63, v63
    s_setprio 3
    v_exp_f32 v64, v64
    v_exp_f32 v65, v65
    v_smfmac_f32_32x32x32_bf16 v[112:127], v[132:135], v[56:63], v30
    v_exp_f32 v66, v66
    s_mov_b64 exec, s[40:41]
    ds_read_b128 v[128:131], v4 offset:0
    ds_read_b128 v[132:135], v4 offset:640
    s_mov_b64 exec, -1
    v_exp_f32 v67, v67
    v_exp_f32 v68, v68
    s_waitcnt lgkmcnt(2)
    v_mfma_f32_32x32x4_2b_bf16 v[32:63], v[148:149], v[150:151], 0 cbsz:1 abid:0
    v_exp_f32 v69, v69
    v_exp_f32 v70, v70
    v_exp_f32 v71, v71
    v_exp_f32 v72, v72
    v_exp_f32 v73, v73
    v_exp_f32 v74, v74
    v_exp_f32 v75, v75
    v_exp_f32 v76, v76
    v_smfmac_f32_32x32x32_bf16 v[96:111], v[136:139], v[64:71], v30
    v_exp_f32 v77, v77
    s_add_u32 m0, s30, 146432
    s_add_u32 s24, s31, 4918272
    buffer_load_dwordx4 v2, s[4:7], s24 offen offset:0 sc1 lds
    buffer_load_dwordx4 v2, s[4:7], s24 offen offset:1024 sc1 lds
    v_exp_f32 v78, v78
    v_exp_f32 v79, v79
    v_exp_f32 v80, v80
    v_exp_f32 v81, v81
    v_smfmac_f32_32x32x32_bf16 v[96:111], v[140:143], v[72:79], v30
    v_exp_f32 v82, v82
    v_exp_f32 v83, v83
    v_exp_f32 v84, v84
    v_mfma_f32_32x32x16_bf16 v[32:47], v[144:147], v[152:155], v[32:47]
    v_exp_f32 v85, v85
    v_exp_f32 v86, v86
    v_exp_f32 v87, v87
    v_mfma_f32_32x32x16_bf16 v[48:63], v[144:147], v[156:159], v[48:63]
    v_exp_f32 v88, v88
    ds_read_b128 v[144:147], v11 offset:5120
    v_exp_f32 v89, v89
    v_exp_f32 v90, v90
    v_smfmac_f32_32x32x32_bf16 v[112:127], v[136:139], v[80:87], v30
    v_exp_f32 v91, v91
    v_exp_f32 v92, v92
    v_exp_f32 v93, v93
    v_exp_f32 v94, v94
    v_exp_f32 v95, v95
    s_setprio 2
    v_exp_f32 v32, v32
    v_exp_f32 v33, v33
    v_smfmac_f32_32x32x32_bf16 v[112:127], v[140:143], v[88:95], v30
    v_exp_f32 v34, v34
    s_mov_b64 exec, s[40:41]
    ds_read_b128 v[136:139], v4 offset:5120
    ds_read_b128 v[140:143], v4 offset:5760
    s_mov_b64 exec, -1
    v_exp_f32 v35, v35
    v_exp_f32 v36, v36
    s_waitcnt lgkmcnt(2)
    v_mfma_f32_32x32x4_2b_bf16 v[64:95], v[148:149], v[150:151], 0 cbsz:1 abid:1
    v_exp_f32 v37, v37
    v_exp_f32 v38, v38
    v_exp_f32 v39, v39
    v_exp_f32 v40, v40
    v_exp_f32 v41, v41
    v_exp_f32 v42, v42
    v_exp_f32 v43, v43
    v_exp_f32 v44, v44
    v_smfmac_f32_32x32x32_bf16 v[96:111], v[128:131], v[32:39], v30
    v_exp_f32 v45, v45
    s_add_u32 s24, s39, 892928
    buffer_load_dwordx4 v[208:211], v2, s[4:7], s24 offen offset:0
    buffer_load_dwordx4 v[212:215], v2, s[4:7], s24 offen offset:1024
    buffer_load_dwordx4 v[216:219], v2, s[4:7], s24 offen offset:2048
    v_exp_f32 v46, v46
    v_exp_f32 v47, v47
    v_exp_f32 v48, v48
    v_exp_f32 v49, v49
    v_smfmac_f32_32x32x32_bf16 v[96:111], v[132:135], v[40:47], v30
    v_exp_f32 v50, v50
    v_exp_f32 v51, v51
    v_exp_f32 v52, v52
    v_mfma_f32_32x32x16_bf16 v[64:79], v[144:147], v[152:155], v[64:79]
    v_exp_f32 v53, v53
    v_exp_f32 v54, v54
    v_exp_f32 v55, v55
    v_mfma_f32_32x32x16_bf16 v[80:95], v[144:147], v[156:159], v[80:95]
    v_exp_f32 v56, v56
    ds_read_b64 v[148:149], v3 offset:10240
    ds_read_b128 v[144:147], v11 offset:10240
    v_exp_f32 v57, v57
    v_exp_f32 v58, v58
    v_smfmac_f32_32x32x32_bf16 v[112:127], v[128:131], v[48:55], v30
    v_exp_f32 v59, v59
    v_exp_f32 v60, v60
    v_exp_f32 v61, v61
    v_exp_f32 v62, v62
    v_exp_f32 v63, v63
    s_setprio 1
    v_exp_f32 v64, v64
    v_exp_f32 v65, v65
    v_smfmac_f32_32x32x32_bf16 v[112:127], v[132:135], v[56:63], v30
    v_exp_f32 v66, v66
    s_mov_b64 exec, s[40:41]
    ds_read_b128 v[128:131], v4 offset:10240
    ds_read_b128 v[132:135], v4 offset:10880
    s_mov_b64 exec, -1
    v_exp_f32 v67, v67
    v_exp_f32 v68, v68
    s_waitcnt lgkmcnt(2)
    v_mfma_f32_32x32x4_2b_bf16 v[32:63], v[148:149], v[150:151], 0 cbsz:1 abid:0
    v_exp_f32 v69, v69
    v_exp_f32 v70, v70
    v_exp_f32 v71, v71
    v_exp_f32 v72, v72
    v_exp_f32 v73, v73
    v_exp_f32 v74, v74
    v_exp_f32 v75, v75
    v_exp_f32 v76, v76
    v_smfmac_f32_32x32x32_bf16 v[96:111], v[136:139], v[64:71], v30
    v_exp_f32 v77, v77
    s_add_u32 s24, s39, 905216
    buffer_load_dwordx4 v[220:223], v2, s[4:7], s24 offen offset:0
    buffer_load_dwordx4 v[224:227], v2, s[4:7], s24 offen offset:1024
    buffer_load_dwordx4 v[228:231], v2, s[4:7], s24 offen offset:2048
    v_exp_f32 v78, v78
    v_exp_f32 v79, v79
    v_exp_f32 v80, v80
    v_exp_f32 v81, v81
    v_smfmac_f32_32x32x32_bf16 v[96:111], v[140:143], v[72:79], v30
    v_exp_f32 v82, v82
    v_exp_f32 v83, v83
    v_exp_f32 v84, v84
    v_mfma_f32_32x32x16_bf16 v[32:47], v[144:147], v[152:155], v[32:47]
    v_exp_f32 v85, v85
    v_exp_f32 v86, v86
    v_exp_f32 v87, v87
    v_mfma_f32_32x32x16_bf16 v[48:63], v[144:147], v[156:159], v[48:63]
    v_exp_f32 v88, v88
    ds_read_b128 v[144:147], v11 offset:15360
    v_exp_f32 v89, v89
    v_exp_f32 v90, v90
    v_smfmac_f32_32x32x32_bf16 v[112:127], v[136:139], v[80:87], v30
    v_exp_f32 v91, v91
    v_exp_f32 v92, v92
    v_exp_f32 v93, v93
    v_exp_f32 v94, v94
    v_exp_f32 v95, v95
    s_setprio 0
    v_exp_f32 v32, v32
    v_exp_f32 v33, v33
    v_smfmac_f32_32x32x32_bf16 v[112:127], v[140:143], v[88:95], v30
    v_exp_f32 v34, v34
    s_mov_b64 exec, s[40:41]
    ds_read_b128 v[136:139], v4 offset:15360
    ds_read_b128 v[140:143], v4 offset:16000
    s_mov_b64 exec, -1
    v_exp_f32 v35, v35
    v_exp_f32 v36, v36
    s_waitcnt lgkmcnt(2)
    v_mfma_f32_32x32x4_2b_bf16 v[64:95], v[148:149], v[150:151], 0 cbsz:1 abid:1
    v_exp_f32 v37, v37
    v_exp_f32 v38, v38
    v_exp_f32 v39, v39
    v_exp_f32 v40, v40
    v_exp_f32 v41, v41
    v_exp_f32 v42, v42
    v_exp_f32 v43, v43
    v_exp_f32 v44, v44
    v_smfmac_f32_32x32x32_bf16 v[96:111], v[128:131], v[32:39], v30
    v_exp_f32 v45, v45
    v_exp_f32 v46, v46
    v_exp_f32 v47, v47
    v_exp_f32 v48, v48
    v_exp_f32 v49, v49
    v_smfmac_f32_32x32x32_bf16 v[96:111], v[132:135], v[40:47], v30
    v_exp_f32 v50, v50
    v_exp_f32 v51, v51
    v_exp_f32 v52, v52
    v_mfma_f32_32x32x16_bf16 v[64:79], v[144:147], v[152:155], v[64:79]
    v_exp_f32 v53, v53
    v_exp_f32 v54, v54
    v_exp_f32 v55, v55
    v_mfma_f32_32x32x16_bf16 v[80:95], v[144:147], v[156:159], v[80:95]
    v_exp_f32 v56, v56
    s_waitcnt vmcnt(17)
    s_waitcnt lgkmcnt(0)
    s_barrier
    ds_read_b64 v[148:149], v3 offset:20480
    ds_read_b128 v[144:147], v11 offset:20480
    s_add_u32 m0, s30, 102400
    s_add_u32 s24, s31, 5898240
    buffer_load_dwordx4 v2, s[4:7], s24 offen offset:0 sc1 lds
    buffer_load_dwordx4 v2, s[4:7], s24 offen offset:1024 sc1 lds
    buffer_load_dwordx4 v2, s[4:7], s24 offen offset:2048 sc1 lds
    v_exp_f32 v57, v57
    v_exp_f32 v58, v58
    v_smfmac_f32_32x32x32_bf16 v[112:127], v[128:131], v[48:55], v30
    v_exp_f32 v59, v59
    v_exp_f32 v60, v60
    v_exp_f32 v61, v61
    v_exp_f32 v62, v62
    v_exp_f32 v63, v63
    s_setprio 3
    v_exp_f32 v64, v64
    v_exp_f32 v65, v65
    v_smfmac_f32_32x32x32_bf16 v[112:127], v[132:135], v[56:63], v30
    v_exp_f32 v66, v66
    s_mov_b64 exec, s[40:41]
    ds_read_b128 v[128:131], v4 offset:20480
    ds_read_b128 v[132:135], v4 offset:21120
    s_mov_b64 exec, -1
    v_exp_f32 v67, v67
    v_exp_f32 v68, v68
    s_waitcnt lgkmcnt(2)
    v_mfma_f32_32x32x4_2b_bf16 v[32:63], v[148:149], v[150:151], 0 cbsz:1 abid:0
    v_exp_f32 v69, v69
    v_exp_f32 v70, v70
    v_exp_f32 v71, v71
    v_exp_f32 v72, v72
    v_exp_f32 v73, v73
    v_exp_f32 v74, v74
    v_exp_f32 v75, v75
    v_exp_f32 v76, v76
    v_smfmac_f32_32x32x32_bf16 v[96:111], v[136:139], v[64:71], v30
    v_exp_f32 v77, v77
    s_add_u32 m0, s30, 105472
    s_add_u32 s24, s31, 5901312
    buffer_load_dwordx4 v2, s[4:7], s24 offen offset:0 sc1 lds
    buffer_load_dwordx4 v2, s[4:7], s24 offen offset:1024 sc1 lds
    v_exp_f32 v78, v78
    v_exp_f32 v79, v79
    v_exp_f32 v80, v80
    v_exp_f32 v81, v81
    v_smfmac_f32_32x32x32_bf16 v[96:111], v[140:143], v[72:79], v30
    v_exp_f32 v82, v82
    v_exp_f32 v83, v83
    v_exp_f32 v84, v84
    v_mfma_f32_32x32x16_bf16 v[32:47], v[144:147], v[152:155], v[32:47]
    v_exp_f32 v85, v85
    v_exp_f32 v86, v86
    v_exp_f32 v87, v87
    v_mfma_f32_32x32x16_bf16 v[48:63], v[144:147], v[156:159], v[48:63]
    v_exp_f32 v88, v88
    ds_read_b128 v[144:147], v11 offset:25600
    v_exp_f32 v89, v89
    v_exp_f32 v90, v90
    v_smfmac_f32_32x32x32_bf16 v[112:127], v[136:139], v[80:87], v30
    v_exp_f32 v91, v91
    v_exp_f32 v92, v92
    v_exp_f32 v93, v93
    v_exp_f32 v94, v94
    v_exp_f32 v95, v95
    s_setprio 2
    v_exp_f32 v32, v32
    v_exp_f32 v33, v33
    v_smfmac_f32_32x32x32_bf16 v[112:127], v[140:143], v[88:95], v30
    v_exp_f32 v34, v34
    s_mov_b64 exec, s[40:41]
    ds_read_b128 v[136:139], v4 offset:25600
    ds_read_b128 v[140:143], v4 offset:26240
    s_mov_b64 exec, -1
    v_exp_f32 v35, v35
    v_exp_f32 v36, v36
    s_waitcnt lgkmcnt(2)
    v_mfma_f32_32x32x4_2b_bf16 v[64:95], v[148:149], v[150:151], 0 cbsz:1 abid:1
    v_exp_f32 v37, v37
    v_exp_f32 v38, v38
    v_exp_f32 v39, v39
    v_exp_f32 v40, v40
    v_exp_f32 v41, v41
    v_exp_f32 v42, v42
    v_exp_f32 v43, v43
    v_exp_f32 v44, v44
    v_smfmac_f32_32x32x32_bf16 v[96:111], v[128:131], v[32:39], v30
    v_exp_f32 v45, v45
    s_add_u32 s24, s39, 917504
    buffer_load_dwordx4 v[232:235], v2, s[4:7], s24 offen offset:0
    buffer_load_dwordx4 v[236:239], v2, s[4:7], s24 offen offset:1024
    buffer_load_dwordx4 v[240:243], v2, s[4:7], s24 offen offset:2048
    v_exp_f32 v46, v46
    v_exp_f32 v47, v47
    v_exp_f32 v48, v48
    v_exp_f32 v49, v49
    v_smfmac_f32_32x32x32_bf16 v[96:111], v[132:135], v[40:47], v30
    v_exp_f32 v50, v50
    v_exp_f32 v51, v51
    v_exp_f32 v52, v52
    v_mfma_f32_32x32x16_bf16 v[64:79], v[144:147], v[152:155], v[64:79]
    v_exp_f32 v53, v53
    v_exp_f32 v54, v54
    v_exp_f32 v55, v55
    v_mfma_f32_32x32x16_bf16 v[80:95], v[144:147], v[156:159], v[80:95]
    v_exp_f32 v56, v56
    ds_read_b64 v[148:149], v3 offset:30720
    ds_read_b128 v[144:147], v11 offset:30720
    v_exp_f32 v57, v57
    v_exp_f32 v58, v58
    v_smfmac_f32_32x32x32_bf16 v[112:127], v[128:131], v[48:55], v30
    v_exp_f32 v59, v59
    v_exp_f32 v60, v60
    v_exp_f32 v61, v61
    v_exp_f32 v62, v62
    v_exp_f32 v63, v63
    s_setprio 1
    v_exp_f32 v64, v64
    v_exp_f32 v65, v65
    v_smfmac_f32_32x32x32_bf16 v[112:127], v[132:135], v[56:63], v30
    v_exp_f32 v66, v66
    s_mov_b64 exec, s[40:41]
    ds_read_b128 v[128:131], v4 offset:30720
    ds_read_b128 v[132:135], v4 offset:31360
    s_mov_b64 exec, -1
    v_exp_f32 v67, v67
    v_exp_f32 v68, v68
    s_waitcnt lgkmcnt(2)
    v_mfma_f32_32x32x4_2b_bf16 v[32:63], v[148:149], v[150:151], 0 cbsz:1 abid:0
    v_exp_f32 v69, v69
    v_exp_f32 v70, v70
    v_exp_f32 v71, v71
    v_exp_f32 v72, v72
    v_exp_f32 v73, v73
    v_exp_f32 v74, v74
    v_exp_f32 v75, v75
    v_exp_f32 v76, v76
    v_smfmac_f32_32x32x32_bf16 v[96:111], v[136:139], v[64:71], v30
    v_exp_f32 v77, v77
    s_add_u32 s24, s39, 929792
    buffer_load_dwordx4 v[244:247], v2, s[4:7], s24 offen offset:0
    buffer_load_dwordx4 v[248:251], v2, s[4:7], s24 offen offset:1024
    buffer_load_dwordx4 v[252:255], v2, s[4:7], s24 offen offset:2048
    v_exp_f32 v78, v78
    v_exp_f32 v79, v79
    v_exp_f32 v80, v80
    v_exp_f32 v81, v81
    v_smfmac_f32_32x32x32_bf16 v[96:111], v[140:143], v[72:79], v30
    v_exp_f32 v82, v82
    v_exp_f32 v83, v83
    v_exp_f32 v84, v84
    v_mfma_f32_32x32x16_bf16 v[32:47], v[144:147], v[152:155], v[32:47]
    v_exp_f32 v85, v85
    v_exp_f32 v86, v86
    v_exp_f32 v87, v87
    v_mfma_f32_32x32x16_bf16 v[48:63], v[144:147], v[156:159], v[48:63]
    v_exp_f32 v88, v88
    ds_read_b128 v[144:147], v11 offset:35840
    v_exp_f32 v89, v89
    v_exp_f32 v90, v90
    v_smfmac_f32_32x32x32_bf16 v[112:127], v[136:139], v[80:87], v30
    v_exp_f32 v91, v91
    v_exp_f32 v92, v92
    v_exp_f32 v93, v93
    v_exp_f32 v94, v94
    v_exp_f32 v95, v95
    s_setprio 0
    v_exp_f32 v32, v32
    v_exp_f32 v33, v33
    v_smfmac_f32_32x32x32_bf16 v[112:127], v[140:143], v[88:95], v30
    v_exp_f32 v34, v34
    s_mov_b64 exec, s[40:41]
    ds_read_b128 v[136:139], v4 offset:35840
    ds_read_b128 v[140:143], v4 offset:36480
    s_mov_b64 exec, -1
    v_exp_f32 v35, v35
    v_exp_f32 v36, v36
    s_waitcnt lgkmcnt(2)
    v_mfma_f32_32x32x4_2b_bf16 v[64:95], v[148:149], v[150:151], 0 cbsz:1 abid:1
    v_exp_f32 v37, v37
    v_exp_f32 v38, v38
    v_exp_f32 v39, v39
    v_exp_f32 v40, v40
    v_exp_f32 v41, v41
    v_exp_f32 v42, v42
    v_exp_f32 v43, v43
    v_exp_f32 v44, v44
    v_smfmac_f32_32x32x32_bf16 v[96:111], v[128:131], v[32:39], v30
    v_exp_f32 v45, v45
    v_exp_f32 v46, v46
    v_exp_f32 v47, v47
    v_exp_f32 v48, v48
    v_exp_f32 v49, v49
    v_smfmac_f32_32x32x32_bf16 v[96:111], v[132:135], v[40:47], v30
    v_exp_f32 v50, v50
    v_exp_f32 v51, v51
    v_exp_f32 v52, v52
    v_mfma_f32_32x32x16_bf16 v[64:79], v[144:147], v[152:155], v[64:79]
    v_exp_f32 v53, v53
    v_exp_f32 v54, v54
    v_exp_f32 v55, v55
    v_mfma_f32_32x32x16_bf16 v[80:95], v[144:147], v[156:159], v[80:95]
    v_exp_f32 v56, v56
    s_waitcnt vmcnt(17)
    s_waitcnt lgkmcnt(0)
    s_barrier
    ds_read_b64 v[148:149], v3 offset:40960
    ds_read_b128 v[144:147], v11 offset:40960
    s_add_u32 m0, s30, 122880
    s_add_u32 s24, s31, 6881280
    buffer_load_dwordx4 v2, s[4:7], s24 offen offset:0 sc1 lds
    buffer_load_dwordx4 v2, s[4:7], s24 offen offset:1024 sc1 lds
    buffer_load_dwordx4 v2, s[4:7], s24 offen offset:2048 sc1 lds
    v_exp_f32 v57, v57
    v_exp_f32 v58, v58
    v_smfmac_f32_32x32x32_bf16 v[112:127], v[128:131], v[48:55], v30
    v_exp_f32 v59, v59
    v_exp_f32 v60, v60
    v_exp_f32 v61, v61
    v_exp_f32 v62, v62
    v_exp_f32 v63, v63
    s_setprio 3
    v_exp_f32 v64, v64
    v_exp_f32 v65, v65
    v_smfmac_f32_32x32x32_bf16 v[112:127], v[132:135], v[56:63], v30
    v_exp_f32 v66, v66
    s_mov_b64 exec, s[40:41]
    ds_read_b128 v[128:131], v4 offset:40960
    ds_read_b128 v[132:135], v4 offset:41600
    s_mov_b64 exec, -1
    v_exp_f32 v67, v67
    v_exp_f32 v68, v68
    s_waitcnt lgkmcnt(2)
    v_mfma_f32_32x32x4_2b_bf16 v[32:63], v[148:149], v[150:151], 0 cbsz:1 abid:0
    v_exp_f32 v69, v69
    v_exp_f32 v70, v70
    v_exp_f32 v71, v71
    v_exp_f32 v72, v72
    v_exp_f32 v73, v73
    v_exp_f32 v74, v74
    v_exp_f32 v75, v75
    v_exp_f32 v76, v76
    v_smfmac_f32_32x32x32_bf16 v[96:111], v[136:139], v[64:71], v30
    v_exp_f32 v77, v77
    s_add_u32 m0, s30, 125952
    s_add_u32 s24, s31, 6884352
    buffer_load_dwordx4 v2, s[4:7], s24 offen offset:0 sc1 lds
    buffer_load_dwordx4 v2, s[4:7], s24 offen offset:1024 sc1 lds
    v_exp_f32 v78, v78
    v_exp_f32 v79, v79
    v_exp_f32 v80, v80
    v_exp_f32 v81, v81
    v_smfmac_f32_32x32x32_bf16 v[96:111], v[140:143], v[72:79], v30
    v_exp_f32 v82, v82
    v_exp_f32 v83, v83
    v_exp_f32 v84, v84
    v_mfma_f32_32x32x16_bf16 v[32:47], v[144:147], v[152:155], v[32:47]
    v_exp_f32 v85, v85
    v_exp_f32 v86, v86
    v_exp_f32 v87, v87
    v_mfma_f32_32x32x16_bf16 v[48:63], v[144:147], v[156:159], v[48:63]
    v_exp_f32 v88, v88
    ds_read_b128 v[144:147], v11 offset:46080
    v_exp_f32 v89, v89
    v_exp_f32 v90, v90
    v_smfmac_f32_32x32x32_bf16 v[112:127], v[136:139], v[80:87], v30
    v_exp_f32 v91, v91
    v_exp_f32 v92, v92
    v_exp_f32 v93, v93
    v_exp_f32 v94, v94
    v_exp_f32 v95, v95
    s_setprio 2
    v_exp_f32 v32, v32
    v_exp_f32 v33, v33
    v_smfmac_f32_32x32x32_bf16 v[112:127], v[140:143], v[88:95], v30
    v_exp_f32 v34, v34
    s_mov_b64 exec, s[40:41]
    ds_read_b128 v[136:139], v4 offset:46080
    ds_read_b128 v[140:143], v4 offset:46720
    s_mov_b64 exec, -1
    v_exp_f32 v35, v35
    v_exp_f32 v36, v36
    s_waitcnt lgkmcnt(2)
    v_mfma_f32_32x32x4_2b_bf16 v[64:95], v[148:149], v[150:151], 0 cbsz:1 abid:1
    v_exp_f32 v37, v37
    v_exp_f32 v38, v38
    v_exp_f32 v39, v39
    v_exp_f32 v40, v40
    v_exp_f32 v41, v41
    v_exp_f32 v42, v42
    v_exp_f32 v43, v43
    v_exp_f32 v44, v44
    v_smfmac_f32_32x32x32_bf16 v[96:111], v[128:131], v[32:39], v30
    v_exp_f32 v45, v45
    v_exp_f32 v46, v46
    v_exp_f32 v47, v47
    v_exp_f32 v48, v48
    v_exp_f32 v49, v49
    v_smfmac_f32_32x32x32_bf16 v[96:111], v[132:135], v[40:47], v30
    v_exp_f32 v50, v50
    v_exp_f32 v51, v51
    v_exp_f32 v52, v52
    v_mfma_f32_32x32x16_bf16 v[64:79], v[144:147], v[152:155], v[64:79]
    v_exp_f32 v53, v53
    v_exp_f32 v54, v54
    v_exp_f32 v55, v55
    v_mfma_f32_32x32x16_bf16 v[80:95], v[144:147], v[156:159], v[80:95]
    v_exp_f32 v56, v56
    ds_read_b64 v[148:149], v3 offset:51200
    ds_read_b128 v[144:147], v11 offset:51200
    v_exp_f32 v57, v57
    v_exp_f32 v58, v58
    v_smfmac_f32_32x32x32_bf16 v[112:127], v[128:131], v[48:55], v30
    v_exp_f32 v59, v59
    v_exp_f32 v60, v60
    v_exp_f32 v61, v61
    v_exp_f32 v62, v62
    v_exp_f32 v63, v63
    s_setprio 1
    v_exp_f32 v64, v64
    v_exp_f32 v65, v65
    v_smfmac_f32_32x32x32_bf16 v[112:127], v[132:135], v[56:63], v30
    v_exp_f32 v66, v66
    s_mov_b64 exec, s[40:41]
    ds_read_b128 v[128:131], v4 offset:51200
    ds_read_b128 v[132:135], v4 offset:51840
    s_mov_b64 exec, -1
    v_exp_f32 v67, v67
    v_exp_f32 v68, v68
    s_waitcnt lgkmcnt(2)
    v_mfma_f32_32x32x4_2b_bf16 v[32:63], v[148:149], v[150:151], 0 cbsz:1 abid:0
    v_exp_f32 v69, v69
    v_exp_f32 v70, v70
    v_exp_f32 v71, v71
    v_exp_f32 v72, v72
    v_exp_f32 v73, v73
    v_exp_f32 v74, v74
    v_exp_f32 v75, v75
    v_exp_f32 v76, v76
    v_smfmac_f32_32x32x32_bf16 v[96:111], v[136:139], v[64:71], v30
    v_exp_f32 v77, v77
    v_exp_f32 v78, v78
    v_exp_f32 v79, v79
    v_exp_f32 v80, v80
    v_exp_f32 v81, v81
    v_smfmac_f32_32x32x32_bf16 v[96:111], v[140:143], v[72:79], v30
    v_exp_f32 v82, v82
    v_exp_f32 v83, v83
    v_exp_f32 v84, v84
    v_mfma_f32_32x32x16_bf16 v[32:47], v[144:147], v[152:155], v[32:47]
    v_exp_f32 v85, v85
    v_exp_f32 v86, v86
    v_exp_f32 v87, v87
    v_mfma_f32_32x32x16_bf16 v[48:63], v[144:147], v[156:159], v[48:63]
    v_exp_f32 v88, v88
    ds_read_b128 v[144:147], v11 offset:56320
    v_exp_f32 v89, v89
    v_exp_f32 v90, v90
    v_smfmac_f32_32x32x32_bf16 v[112:127], v[136:139], v[80:87], v30
    v_exp_f32 v91, v91
    v_exp_f32 v92, v92
    v_exp_f32 v93, v93
    v_exp_f32 v94, v94
    v_exp_f32 v95, v95
    s_setprio 0
    v_exp_f32 v32, v32
    v_exp_f32 v33, v33
    v_smfmac_f32_32x32x32_bf16 v[112:127], v[140:143], v[88:95], v30
    v_exp_f32 v34, v34
    s_mov_b64 exec, s[40:41]
    ds_read_b128 v[136:139], v4 offset:56320
    ds_read_b128 v[140:143], v4 offset:56960
    s_mov_b64 exec, -1
    v_exp_f32 v35, v35
    v_exp_f32 v36, v36
    s_waitcnt lgkmcnt(2)
    v_mfma_f32_32x32x4_2b_bf16 v[64:95], v[148:149], v[150:151], 0 cbsz:1 abid:1
    v_exp_f32 v37, v37
    v_exp_f32 v38, v38
    v_exp_f32 v39, v39
    v_exp_f32 v40, v40
    v_exp_f32 v41, v41
    v_exp_f32 v42, v42
    v_exp_f32 v43, v43
    v_exp_f32 v44, v44
    v_smfmac_f32_32x32x32_bf16 v[96:111], v[128:131], v[32:39], v30
    v_exp_f32 v45, v45
    v_exp_f32 v46, v46
    v_exp_f32 v47, v47
    v_exp_f32 v48, v48
    v_exp_f32 v49, v49
    v_smfmac_f32_32x32x32_bf16 v[96:111], v[132:135], v[40:47], v30
    v_exp_f32 v50, v50
    v_exp_f32 v51, v51
    v_exp_f32 v52, v52
    v_mfma_f32_32x32x16_bf16 v[64:79], v[144:147], v[152:155], v[64:79]
    v_exp_f32 v53, v53
    v_exp_f32 v54, v54
    v_exp_f32 v55, v55
    v_mfma_f32_32x32x16_bf16 v[80:95], v[144:147], v[156:159], v[80:95]
    v_exp_f32 v56, v56
    s_waitcnt vmcnt(11)
    s_waitcnt lgkmcnt(0)
    s_barrier
    ds_read_b64 v[148:149], v3 offset:0
    ds_read_b128 v[144:147], v11 offset:0
    v_exp_f32 v57, v57
    v_exp_f32 v58, v58
    v_smfmac_f32_32x32x32_bf16 v[112:127], v[128:131], v[48:55], v30
    v_exp_f32 v59, v59
    v_exp_f32 v60, v60
    v_exp_f32 v61, v61
    v_exp_f32 v62, v62
    v_exp_f32 v63, v63
    s_setprio 3
    v_exp_f32 v64, v64
    v_exp_f32 v65, v65
    v_smfmac_f32_32x32x32_bf16 v[112:127], v[132:135], v[56:63], v30
    v_exp_f32 v66, v66
    s_mov_b64 exec, s[40:41]
    ds_read_b128 v[128:131], v4 offset:0
    ds_read_b128 v[132:135], v4 offset:640
    s_mov_b64 exec, -1
    v_exp_f32 v67, v67
    v_exp_f32 v68, v68
    s_waitcnt lgkmcnt(2)
    v_mfma_f32_32x32x4_2b_bf16 v[32:63], v[148:149], v[150:151], 0 cbsz:1 abid:0
    v_exp_f32 v69, v69
    v_exp_f32 v70, v70
    v_exp_f32 v71, v71
    v_exp_f32 v72, v72
    v_exp_f32 v73, v73
    v_exp_f32 v74, v74
    v_exp_f32 v75, v75
    v_exp_f32 v76, v76
    v_smfmac_f32_32x32x32_bf16 v[96:111], v[136:139], v[64:71], v30
    v_exp_f32 v77, v77
    v_exp_f32 v78, v78
    v_exp_f32 v79, v79
    v_exp_f32 v80, v80
    v_exp_f32 v81, v81
    v_smfmac_f32_32x32x32_bf16 v[96:111], v[140:143], v[72:79], v30
    v_exp_f32 v82, v82
    v_exp_f32 v83, v83
    v_exp_f32 v84, v84
    v_mfma_f32_32x32x16_bf16 v[32:47], v[144:147], v[152:155], v[32:47]
    v_exp_f32 v85, v85
    v_exp_f32 v86, v86
    v_exp_f32 v87, v87
    v_mfma_f32_32x32x16_bf16 v[48:63], v[144:147], v[156:159], v[48:63]
    v_exp_f32 v88, v88
    ds_read_b128 v[144:147], v11 offset:5120
    v_exp_f32 v89, v89
    v_exp_f32 v90, v90
    v_smfmac_f32_32x32x32_bf16 v[112:127], v[136:139], v[80:87], v30
    v_exp_f32 v91, v91
    v_exp_f32 v92, v92
    v_exp_f32 v93, v93
    v_exp_f32 v94, v94
    v_exp_f32 v95, v95
    s_setprio 2
    v_exp_f32 v32, v32
    v_exp_f32 v33, v33
    v_smfmac_f32_32x32x32_bf16 v[112:127], v[140:143], v[88:95], v30
    v_exp_f32 v34, v34
    s_mov_b64 exec, s[40:41]
    ds_read_b128 v[136:139], v4 offset:5120
    ds_read_b128 v[140:143], v4 offset:5760
    s_mov_b64 exec, -1
    v_exp_f32 v35, v35
    v_exp_f32 v36, v36
    s_waitcnt lgkmcnt(2)
    v_mfma_f32_32x32x4_2b_bf16 v[64:95], v[148:149], v[150:151], 0 cbsz:1 abid:1
    v_exp_f32 v37, v37
    v_exp_f32 v38, v38
    v_exp_f32 v39, v39
    v_exp_f32 v40, v40
    v_exp_f32 v41, v41
    v_exp_f32 v42, v42
    v_exp_f32 v43, v43
    v_exp_f32 v44, v44
    v_smfmac_f32_32x32x32_bf16 v[96:111], v[128:131], v[32:39], v30
    v_exp_f32 v45, v45
    v_exp_f32 v46, v46
    v_exp_f32 v47, v47
    v_exp_f32 v48, v48
    v_exp_f32 v49, v49
    v_smfmac_f32_32x32x32_bf16 v[96:111], v[132:135], v[40:47], v30
    v_exp_f32 v50, v50
    v_exp_f32 v51, v51
    v_exp_f32 v52, v52
    v_mfma_f32_32x32x16_bf16 v[64:79], v[144:147], v[152:155], v[64:79]
    v_exp_f32 v53, v53
    v_exp_f32 v54, v54
    v_exp_f32 v55, v55
    v_mfma_f32_32x32x16_bf16 v[80:95], v[144:147], v[156:159], v[80:95]
    v_exp_f32 v56, v56
    ds_read_b64 v[148:149], v3 offset:10240
    ds_read_b128 v[144:147], v11 offset:10240
    v_exp_f32 v57, v57
    v_exp_f32 v58, v58
    v_smfmac_f32_32x32x32_bf16 v[112:127], v[128:131], v[48:55], v30
    v_exp_f32 v59, v59
    v_exp_f32 v60, v60
    v_exp_f32 v61, v61
    v_exp_f32 v62, v62
    v_exp_f32 v63, v63
    s_setprio 1
    v_exp_f32 v64, v64
    v_exp_f32 v65, v65
    v_smfmac_f32_32x32x32_bf16 v[112:127], v[132:135], v[56:63], v30
    v_exp_f32 v66, v66
    s_mov_b64 exec, s[40:41]
    ds_read_b128 v[128:131], v4 offset:10240
    ds_read_b128 v[132:135], v4 offset:10880
    s_mov_b64 exec, -1
    v_exp_f32 v67, v67
    v_exp_f32 v68, v68
    s_waitcnt lgkmcnt(2)
    v_mfma_f32_32x32x4_2b_bf16 v[32:63], v[148:149], v[150:151], 0 cbsz:1 abid:0
    v_exp_f32 v69, v69
    v_exp_f32 v70, v70
    v_exp_f32 v71, v71
    v_exp_f32 v72, v72
    v_exp_f32 v73, v73
    v_exp_f32 v74, v74
    v_exp_f32 v75, v75
    v_exp_f32 v76, v76
    v_smfmac_f32_32x32x32_bf16 v[96:111], v[136:139], v[64:71], v30
    v_exp_f32 v77, v77
    v_exp_f32 v78, v78
    v_exp_f32 v79, v79
    v_exp_f32 v80, v80
    v_exp_f32 v81, v81
    v_smfmac_f32_32x32x32_bf16 v[96:111], v[140:143], v[72:79], v30
    v_exp_f32 v82, v82
    v_exp_f32 v83, v83
    v_exp_f32 v84, v84
    v_mfma_f32_32x32x16_bf16 v[32:47], v[144:147], v[152:155], v[32:47]
    v_exp_f32 v85, v85
    v_exp_f32 v86, v86
    v_exp_f32 v87, v87
    v_mfma_f32_32x32x16_bf16 v[48:63], v[144:147], v[156:159], v[48:63]
    v_exp_f32 v88, v88
    ds_read_b128 v[144:147], v11 offset:15360
    v_exp_f32 v89, v89
    v_exp_f32 v90, v90
    v_smfmac_f32_32x32x32_bf16 v[112:127], v[136:139], v[80:87], v30
    v_exp_f32 v91, v91
    v_exp_f32 v92, v92
    v_exp_f32 v93, v93
    v_exp_f32 v94, v94
    v_exp_f32 v95, v95
    s_setprio 0
    v_exp_f32 v32, v32
    v_exp_f32 v33, v33
    v_smfmac_f32_32x32x32_bf16 v[112:127], v[140:143], v[88:95], v30
    v_exp_f32 v34, v34
    s_mov_b64 exec, s[40:41]
    ds_read_b128 v[136:139], v4 offset:15360
    ds_read_b128 v[140:143], v4 offset:16000
    s_mov_b64 exec, -1
    v_exp_f32 v35, v35
    v_exp_f32 v36, v36
    s_waitcnt lgkmcnt(2)
    v_mfma_f32_32x32x4_2b_bf16 v[64:95], v[148:149], v[150:151], 0 cbsz:1 abid:1
    v_exp_f32 v37, v37
    v_exp_f32 v38, v38
    v_exp_f32 v39, v39
    v_exp_f32 v40, v40
    v_exp_f32 v41, v41
    v_exp_f32 v42, v42
    v_exp_f32 v43, v43
    v_exp_f32 v44, v44
    v_smfmac_f32_32x32x32_bf16 v[96:111], v[128:131], v[32:39], v30
    v_exp_f32 v45, v45
    v_exp_f32 v46, v46
    v_exp_f32 v47, v47
    v_exp_f32 v48, v48
    v_exp_f32 v49, v49
    v_smfmac_f32_32x32x32_bf16 v[96:111], v[132:135], v[40:47], v30
    v_exp_f32 v50, v50
    v_exp_f32 v51, v51
    v_exp_f32 v52, v52
    v_mfma_f32_32x32x16_bf16 v[64:79], v[144:147], v[152:155], v[64:79]
    v_exp_f32 v53, v53
    v_exp_f32 v54, v54
    v_exp_f32 v55, v55
    v_mfma_f32_32x32x16_bf16 v[80:95], v[144:147], v[156:159], v[80:95]
    v_exp_f32 v56, v56
    s_waitcnt vmcnt(0)
    s_waitcnt lgkmcnt(0)
    s_barrier
    v_mov_b32 v8, 162816
    ds_write_b128 v8, v[16:19]
    s_waitcnt lgkmcnt(0)
    ds_read_b64 v[148:149], v3 offset:20480
    ds_read_b128 v[144:147], v11 offset:20480
    v_exp_f32 v57, v57
    v_exp_f32 v58, v58
    v_smfmac_f32_32x32x32_bf16 v[112:127], v[128:131], v[48:55], v30
    v_exp_f32 v59, v59
    v_exp_f32 v60, v60
    v_exp_f32 v61, v61
    v_exp_f32 v62, v62
    v_exp_f32 v63, v63
    s_setprio 3
    v_exp_f32 v64, v64
    v_exp_f32 v65, v65
    v_smfmac_f32_32x32x32_bf16 v[112:127], v[132:135], v[56:63], v30
    v_exp_f32 v66, v66
    s_mov_b64 exec, s[40:41]
    ds_read_b128 v[128:131], v4 offset:20480
    ds_read_b128 v[132:135], v4 offset:21120
    s_mov_b64 exec, -1
    v_exp_f32 v67, v67
    v_exp_f32 v68, v68
    s_waitcnt lgkmcnt(2)
    v_mfma_f32_32x32x4_2b_bf16 v[32:63], v[148:149], v[150:151], 0 cbsz:1 abid:0
    v_exp_f32 v69, v69
    v_exp_f32 v70, v70
    v_exp_f32 v71, v71
    v_exp_f32 v72, v72
    v_exp_f32 v73, v73
    v_exp_f32 v74, v74
    v_exp_f32 v75, v75
    v_exp_f32 v76, v76
    v_smfmac_f32_32x32x32_bf16 v[96:111], v[136:139], v[64:71], v30
    v_exp_f32 v77, v77
    s_and_b32 s22, s51, 15
    s_lshl_b32 s24, s22, 9
    s_add_u32 s24, s24, 7372800
    s_mov_b32 m0, 156672
    s_mov_b32 exec_hi, 0
    buffer_load_dwordx4 v2, s[4:7], s24 offen lds
    s_mov_b64 exec, -1
    v_exp_f32 v78, v78
    v_exp_f32 v79, v79
    v_exp_f32 v80, v80
    v_exp_f32 v81, v81
    v_smfmac_f32_32x32x32_bf16 v[96:111], v[140:143], v[72:79], v30
    v_exp_f32 v82, v82
    v_exp_f32 v83, v83
    v_exp_f32 v84, v84
    v_mfma_f32_32x32x16_bf16 v[32:47], v[144:147], v[152:155], v[32:47]
    v_exp_f32 v85, v85
    v_exp_f32 v86, v86
    v_exp_f32 v87, v87
    v_mfma_f32_32x32x16_bf16 v[48:63], v[144:147], v[156:159], v[48:63]
    v_exp_f32 v88, v88
    ds_read_b128 v[144:147], v11 offset:25600
    v_exp_f32 v89, v89
    v_exp_f32 v90, v90
    v_smfmac_f32_32x32x32_bf16 v[112:127], v[136:139], v[80:87], v30
    v_exp_f32 v91, v91
    v_exp_f32 v92, v92
    v_exp_f32 v93, v93
    v_exp_f32 v94, v94
    v_exp_f32 v95, v95
    s_setprio 2
    v_exp_f32 v32, v32
    v_exp_f32 v33, v33
    v_smfmac_f32_32x32x32_bf16 v[112:127], v[140:143], v[88:95], v30
    v_exp_f32 v34, v34
    s_mov_b64 exec, s[40:41]
    ds_read_b128 v[136:139], v4 offset:25600
    ds_read_b128 v[140:143], v4 offset:26240
    s_mov_b64 exec, -1
    v_exp_f32 v35, v35
    v_exp_f32 v36, v36
    s_waitcnt lgkmcnt(2)
    v_mfma_f32_32x32x4_2b_bf16 v[64:95], v[148:149], v[150:151], 0 cbsz:1 abid:1
    v_exp_f32 v37, v37
    v_exp_f32 v38, v38
    v_exp_f32 v39, v39
    v_exp_f32 v40, v40
    v_exp_f32 v41, v41
    v_exp_f32 v42, v42
    v_exp_f32 v43, v43
    v_exp_f32 v44, v44
    v_smfmac_f32_32x32x32_bf16 v[96:111], v[128:131], v[32:39], v30
    v_exp_f32 v45, v45
    v_exp_f32 v46, v46
    v_exp_f32 v47, v47
    v_exp_f32 v48, v48
    v_exp_f32 v49, v49
    v_smfmac_f32_32x32x32_bf16 v[96:111], v[132:135], v[40:47], v30
    v_exp_f32 v50, v50
    v_exp_f32 v51, v51
    v_exp_f32 v52, v52
    v_mfma_f32_32x32x16_bf16 v[64:79], v[144:147], v[152:155], v[64:79]
    v_exp_f32 v53, v53
    v_exp_f32 v54, v54
    v_exp_f32 v55, v55
    v_mfma_f32_32x32x16_bf16 v[80:95], v[144:147], v[156:159], v[80:95]
    v_exp_f32 v56, v56
    ds_read_b64 v[148:149], v3 offset:30720
    ds_read_b128 v[144:147], v11 offset:30720
    v_exp_f32 v57, v57
    v_exp_f32 v58, v58
    v_smfmac_f32_32x32x32_bf16 v[112:127], v[128:131], v[48:55], v30
    v_exp_f32 v59, v59
    v_exp_f32 v60, v60
    v_exp_f32 v61, v61
    v_exp_f32 v62, v62
    v_exp_f32 v63, v63
    s_setprio 1
    v_exp_f32 v64, v64
    v_exp_f32 v65, v65
    v_smfmac_f32_32x32x32_bf16 v[112:127], v[132:135], v[56:63], v30
    v_exp_f32 v66, v66
    s_mov_b64 exec, s[40:41]
    ds_read_b128 v[128:131], v4 offset:30720
    ds_read_b128 v[132:135], v4 offset:31360
    s_mov_b64 exec, -1
    v_exp_f32 v67, v67
    v_exp_f32 v68, v68
    s_waitcnt lgkmcnt(2)
    v_mfma_f32_32x32x4_2b_bf16 v[32:63], v[148:149], v[150:151], 0 cbsz:1 abid:0
    v_exp_f32 v69, v69
    v_exp_f32 v70, v70
    v_exp_f32 v71, v71
    v_exp_f32 v72, v72
    v_exp_f32 v73, v73
    v_exp_f32 v74, v74
    v_exp_f32 v75, v75
    v_exp_f32 v76, v76
    v_smfmac_f32_32x32x32_bf16 v[96:111], v[136:139], v[64:71], v30
    v_exp_f32 v77, v77
    v_exp_f32 v78, v78
    v_exp_f32 v79, v79
    v_exp_f32 v80, v80
    v_exp_f32 v81, v81
    v_smfmac_f32_32x32x32_bf16 v[96:111], v[140:143], v[72:79], v30
    v_exp_f32 v82, v82
    v_exp_f32 v83, v83
    v_exp_f32 v84, v84
    v_mfma_f32_32x32x16_bf16 v[32:47], v[144:147], v[152:155], v[32:47]
    v_exp_f32 v85, v85
    v_exp_f32 v86, v86
    v_exp_f32 v87, v87
    v_mfma_f32_32x32x16_bf16 v[48:63], v[144:147], v[156:159], v[48:63]
    v_exp_f32 v88, v88
    ds_read_b128 v[144:147], v11 offset:35840
    buffer_load_dword v27, v26, s[56:59], 0 offen sc1
    v_exp_f32 v89, v89
    v_exp_f32 v90, v90
    v_smfmac_f32_32x32x32_bf16 v[112:127], v[136:139], v[80:87], v30
    v_exp_f32 v91, v91
    v_exp_f32 v92, v92
    v_exp_f32 v93, v93
    v_exp_f32 v94, v94
    v_exp_f32 v95, v95
    s_setprio 0
    v_exp_f32 v32, v32
    v_exp_f32 v33, v33
    v_smfmac_f32_32x32x32_bf16 v[112:127], v[140:143], v[88:95], v30
    v_exp_f32 v34, v34
    s_mov_b64 exec, s[40:41]
    ds_read_b128 v[136:139], v4 offset:35840
    ds_read_b128 v[140:143], v4 offset:36480
    s_mov_b64 exec, -1
    v_exp_f32 v35, v35
    v_exp_f32 v36, v36
    s_waitcnt lgkmcnt(2)
    v_mfma_f32_32x32x4_2b_bf16 v[64:95], v[148:149], v[150:151], 0 cbsz:1 abid:1
    v_exp_f32 v37, v37
    v_exp_f32 v38, v38
    v_exp_f32 v39, v39
    v_exp_f32 v40, v40
    v_exp_f32 v41, v41
    v_exp_f32 v42, v42
    v_exp_f32 v43, v43
    v_exp_f32 v44, v44
    v_smfmac_f32_32x32x32_bf16 v[96:111], v[128:131], v[32:39], v30
    v_exp_f32 v45, v45
    v_exp_f32 v46, v46
    v_exp_f32 v47, v47
    v_exp_f32 v48, v48
    v_exp_f32 v49, v49
    v_smfmac_f32_32x32x32_bf16 v[96:111], v[132:135], v[40:47], v30
    v_exp_f32 v50, v50
    v_exp_f32 v51, v51
    v_exp_f32 v52, v52
    v_mfma_f32_32x32x16_bf16 v[80:95], v[144:147], v[156:159], v[80:95]
    v_exp_f32 v53, v53
    v_exp_f32 v54, v54
    v_exp_f32 v55, v55
    v_mfma_f32_32x32x16_bf16 v[64:79], v[144:147], v[152:155], v[64:79]
    v_exp_f32 v56, v56
    v_exp_f32 v57, v57
    v_exp_f32 v58, v58
    v_smfmac_f32_32x32x32_bf16 v[112:127], v[128:131], v[48:55], v30
    v_exp_f32 v59, v59
    v_exp_f32 v60, v60
    v_exp_f32 v61, v61
    v_exp_f32 v62, v62
    v_exp_f32 v63, v63
    s_setprio 3
    v_exp_f32 v80, v80
    v_exp_f32 v81, v81
    v_smfmac_f32_32x32x32_bf16 v[112:127], v[132:135], v[56:63], v30
    v_exp_f32 v82, v82
    v_exp_f32 v83, v83
    v_exp_f32 v84, v84
    v_exp_f32 v85, v85
    v_exp_f32 v86, v86
    v_exp_f32 v87, v87
    v_exp_f32 v88, v88
    v_exp_f32 v89, v89
    v_exp_f32 v90, v90
    v_exp_f32 v91, v91
    v_exp_f32 v92, v92
    s_waitcnt lgkmcnt(0)
    v_smfmac_f32_32x32x32_bf16 v[112:127], v[136:139], v[80:87], v30
    v_exp_f32 v93, v93
    v_exp_f32 v94, v94
    v_exp_f32 v95, v95
    v_exp_f32 v64, v64
    v_exp_f32 v65, v65
    v_smfmac_f32_32x32x32_bf16 v[112:127], v[140:143], v[88:95], v30
    v_exp_f32 v66, v66
    v_exp_f32 v67, v67
    v_exp_f32 v68, v68
    v_exp_f32 v69, v69
    v_exp_f32 v70, v70
    v_exp_f32 v71, v71
    v_exp_f32 v72, v72
    v_exp_f32 v73, v73
    v_exp_f32 v74, v74
    v_smfmac_f32_32x32x32_bf16 v[96:111], v[136:139], v[64:71], v30
    v_exp_f32 v75, v75
    v_exp_f32 v76, v76
    v_exp_f32 v77, v77
    ds_write_b128 v12, v[112:115] offset:0
    ds_write_b128 v12, v[116:119] offset:1024
    ds_write_b128 v12, v[120:123] offset:2048
    v_exp_f32 v78, v78
    v_exp_f32 v79, v79
    v_cmp_nle_f32 vcc, 0x1f800000, v120
    v_cmp_nle_f32 s[36:37], v120, v25
    v_smfmac_f32_32x32x32_bf16 v[96:111], v[140:143], v[72:79], v30
    s_setprio 0
L_red_28:
    s_or_b32 s35, vcc_hi, s37
    s_waitcnt vmcnt(0)
    s_mov_b32 s23, 200000
L_pur_42:
    v_readfirstlane_b32 s22, v27
    s_and_b32 s24, s22, 0xff
    s_cmp_eq_u32 s24, 32
    s_cbranch_scc1 L_purok_43
    buffer_load_dword v27, v26, s[56:59], 0 offen sc1
    s_waitcnt vmcnt(0)
    s_sub_u32 s23, s23, 1
    s_cbranch_scc0 L_pur_42
L_purok_43:
    s_lshl_b32 s24, s55, 5
    s_cmp_eq_u32 s24, s22
    s_cselect_b32 s54, 1, 0
    s_nop 2
    v_cmp_nle_f32 vcc, 0x1f800000, v104
    v_cmp_nle_f32 s[36:37], v104, v25
    s_or_b32 s35, s35, vcc_hi
    s_or_b32 s35, s35, s37
    v_mov_b32 v8, s35
    ds_write_b32 v23, v8
    s_waitcnt lgkmcnt(0)
    s_barrier
    ds_read_b32 v8, v24
    ds_read_b128 v[120:123], v13 offset:2048
    ds_read_b128 v[112:115], v13 offset:0
    ds_read_b128 v[116:119], v13 offset:1024
    s_waitcnt lgkmcnt(3)
    v_cmp_ne_u32 vcc, 0, v8
    s_cbranch_vccnz L_slow_45
L_epi_44:
    s_waitcnt lgkmcnt(2)
    v_pk_add_f32 v[104:105], v[104:105], v[120:121]
    v_pk_add_f32 v[106:107], v[106:107], v[122:123]
    v_mov_b32 v8, v104
    v_mov_b32 v10, v104
    s_waitcnt lgkmcnt(0)
    v_pk_add_f32 v[96:97], v[96:97], v[112:113]
    v_pk_add_f32 v[98:99], v[98:99], v[114:115]
    v_permlane32_swap_b32 v8, v10
    v_rcp_f32 v10, v10
    v_pk_add_f32 v[100:101], v[100:101], v[116:117]
    v_pk_add_f32 v[102:103], v[102:103], v[118:119]
    v_pk_mul_f32 v[96:97], v[96:97], v[10:11] op_sel_hi:[1,0]
    v_pk_mul_f32 v[98:99], v[98:99], v[10:11] op_sel_hi:[1,0]
    v_pk_mul_f32 v[100:101], v[100:101], v[10:11] op_sel_hi:[1,0]
    v_pk_mul_f32 v[102:103], v[102:103], v[10:11] op_sel_hi:[1,0]
    v_pk_mul_f32 v[104:105], v[104:105], v[10:11] op_sel_hi:[1,0]
    v_pk_mul_f32 v[106:107], v[106:107], v[10:11] op_sel_hi:[1,0]
    v_cvt_pk_bf16_f32 v96, v96, v97
    v_cvt_pk_bf16_f32 v97, v98, v99
    v_cvt_pk_bf16_f32 v98, v100, v101
    v_cvt_pk_bf16_f32 v99, v102, v103
    v_cvt_pk_bf16_f32 v100, v104, v105
    v_cvt_pk_bf16_f32 v101, v106, v107
    buffer_store_dwordx4 v[96:99], v20, s[4:7], s38 offen sc1
    s_mov_b32 exec_hi, 0
    buffer_store_dwordx2 v[100:101], v21, s[4:7], s38 offen sc1
    s_mov_b64 exec, -1
    v_mov_b32 v8, 162816
    v_mov_b32 v9, 1
    s_and_b32 s22, s51, 7
    s_mul_i32 s22, s22, 4
    s_and_b32 s23, s21, 3
    s_add_u32 s22, s22, s23
    s_lshl_b32 s22, s22, 8
    s_add_u32 s22, s22, s52
    s_mov_b64 exec, 1
    s_waitcnt vmcnt(0)
    ds_add_rtn_u32 v10, v8, v9
    v_mov_b32 v8, 0
    s_waitcnt lgkmcnt(0)
    v_cmp_ne_u32 vcc, 7, v10
    s_cbranch_vccnz L_nosig_46
    buffer_atomic_add v9, v8, s[4:7], s22 offen sc1
L_nosig_46:
    s_mov_b64 exec, -1
    s_cmp_lt_u32 s20, 4
    s_cbranch_scc1 L_comp_48
    s_and_b32 s29, s20, 3
    s_mul_i32 s30, s29, 5120
    s_and_b32 s31, s51, 7
    s_mul_i32 s31, s31, 245760
    s_add_u32 s31, s31, s30
    s_mul_i32 s32, s29, 3072
    s_lshl_b32 s33, s29, 12
    s_and_b32 s34, s51, 15
    s_mov_b32 s35, s50
    s_mul_i32 s34, s34, 163840
    s_add_u32 s34, s34, s33
    s_lshl_b32 s22, s35, 31
    s_or_b32 s38, s34, s22
    v_lshlrev_b32 v12, 2, v0
    v_add_u32 v12, s30, v12
    v_add_u32 v12, 0x10000, v12
    v_lshlrev_b32 v15, 7, v0
    s_lshl_b32 s39, s50, 31
    s_add_u32 s24, s31, 2785280
    buffer_load_dwordx4 v[20:23], v2, s[4:7], s24 offen
    s_waitcnt vmcnt(2)
    s_add_u32 s24, s31, 2786304
    buffer_load_dwordx4 v[24:27], v2, s[4:7], s24 offen
    s_waitcnt vmcnt(2)
    s_add_u32 s24, s31, 2787328
    buffer_load_dwordx4 v[28:31], v2, s[4:7], s24 offen
    s_waitcnt vmcnt(2)
    s_add_u32 s24, s31, 2788352
    buffer_load_dwordx4 v[32:35], v2, s[4:7], s24 offen
    s_waitcnt vmcnt(2)
    s_add_u32 s24, s31, 2789376
    buffer_load_dwordx4 v[36:39], v2, s[4:7], s24 offen
    s_waitcnt vmcnt(2)
    s_add_u32 s24, s31, 2805760
    buffer_load_dwordx4 v[40:43], v2, s[4:7], s24 offen
    s_waitcnt vmcnt(2)
    s_add_u32 s24, s31, 2806784
    buffer_load_dwordx4 v[44:47], v2, s[4:7], s24 offen
    s_waitcnt vmcnt(2)
    s_add_u32 s24, s31, 2807808
    buffer_load_dwordx4 v[48:51], v2, s[4:7], s24 offen
    s_waitcnt vmcnt(2)
    s_add_u32 s24, s31, 2808832
    buffer_load_dwordx4 v[52:55], v2, s[4:7], s24 offen
    s_waitcnt vmcnt(2)
    s_add_u32 s24, s31, 2809856
    buffer_load_dwordx4 v[56:59], v2, s[4:7], s24 offen
    s_waitcnt vmcnt(2)
    s_add_u32 s24, s31, 2826240
    buffer_load_dwordx4 v[60:63], v2, s[4:7], s24 offen
    s_waitcnt vmcnt(2)
    s_add_u32 s24, s31, 2827264
    buffer_load_dwordx4 v[64:67], v2, s[4:7], s24 offen
    s_waitcnt vmcnt(2)
    s_add_u32 s24, s31, 2828288
    buffer_load_dwordx4 v[68:71], v2, s[4:7], s24 offen
    s_waitcnt vmcnt(2)
    s_add_u32 s24, s31, 2829312
    buffer_load_dwordx4 v[72:75], v2, s[4:7], s24 offen
    s_waitcnt vmcnt(2)
    s_add_u32 s24, s31, 2830336
    buffer_load_dwordx4 v[76:79], v2, s[4:7], s24 offen
    s_waitcnt vmcnt(2)
    s_add_u32 s24, s31, 2846720
    buffer_load_dwordx4 v[80:83], v2, s[4:7], s24 offen
    s_waitcnt vmcnt(2)
    s_add_u32 s24, s31, 2847744
    buffer_load_dwordx4 v[84:87], v2, s[4:7], s24 offen
    s_waitcnt vmcnt(2)
    s_add_u32 s24, s31, 2848768
    buffer_load_dwordx4 v[88:91], v2, s[4:7], s24 offen
    s_waitcnt vmcnt(2)
    s_add_u32 s24, s31, 2849792
    buffer_load_dwordx4 v[92:95], v2, s[4:7], s24 offen
    s_waitcnt vmcnt(2)
    s_add_u32 s24, s31, 2850816
    buffer_load_dwordx4 v[96:99], v2, s[4:7], s24 offen
    s_waitcnt vmcnt(2)
    s_add_u32 s24, s31, 2867200
    buffer_load_dwordx4 v[100:103], v2, s[4:7], s24 offen
    s_waitcnt vmcnt(2)
    s_add_u32 s24, s31, 2868224
    buffer_load_dwordx4 v[104:107], v2, s[4:7], s24 offen
    s_waitcnt vmcnt(2)
    s_barrier
    s_add_u32 m0, s32, 0
    s_nop 0
    ds_write_addtid_b32 v160 offset:24576
    ds_write_addtid_b32 v161 offset:24832
    ds_write_addtid_b32 v162 offset:25088
    ds_write_addtid_b32 v163 offset:25344
    ds_write_addtid_b32 v164 offset:25600
    ds_write_addtid_b32 v165 offset:25856
    ds_write_addtid_b32 v166 offset:26112
    ds_write_addtid_b32 v167 offset:26368
    ds_write_addtid_b32 v168 offset:26624
    ds_write_addtid_b32 v169 offset:26880
    ds_write_addtid_b32 v170 offset:27136
    ds_write_addtid_b32 v171 offset:27392
    ds_write_addtid_b32 v172 offset:36864
    ds_write_addtid_b32 v173 offset:37120
    ds_write_addtid_b32 v174 offset:37376
    ds_write_addtid_b32 v175 offset:37632
    ds_write_addtid_b32 v176 offset:37888
    ds_write_addtid_b32 v177 offset:38144
    ds_write_addtid_b32 v178 offset:38400
    ds_write_addtid_b32 v179 offset:38656
    ds_write_addtid_b32 v180 offset:38912
    ds_write_addtid_b32 v181 offset:39168
    ds_write_addtid_b32 v182 offset:39424
    ds_write_addtid_b32 v183 offset:39680
    ds_write_addtid_b32 v184 offset:49152
    ds_write_addtid_b32 v185 offset:49408
    ds_write_addtid_b32 v186 offset:49664
    ds_write_addtid_b32 v187 offset:49920
    ds_write_addtid_b32 v188 offset:50176
    ds_write_addtid_b32 v189 offset:50432
    ds_write_addtid_b32 v190 offset:50688
    ds_write_addtid_b32 v191 offset:50944
    ds_write_addtid_b32 v192 offset:51200
    ds_write_addtid_b32 v193 offset:51456
    ds_write_addtid_b32 v194 offset:51712
    ds_write_addtid_b32 v195 offset:51968
    ds_write_addtid_b32 v196 offset:61440
    ds_write_addtid_b32 v197 offset:61696
    ds_write_addtid_b32 v198 offset:61952
    ds_write_addtid_b32 v199 offset:62208
    ds_write_addtid_b32 v200 offset:62464
    ds_write_addtid_b32 v201 offset:62720
    ds_write_addtid_b32 v202 offset:62976
    ds_write_addtid_b32 v203 offset:63232
    ds_write_addtid_b32 v204 offset:63488
    ds_write_addtid_b32 v205 offset:63744
    ds_write_addtid_b32 v206 offset:64000
    ds_write_addtid_b32 v207 offset:64256
    s_add_u32 m0, s32, 49152
    s_nop 0
    ds_write_addtid_b32 v208 offset:24576
    ds_write_addtid_b32 v209 offset:24832
    ds_write_addtid_b32 v210 offset:25088
    ds_write_addtid_b32 v211 offset:25344
    ds_write_addtid_b32 v212 offset:25600
    ds_write_addtid_b32 v213 offset:25856
    ds_write_addtid_b32 v214 offset:26112
    ds_write_addtid_b32 v215 offset:26368
    ds_write_addtid_b32 v216 offset:26624
    ds_write_addtid_b32 v217 offset:26880
    ds_write_addtid_b32 v218 offset:27136
    ds_write_addtid_b32 v219 offset:27392
    ds_write_addtid_b32 v220 offset:36864
    ds_write_addtid_b32 v221 offset:37120
    ds_write_addtid_b32 v222 offset:37376
    ds_write_addtid_b32 v223 offset:37632
    ds_write_addtid_b32 v224 offset:37888
    ds_write_addtid_b32 v225 offset:38144
    ds_write_addtid_b32 v226 offset:38400
    ds_write_addtid_b32 v227 offset:38656
    ds_write_addtid_b32 v228 offset:38912
    ds_write_addtid_b32 v229 offset:39168
    ds_write_addtid_b32 v230 offset:39424
    ds_write_addtid_b32 v231 offset:39680
    ds_write_addtid_b32 v232 offset:49152
    ds_write_addtid_b32 v233 offset:49408
    ds_write_addtid_b32 v234 offset:49664
    ds_write_addtid_b32 v235 offset:49920
    ds_write_addtid_b32 v236 offset:50176
    ds_write_addtid_b32 v237 offset:50432
    ds_write_addtid_b32 v238 offset:50688
    ds_write_addtid_b32 v239 offset:50944
    ds_write_addtid_b32 v240 offset:51200
    ds_write_addtid_b32 v241 offset:51456
    ds_write_addtid_b32 v242 offset:51712
    ds_write_addtid_b32 v243 offset:51968
    ds_write_addtid_b32 v244 offset:61440
    ds_write_addtid_b32 v245 offset:61696
    ds_write_addtid_b32 v246 offset:61952
    ds_write_addtid_b32 v247 offset:62208
    ds_write_addtid_b32 v248 offset:62464
    ds_write_addtid_b32 v249 offset:62720
    ds_write_addtid_b32 v250 offset:62976
    ds_write_addtid_b32 v251 offset:63232
    ds_write_addtid_b32 v252 offset:63488
    ds_write_addtid_b32 v253 offset:63744
    ds_write_addtid_b32 v254 offset:64000
    ds_write_addtid_b32 v255 offset:64256
    s_waitcnt lgkmcnt(0)
    s_add_u32 s24, s31, 2869248
    buffer_load_dwordx4 v[108:111], v2, s[4:7], s24 offen
    s_add_u32 s24, s31, 2870272
    buffer_load_dwordx4 v[112:115], v2, s[4:7], s24 offen
    s_add_u32 s24, s31, 2871296
    buffer_load_dwordx4 v[116:119], v2, s[4:7], s24 offen
    s_barrier
    s_cmp_lg_u32 s29, 0
    s_cbranch_scc1 L_gdone_49
    s_mov_b32 s23, 200000
    v_lshlrev_b32 v9, 8, v0
    s_mov_b32 exec_hi, 0
L_gpoll_50:
    buffer_load_dword v10, v9, s[4:7], s52 offen sc1
    s_sub_u32 s23, s23, 1
    s_cbranch_scc1 L_gdone_49
    s_waitcnt vmcnt(0)
    v_cmp_gt_u32 vcc, 8, v10
    s_cbranch_vccnz L_gpoll_50
L_gdone_49:
    s_mov_b64 exec, -1
    s_barrier
    s_add_u32 s24, s31, 2887680
    buffer_load_dwordx4 v[120:123], v2, s[4:7], s24 offen
    s_waitcnt vmcnt(2)
    s_add_u32 s24, s31, 2888704
    buffer_load_dwordx4 v[124:127], v2, s[4:7], s24 offen
    s_waitcnt vmcnt(2)
    s_add_u32 s24, s31, 2889728
    buffer_load_dwordx4 v[128:131], v2, s[4:7], s24 offen
    s_waitcnt vmcnt(2)
    s_add_u32 s24, s31, 2890752
    buffer_load_dwordx4 v[132:135], v2, s[4:7], s24 offen
    s_waitcnt vmcnt(2)
    s_barrier
    s_add_u32 s24, s31, 2891776
    buffer_load_dwordx4 v[136:139], v2, s[4:7], s24 offen
    s_waitcnt vmcnt(3)
    s_add_u32 s24, s31, 2908160
    buffer_load_dwordx4 v[140:143], v2, s[4:7], s24 offen
    s_waitcnt vmcnt(3)
    s_add_u32 s24, s31, 2909184
    buffer_load_dwordx4 v[144:147], v2, s[4:7], s24 offen
    s_waitcnt vmcnt(3)
    s_add_u32 s24, s31, 2910208
    buffer_load_dwordx4 v[148:151], v2, s[4:7], s24 offen
    s_waitcnt vmcnt(3)
    s_add_u32 s24, s31, 2911232
    buffer_load_dwordx4 v[152:155], v2, s[4:7], s24 offen
    s_waitcnt vmcnt(3)
    s_add_u32 s24, s31, 2912256
    buffer_load_dwordx4 v[156:159], v2, s[4:7], s24 offen
    s_waitcnt vmcnt(3)
    s_add_u32 s24, s31, 2928640
    buffer_load_dwordx4 v[160:163], v2, s[4:7], s24 offen
    s_waitcnt vmcnt(3)
    s_add_u32 s24, s31, 2929664
    buffer_load_dwordx4 v[164:167], v2, s[4:7], s24 offen
    s_waitcnt vmcnt(3)
    s_add_u32 s24, s31, 2930688
    buffer_load_dwordx4 v[168:171], v2, s[4:7], s24 offen
    s_waitcnt vmcnt(3)
    s_add_u32 s24, s31, 2931712
    buffer_load_dwordx4 v[172:175], v2, s[4:7], s24 offen
    s_waitcnt vmcnt(3)
    s_barrier
    s_add_u32 s24, s31, 2932736
    buffer_load_dwordx4 v[176:179], v2, s[4:7], s24 offen
    s_add_u32 s24, s31, 2949120
    buffer_load_dwordx4 v[180:183], v2, s[4:7], s24 offen
    s_waitcnt vmcnt(2)
    s_waitcnt vmcnt(36)
    s_add_u32 m0, s30, 0
    s_nop 0
    ds_write_addtid_b32 v20 offset:0
    ds_write_addtid_b32 v21 offset:256
    ds_write_addtid_b32 v22 offset:512
    ds_write_addtid_b32 v23 offset:768
    ds_write_addtid_b32 v24 offset:1024
    ds_write_addtid_b32 v25 offset:1280
    ds_write_addtid_b32 v26 offset:1536
    ds_write_addtid_b32 v27 offset:1792
    ds_write_addtid_b32 v28 offset:2048
    ds_write_addtid_b32 v29 offset:2304
    ds_write_addtid_b32 v30 offset:2560
    ds_write_addtid_b32 v31 offset:2816
    ds_write_addtid_b32 v32 offset:3072
    ds_write_addtid_b32 v33 offset:3328
    ds_write_addtid_b32 v34 offset:3584
    ds_write_addtid_b32 v35 offset:3840
    ds_write_addtid_b32 v36 offset:4096
    ds_write_addtid_b32 v37 offset:4352
    ds_write_addtid_b32 v38 offset:4608
    ds_write_addtid_b32 v39 offset:4864
    s_add_u32 s24, s31, 2950144
    buffer_load_dwordx4 v[184:187], v2, s[4:7], s24 offen
    s_add_u32 s24, s31, 2951168
    buffer_load_dwordx4 v[188:191], v2, s[4:7], s24 offen
    s_waitcnt vmcnt(2)
    s_waitcnt vmcnt(33)
    ds_write_addtid_b32 v40 offset:20480
    ds_write_addtid_b32 v41 offset:20736
    ds_write_addtid_b32 v42 offset:20992
    ds_write_addtid_b32 v43 offset:21248
    ds_write_addtid_b32 v44 offset:21504
    ds_write_addtid_b32 v45 offset:21760
    ds_write_addtid_b32 v46 offset:22016
    ds_write_addtid_b32 v47 offset:22272
    ds_write_addtid_b32 v48 offset:22528
    ds_write_addtid_b32 v49 offset:22784
    ds_write_addtid_b32 v50 offset:23040
    ds_write_addtid_b32 v51 offset:23296
    ds_write_addtid_b32 v52 offset:23552
    ds_write_addtid_b32 v53 offset:23808
    ds_write_addtid_b32 v54 offset:24064
    ds_write_addtid_b32 v55 offset:24320
    ds_write_addtid_b32 v56 offset:24576
    ds_write_addtid_b32 v57 offset:24832
    ds_write_addtid_b32 v58 offset:25088
    ds_write_addtid_b32 v59 offset:25344
    s_add_u32 s24, s31, 2952192
    buffer_load_dwordx4 v[192:195], v2, s[4:7], s24 offen
    s_add_u32 s24, s31, 2953216
    buffer_load_dwordx4 v[196:199], v2, s[4:7], s24 offen
    s_waitcnt vmcnt(2)
    s_waitcnt vmcnt(30)
    ds_write_addtid_b32 v60 offset:40960
    ds_write_addtid_b32 v61 offset:41216
    ds_write_addtid_b32 v62 offset:41472
    ds_write_addtid_b32 v63 offset:41728
    ds_write_addtid_b32 v64 offset:41984
    ds_write_addtid_b32 v65 offset:42240
    ds_write_addtid_b32 v66 offset:42496
    ds_write_addtid_b32 v67 offset:42752
    ds_write_addtid_b32 v68 offset:43008
    ds_write_addtid_b32 v69 offset:43264
    ds_write_addtid_b32 v70 offset:43520
    ds_write_addtid_b32 v71 offset:43776
    ds_write_addtid_b32 v72 offset:44032
    ds_write_addtid_b32 v73 offset:44288
    ds_write_addtid_b32 v74 offset:44544
    ds_write_addtid_b32 v75 offset:44800
    ds_write_addtid_b32 v76 offset:45056
    ds_write_addtid_b32 v77 offset:45312
    ds_write_addtid_b32 v78 offset:45568
    ds_write_addtid_b32 v79 offset:45824
    s_add_u32 s24, s31, 2969600
    buffer_load_dwordx4 v[200:203], v2, s[4:7], s24 offen
    s_add_u32 s24, s31, 2970624
    buffer_load_dwordx4 v[204:207], v2, s[4:7], s24 offen
    s_waitcnt vmcnt(2)
    s_waitcnt vmcnt(27)
    ds_write_addtid_b32 v80 offset:61440
    ds_write_addtid_b32 v81 offset:61696
    ds_write_addtid_b32 v82 offset:61952
    ds_write_addtid_b32 v83 offset:62208
    ds_write_addtid_b32 v84 offset:62464
    ds_write_addtid_b32 v85 offset:62720
    ds_write_addtid_b32 v86 offset:62976
    ds_write_addtid_b32 v87 offset:63232
    ds_write_addtid_b32 v88 offset:63488
    ds_write_addtid_b32 v89 offset:63744
    ds_write_addtid_b32 v90 offset:64000
    ds_write_addtid_b32 v91 offset:64256
    ds_write_addtid_b32 v92 offset:64512
    ds_write_addtid_b32 v93 offset:64768
    ds_write_addtid_b32 v94 offset:65024
    ds_write_addtid_b32 v95 offset:65280
    s_add_u32 m0, s30, 49152
    s_nop 0
    ds_write_addtid_b32 v96 offset:16384
    ds_write_addtid_b32 v97 offset:16640
    ds_write_addtid_b32 v98 offset:16896
    ds_write_addtid_b32 v99 offset:17152
    s_add_u32 s24, s31, 2971648
    buffer_load_dwordx4 v[208:211], v2, s[4:7], s24 offen
    s_add_u32 s24, s31, 2972672
    buffer_load_dwordx4 v[212:215], v2, s[4:7], s24 offen
    s_waitcnt vmcnt(2)
    s_waitcnt vmcnt(24)
    ds_write_addtid_b32 v100 offset:32768
    ds_write_addtid_b32 v101 offset:33024
    ds_write_addtid_b32 v102 offset:33280
    ds_write_addtid_b32 v103 offset:33536
    ds_write_addtid_b32 v104 offset:33792
    ds_write_addtid_b32 v105 offset:34048
    ds_write_addtid_b32 v106 offset:34304
    ds_write_addtid_b32 v107 offset:34560
    ds_write_addtid_b32 v108 offset:34816
    ds_write_addtid_b32 v109 offset:35072
    ds_write_addtid_b32 v110 offset:35328
    ds_write_addtid_b32 v111 offset:35584
    ds_write_addtid_b32 v112 offset:35840
    ds_write_addtid_b32 v113 offset:36096
    ds_write_addtid_b32 v114 offset:36352
    ds_write_addtid_b32 v115 offset:36608
    ds_write_addtid_b32 v116 offset:36864
    ds_write_addtid_b32 v117 offset:37120
    ds_write_addtid_b32 v118 offset:37376
    ds_write_addtid_b32 v119 offset:37632
    s_add_u32 s24, s31, 2973696
    buffer_load_dwordx4 v[216:219], v2, s[4:7], s24 offen
    s_add_u32 s24, s31, 2990080
    buffer_load_dwordx4 v[220:223], v2, s[4:7], s24 offen
    s_waitcnt vmcnt(2)
    s_waitcnt vmcnt(21)
    ds_write_addtid_b32 v120 offset:53248
    ds_write_addtid_b32 v121 offset:53504
    ds_write_addtid_b32 v122 offset:53760
    ds_write_addtid_b32 v123 offset:54016
    ds_write_addtid_b32 v124 offset:54272
    ds_write_addtid_b32 v125 offset:54528
    ds_write_addtid_b32 v126 offset:54784
    ds_write_addtid_b32 v127 offset:55040
    ds_write_addtid_b32 v128 offset:55296
    ds_write_addtid_b32 v129 offset:55552
    ds_write_addtid_b32 v130 offset:55808
    ds_write_addtid_b32 v131 offset:56064
    ds_write_addtid_b32 v132 offset:56320
    ds_write_addtid_b32 v133 offset:56576
    ds_write_addtid_b32 v134 offset:56832
    ds_write_addtid_b32 v135 offset:57088
    ds_write_addtid_b32 v136 offset:57344
    ds_write_addtid_b32 v137 offset:57600
    ds_write_addtid_b32 v138 offset:57856
    ds_write_addtid_b32 v139 offset:58112
    s_add_u32 s24, s31, 2991104
    buffer_load_dwordx4 v[224:227], v2, s[4:7], s24 offen
    s_add_u32 s24, s31, 2992128
    buffer_load_dwordx4 v[228:231], v2, s[4:7], s24 offen
    s_waitcnt vmcnt(2)
    s_waitcnt vmcnt(18)
    ds_write_b32 v12, v140 offset:57344
    ds_write_b32 v12, v141 offset:57600
    ds_write_b32 v12, v142 offset:57856
    ds_write_b32 v12, v143 offset:58112
    ds_write_b32 v12, v144 offset:58368
    ds_write_b32 v12, v145 offset:58624
    ds_write_b32 v12, v146 offset:58880
    ds_write_b32 v12, v147 offset:59136
    ds_write_b32 v12, v148 offset:59392
    ds_write_b32 v12, v149 offset:59648
    ds_write_b32 v12, v150 offset:59904
    ds_write_b32 v12, v151 offset:60160
    ds_write_b32 v12, v152 offset:60416
    ds_write_b32 v12, v153 offset:60672
    ds_write_b32 v12, v154 offset:60928
    ds_write_b32 v12, v155 offset:61184
    ds_write_b32 v12, v156 offset:61440
    ds_write_b32 v12, v157 offset:61696
    ds_write_b32 v12, v158 offset:61952
    ds_write_b32 v12, v159 offset:62208
    s_waitcnt lgkmcnt(0)
    s_barrier
    s_add_u32 s24, s31, 2993152
    buffer_load_dwordx4 v[232:235], v2, s[4:7], s24 offen
    s_add_u32 s24, s31, 2994176
    buffer_load_dwordx4 v[236:239], v2, s[4:7], s24 offen
    s_add_u32 s24, s31, 3010560
    buffer_load_dwordx4 v[240:243], v2, s[4:7], s24 offen
    s_add_u32 s24, s31, 3011584
    buffer_load_dwordx4 v[244:247], v2, s[4:7], s24 offen
    s_add_u32 s24, s31, 3012608
    buffer_load_dwordx4 v[248:251], v2, s[4:7], s24 offen
    s_add_u32 s24, s31, 3013632
    buffer_load_dwordx4 v[252:255], v2, s[4:7], s24 offen
    s_add_u32 s24, s31, 3014656
    buffer_load_dwordx4 v[16:19], v2, s[4:7], s24 offen
    s_setprio 0
    s_barrier
    s_waitcnt vmcnt(20)
    s_add_u32 m0, s30, 0
    s_nop 0
    ds_write_addtid_b32 v160 offset:0
    ds_write_addtid_b32 v161 offset:256
    ds_write_addtid_b32 v162 offset:512
    ds_write_addtid_b32 v163 offset:768
    ds_write_addtid_b32 v164 offset:1024
    ds_write_addtid_b32 v165 offset:1280
    ds_write_addtid_b32 v166 offset:1536
    ds_write_addtid_b32 v167 offset:1792
    ds_write_addtid_b32 v168 offset:2048
    ds_write_addtid_b32 v169 offset:2304
    ds_write_addtid_b32 v170 offset:2560
    ds_write_addtid_b32 v171 offset:2816
    ds_write_addtid_b32 v172 offset:3072
    ds_write_addtid_b32 v173 offset:3328
    ds_write_addtid_b32 v174 offset:3584
    ds_write_addtid_b32 v175 offset:3840
    ds_write_addtid_b32 v176 offset:4096
    ds_write_addtid_b32 v177 offset:4352
    ds_write_addtid_b32 v178 offset:4608
    ds_write_addtid_b32 v179 offset:4864
    s_waitcnt lgkmcnt(0)
    s_barrier
    s_waitcnt vmcnt(13)
    ds_write_addtid_b32 v180 offset:20480
    ds_write_addtid_b32 v181 offset:20736
    ds_write_addtid_b32 v182 offset:20992
    ds_write_addtid_b32 v183 offset:21248
    ds_write_addtid_b32 v184 offset:21504
    ds_write_addtid_b32 v185 offset:21760
    ds_write_addtid_b32 v186 offset:22016
    ds_write_addtid_b32 v187 offset:22272
    ds_write_addtid_b32 v188 offset:22528
    ds_write_addtid_b32 v189 offset:22784
    ds_write_addtid_b32 v190 offset:23040
    ds_write_addtid_b32 v191 offset:23296
    ds_write_addtid_b32 v192 offset:23552
    ds_write_addtid_b32 v193 offset:23808
    ds_write_addtid_b32 v194 offset:24064
    ds_write_addtid_b32 v195 offset:24320
    ds_write_addtid_b32 v196 offset:24576
    ds_write_addtid_b32 v197 offset:24832
    ds_write_addtid_b32 v198 offset:25088
    ds_write_addtid_b32 v199 offset:25344
    ds_write_addtid_b32 v200 offset:40960
    ds_write_addtid_b32 v201 offset:41216
    ds_write_addtid_b32 v202 offset:41472
    ds_write_addtid_b32 v203 offset:41728
    ds_write_addtid_b32 v204 offset:41984
    ds_write_addtid_b32 v205 offset:42240
    ds_write_addtid_b32 v206 offset:42496
    ds_write_addtid_b32 v207 offset:42752
    s_waitcnt lgkmcnt(0)
    s_barrier
    s_waitcnt vmcnt(6)
    ds_write_addtid_b32 v208 offset:43008
    ds_write_addtid_b32 v209 offset:43264
    ds_write_addtid_b32 v210 offset:43520
    ds_write_addtid_b32 v211 offset:43776
    ds_write_addtid_b32 v212 offset:44032
    ds_write_addtid_b32 v213 offset:44288
    ds_write_addtid_b32 v214 offset:44544
    ds_write_addtid_b32 v215 offset:44800
    ds_write_addtid_b32 v216 offset:45056
    ds_write_addtid_b32 v217 offset:45312
    ds_write_addtid_b32 v218 offset:45568
    ds_write_addtid_b32 v219 offset:45824
    ds_write_addtid_b32 v220 offset:61440
    ds_write_addtid_b32 v221 offset:61696
    ds_write_addtid_b32 v222 offset:61952
    ds_write_addtid_b32 v223 offset:62208
    ds_write_addtid_b32 v224 offset:62464
    ds_write_addtid_b32 v225 offset:62720
    ds_write_addtid_b32 v226 offset:62976
    ds_write_addtid_b32 v227 offset:63232
    ds_write_addtid_b32 v228 offset:63488
    ds_write_addtid_b32 v229 offset:63744
    ds_write_addtid_b32 v230 offset:64000
    ds_write_addtid_b32 v231 offset:64256
    ds_write_addtid_b32 v232 offset:64512
    ds_write_addtid_b32 v233 offset:64768
    ds_write_addtid_b32 v234 offset:65024
    ds_write_addtid_b32 v235 offset:65280
    s_waitcnt lgkmcnt(0)
    s_barrier
    s_waitcnt vmcnt(0)
    s_add_u32 m0, s30, 49152
    s_nop 0
    ds_write_addtid_b32 v236 offset:16384
    ds_write_addtid_b32 v237 offset:16640
    ds_write_addtid_b32 v238 offset:16896
    ds_write_addtid_b32 v239 offset:17152
    ds_write_addtid_b32 v240 offset:32768
    ds_write_addtid_b32 v241 offset:33024
    ds_write_addtid_b32 v242 offset:33280
    ds_write_addtid_b32 v243 offset:33536
    ds_write_addtid_b32 v244 offset:33792
    ds_write_addtid_b32 v245 offset:34048
    ds_write_addtid_b32 v246 offset:34304
    ds_write_addtid_b32 v247 offset:34560
    ds_write_addtid_b32 v248 offset:34816
    ds_write_addtid_b32 v249 offset:35072
    ds_write_addtid_b32 v250 offset:35328
    ds_write_addtid_b32 v251 offset:35584
    ds_write_addtid_b32 v252 offset:35840
    ds_write_addtid_b32 v253 offset:36096
    ds_write_addtid_b32 v254 offset:36352
    ds_write_addtid_b32 v255 offset:36608
    ds_write_addtid_b32 v16 offset:36864
    ds_write_addtid_b32 v17 offset:37120
    ds_write_addtid_b32 v18 offset:37376
    ds_write_addtid_b32 v19 offset:37632
    s_waitcnt lgkmcnt(0)
    s_barrier
    s_waitcnt lgkmcnt(0)
    s_setprio 0
    s_add_u32 s24, s38, 4751360
    buffer_load_dwordx4 v[20:23], v2, s[4:7], s24 offen
    s_add_u32 s24, s38, 4752384
    buffer_load_dwordx4 v[24:27], v2, s[4:7], s24 offen
    s_add_u32 s24, s38, 4753408
    buffer_load_dwordx4 v[28:31], v2, s[4:7], s24 offen
    s_add_u32 s24, s38, 4754432
    buffer_load_dwordx4 v[32:35], v2, s[4:7], s24 offen
    s_add_u32 s24, s38, 4767744
    buffer_load_dwordx4 v[36:39], v2, s[4:7], s24 offen
    s_add_u32 s24, s38, 4768768
    buffer_load_dwordx4 v[40:43], v2, s[4:7], s24 offen
    s_add_u32 s24, s38, 4769792
    buffer_load_dwordx4 v[44:47], v2, s[4:7], s24 offen
    s_add_u32 s24, s38, 4770816
    buffer_load_dwordx4 v[48:51], v2, s[4:7], s24 offen
    s_add_u32 s24, s38, 4784128
    buffer_load_dwordx4 v[52:55], v2, s[4:7], s24 offen
    s_add_u32 s24, s38, 4785152
    buffer_load_dwordx4 v[56:59], v2, s[4:7], s24 offen
    s_add_u32 s24, s38, 4786176
    buffer_load_dwordx4 v[60:63], v2, s[4:7], s24 offen
    s_add_u32 s24, s38, 4787200
    buffer_load_dwordx4 v[64:67], v2, s[4:7], s24 offen
    s_add_u32 s24, s38, 4800512
    buffer_load_dwordx4 v[68:71], v2, s[4:7], s24 offen
    s_add_u32 s24, s38, 4801536
    buffer_load_dwordx4 v[72:75], v2, s[4:7], s24 offen
    s_add_u32 s24, s38, 4802560
    buffer_load_dwordx4 v[76:79], v2, s[4:7], s24 offen
    s_add_u32 s24, s38, 4803584
    buffer_load_dwordx4 v[80:83], v2, s[4:7], s24 offen
    s_barrier
    s_cmp_lg_u32 s35, 0
    s_cbranch_scc1 L_fin_47
    s_waitcnt vmcnt(0)
    s_add_u32 m0, s33, 0
    s_nop 0
    ds_write_addtid_b32 v20 offset:0
    ds_write_addtid_b32 v21 offset:256
    ds_write_addtid_b32 v22 offset:512
    ds_write_addtid_b32 v23 offset:768
    ds_write_addtid_b32 v24 offset:1024
    ds_write_addtid_b32 v25 offset:1280
    ds_write_addtid_b32 v26 offset:1536
    ds_write_addtid_b32 v27 offset:1792
    ds_write_addtid_b32 v28 offset:2048
    ds_write_addtid_b32 v29 offset:2304
    ds_write_addtid_b32 v30 offset:2560
    ds_write_addtid_b32 v31 offset:2816
    ds_write_addtid_b32 v32 offset:3072
    ds_write_addtid_b32 v33 offset:3328
    ds_write_addtid_b32 v34 offset:3584
    ds_write_addtid_b32 v35 offset:3840
    ds_write_addtid_b32 v36 offset:16384
    ds_write_addtid_b32 v37 offset:16640
    ds_write_addtid_b32 v38 offset:16896
    ds_write_addtid_b32 v39 offset:17152
    ds_write_addtid_b32 v40 offset:17408
    ds_write_addtid_b32 v41 offset:17664
    ds_write_addtid_b32 v42 offset:17920
    ds_write_addtid_b32 v43 offset:18176
    ds_write_addtid_b32 v44 offset:18432
    ds_write_addtid_b32 v45 offset:18688
    ds_write_addtid_b32 v46 offset:18944
    ds_write_addtid_b32 v47 offset:19200
    ds_write_addtid_b32 v48 offset:19456
    ds_write_addtid_b32 v49 offset:19712
    ds_write_addtid_b32 v50 offset:19968
    ds_write_addtid_b32 v51 offset:20224
    ds_write_addtid_b32 v52 offset:32768
    ds_write_addtid_b32 v53 offset:33024
    ds_write_addtid_b32 v54 offset:33280
    ds_write_addtid_b32 v55 offset:33536
    ds_write_addtid_b32 v56 offset:33792
    ds_write_addtid_b32 v57 offset:34048
    ds_write_addtid_b32 v58 offset:34304
    ds_write_addtid_b32 v59 offset:34560
    ds_write_addtid_b32 v60 offset:34816
    ds_write_addtid_b32 v61 offset:35072
    ds_write_addtid_b32 v62 offset:35328
    ds_write_addtid_b32 v63 offset:35584
    ds_write_addtid_b32 v64 offset:35840
    ds_write_addtid_b32 v65 offset:36096
    ds_write_addtid_b32 v66 offset:36352
    ds_write_addtid_b32 v67 offset:36608
    ds_write_addtid_b32 v68 offset:49152
    ds_write_addtid_b32 v69 offset:49408
    ds_write_addtid_b32 v70 offset:49664
    ds_write_addtid_b32 v71 offset:49920
    ds_write_addtid_b32 v72 offset:50176
    ds_write_addtid_b32 v73 offset:50432
    ds_write_addtid_b32 v74 offset:50688
    ds_write_addtid_b32 v75 offset:50944
    ds_write_addtid_b32 v76 offset:51200
    ds_write_addtid_b32 v77 offset:51456
    ds_write_addtid_b32 v78 offset:51712
    ds_write_addtid_b32 v79 offset:51968
    ds_write_addtid_b32 v80 offset:52224
    ds_write_addtid_b32 v81 offset:52480
    ds_write_addtid_b32 v82 offset:52736
    ds_write_addtid_b32 v83 offset:52992
    s_waitcnt lgkmcnt(0)
    s_barrier
    s_add_u32 m0, s33, 65536
    s_add_u32 s24, s34, 4816896
    buffer_load_dwordx4 v2, s[4:7], s24 offen offset:0  lds
    buffer_load_dwordx4 v2, s[4:7], s24 offen offset:1024  lds
    buffer_load_dwordx4 v2, s[4:7], s24 offen offset:2048  lds
    buffer_load_dwordx4 v2, s[4:7], s24 offen offset:3072  lds
    s_barrier
    s_add_u32 m0, s33, 81920
    s_add_u32 s24, s34, 4833280
    buffer_load_dwordx4 v2, s[4:7], s24 offen offset:0  lds
    buffer_load_dwordx4 v2, s[4:7], s24 offen offset:1024  lds
    buffer_load_dwordx4 v2, s[4:7], s24 offen offset:2048  lds
    buffer_load_dwordx4 v2, s[4:7], s24 offen offset:3072  lds
    s_barrier
    s_add_u32 m0, s33, 122880
    s_add_u32 s24, s34, 4849664
    buffer_load_dwordx4 v2, s[4:7], s24 offen offset:0  lds
    buffer_load_dwordx4 v2, s[4:7], s24 offen offset:1024  lds
    buffer_load_dwordx4 v2, s[4:7], s24 offen offset:2048  lds
    buffer_load_dwordx4 v2, s[4:7], s24 offen offset:3072  lds
    s_barrier
    s_add_u32 m0, s33, 139264
    s_add_u32 s24, s34, 4866048
    buffer_load_dwordx4 v2, s[4:7], s24 offen offset:0  lds
    buffer_load_dwordx4 v2, s[4:7], s24 offen offset:1024  lds
    buffer_load_dwordx4 v2, s[4:7], s24 offen offset:2048  lds
    buffer_load_dwordx4 v2, s[4:7], s24 offen offset:3072  lds
    s_waitcnt vmcnt(12)
    s_barrier
    s_add_u32 m0, s33, 102400
    s_add_u32 s24, s34, 4882432
    buffer_load_dwordx4 v2, s[4:7], s24 offen offset:0  lds
    buffer_load_dwordx4 v2, s[4:7], s24 offen offset:1024  lds
    buffer_load_dwordx4 v2, s[4:7], s24 offen offset:2048  lds
    buffer_load_dwordx4 v2, s[4:7], s24 offen offset:3072  lds
    s_waitcnt vmcnt(12)
    s_barrier
    s_add_u32 m0, s33, 0
    s_add_u32 s24, s34, 4898816
    buffer_load_dwordx4 v2, s[4:7], s24 offen offset:0  lds
    buffer_load_dwordx4 v2, s[4:7], s24 offen offset:1024  lds
    buffer_load_dwordx4 v2, s[4:7], s24 offen offset:2048  lds
    buffer_load_dwordx4 v2, s[4:7], s24 offen offset:3072  lds
    s_waitcnt vmcnt(12)
    s_barrier
    s_waitcnt vmcnt(8)
    s_barrier
    s_waitcnt vmcnt(4)
    s_barrier
    s_waitcnt vmcnt(0)
    s_barrier
    s_branch L_next
L_slow_45:
    s_cmp_lg_u32 s34, 0
    s_cbranch_scc1 L_epi_44
    s_mov_b32 s34, 1
    v_mov_b32 v14, 0xff800000
    v_mov_b32 v15, 0xff800000
    v_lshlrev_b32 v16, 3, v0
    s_mov_b32 s36, s26
    s_mov_b32 s37, 32
L_maxloop_51:
    buffer_load_dwordx2 v[148:149], v16, s[4:7], s36 offen offset:2048 sc1
    buffer_load_dwordx4 v[144:147], v2, s[4:7], s36 offen offset:0 sc1
    s_waitcnt vmcnt(0)
    v_mfma_f32_32x32x4_2b_bf16 v[32:63], v[148:149], v[150:151], 0 cbsz:1 abid:0
    s_nop 15
    s_nop 1
    v_mfma_f32_32x32x16_bf16 v[32:47], v[144:147], v[152:155], v[32:47]
    v_mfma_f32_32x32x16_bf16 v[48:63], v[144:147], v[156:159], v[48:63]
    s_nop 11
    v_max3_f32 v14, v32, v33, v14
    v_max3_f32 v15, v48, v49, v15
    v_max3_f32 v14, v34, v35, v14
    v_max3_f32 v15, v50, v51, v15
    v_max3_f32 v14, v36, v37, v14
    v_max3_f32 v15, v52, v53, v15
    v_max3_f32 v14, v38, v39, v14
    v_max3_f32 v15, v54, v55, v15
    v_max3_f32 v14, v40, v41, v14
    v_max3_f32 v15, v56, v57, v15
    v_max3_f32 v14, v42, v43, v14
    v_max3_f32 v15, v58, v59, v15
    v_max3_f32 v14, v44, v45, v14
    v_max3_f32 v15, v60, v61, v15
    v_max3_f32 v14, v46, v47, v14
    v_max3_f32 v15, v62, v63, v15
    buffer_load_dwordx4 v[144:147], v2, s[4:7], s36 offen offset:1024 sc1
    s_waitcnt vmcnt(0)
    v_mfma_f32_32x32x4_2b_bf16 v[32:63], v[148:149], v[150:151], 0 cbsz:1 abid:1
    s_nop 15
    s_nop 1
    v_mfma_f32_32x32x16_bf16 v[32:47], v[144:147], v[152:155], v[32:47]
    v_mfma_f32_32x32x16_bf16 v[48:63], v[144:147], v[156:159], v[48:63]
    s_nop 11
    v_max3_f32 v14, v32, v33, v14
    v_max3_f32 v15, v48, v49, v15
    v_max3_f32 v14, v34, v35, v14
    v_max3_f32 v15, v50, v51, v15
    v_max3_f32 v14, v36, v37, v14
    v_max3_f32 v15, v52, v53, v15
    v_max3_f32 v14, v38, v39, v14
    v_max3_f32 v15, v54, v55, v15
    v_max3_f32 v14, v40, v41, v14
    v_max3_f32 v15, v56, v57, v15
    v_max3_f32 v14, v42, v43, v14
    v_max3_f32 v15, v58, v59, v15
    v_max3_f32 v14, v44, v45, v14
    v_max3_f32 v15, v60, v61, v15
    v_max3_f32 v14, v46, v47, v14
    v_max3_f32 v15, v62, v63, v15
    s_bitcmp1_b32 s37, 0
    s_cselect_b32 s22, 481280, 0
    s_add_u32 s36, s36, s22
    s_add_u32 s36, s36, 5120
    s_sub_u32 s37, s37, 1
    s_cmp_lg_u32 s37, 0
    s_cbranch_scc1 L_maxloop_51
    v_mov_b32 v16, v14
    s_nop 1
    v_permlane32_swap_b32 v14, v16
    v_max_f32 v14, v14, v16
    v_mov_b32 v16, v15
    s_nop 1
    v_permlane32_swap_b32 v15, v16
    v_max_f32 v15, v15, v16
    s_waitcnt lgkmcnt(0)
    v_sub_f32 v64, 0, v14
    v_mov_b32 v96, 0
    v_sub_f32 v65, 0, v14
    v_mov_b32 v97, 0
    v_sub_f32 v66, 0, v14
    v_mov_b32 v98, 0
    v_sub_f32 v67, 0, v14
    v_mov_b32 v99, 0
    v_sub_f32 v68, 0, v14
    v_mov_b32 v100, 0
    v_sub_f32 v69, 0, v14
    v_mov_b32 v101, 0
    v_sub_f32 v70, 0, v14
    v_mov_b32 v102, 0
    v_sub_f32 v71, 0, v14
    v_mov_b32 v103, 0
    v_sub_f32 v72, 0, v14
    v_mov_b32 v104, 0
    v_sub_f32 v73, 0, v14
    v_mov_b32 v105, 0
    v_sub_f32 v74, 0, v14
    v_mov_b32 v106, 0
    v_sub_f32 v75, 0, v14
    v_mov_b32 v107, 0
    v_sub_f32 v76, 0, v14
    v_mov_b32 v108, 0
    v_sub_f32 v77, 0, v14
    v_mov_b32 v109, 0
    v_sub_f32 v78, 0, v14
    v_mov_b32 v110, 0
    v_sub_f32 v79, 0, v14
    v_mov_b32 v111, 0
    v_sub_f32 v80, 0, v15
    v_mov_b32 v112, 0
    v_sub_f32 v81, 0, v15
    v_mov_b32 v113, 0
    v_sub_f32 v82, 0, v15
    v_mov_b32 v114, 0
    v_sub_f32 v83, 0, v15
    v_mov_b32 v115, 0
    v_sub_f32 v84, 0, v15
    v_mov_b32 v116, 0
    v_sub_f32 v85, 0, v15
    v_mov_b32 v117, 0
    v_sub_f32 v86, 0, v15
    v_mov_b32 v118, 0
    v_sub_f32 v87, 0, v15
    v_mov_b32 v119, 0
    v_sub_f32 v88, 0, v15
    v_mov_b32 v120, 0
    v_sub_f32 v89, 0, v15
    v_mov_b32 v121, 0
    v_sub_f32 v90, 0, v15
    v_mov_b32 v122, 0
    v_sub_f32 v91, 0, v15
    v_mov_b32 v123, 0
    v_sub_f32 v92, 0, v15
    v_mov_b32 v124, 0
    v_sub_f32 v93, 0, v15
    v_mov_b32 v125, 0
    v_sub_f32 v94, 0, v15
    v_mov_b32 v126, 0
    v_sub_f32 v95, 0, v15
    v_mov_b32 v127, 0
    v_subrev_u32 v14, 102400, v11
    v_subrev_u32 v15, 102400, v4
    s_lshl_b32 s22, s33, 8
    v_lshlrev_b32 v16, 3, v5
    v_add_u32 v16, s22, v16
    s_mov_b32 s36, s26
    s_mov_b32 s37, 32
L_pass2_52:
    buffer_load_dwordx2 v[148:149], v16, s[4:7], s36 offen offset:2048 sc1
    buffer_load_dwordx4 v[144:147], v14, s[4:7], s36 offen sc1
    s_mov_b64 exec, s[40:41]
    buffer_load_dwordx4 v[128:131], v15, s[4:7], s36 offen sc1
    buffer_load_dwordx4 v[132:135], v15, s[4:7], s36 offen offset:640 sc1
    s_mov_b64 exec, -1
    s_waitcnt vmcnt(0)
    v_mfma_f32_32x32x4_2b_bf16 v[32:63], v[148:149], v[150:151], v[64:95] cbsz:1 abid:0
    s_nop 15
    s_nop 1
    v_mfma_f32_32x32x16_bf16 v[32:47], v[144:147], v[152:155], v[32:47]
    v_mfma_f32_32x32x16_bf16 v[48:63], v[144:147], v[156:159], v[48:63]
    s_nop 11
    v_exp_f32 v32, v32
    v_exp_f32 v33, v33
    v_exp_f32 v34, v34
    v_exp_f32 v35, v35
    v_exp_f32 v36, v36
    v_exp_f32 v37, v37
    v_exp_f32 v38, v38
    v_exp_f32 v39, v39
    v_exp_f32 v40, v40
    v_exp_f32 v41, v41
    v_exp_f32 v42, v42
    v_exp_f32 v43, v43
    v_exp_f32 v44, v44
    v_exp_f32 v45, v45
    v_exp_f32 v46, v46
    v_exp_f32 v47, v47
    v_exp_f32 v48, v48
    v_exp_f32 v49, v49
    v_exp_f32 v50, v50
    v_exp_f32 v51, v51
    v_exp_f32 v52, v52
    v_exp_f32 v53, v53
    v_exp_f32 v54, v54
    v_exp_f32 v55, v55
    v_exp_f32 v56, v56
    v_exp_f32 v57, v57
    v_exp_f32 v58, v58
    v_exp_f32 v59, v59
    v_exp_f32 v60, v60
    v_exp_f32 v61, v61
    v_exp_f32 v62, v62
    v_exp_f32 v63, v63
    s_nop 1
    v_smfmac_f32_32x32x32_bf16 v[96:111], v[128:131], v[32:39], v30
    v_smfmac_f32_32x32x32_bf16 v[96:111], v[132:135], v[40:47], v30
    v_smfmac_f32_32x32x32_bf16 v[112:127], v[128:131], v[48:55], v30
    v_smfmac_f32_32x32x32_bf16 v[112:127], v[132:135], v[56:63], v30
    s_bitcmp1_b32 s37, 0
    s_cselect_b32 s22, 481280, 0
    s_add_u32 s36, s36, s22
    s_add_u32 s36, s36, 5120
    s_sub_u32 s37, s37, 1
    s_cmp_lg_u32 s37, 0
    s_cbranch_scc1 L_pass2_52
    s_nop 11
    s_barrier
    ds_write_b128 v12, v[112:115] offset:0
    ds_write_b128 v12, v[116:119] offset:1024
    ds_write_b128 v12, v[120:123] offset:2048
    s_branch L_red_28
L_comp_48:
    s_lshr_b32 s22, s51, 3
    s_lshl_b32 s22, s22, 2
    s_and_b32 s23, s20, 1
    s_lshl_b32 s23, s23, 1
    s_add_u32 s22, s22, s23
    s_lshr_b32 s23, s20, 1
    s_add_u32 s34, s22, s23
    s_lshr_b32 s35, s34, 1
    s_mul_i32 s35, s35, 40960
    s_and_b32 s22, s34, 1
    s_lshl_b32 s22, s22, 8
    s_add_u32 s35, s35, s22
    s_and_b32 s23, s51, 7
    s_mul_i32 s22, s23, 5120
    s_add_u32 s35, s35, s22
    s_mul_i32 s22, s21, 327680
    s_add_u32 s35, s35, s22
    s_lshl_b32 s42, s21, 4
    s_add_u32 s42, s42, s34
    s_mul_i32 s42, s42, 20480
    s_mul_i32 s22, s23, 160
    s_add_u32 s42, s42, s22
    v_and_b32 v234, 15, v0
    v_lshrrev_b32 v235, 4, v0
    v_lshrrev_b32 v236, 5, v0
    v_lshlrev_b32 v236, 9, v236
    v_lshl_add_u32 v7, v234, 4, v236
    v_and_b32 v236, 1, v235
    v_lshl_add_u32 v7, v236, 3, v7
    v_mul_u32_u24 v15, 1280, v234
    v_lshl_add_u32 v15, v235, 3, v15
    s_and_b32 s27, s51, 7
    s_lshr_b32 s30, s20, 1
    s_xor_b32 s31, s34, 1
    s_lshl_b32 s22, s30, 10
    s_add_u32 s22, s22, s3
    s_mul_i32 s32, s34, 20480
    s_add_u32 s32, s32, s22
    s_mul_i32 s33, s31, 20480
    s_add_u32 s33, s33, s22
    s_mul_i32 s38, s30, 5120
    v_add_u32 v12, s38, v2
    v_add_u32 v13, 0x10000, v12
    v_add_u32 v14, 0x20000, v12
    s_mul_i32 s39, s20, 5120
    s_add_u32 s39, s39, 131072
    v_add_u32 v3, s39, v2
    s_xor_b32 s40, s20, 2
    s_mul_i32 s40, s40, 5120
    s_add_u32 s40, s40, 131072
    v_add_u32 v4, s40, v2
    s_add_u32 s37, s35, 4096
    s_lshl_b32 s43, s34, 10
    s_lshl_b32 s44, s27, 3
    s_add_u32 s43, s43, s44
    s_add_u32 s43, s43, s3
    s_add_u32 s43, s43, 327680
    s_lshr_b32 s45, s34, 1
    s_lshl_b32 s46, s27, 1
    s_add_u32 s46, s46, s30
    v_lshlrev_b32 v1, 6, v234
    v_and_b32 v236, 1, v235
    v_mul_u32_u24 v5, 1016, v236
    v_add_u32 v5, v5, v7
    v_lshlrev_b32 v6, 8, v235
    v_lshl_add_u32 v6, v234, 3, v6
    v_lshlrev_b32 v96, 16, v240
    v_and_b32 v97, 0xffff0000, v240
    v_lshlrev_b32 v98, 16, v241
    v_and_b32 v99, 0xffff0000, v241
    v_lshlrev_b32 v100, 16, v242
    v_and_b32 v101, 0xffff0000, v242
    v_lshlrev_b32 v102, 16, v243
    v_and_b32 v103, 0xffff0000, v243
    v_lshlrev_b32 v104, 16, v244
    v_and_b32 v105, 0xffff0000, v244
    v_lshlrev_b32 v106, 16, v245
    v_and_b32 v107, 0xffff0000, v245
    v_lshlrev_b32 v108, 16, v246
    v_and_b32 v109, 0xffff0000, v246
    v_lshlrev_b32 v110, 16, v247
    v_and_b32 v111, 0xffff0000, v247
    v_lshlrev_b32 v112, 16, v248
    v_and_b32 v113, 0xffff0000, v248
    v_lshlrev_b32 v114, 16, v249
    v_and_b32 v115, 0xffff0000, v249
    v_mov_b32 v8, 162820
    s_cmp_lg_u32 s20, 0
    s_cbranch_scc1 L_spin_53
    s_mul_i32 s22, s21, 1024
    s_add_u32 s22, s22, s52
    s_mov_b32 s23, 200000
    v_lshlrev_b32 v9, 8, v0
    s_mov_b64 exec, 15
L_poll_55:
    buffer_load_dword v10, v9, s[4:7], s22 offen sc1
    s_sub_u32 s23, s23, 1
    s_cbranch_scc1 L_polled_56
    s_waitcnt vmcnt(0)
    v_cmp_gt_u32 vcc, 8, v10
    s_cbranch_vccnz L_poll_55
L_polled_56:
    v_mov_b32 v9, 1
    ds_write_b32 v8, v9
    s_branch L_go_54
L_spin_53:
    s_mov_b64 exec, 1
    s_mov_b32 s23, 8000000
L_sp_57:
    ds_read_b32 v9, v8
    s_sub_u32 s23, s23, 1
    s_cbranch_scc1 L_go_54
    s_waitcnt lgkmcnt(0)
    v_cmp_gt_u32 vcc, 1, v9
    s_cbranch_vccnz L_sp_57
L_go_54:
    s_waitcnt lgkmcnt(0)
    s_mov_b64 exec, -1
    s_setprio 3
    s_add_u32 s24, s32, 0
    buffer_load_dwordx4 v[128:131], v2, s[4:7], s24 offen offset:0 sc1
    s_add_u32 s25, s33, 0
    buffer_load_dwordx4 v[132:135], v2, s[4:7], s25 offen offset:0 sc1
    s_setprio 2
    buffer_load_dwordx4 v[136:139], v2, s[4:7], s24 offen offset:2048 sc1
    buffer_load_dwordx4 v[140:143], v2, s[4:7], s25 offen offset:2048 sc1
    s_setprio 1
    s_add_u32 s24, s32, 4096
    buffer_load_dwordx4 v[144:147], v2, s[4:7], s24 offen offset:0 sc1
    s_add_u32 s25, s33, 4096
    buffer_load_dwordx4 v[148:151], v2, s[4:7], s25 offen offset:0 sc1
    buffer_load_dwordx4 v[152:155], v2, s[4:7], s24 offen offset:2048 sc1
    buffer_load_dwordx4 v[156:159], v2, s[4:7], s25 offen offset:2048 sc1
    s_setprio 0
    s_add_u32 s24, s32, 8192
    buffer_load_dwordx4 v[160:163], v2, s[4:7], s24 offen offset:0 sc1
    s_add_u32 s25, s33, 8192
    buffer_load_dwordx4 v[164:167], v2, s[4:7], s25 offen offset:0 sc1
    buffer_load_dwordx4 v[168:171], v2, s[4:7], s24 offen offset:2048 sc1
    buffer_load_dwordx4 v[172:175], v2, s[4:7], s25 offen offset:2048 sc1
    s_setprio 0
    ds_read_b128 v[56:59], v12 offset:0
    ds_read_b128 v[60:63], v12 offset:1024
    ds_read_b128 v[64:67], v12 offset:2048
    ds_read_b128 v[68:71], v12 offset:3072
    ds_read_b128 v[72:75], v12 offset:4096
    v_mov_b32 v8, 0
    v_mov_b32 v9, 0
    v_mov_b32 v11, 0x3f803f80
    s_waitcnt vmcnt(11) lgkmcnt(4)
    v_mfma_f32_16x16x32_bf16 v[16:19], v[56:59], v[128:131], v[96:99]
    s_waitcnt vmcnt(10)
    v_mfma_f32_16x16x32_bf16 v[36:39], v[56:59], v[132:135], 0
    ds_read_b128 v[76:79], v12 offset:10240
    s_waitcnt lgkmcnt(4)
    v_mfma_f32_16x16x32_bf16 v[20:23], v[60:63], v[128:131], v[100:103]
    v_mfma_f32_16x16x32_bf16 v[40:43], v[60:63], v[132:135], 0
    ds_read_b128 v[80:83], v12 offset:11264
    s_add_u32 s24, s32, 12288
    buffer_load_dwordx4 v[176:179], v2, s[4:7], s24 offen offset:0 sc1
    s_waitcnt lgkmcnt(4)
    v_mfma_f32_16x16x32_bf16 v[24:27], v[64:67], v[128:131], v[104:107]
    v_mfma_f32_16x16x32_bf16 v[44:47], v[64:67], v[132:135], 0
    ds_read_b128 v[84:87], v12 offset:12288
    s_waitcnt lgkmcnt(4)
    v_mfma_f32_16x16x32_bf16 v[28:31], v[68:71], v[128:131], v[108:111]
    v_mfma_f32_16x16x32_bf16 v[48:51], v[68:71], v[132:135], 0
    ds_read_b128 v[88:91], v12 offset:13312
    s_add_u32 s25, s33, 12288
    buffer_load_dwordx4 v[180:183], v2, s[4:7], s25 offen offset:0 sc1
    s_waitcnt lgkmcnt(4)
    v_mfma_f32_16x16x32_bf16 v[32:35], v[72:75], v[128:131], v[112:115]
    v_mfma_f32_16x16x32_bf16 v[52:55], v[72:75], v[132:135], 0
    ds_read_b128 v[92:95], v12 offset:14336
    s_waitcnt vmcnt(11) lgkmcnt(4)
    v_mfma_f32_16x16x32_bf16 v[16:19], v[76:79], v[136:139], v[16:19]
    s_waitcnt vmcnt(10)
    v_mfma_f32_16x16x32_bf16 v[36:39], v[76:79], v[140:143], v[36:39]
    ds_read_b128 v[56:59], v12 offset:20480
    s_waitcnt lgkmcnt(4)
    v_mfma_f32_16x16x32_bf16 v[20:23], v[80:83], v[136:139], v[20:23]
    v_mfma_f32_16x16x32_bf16 v[40:43], v[80:83], v[140:143], v[40:43]
    ds_read_b128 v[60:63], v12 offset:21504
    buffer_load_dwordx4 v[184:187], v2, s[4:7], s24 offen offset:2048 sc1
    s_waitcnt lgkmcnt(4)
    v_mfma_f32_16x16x32_bf16 v[24:27], v[84:87], v[136:139], v[24:27]
    v_mfma_f32_16x16x32_bf16 v[44:47], v[84:87], v[140:143], v[44:47]
    ds_read_b128 v[64:67], v12 offset:22528
    s_waitcnt lgkmcnt(4)
    v_mfma_f32_16x16x32_bf16 v[28:31], v[88:91], v[136:139], v[28:31]
    v_mfma_f32_16x16x32_bf16 v[48:51], v[88:91], v[140:143], v[48:51]
    ds_read_b128 v[68:71], v12 offset:23552
    buffer_load_dwordx4 v[188:191], v2, s[4:7], s25 offen offset:2048 sc1
    s_waitcnt lgkmcnt(4)
    v_mfma_f32_16x16x32_bf16 v[32:35], v[92:95], v[136:139], v[32:35]
    v_mfma_f32_16x16x32_bf16 v[52:55], v[92:95], v[140:143], v[52:55]
    ds_read_b128 v[72:75], v12 offset:24576
    s_waitcnt vmcnt(11) lgkmcnt(4)
    v_mfma_f32_16x16x32_bf16 v[16:19], v[56:59], v[144:147], v[16:19]
    s_waitcnt vmcnt(10)
    v_mfma_f32_16x16x32_bf16 v[36:39], v[56:59], v[148:151], v[36:39]
    ds_read_b128 v[76:79], v12 offset:30720
    s_waitcnt lgkmcnt(4)
    v_mfma_f32_16x16x32_bf16 v[20:23], v[60:63], v[144:147], v[20:23]
    v_mfma_f32_16x16x32_bf16 v[40:43], v[60:63], v[148:151], v[40:43]
    ds_read_b128 v[80:83], v12 offset:31744
    s_add_u32 s24, s32, 16384
    buffer_load_dwordx2 v[192:193], v6, s[4:7], s24 offen offset:0 sc1
    buffer_load_dwordx2 v[194:195], v6, s[4:7], s24 offen offset:128 sc1
    s_waitcnt lgkmcnt(4)
    v_mfma_f32_16x16x32_bf16 v[24:27], v[64:67], v[144:147], v[24:27]
    v_mfma_f32_16x16x32_bf16 v[44:47], v[64:67], v[148:151], v[44:47]
    ds_read_b128 v[84:87], v12 offset:32768
    s_waitcnt lgkmcnt(4)
    v_mfma_f32_16x16x32_bf16 v[28:31], v[68:71], v[144:147], v[28:31]
    v_mfma_f32_16x16x32_bf16 v[48:51], v[68:71], v[148:151], v[48:51]
    ds_read_b128 v[88:91], v12 offset:33792
    s_add_u32 s25, s33, 16384
    buffer_load_dwordx2 v[196:197], v6, s[4:7], s25 offen offset:0 sc1
    buffer_load_dwordx2 v[198:199], v6, s[4:7], s25 offen offset:128 sc1
    s_waitcnt lgkmcnt(4)
    v_mfma_f32_16x16x32_bf16 v[32:35], v[72:75], v[144:147], v[32:35]
    v_mfma_f32_16x16x32_bf16 v[52:55], v[72:75], v[148:151], v[52:55]
    ds_read_b128 v[92:95], v12 offset:34816
    s_waitcnt vmcnt(13) lgkmcnt(4)
    v_mfma_f32_16x16x32_bf16 v[16:19], v[76:79], v[152:155], v[16:19]
    s_waitcnt vmcnt(12)
    v_mfma_f32_16x16x32_bf16 v[36:39], v[76:79], v[156:159], v[36:39]
    ds_read_b128 v[56:59], v12 offset:40960
    s_waitcnt lgkmcnt(4)
    v_mfma_f32_16x16x32_bf16 v[20:23], v[80:83], v[152:155], v[20:23]
    v_mfma_f32_16x16x32_bf16 v[40:43], v[80:83], v[156:159], v[40:43]
    ds_read_b128 v[60:63], v12 offset:41984
    buffer_load_dwordx2 v[200:201], v6, s[4:7], s24 offen offset:2048 sc1
    buffer_load_dwordx2 v[202:203], v6, s[4:7], s24 offen offset:2176 sc1
    s_waitcnt lgkmcnt(4)
    v_mfma_f32_16x16x32_bf16 v[24:27], v[84:87], v[152:155], v[24:27]
    v_mfma_f32_16x16x32_bf16 v[44:47], v[84:87], v[156:159], v[44:47]
    ds_read_b128 v[64:67], v12 offset:43008
    s_waitcnt lgkmcnt(4)
    v_mfma_f32_16x16x32_bf16 v[28:31], v[88:91], v[152:155], v[28:31]
    v_mfma_f32_16x16x32_bf16 v[48:51], v[88:91], v[156:159], v[48:51]
    ds_read_b128 v[68:71], v12 offset:44032
    buffer_load_dwordx2 v[204:205], v6, s[4:7], s25 offen offset:2048 sc1
    buffer_load_dwordx2 v[206:207], v6, s[4:7], s25 offen offset:2176 sc1
    s_waitcnt lgkmcnt(4)
    v_mfma_f32_16x16x32_bf16 v[32:35], v[92:95], v[152:155], v[32:35]
    v_mfma_f32_16x16x32_bf16 v[52:55], v[92:95], v[156:159], v[52:55]
    ds_read_b128 v[72:75], v12 offset:45056
    s_waitcnt vmcnt(15) lgkmcnt(4)
    v_mfma_f32_16x16x32_bf16 v[16:19], v[56:59], v[160:163], v[16:19]
    s_waitcnt vmcnt(14)
    v_mfma_f32_16x16x32_bf16 v[36:39], v[56:59], v[164:167], v[36:39]
    ds_read_b128 v[76:79], v12 offset:51200
    s_waitcnt lgkmcnt(4)
    v_mfma_f32_16x16x32_bf16 v[20:23], v[60:63], v[160:163], v[20:23]
    v_mfma_f32_16x16x32_bf16 v[40:43], v[60:63], v[164:167], v[40:43]
    ds_read_b128 v[80:83], v12 offset:52224
    s_waitcnt lgkmcnt(4)
    v_mfma_f32_16x16x32_bf16 v[24:27], v[64:67], v[160:163], v[24:27]
    v_mfma_f32_16x16x32_bf16 v[44:47], v[64:67], v[164:167], v[44:47]
    ds_read_b128 v[84:87], v12 offset:53248
    s_waitcnt lgkmcnt(4)
    v_mfma_f32_16x16x32_bf16 v[28:31], v[68:71], v[160:163], v[28:31]
    v_mfma_f32_16x16x32_bf16 v[48:51], v[68:71], v[164:167], v[48:51]
    ds_read_b128 v[88:91], v12 offset:54272
    s_waitcnt lgkmcnt(4)
    v_mfma_f32_16x16x32_bf16 v[32:35], v[72:75], v[160:163], v[32:35]
    v_mfma_f32_16x16x32_bf16 v[52:55], v[72:75], v[164:167], v[52:55]
    ds_read_b128 v[92:95], v12 offset:55296
    s_waitcnt vmcnt(13) lgkmcnt(4)
    v_mfma_f32_16x16x32_bf16 v[16:19], v[76:79], v[168:171], v[16:19]
    s_waitcnt vmcnt(12)
    v_mfma_f32_16x16x32_bf16 v[36:39], v[76:79], v[172:175], v[36:39]
    ds_read_b128 v[56:59], v12 offset:61440
    s_waitcnt lgkmcnt(4)
    v_mfma_f32_16x16x32_bf16 v[20:23], v[80:83], v[168:171], v[20:23]
    v_mfma_f32_16x16x32_bf16 v[40:43], v[80:83], v[172:175], v[40:43]
    ds_read_b128 v[60:63], v12 offset:62464
    s_waitcnt lgkmcnt(4)
    v_mfma_f32_16x16x32_bf16 v[24:27], v[84:87], v[168:171], v[24:27]
    v_mfma_f32_16x16x32_bf16 v[44:47], v[84:87], v[172:175], v[44:47]
    ds_read_b128 v[64:67], v12 offset:63488
    s_waitcnt lgkmcnt(4)
    v_mfma_f32_16x16x32_bf16 v[28:31], v[88:91], v[168:171], v[28:31]
    v_mfma_f32_16x16x32_bf16 v[48:51], v[88:91], v[172:175], v[48:51]
    ds_read_b128 v[68:71], v12 offset:64512
    s_waitcnt lgkmcnt(4)
    v_mfma_f32_16x16x32_bf16 v[32:35], v[92:95], v[168:171], v[32:35]
    v_mfma_f32_16x16x32_bf16 v[52:55], v[92:95], v[172:175], v[52:55]
    ds_read_b128 v[72:75], v13 offset:0
    s_waitcnt vmcnt(11) lgkmcnt(4)
    v_mfma_f32_16x16x32_bf16 v[16:19], v[56:59], v[176:179], v[16:19]
    s_waitcnt vmcnt(10)
    v_mfma_f32_16x16x32_bf16 v[36:39], v[56:59], v[180:183], v[36:39]
    ds_read_b128 v[76:79], v13 offset:6144
    s_waitcnt lgkmcnt(4)
    v_mfma_f32_16x16x32_bf16 v[20:23], v[60:63], v[176:179], v[20:23]
    v_mfma_f32_16x16x32_bf16 v[40:43], v[60:63], v[180:183], v[40:43]
    ds_read_b128 v[80:83], v13 offset:7168
    s_waitcnt lgkmcnt(4)
    v_mfma_f32_16x16x32_bf16 v[24:27], v[64:67], v[176:179], v[24:27]
    v_mfma_f32_16x16x32_bf16 v[44:47], v[64:67], v[180:183], v[44:47]
    ds_read_b128 v[84:87], v13 offset:8192
    s_waitcnt lgkmcnt(4)
    v_mfma_f32_16x16x32_bf16 v[28:31], v[68:71], v[176:179], v[28:31]
    v_mfma_f32_16x16x32_bf16 v[48:51], v[68:71], v[180:183], v[48:51]
    ds_read_b128 v[88:91], v13 offset:9216
    s_waitcnt lgkmcnt(4)
    v_mfma_f32_16x16x32_bf16 v[32:35], v[72:75], v[176:179], v[32:35]
    v_mfma_f32_16x16x32_bf16 v[52:55], v[72:75], v[180:183], v[52:55]
    ds_read_b128 v[92:95], v13 offset:10240
    s_waitcnt vmcnt(9) lgkmcnt(4)
    v_mfma_f32_16x16x32_bf16 v[16:19], v[76:79], v[184:187], v[16:19]
    s_waitcnt vmcnt(8)
    v_mfma_f32_16x16x32_bf16 v[36:39], v[76:79], v[188:191], v[36:39]
    ds_read_b128 v[56:59], v13 offset:16384
    s_waitcnt lgkmcnt(4)
    v_mfma_f32_16x16x32_bf16 v[20:23], v[80:83], v[184:187], v[20:23]
    v_mfma_f32_16x16x32_bf16 v[40:43], v[80:83], v[188:191], v[40:43]
    ds_read_b128 v[60:63], v13 offset:17408
    s_waitcnt lgkmcnt(4)
    v_mfma_f32_16x16x32_bf16 v[24:27], v[84:87], v[184:187], v[24:27]
    v_mfma_f32_16x16x32_bf16 v[44:47], v[84:87], v[188:191], v[44:47]
    ds_read_b128 v[64:67], v13 offset:18432
    s_waitcnt lgkmcnt(4)
    v_mfma_f32_16x16x32_bf16 v[28:31], v[88:91], v[184:187], v[28:31]
    v_mfma_f32_16x16x32_bf16 v[48:51], v[88:91], v[188:191], v[48:51]
    ds_read_b128 v[68:71], v13 offset:19456
    s_waitcnt lgkmcnt(4)
    v_mfma_f32_16x16x32_bf16 v[32:35], v[92:95], v[184:187], v[32:35]
    v_mfma_f32_16x16x32_bf16 v[52:55], v[92:95], v[188:191], v[52:55]
    ds_read_b128 v[72:75], v13 offset:20480
    s_waitcnt vmcnt(6) lgkmcnt(4)
    v_mfma_f32_16x16x32_bf16 v[16:19], v[56:59], v[192:195], v[16:19]
    s_waitcnt vmcnt(4)
    v_mfma_f32_16x16x32_bf16 v[36:39], v[56:59], v[196:199], v[36:39]
    ds_read_b128 v[76:79], v13 offset:26624
    s_waitcnt lgkmcnt(4)
    v_mfma_f32_16x16x32_bf16 v[20:23], v[60:63], v[192:195], v[20:23]
    v_mfma_f32_16x16x32_bf16 v[40:43], v[60:63], v[196:199], v[40:43]
    ds_read_b128 v[80:83], v13 offset:27648
    s_waitcnt lgkmcnt(4)
    v_mfma_f32_16x16x32_bf16 v[24:27], v[64:67], v[192:195], v[24:27]
    v_mfma_f32_16x16x32_bf16 v[44:47], v[64:67], v[196:199], v[44:47]
    ds_read_b128 v[84:87], v13 offset:28672
    s_waitcnt lgkmcnt(4)
    v_mfma_f32_16x16x32_bf16 v[28:31], v[68:71], v[192:195], v[28:31]
    v_mfma_f32_16x16x32_bf16 v[48:51], v[68:71], v[196:199], v[48:51]
    ds_read_b128 v[88:91], v13 offset:29696
    s_waitcnt lgkmcnt(4)
    v_mfma_f32_16x16x32_bf16 v[32:35], v[72:75], v[192:195], v[32:35]
    v_mfma_f32_16x16x32_bf16 v[52:55], v[72:75], v[196:199], v[52:55]
    ds_read_b128 v[92:95], v13 offset:30720
    s_waitcnt vmcnt(0) lgkmcnt(4)
    v_mfma_f32_16x16x32_bf16 v[36:39], v[76:79], v[204:207], v[36:39]
    s_waitcnt lgkmcnt(3)
    v_mfma_f32_16x16x32_bf16 v[40:43], v[80:83], v[204:207], v[40:43]
    s_waitcnt lgkmcnt(2)
    v_mfma_f32_16x16x32_bf16 v[44:47], v[84:87], v[204:207], v[44:47]
    s_waitcnt lgkmcnt(1)
    v_mfma_f32_16x16x32_bf16 v[48:51], v[88:91], v[204:207], v[48:51]
    s_waitcnt lgkmcnt(0)
    v_mfma_f32_16x16x32_bf16 v[52:55], v[92:95], v[204:207], v[52:55]
    s_waitcnt vmcnt(2)
    v_mfma_f32_16x16x32_bf16 v[16:19], v[76:79], v[200:203], v[16:19]
    v_mfma_f32_16x16x32_bf16 v[20:23], v[80:83], v[200:203], v[20:23]
    v_mfma_f32_16x16x32_bf16 v[24:27], v[84:87], v[200:203], v[24:27]
    v_mfma_f32_16x16x32_bf16 v[28:31], v[88:91], v[200:203], v[28:31]
    v_mfma_f32_16x16x32_bf16 v[32:35], v[92:95], v[200:203], v[32:35]
    ds_write_b128 v3, v[36:39] offset:0
    ds_write_b128 v3, v[40:43] offset:1024
    ds_write_b128 v3, v[44:47] offset:2048
    ds_write_b128 v3, v[48:51] offset:3072
    ds_write_b128 v3, v[52:55] offset:4096
    s_waitcnt lgkmcnt(0)
    s_barrier
    ds_read_b128 v[56:59], v4 offset:0
    ds_read_b128 v[60:63], v4 offset:1024
    ds_read_b128 v[64:67], v4 offset:2048
    ds_read_b128 v[68:71], v4 offset:3072
    ds_read_b128 v[72:75], v4 offset:4096
    s_waitcnt lgkmcnt(4)
    v_pk_add_f32 v[16:17], v[16:17], v[56:57]
    v_pk_add_f32 v[18:19], v[18:19], v[58:59]
    v_cvt_pk_bf16_f32 v112, v16, v17
    v_cvt_pk_bf16_f32 v113, v18, v19
    s_waitcnt lgkmcnt(3)
    v_pk_add_f32 v[20:21], v[20:21], v[60:61]
    v_pk_add_f32 v[22:23], v[22:23], v[62:63]
    v_cvt_pk_bf16_f32 v114, v20, v21
    v_cvt_pk_bf16_f32 v115, v22, v23
    v_pk_mov_b32 v[76:77], v[112:113], v[112:113] op_sel:[0,1]
    v_pk_mov_b32 v[78:79], v[114:115], v[114:115] op_sel:[0,1]
    s_nop 1
    v_permlane16_swap_b32 v76, v78
    v_permlane16_swap_b32 v77, v79
    buffer_store_dwordx4 v[76:79], v5, s[12:15], s35 offen offset:0
    s_waitcnt lgkmcnt(2)
    v_pk_add_f32 v[24:25], v[24:25], v[64:65]
    v_pk_add_f32 v[26:27], v[26:27], v[66:67]
    v_cvt_pk_bf16_f32 v116, v24, v25
    v_cvt_pk_bf16_f32 v117, v26, v27
    s_waitcnt lgkmcnt(1)
    v_pk_add_f32 v[28:29], v[28:29], v[68:69]
    v_pk_add_f32 v[30:31], v[30:31], v[70:71]
    v_cvt_pk_bf16_f32 v118, v28, v29
    v_cvt_pk_bf16_f32 v119, v30, v31
    v_pk_mov_b32 v[80:81], v[116:117], v[116:117] op_sel:[0,1]
    v_pk_mov_b32 v[82:83], v[118:119], v[118:119] op_sel:[0,1]
    s_nop 1
    v_permlane16_swap_b32 v80, v82
    v_permlane16_swap_b32 v81, v83
    buffer_store_dwordx4 v[80:83], v5, s[12:15], s35 offen offset:2048
    s_waitcnt lgkmcnt(0)
    v_pk_add_f32 v[32:33], v[32:33], v[72:73]
    v_pk_add_f32 v[34:35], v[34:35], v[74:75]
    v_cvt_pk_bf16_f32 v120, v32, v33
    v_cvt_pk_bf16_f32 v121, v34, v35
    buffer_store_dwordx2 v[120:121], v7, s[12:15], s37 offen
    v_dot2_f32_bf16 v8, v112, v11, v8
    v_dot2_f32_bf16 v9, v112, v112, v9
    v_dot2_f32_bf16 v8, v113, v11, v8
    v_dot2_f32_bf16 v9, v113, v113, v9
    v_dot2_f32_bf16 v8, v114, v11, v8
    v_dot2_f32_bf16 v9, v114, v114, v9
    v_dot2_f32_bf16 v8, v115, v11, v8
    v_dot2_f32_bf16 v9, v115, v115, v9
    v_dot2_f32_bf16 v8, v116, v11, v8
    v_dot2_f32_bf16 v9, v116, v116, v9
    v_dot2_f32_bf16 v8, v117, v11, v8
    v_dot2_f32_bf16 v9, v117, v117, v9
    v_dot2_f32_bf16 v8, v118, v11, v8
    v_dot2_f32_bf16 v9, v118, v118, v9
    v_dot2_f32_bf16 v8, v119, v11, v8
    v_dot2_f32_bf16 v9, v119, v119, v9
    v_dot2_f32_bf16 v8, v120, v11, v8
    v_dot2_f32_bf16 v9, v120, v120, v9
    v_dot2_f32_bf16 v8, v121, v11, v8
    v_dot2_f32_bf16 v9, v121, v121, v9
    s_nop 1
    v_mov_b32 v10, v8
    v_mov_b32 v11, v9
    s_nop 0
    v_permlane16_swap_b32 v8, v10
    v_permlane16_swap_b32 v9, v11
    v_pk_add_f32 v[8:9], v[8:9], v[10:11]
    v_pk_mov_b32 v[10:11], v[8:9], v[8:9] op_sel:[0,1]
    s_nop 1
    v_permlane32_swap_b32 v8, v10
    v_permlane32_swap_b32 v9, v11
    v_pk_add_f32 v[8:9], v[8:9], v[10:11]
    s_mov_b64 exec, 0xffff
    buffer_store_dwordx2 v[8:9], v1, s[4:7], s43 offen
    s_mov_b64 exec, -1
    s_mul_i32 s32, s20, 3072
    s_add_u32 m0, s32, 0
    s_nop 0
    ds_write_addtid_b32 v208 offset:0
    ds_write_addtid_b32 v209 offset:256
    ds_write_addtid_b32 v210 offset:512
    ds_write_addtid_b32 v211 offset:768
    ds_write_addtid_b32 v212 offset:1024
    ds_write_addtid_b32 v213 offset:1280
    ds_write_addtid_b32 v214 offset:1536
    ds_write_addtid_b32 v215 offset:1792
    ds_write_addtid_b32 v216 offset:2048
    ds_write_addtid_b32 v217 offset:2304
    ds_write_addtid_b32 v218 offset:2560
    ds_write_addtid_b32 v219 offset:2816
    ds_write_addtid_b32 v220 offset:12288
    ds_write_addtid_b32 v221 offset:12544
    ds_write_addtid_b32 v222 offset:12800
    ds_write_addtid_b32 v223 offset:13056
    ds_write_addtid_b32 v224 offset:13312
    ds_write_addtid_b32 v225 offset:13568
    ds_write_addtid_b32 v226 offset:13824
    ds_write_addtid_b32 v227 offset:14080
    ds_write_addtid_b32 v228 offset:14336
    ds_write_addtid_b32 v229 offset:14592
    ds_write_addtid_b32 v230 offset:14848
    ds_write_addtid_b32 v231 offset:15104
    s_lshl_b32 s100, s21, 3
    s_add_u32 s100, s100, s45
    s_lshl_b32 s100, s100, 6
    s_add_u32 s100, s100, s52
    s_add_u32 s100, s100, 12288
    s_lshl_b32 s23, s46, 2
    s_add_u32 s100, s100, s23
    s_lshl_b32 s29, s53, 2
    s_add_u32 s29, s29, s20
    v_lshlrev_b32 v2, 4, v0
    v_and_b32 v5, 31, v0
    v_lshrrev_b32 v6, 5, v0
    s_and_b32 s28, s29, 7
    s_mul_i32 s30, s29, 40960
    v_add_u32 v3, 0x10000, v2
    v_add_u32 v4, 0x20000, v2
    v_lshlrev_b32 v7, 6, v5
    v_lshl_add_u32 v7, v6, 5, v7
    s_lshl_b32 s31, s28, 11
    s_add_u32 s31, s31, s3
    s_add_u32 s31, s31, 327680
    s_and_b32 s27, s51, 15
    v_lshlrev_b32 v16, 4, v6
    v_add_u32 v16, 161792, v16
    v_lshrrev_b32 v62, 4, v0
    v_lshlrev_b32 v62, 3, v62
    s_and_b32 s33, s51, 7
    s_mul_i32 s33, s33, 160
    v_lshrrev_b32 v17, 4, v5
    v_mul_u32_u24 v17, 49152, v17
    v_and_b32 v18, 15, v5
    v_lshl_add_u32 v17, v18, 4, v17
    v_lshl_add_u32 v17, v6, 8, v17
    s_mul_i32 s34, s20, 98304
    s_mul_i32 s35, s27, 3072
    s_add_u32 s34, s34, s35
    s_mul_i32 s35, s53, 491520
    s_add_u32 s34, s34, s35
    s_add_u32 s34, s34, 10321920
    s_mov_b32 s36, 0xc0135761
    s_mov_b32 s37, 0xc0135761
    v_mov_b32 v18, 0xbdd2d3e8
    v_mov_b32 v8, 0
    v_mov_b32 v9, 1
    s_cmp_eq_u32 s54, 0
    s_mov_b64 exec, 1
    s_waitcnt vmcnt(0)
    s_cbranch_scc1 L_sigimp_59
    buffer_store_dword v9, v8, s[4:7], s100 offen
L_sigback_60:
    s_mov_b64 exec, -1
    s_lshl_b32 s22, s21, 3
    s_add_u32 s22, s22, s28
    s_lshl_b32 s22, s22, 6
    s_add_u32 s22, s22, s52
    s_add_u32 s22, s22, 12288
    s_mov_b32 s23, 200000
    v_lshlrev_b32 v9, 2, v0
    s_cmp_eq_u32 s54, 0
    s_cbranch_scc1 L_pollimp_63
    s_mov_b64 exec, 0xffff
L_poll_61:
    buffer_load_dword v10, v9, s[4:7], s22 offen sc1
    s_sub_u32 s23, s23, 1
    s_cbranch_scc1 L_polled_62
    s_waitcnt vmcnt(0)
    v_cmp_ne_u32 vcc, 1, v10
    s_cbranch_vccnz L_poll_61
L_polled_62:
    s_waitcnt lgkmcnt(0)
    s_mov_b64 exec, -1
    s_setprio 3
    s_add_u32 s25, s30, 0
    buffer_load_dwordx4 v[160:163], v2, s[12:15], s25 offen offset:0 sc1
    buffer_load_dwordx4 v[164:167], v2, s[12:15], s25 offen offset:1024 sc1
    s_setprio 2
    buffer_load_dwordx4 v[168:171], v2, s[12:15], s25 offen offset:2048 sc1
    buffer_load_dwordx4 v[172:175], v2, s[12:15], s25 offen offset:3072 sc1
    s_setprio 1
    s_add_u32 s25, s30, 4096
    buffer_load_dwordx4 v[176:179], v2, s[12:15], s25 offen offset:0 sc1
    buffer_load_dwordx4 v[180:183], v2, s[12:15], s25 offen offset:1024 sc1
    buffer_load_dwordx4 v[184:187], v2, s[12:15], s25 offen offset:2048 sc1
    s_setprio 0
    buffer_load_dwordx4 v[188:191], v2, s[12:15], s25 offen offset:3072 sc1
    s_setprio 0
    buffer_load_dwordx4 v[8:11], v7, s[4:7], s31 offen sc1
    buffer_load_dwordx4 v[12:15], v7, s[4:7], s31 offen offset:16 sc1
    s_barrier
    ds_read_b128 v[128:131], v2 offset:0
    ds_read_b128 v[132:135], v2 offset:1024
    ds_read_b128 v[136:139], v2 offset:2048
    s_waitcnt vmcnt(9) lgkmcnt(2)
    v_mfma_f32_32x32x16_bf16 v[64:79], v[128:131], v[160:163], 0
    ds_read_b128 v[140:143], v2 offset:3072
    s_waitcnt lgkmcnt(2)
    v_mfma_f32_32x32x16_bf16 v[80:95], v[132:135], v[160:163], 0
    ds_read_b128 v[144:147], v2 offset:4096
    s_waitcnt lgkmcnt(2)
    v_mfma_f32_32x32x16_bf16 v[96:111], v[136:139], v[160:163], 0
    ds_read_b128 v[148:151], v2 offset:5120
    s_add_u32 s25, s30, 8192
    buffer_load_dwordx4 v[192:195], v2, s[12:15], s25 offen offset:0 sc1
    s_waitcnt vmcnt(9) lgkmcnt(2)
    v_mfma_f32_32x32x16_bf16 v[64:79], v[140:143], v[164:167], v[64:79]
    ds_read_b128 v[128:131], v2 offset:6144
    ds_read_b128 v[216:219], v16 offset:384
    s_waitcnt lgkmcnt(3)
    v_mfma_f32_32x32x16_bf16 v[80:95], v[144:147], v[164:167], v[80:95]
    ds_read_b128 v[132:135], v2 offset:7168
    ds_read_b128 v[220:223], v16 offset:416
    s_waitcnt lgkmcnt(4)
    v_mfma_f32_32x32x16_bf16 v[96:111], v[148:151], v[164:167], v[96:111]
    ds_read_b128 v[136:139], v2 offset:8192
    buffer_load_dwordx4 v[196:199], v2, s[12:15], s25 offen offset:1024 sc1
    ds_read_b128 v[224:227], v16 offset:448
    s_waitcnt vmcnt(9) lgkmcnt(5)
    v_mfma_f32_32x32x16_bf16 v[64:79], v[128:131], v[168:171], v[64:79]
    ds_read_b128 v[140:143], v2 offset:9216
    ds_read_b128 v[228:231], v16 offset:480
    s_waitcnt lgkmcnt(5)
    v_mfma_f32_32x32x16_bf16 v[80:95], v[132:135], v[168:171], v[80:95]
    ds_read_b128 v[144:147], v2 offset:10240
    ds_read_b128 v[232:235], v16 offset:512
    s_waitcnt lgkmcnt(5)
    v_mfma_f32_32x32x16_bf16 v[96:111], v[136:139], v[168:171], v[96:111]
    ds_read_b128 v[148:151], v2 offset:11264
    buffer_load_dwordx4 v[200:203], v2, s[12:15], s25 offen offset:2048 sc1
    ds_read_b128 v[236:239], v16 offset:544
    s_waitcnt vmcnt(9) lgkmcnt(5)
    v_mfma_f32_32x32x16_bf16 v[64:79], v[140:143], v[172:175], v[64:79]
    ds_read_b128 v[128:131], v2 offset:12288
    ds_read_b128 v[240:243], v16 offset:576
    s_waitcnt lgkmcnt(5)
    v_mfma_f32_32x32x16_bf16 v[80:95], v[144:147], v[172:175], v[80:95]
    ds_read_b128 v[132:135], v2 offset:13312
    ds_read_b128 v[244:247], v16 offset:608
    s_waitcnt lgkmcnt(5)
    v_mfma_f32_32x32x16_bf16 v[96:111], v[148:151], v[172:175], v[96:111]
    ds_read_b128 v[136:139], v2 offset:14336
    buffer_load_dwordx4 v[204:207], v2, s[12:15], s25 offen offset:3072 sc1
    ds_read_b128 v[248:251], v16 offset:640
    s_waitcnt vmcnt(9) lgkmcnt(5)
    v_mfma_f32_32x32x16_bf16 v[64:79], v[128:131], v[176:179], v[64:79]
    ds_read_b128 v[140:143], v2 offset:15360
    ds_read_b128 v[252:255], v16 offset:672
    s_waitcnt lgkmcnt(5)
    v_mfma_f32_32x32x16_bf16 v[80:95], v[132:135], v[176:179], v[80:95]
    ds_read_b128 v[144:147], v2 offset:16384
    ds_read_b128 v[152:155], v16 offset:704
    s_waitcnt lgkmcnt(5)
    v_mfma_f32_32x32x16_bf16 v[96:111], v[136:139], v[176:179], v[96:111]
    ds_read_b128 v[148:151], v2 offset:17408
    s_add_u32 s25, s30, 12288
    buffer_load_dwordx4 v[208:211], v2, s[12:15], s25 offen offset:0 sc1
    ds_read_b128 v[156:159], v16 offset:736
    s_waitcnt vmcnt(9) lgkmcnt(5)
    v_mfma_f32_32x32x16_bf16 v[64:79], v[140:143], v[180:183], v[64:79]
    ds_read_b128 v[128:131], v2 offset:18432
    ds_read_b128 v[20:23], v16 offset:0
    s_waitcnt lgkmcnt(5)
    v_mfma_f32_32x32x16_bf16 v[80:95], v[144:147], v[180:183], v[80:95]
    ds_read_b128 v[132:135], v2 offset:19456
    ds_read_b128 v[24:27], v16 offset:32
    s_waitcnt lgkmcnt(5)
    v_mfma_f32_32x32x16_bf16 v[96:111], v[148:151], v[180:183], v[96:111]
    ds_read_b128 v[136:139], v2 offset:20480
    buffer_load_dwordx4 v[212:215], v2, s[12:15], s25 offen offset:1024 sc1
    ds_read_b128 v[28:31], v16 offset:64
    s_waitcnt vmcnt(9) lgkmcnt(5)
    v_mfma_f32_32x32x16_bf16 v[64:79], v[128:131], v[184:187], v[64:79]
    ds_read_b128 v[140:143], v2 offset:21504
    ds_read_b128 v[32:35], v16 offset:96
    s_waitcnt lgkmcnt(5)
    v_mfma_f32_32x32x16_bf16 v[80:95], v[132:135], v[184:187], v[80:95]
    ds_read_b128 v[144:147], v2 offset:22528
    ds_read_b128 v[36:39], v16 offset:128
    s_waitcnt lgkmcnt(5)
    v_mfma_f32_32x32x16_bf16 v[96:111], v[136:139], v[184:187], v[96:111]
    ds_read_b128 v[148:151], v2 offset:23552
    buffer_load_dwordx4 v[160:163], v2, s[12:15], s25 offen offset:2048 sc1
    ds_read_b128 v[40:43], v16 offset:160
    s_waitcnt vmcnt(9) lgkmcnt(5)
    v_mfma_f32_32x32x16_bf16 v[64:79], v[140:143], v[188:191], v[64:79]
    ds_read_b128 v[128:131], v2 offset:24576
    s_waitcnt lgkmcnt(4)
    v_mfma_f32_32x32x16_bf16 v[80:95], v[144:147], v[188:191], v[80:95]
    ds_read_b128 v[132:135], v2 offset:25600
    s_waitcnt lgkmcnt(3)
    v_mfma_f32_32x32x16_bf16 v[96:111], v[148:151], v[188:191], v[96:111]
    ds_read_b128 v[136:139], v2 offset:26624
    buffer_load_dwordx4 v[164:167], v2, s[12:15], s25 offen offset:3072 sc1
    s_waitcnt vmcnt(7) lgkmcnt(2)
    v_mfma_f32_32x32x16_bf16 v[64:79], v[128:131], v[192:195], v[64:79]
    ds_read_b128 v[140:143], v2 offset:27648
    v_add_f32 v8, v8, v10
    v_add_f32 v9, v9, v11
    s_waitcnt lgkmcnt(2)
    v_mfma_f32_32x32x16_bf16 v[80:95], v[132:135], v[192:195], v[80:95]
    ds_read_b128 v[144:147], v2 offset:28672
    v_add_f32 v12, v12, v14
    v_add_f32 v13, v13, v15
    s_waitcnt lgkmcnt(2)
    v_mfma_f32_32x32x16_bf16 v[96:111], v[136:139], v[192:195], v[96:111]
    ds_read_b128 v[148:151], v2 offset:29696
    s_add_u32 s25, s30, 16384
    buffer_load_dwordx4 v[168:171], v2, s[12:15], s25 offen offset:0 sc1
    v_add_f32 v8, v8, v12
    v_add_f32 v9, v9, v13
    s_waitcnt vmcnt(7) lgkmcnt(2)
    v_mfma_f32_32x32x16_bf16 v[64:79], v[140:143], v[196:199], v[64:79]
    ds_read_b128 v[128:131], v2 offset:30720
    v_mov_b32 v10, v8
    s_nop 1
    s_waitcnt lgkmcnt(2)
    v_mfma_f32_32x32x16_bf16 v[80:95], v[144:147], v[196:199], v[80:95]
    ds_read_b128 v[132:135], v2 offset:31744
    v_permlane32_swap_b32 v8, v10
    v_add_f32 v8, v8, v10
    s_waitcnt lgkmcnt(2)
    v_mfma_f32_32x32x16_bf16 v[96:111], v[148:151], v[196:199], v[96:111]
    ds_read_b128 v[136:139], v2 offset:32768
    buffer_load_dwordx4 v[172:175], v2, s[12:15], s25 offen offset:1024 sc1
    v_mov_b32 v11, v9
    s_nop 1
    s_waitcnt vmcnt(7) lgkmcnt(2)
    v_mfma_f32_32x32x16_bf16 v[64:79], v[128:131], v[200:203], v[64:79]
    ds_read_b128 v[140:143], v2 offset:33792
    v_permlane32_swap_b32 v9, v11
    v_add_f32 v9, v9, v11
    s_waitcnt lgkmcnt(2)
    v_mfma_f32_32x32x16_bf16 v[80:95], v[132:135], v[200:203], v[80:95]
    ds_read_b128 v[144:147], v2 offset:34816
    v_mul_f32 v8, 0x3acccccd, v8
    v_mul_f32 v9, 0x3acccccd, v9
    s_waitcnt lgkmcnt(2)
    v_mfma_f32_32x32x16_bf16 v[96:111], v[136:139], v[200:203], v[96:111]
    ds_read_b128 v[148:151], v2 offset:35840
    buffer_load_dwordx4 v[176:179], v2, s[12:15], s25 offen offset:2048 sc1
    v_fma_f32 v9, -v8, v8, v9
    v_max_f32 v9, 0, v9
    s_waitcnt vmcnt(7) lgkmcnt(2)
    v_mfma_f32_32x32x16_bf16 v[64:79], v[140:143], v[204:207], v[64:79]
    s_barrier
    ds_read_b128 v[128:131], v2 offset:36864
    v_add_f32 v10, 0x3727c5ac, v9
    v_rsq_f32 v10, v10
    s_waitcnt lgkmcnt(2)
    v_mfma_f32_32x32x16_bf16 v[80:95], v[144:147], v[204:207], v[80:95]
    ds_read_b128 v[132:135], v2 offset:37888
    s_nop 0
    v_mul_f32 v11, v10, v10
    s_waitcnt lgkmcnt(2)
    v_mfma_f32_32x32x16_bf16 v[96:111], v[148:151], v[204:207], v[96:111]
    ds_read_b128 v[136:139], v2 offset:38912
    buffer_load_dwordx4 v[180:183], v2, s[12:15], s25 offen offset:3072 sc1
    v_mul_f32 v11, v11, v9
    v_add_f32 v11, 0x3727c5ac, v11
    s_waitcnt vmcnt(7) lgkmcnt(2)
    v_mfma_f32_32x32x16_bf16 v[64:79], v[128:131], v[208:211], v[64:79]
    ds_read_b128 v[140:143], v2 offset:39936
    v_rsq_f32 v11, v11
    s_nop 0
    s_waitcnt lgkmcnt(2)
    v_mfma_f32_32x32x16_bf16 v[80:95], v[132:135], v[208:211], v[80:95]
    ds_read_b128 v[144:147], v2 offset:40960
    v_mul_f32 v9, v10, v11
    v_mul_f32 v8, v8, v9
    s_waitcnt lgkmcnt(2)
    v_mfma_f32_32x32x16_bf16 v[96:111], v[136:139], v[208:211], v[96:111]
    ds_read_b128 v[148:151], v2 offset:41984
    s_add_u32 s25, s30, 20480
    buffer_load_dwordx4 v[184:187], v2, s[12:15], s25 offen offset:0 sc1
    v_mov_b32 v10, v9
    v_fma_f32 v216, -v8, v20, v216
    s_waitcnt vmcnt(7) lgkmcnt(2)
    v_mfma_f32_32x32x16_bf16 v[64:79], v[140:143], v[212:215], v[64:79]
    ds_read_b128 v[128:131], v2 offset:43008
    v_fma_f32 v217, -v8, v21, v217
    v_fma_f32 v218, -v8, v22, v218
    s_waitcnt lgkmcnt(2)
    v_mfma_f32_32x32x16_bf16 v[80:95], v[144:147], v[212:215], v[80:95]
    ds_read_b128 v[132:135], v2 offset:44032
    v_fma_f32 v219, -v8, v23, v219
    ds_read_b128 v[20:23], v16 offset:192
    s_waitcnt lgkmcnt(3)
    v_mfma_f32_32x32x16_bf16 v[96:111], v[148:151], v[212:215], v[96:111]
    ds_read_b128 v[136:139], v2 offset:45056
    buffer_load_dwordx4 v[188:191], v2, s[12:15], s25 offen offset:1024 sc1
    v_fma_f32 v220, -v8, v24, v220
    v_fma_f32 v221, -v8, v25, v221
    s_waitcnt vmcnt(7) lgkmcnt(3)
    v_mfma_f32_32x32x16_bf16 v[64:79], v[128:131], v[160:163], v[64:79]
    ds_read_b128 v[140:143], v2 offset:46080
    v_fma_f32 v222, -v8, v26, v222
    v_fma_f32 v223, -v8, v27, v223
    s_waitcnt lgkmcnt(3)
    v_mfma_f32_32x32x16_bf16 v[80:95], v[132:135], v[160:163], v[80:95]
    ds_read_b128 v[144:147], v2 offset:47104
    ds_read_b128 v[24:27], v16 offset:224
    v_fma_f32 v224, -v8, v28, v224
    s_waitcnt lgkmcnt(3)
    v_mfma_f32_32x32x16_bf16 v[96:111], v[136:139], v[160:163], v[96:111]
    ds_read_b128 v[148:151], v2 offset:48128
    buffer_load_dwordx4 v[192:195], v2, s[12:15], s25 offen offset:2048 sc1
    v_fma_f32 v225, -v8, v29, v225
    v_fma_f32 v226, -v8, v30, v226
    s_waitcnt vmcnt(7) lgkmcnt(3)
    v_mfma_f32_32x32x16_bf16 v[64:79], v[140:143], v[164:167], v[64:79]
    ds_read_b128 v[128:131], v2 offset:49152
    v_fma_f32 v227, -v8, v31, v227
    ds_read_b128 v[28:31], v16 offset:256
    s_waitcnt lgkmcnt(4)
    v_mfma_f32_32x32x16_bf16 v[80:95], v[144:147], v[164:167], v[80:95]
    ds_read_b128 v[132:135], v2 offset:50176
    v_fma_f32 v228, -v8, v32, v228
    v_fma_f32 v229, -v8, v33, v229
    s_waitcnt lgkmcnt(3)
    v_mfma_f32_32x32x16_bf16 v[96:111], v[148:151], v[164:167], v[96:111]
    ds_read_b128 v[136:139], v2 offset:51200
    buffer_load_dwordx4 v[196:199], v2, s[12:15], s25 offen offset:3072 sc1
    v_fma_f32 v230, -v8, v34, v230
    v_fma_f32 v231, -v8, v35, v231
    s_waitcnt vmcnt(7) lgkmcnt(3)
    v_mfma_f32_32x32x16_bf16 v[64:79], v[128:131], v[168:171], v[64:79]
    ds_read_b128 v[140:143], v2 offset:52224
    ds_read_b128 v[32:35], v16 offset:288
    v_fma_f32 v232, -v8, v36, v232
    s_waitcnt lgkmcnt(3)
    v_mfma_f32_32x32x16_bf16 v[80:95], v[132:135], v[168:171], v[80:95]
    ds_read_b128 v[144:147], v2 offset:53248
    v_fma_f32 v233, -v8, v37, v233
    v_fma_f32 v234, -v8, v38, v234
    s_waitcnt lgkmcnt(3)
    v_mfma_f32_32x32x16_bf16 v[96:111], v[136:139], v[168:171], v[96:111]
    ds_read_b128 v[148:151], v2 offset:54272
    s_add_u32 s25, s30, 24576
    buffer_load_dwordx4 v[200:203], v2, s[12:15], s25 offen offset:0 sc1
    v_fma_f32 v235, -v8, v39, v235
    ds_read_b128 v[36:39], v16 offset:320
    s_waitcnt vmcnt(7) lgkmcnt(4)
    v_mfma_f32_32x32x16_bf16 v[64:79], v[140:143], v[172:175], v[64:79]
    ds_read_b128 v[128:131], v2 offset:55296
    v_fma_f32 v236, -v8, v40, v236
    v_fma_f32 v237, -v8, v41, v237
    s_waitcnt lgkmcnt(3)
    v_mfma_f32_32x32x16_bf16 v[80:95], v[144:147], v[172:175], v[80:95]
    ds_read_b128 v[132:135], v2 offset:56320
    v_fma_f32 v238, -v8, v42, v238
    v_fma_f32 v239, -v8, v43, v239
    s_waitcnt lgkmcnt(3)
    v_mfma_f32_32x32x16_bf16 v[96:111], v[148:151], v[172:175], v[96:111]
    ds_read_b128 v[136:139], v2 offset:57344
    buffer_load_dwordx4 v[204:207], v2, s[12:15], s25 offen offset:1024 sc1
    ds_read_b128 v[40:43], v16 offset:352
    v_fma_f32 v240, -v8, v20, v240
    s_waitcnt vmcnt(7) lgkmcnt(3)
    v_mfma_f32_32x32x16_bf16 v[64:79], v[128:131], v[176:179], v[64:79]
    ds_read_b128 v[140:143], v2 offset:58368
    v_fma_f32 v241, -v8, v21, v241
    v_fma_f32 v242, -v8, v22, v242
    s_waitcnt lgkmcnt(3)
    v_mfma_f32_32x32x16_bf16 v[80:95], v[132:135], v[176:179], v[80:95]
    ds_read_b128 v[144:147], v2 offset:59392
    v_fma_f32 v243, -v8, v23, v243
    v_fma_f32 v244, -v8, v24, v244
    s_waitcnt lgkmcnt(3)
    v_mfma_f32_32x32x16_bf16 v[96:111], v[136:139], v[176:179], v[96:111]
    ds_read_b128 v[148:151], v2 offset:60416
    buffer_load_dwordx4 v[208:211], v2, s[12:15], s25 offen offset:2048 sc1
    v_fma_f32 v245, -v8, v25, v245
    v_fma_f32 v246, -v8, v26, v246
    s_waitcnt vmcnt(7) lgkmcnt(2)
    v_mfma_f32_32x32x16_bf16 v[64:79], v[140:143], v[180:183], v[64:79]
    ds_read_b128 v[128:131], v2 offset:61440
    v_fma_f32 v247, -v8, v27, v247
    v_fma_f32 v248, -v8, v28, v248
    s_waitcnt lgkmcnt(2)
    v_mfma_f32_32x32x16_bf16 v[80:95], v[144:147], v[180:183], v[80:95]
    ds_read_b128 v[132:135], v2 offset:62464
    v_fma_f32 v249, -v8, v29, v249
    v_fma_f32 v250, -v8, v30, v250
    s_waitcnt lgkmcnt(2)
    v_mfma_f32_32x32x16_bf16 v[96:111], v[148:151], v[180:183], v[96:111]
    ds_read_b128 v[136:139], v2 offset:63488
    buffer_load_dwordx4 v[212:215], v2, s[12:15], s25 offen offset:3072 sc1
    v_fma_f32 v251, -v8, v31, v251
    v_fma_f32 v252, -v8, v32, v252
    s_waitcnt vmcnt(7) lgkmcnt(2)
    v_mfma_f32_32x32x16_bf16 v[64:79], v[128:131], v[184:187], v[64:79]
    ds_read_b128 v[140:143], v2 offset:64512
    v_fma_f32 v253, -v8, v33, v253
    v_fma_f32 v254, -v8, v34, v254
    s_waitcnt lgkmcnt(2)
    v_mfma_f32_32x32x16_bf16 v[80:95], v[132:135], v[184:187], v[80:95]
    ds_read_b128 v[144:147], v3 offset:0
    v_fma_f32 v255, -v8, v35, v255
    v_fma_f32 v152, -v8, v36, v152
    s_waitcnt lgkmcnt(2)
    v_mfma_f32_32x32x16_bf16 v[96:111], v[136:139], v[184:187], v[96:111]
    ds_read_b128 v[148:151], v3 offset:1024
    s_add_u32 s25, s30, 28672
    buffer_load_dwordx4 v[160:163], v2, s[12:15], s25 offen offset:0 sc1
    v_fma_f32 v153, -v8, v37, v153
    v_fma_f32 v154, -v8, v38, v154
    s_waitcnt vmcnt(7) lgkmcnt(2)
    v_mfma_f32_32x32x16_bf16 v[64:79], v[140:143], v[188:191], v[64:79]
    ds_read_b128 v[128:131], v3 offset:2048
    v_fma_f32 v155, -v8, v39, v155
    v_fma_f32 v156, -v8, v40, v156
    s_waitcnt lgkmcnt(2)
    v_mfma_f32_32x32x16_bf16 v[80:95], v[144:147], v[188:191], v[80:95]
    ds_read_b128 v[132:135], v3 offset:3072
    v_fma_f32 v157, -v8, v41, v157
    v_fma_f32 v158, -v8, v42, v158
    s_waitcnt lgkmcnt(2)
    v_mfma_f32_32x32x16_bf16 v[96:111], v[148:151], v[188:191], v[96:111]
    ds_read_b128 v[136:139], v3 offset:4096
    buffer_load_dwordx4 v[164:167], v2, s[12:15], s25 offen offset:1024 sc1
    v_fma_f32 v159, -v8, v43, v159
    s_waitcnt vmcnt(7) lgkmcnt(2)
    v_mfma_f32_32x32x16_bf16 v[64:79], v[128:131], v[192:195], v[64:79]
    ds_read_b128 v[140:143], v3 offset:5120
    s_waitcnt lgkmcnt(2)
    v_mfma_f32_32x32x16_bf16 v[80:95], v[132:135], v[192:195], v[80:95]
    ds_read_b128 v[144:147], v3 offset:6144
    s_waitcnt lgkmcnt(2)
    v_mfma_f32_32x32x16_bf16 v[96:111], v[136:139], v[192:195], v[96:111]
    ds_read_b128 v[148:151], v3 offset:7168
    buffer_load_dwordx4 v[168:171], v2, s[12:15], s25 offen offset:2048 sc1
    s_waitcnt vmcnt(7) lgkmcnt(2)
    v_mfma_f32_32x32x16_bf16 v[64:79], v[140:143], v[196:199], v[64:79]
    s_barrier
    ds_read_b128 v[128:131], v3 offset:8192
    s_waitcnt lgkmcnt(2)
    v_mfma_f32_32x32x16_bf16 v[80:95], v[144:147], v[196:199], v[80:95]
    ds_read_b128 v[132:135], v3 offset:9216
    s_waitcnt lgkmcnt(2)
    v_mfma_f32_32x32x16_bf16 v[96:111], v[148:151], v[196:199], v[96:111]
    ds_read_b128 v[136:139], v3 offset:10240
    buffer_load_dwordx4 v[172:175], v2, s[12:15], s25 offen offset:3072 sc1
    s_waitcnt vmcnt(7) lgkmcnt(2)
    v_mfma_f32_32x32x16_bf16 v[64:79], v[128:131], v[200:203], v[64:79]
    ds_read_b128 v[140:143], v3 offset:11264
    s_waitcnt lgkmcnt(2)
    v_mfma_f32_32x32x16_bf16 v[80:95], v[132:135], v[200:203], v[80:95]
    ds_read_b128 v[144:147], v3 offset:12288
    s_waitcnt lgkmcnt(2)
    v_mfma_f32_32x32x16_bf16 v[96:111], v[136:139], v[200:203], v[96:111]
    ds_read_b128 v[148:151], v3 offset:13312
    s_add_u32 s25, s30, 32768
    buffer_load_dwordx4 v[176:179], v2, s[12:15], s25 offen offset:0 sc1
    s_waitcnt vmcnt(7) lgkmcnt(2)
    v_mfma_f32_32x32x16_bf16 v[64:79], v[140:143], v[204:207], v[64:79]
    ds_read_b128 v[128:131], v3 offset:14336
    s_waitcnt lgkmcnt(2)
    v_mfma_f32_32x32x16_bf16 v[80:95], v[144:147], v[204:207], v[80:95]
    ds_read_b128 v[132:135], v3 offset:15360
    s_waitcnt lgkmcnt(2)
    v_mfma_f32_32x32x16_bf16 v[96:111], v[148:151], v[204:207], v[96:111]
    ds_read_b128 v[136:139], v3 offset:16384
    buffer_load_dwordx4 v[180:183], v2, s[12:15], s25 offen offset:1024 sc1
    s_waitcnt vmcnt(7) lgkmcnt(2)
    v_mfma_f32_32x32x16_bf16 v[64:79], v[128:131], v[208:211], v[64:79]
    ds_read_b128 v[140:143], v3 offset:17408
    s_waitcnt lgkmcnt(2)
    v_mfma_f32_32x32x16_bf16 v[80:95], v[132:135], v[208:211], v[80:95]
    ds_read_b128 v[144:147], v3 offset:18432
    s_waitcnt lgkmcnt(2)
    v_mfma_f32_32x32x16_bf16 v[96:111], v[136:139], v[208:211], v[96:111]
    ds_read_b128 v[148:151], v3 offset:19456
    buffer_load_dwordx4 v[184:187], v2, s[12:15], s25 offen offset:2048 sc1
    s_waitcnt vmcnt(7) lgkmcnt(2)
    v_mfma_f32_32x32x16_bf16 v[64:79], v[140:143], v[212:215], v[64:79]
    ds_read_b128 v[128:131], v3 offset:20480
    s_waitcnt lgkmcnt(2)
    v_mfma_f32_32x32x16_bf16 v[80:95], v[144:147], v[212:215], v[80:95]
    ds_read_b128 v[132:135], v3 offset:21504
    s_waitcnt lgkmcnt(2)
    v_mfma_f32_32x32x16_bf16 v[96:111], v[148:151], v[212:215], v[96:111]
    ds_read_b128 v[136:139], v3 offset:22528
    buffer_load_dwordx4 v[188:191], v2, s[12:15], s25 offen offset:3072 sc1
    s_waitcnt vmcnt(7) lgkmcnt(2)
    v_mfma_f32_32x32x16_bf16 v[64:79], v[128:131], v[160:163], v[64:79]
    ds_read_b128 v[140:143], v3 offset:23552
    s_waitcnt lgkmcnt(2)
    v_mfma_f32_32x32x16_bf16 v[80:95], v[132:135], v[160:163], v[80:95]
    ds_read_b128 v[144:147], v3 offset:24576
    s_waitcnt lgkmcnt(2)
    v_mfma_f32_32x32x16_bf16 v[96:111], v[136:139], v[160:163], v[96:111]
    ds_read_b128 v[148:151], v3 offset:25600
    s_add_u32 s25, s30, 36864
    buffer_load_dwordx4 v[192:195], v2, s[12:15], s25 offen offset:0 sc1
    s_waitcnt vmcnt(7) lgkmcnt(2)
    v_mfma_f32_32x32x16_bf16 v[64:79], v[140:143], v[164:167], v[64:79]
    ds_read_b128 v[128:131], v3 offset:26624
    s_waitcnt lgkmcnt(2)
    v_mfma_f32_32x32x16_bf16 v[80:95], v[144:147], v[164:167], v[80:95]
    ds_read_b128 v[132:135], v3 offset:27648
    s_waitcnt lgkmcnt(2)
    v_mfma_f32_32x32x16_bf16 v[96:111], v[148:151], v[164:167], v[96:111]
    ds_read_b128 v[136:139], v3 offset:28672
    buffer_load_dwordx4 v[196:199], v2, s[12:15], s25 offen offset:1024 sc1
    s_waitcnt vmcnt(7) lgkmcnt(2)
    v_mfma_f32_32x32x16_bf16 v[64:79], v[128:131], v[168:171], v[64:79]
    ds_read_b128 v[140:143], v3 offset:29696
    s_waitcnt lgkmcnt(2)
    v_mfma_f32_32x32x16_bf16 v[80:95], v[132:135], v[168:171], v[80:95]
    ds_read_b128 v[144:147], v3 offset:30720
    s_waitcnt lgkmcnt(2)
    v_mfma_f32_32x32x16_bf16 v[96:111], v[136:139], v[168:171], v[96:111]
    ds_read_b128 v[148:151], v3 offset:31744
    buffer_load_dwordx4 v[200:203], v2, s[12:15], s25 offen offset:2048 sc1
    s_waitcnt vmcnt(7) lgkmcnt(2)
    v_mfma_f32_32x32x16_bf16 v[64:79], v[140:143], v[172:175], v[64:79]
    ds_read_b128 v[128:131], v3 offset:32768
    s_waitcnt lgkmcnt(2)
    v_mfma_f32_32x32x16_bf16 v[80:95], v[144:147], v[172:175], v[80:95]
    ds_read_b128 v[132:135], v3 offset:33792
    s_waitcnt lgkmcnt(2)
    v_mfma_f32_32x32x16_bf16 v[96:111], v[148:151], v[172:175], v[96:111]
    ds_read_b128 v[136:139], v3 offset:34816
    buffer_load_dwordx4 v[204:207], v2, s[12:15], s25 offen offset:3072 sc1
    s_waitcnt vmcnt(7) lgkmcnt(2)
    v_mfma_f32_32x32x16_bf16 v[64:79], v[128:131], v[176:179], v[64:79]
    ds_read_b128 v[140:143], v3 offset:35840
    s_waitcnt lgkmcnt(2)
    v_mfma_f32_32x32x16_bf16 v[80:95], v[132:135], v[176:179], v[80:95]
    ds_read_b128 v[144:147], v3 offset:36864
    s_waitcnt lgkmcnt(2)
    v_mfma_f32_32x32x16_bf16 v[96:111], v[136:139], v[176:179], v[96:111]
    ds_read_b128 v[148:151], v3 offset:37888
    s_waitcnt vmcnt(6) lgkmcnt(2)
    v_mfma_f32_32x32x16_bf16 v[64:79], v[140:143], v[180:183], v[64:79]
    ds_read_b128 v[128:131], v3 offset:38912
    s_waitcnt lgkmcnt(2)
    v_mfma_f32_32x32x16_bf16 v[80:95], v[144:147], v[180:183], v[80:95]
    ds_read_b128 v[132:135], v3 offset:39936
    s_waitcnt lgkmcnt(2)
    v_mfma_f32_32x32x16_bf16 v[96:111], v[148:151], v[180:183], v[96:111]
    ds_read_b128 v[136:139], v3 offset:40960
    s_waitcnt vmcnt(5) lgkmcnt(2)
    v_mfma_f32_32x32x16_bf16 v[64:79], v[128:131], v[184:187], v[64:79]
    ds_read_b128 v[140:143], v3 offset:41984
    s_waitcnt lgkmcnt(2)
    v_mfma_f32_32x32x16_bf16 v[80:95], v[132:135], v[184:187], v[80:95]
    ds_read_b128 v[144:147], v3 offset:43008
    s_waitcnt lgkmcnt(2)
    v_mfma_f32_32x32x16_bf16 v[96:111], v[136:139], v[184:187], v[96:111]
    ds_read_b128 v[148:151], v3 offset:44032
    s_waitcnt vmcnt(4) lgkmcnt(2)
    v_mfma_f32_32x32x16_bf16 v[64:79], v[140:143], v[188:191], v[64:79]
    ds_read_b128 v[128:131], v3 offset:45056
    s_waitcnt lgkmcnt(2)
    v_mfma_f32_32x32x16_bf16 v[80:95], v[144:147], v[188:191], v[80:95]
    ds_read_b128 v[132:135], v3 offset:46080
    s_waitcnt lgkmcnt(2)
    v_mfma_f32_32x32x16_bf16 v[96:111], v[148:151], v[188:191], v[96:111]
    ds_read_b128 v[136:139], v3 offset:47104
    s_waitcnt vmcnt(3) lgkmcnt(2)
    v_mfma_f32_32x32x16_bf16 v[64:79], v[128:131], v[192:195], v[64:79]
    ds_read_b128 v[140:143], v3 offset:48128
    s_waitcnt lgkmcnt(2)
    v_mfma_f32_32x32x16_bf16 v[80:95], v[132:135], v[192:195], v[80:95]
    ds_read_b128 v[144:147], v3 offset:49152
    s_waitcnt lgkmcnt(2)
    v_mfma_f32_32x32x16_bf16 v[96:111], v[136:139], v[192:195], v[96:111]
    ds_read_b128 v[148:151], v3 offset:50176
    s_waitcnt vmcnt(2) lgkmcnt(2)
    v_mfma_f32_32x32x16_bf16 v[64:79], v[140:143], v[196:199], v[64:79]
    ds_read_b128 v[128:131], v3 offset:51200
    s_waitcnt lgkmcnt(2)
    v_mfma_f32_32x32x16_bf16 v[80:95], v[144:147], v[196:199], v[80:95]
    ds_read_b128 v[132:135], v3 offset:52224
    s_waitcnt lgkmcnt(2)
    v_mfma_f32_32x32x16_bf16 v[96:111], v[148:151], v[196:199], v[96:111]
    ds_read_b128 v[136:139], v3 offset:53248
    s_waitcnt vmcnt(1) lgkmcnt(2)
    v_mfma_f32_32x32x16_bf16 v[64:79], v[128:131], v[200:203], v[64:79]
    ds_read_b128 v[140:143], v3 offset:54272
    s_waitcnt lgkmcnt(2)
    v_mfma_f32_32x32x16_bf16 v[80:95], v[132:135], v[200:203], v[80:95]
    ds_read_b128 v[144:147], v3 offset:55296
    s_waitcnt lgkmcnt(2)
    v_mfma_f32_32x32x16_bf16 v[96:111], v[136:139], v[200:203], v[96:111]
    ds_read_b128 v[148:151], v3 offset:56320
    s_waitcnt vmcnt(0) lgkmcnt(2)
    v_mfma_f32_32x32x16_bf16 v[64:79], v[140:143], v[204:207], v[64:79]
    buffer_load_dwordx2 v[52:53], v62, s[16:19], s33 offen offset:0
    buffer_load_dwordx2 v[54:55], v62, s[16:19], s33 offen offset:32
    buffer_load_dwordx2 v[56:57], v62, s[16:19], s33 offen offset:64
    buffer_load_dwordx2 v[58:59], v62, s[16:19], s33 offen offset:96
    buffer_load_dwordx2 v[60:61], v62, s[16:19], s33 offen offset:128
    s_waitcnt lgkmcnt(1)
    v_mfma_f32_32x32x16_bf16 v[80:95], v[144:147], v[204:207], v[80:95]
    s_waitcnt lgkmcnt(0)
    v_mfma_f32_32x32x16_bf16 v[96:111], v[148:151], v[204:207], v[96:111]
    s_barrier
    s_nop 7
    v_pk_fma_f32 v[64:65], v[64:65], v[10:11], v[216:217] op_sel_hi:[1,0,1]
    v_pk_fma_f32 v[66:67], v[66:67], v[10:11], v[218:219] op_sel_hi:[1,0,1]
    v_pk_fma_f32 v[68:69], v[68:69], v[10:11], v[220:221] op_sel_hi:[1,0,1]
    v_pk_fma_f32 v[70:71], v[70:71], v[10:11], v[222:223] op_sel_hi:[1,0,1]
    v_pk_mul_f32 v[20:21], v[64:65], v[64:65]
    v_pk_mul_f32 v[22:23], v[66:67], v[66:67]
    v_pk_mul_f32 v[24:25], v[68:69], v[68:69]
    v_pk_mul_f32 v[26:27], v[70:71], v[70:71]
    v_pk_fma_f32 v[20:21], v[20:21], v[18:19], s[36:37] op_sel_hi:[1,0,1]
    v_pk_fma_f32 v[22:23], v[22:23], v[18:19], s[36:37] op_sel_hi:[1,0,1]
    v_pk_fma_f32 v[24:25], v[24:25], v[18:19], s[36:37] op_sel_hi:[1,0,1]
    v_pk_fma_f32 v[26:27], v[26:27], v[18:19], s[36:37] op_sel_hi:[1,0,1]
    v_pk_mul_f32 v[20:21], v[20:21], v[64:65]
    v_pk_mul_f32 v[22:23], v[22:23], v[66:67]
    v_pk_mul_f32 v[24:25], v[24:25], v[68:69]
    v_pk_mul_f32 v[26:27], v[26:27], v[70:71]
    v_exp_f32 v20, v20
    v_exp_f32 v21, v21
    v_exp_f32 v22, v22
    v_exp_f32 v23, v23
    v_exp_f32 v24, v24
    v_exp_f32 v25, v25
    v_exp_f32 v26, v26
    v_exp_f32 v27, v27
    v_pk_add_f32 v[20:21], v[20:21], 1.0 op_sel_hi:[1,0]
    v_pk_add_f32 v[22:23], v[22:23], 1.0 op_sel_hi:[1,0]
    v_pk_add_f32 v[24:25], v[24:25], 1.0 op_sel_hi:[1,0]
    v_pk_add_f32 v[26:27], v[26:27], 1.0 op_sel_hi:[1,0]
    v_rcp_f32 v20, v20
    v_rcp_f32 v21, v21
    v_rcp_f32 v22, v22
    v_rcp_f32 v23, v23
    v_rcp_f32 v24, v24
    v_rcp_f32 v25, v25
    v_rcp_f32 v26, v26
    v_rcp_f32 v27, v27
    v_pk_mul_f32 v[64:65], v[64:65], v[20:21]
    v_pk_mul_f32 v[66:67], v[66:67], v[22:23]
    v_pk_mul_f32 v[68:69], v[68:69], v[24:25]
    v_pk_mul_f32 v[70:71], v[70:71], v[26:27]
    v_cvt_pk_bf16_f32 v64, v64, v65
    v_cvt_pk_bf16_f32 v65, v66, v67
    v_cvt_pk_bf16_f32 v66, v68, v69
    v_cvt_pk_bf16_f32 v67, v70, v71
    buffer_store_dwordx4 v[64:67], v17, s[4:7], s34 offen offset:0 sc1
    v_pk_fma_f32 v[72:73], v[72:73], v[10:11], v[224:225] op_sel_hi:[1,0,1]
    v_pk_fma_f32 v[74:75], v[74:75], v[10:11], v[226:227] op_sel_hi:[1,0,1]
    v_pk_fma_f32 v[76:77], v[76:77], v[10:11], v[228:229] op_sel_hi:[1,0,1]
    v_pk_fma_f32 v[78:79], v[78:79], v[10:11], v[230:231] op_sel_hi:[1,0,1]
    v_pk_mul_f32 v[28:29], v[72:73], v[72:73]
    v_pk_mul_f32 v[30:31], v[74:75], v[74:75]
    v_pk_mul_f32 v[32:33], v[76:77], v[76:77]
    v_pk_mul_f32 v[34:35], v[78:79], v[78:79]
    v_pk_fma_f32 v[28:29], v[28:29], v[18:19], s[36:37] op_sel_hi:[1,0,1]
    v_pk_fma_f32 v[30:31], v[30:31], v[18:19], s[36:37] op_sel_hi:[1,0,1]
    v_pk_fma_f32 v[32:33], v[32:33], v[18:19], s[36:37] op_sel_hi:[1,0,1]
    v_pk_fma_f32 v[34:35], v[34:35], v[18:19], s[36:37] op_sel_hi:[1,0,1]
    v_pk_mul_f32 v[28:29], v[28:29], v[72:73]
    v_pk_mul_f32 v[30:31], v[30:31], v[74:75]
    v_pk_mul_f32 v[32:33], v[32:33], v[76:77]
    v_pk_mul_f32 v[34:35], v[34:35], v[78:79]
    v_exp_f32 v28, v28
    v_exp_f32 v29, v29
    v_exp_f32 v30, v30
    v_exp_f32 v31, v31
    v_exp_f32 v32, v32
    v_exp_f32 v33, v33
    v_exp_f32 v34, v34
    v_exp_f32 v35, v35
    v_pk_add_f32 v[28:29], v[28:29], 1.0 op_sel_hi:[1,0]
    v_pk_add_f32 v[30:31], v[30:31], 1.0 op_sel_hi:[1,0]
    v_pk_add_f32 v[32:33], v[32:33], 1.0 op_sel_hi:[1,0]
    v_pk_add_f32 v[34:35], v[34:35], 1.0 op_sel_hi:[1,0]
    v_rcp_f32 v28, v28
    v_rcp_f32 v29, v29
    v_rcp_f32 v30, v30
    v_rcp_f32 v31, v31
    v_rcp_f32 v32, v32
    v_rcp_f32 v33, v33
    v_rcp_f32 v34, v34
    v_rcp_f32 v35, v35
    v_pk_mul_f32 v[72:73], v[72:73], v[28:29]
    v_pk_mul_f32 v[74:75], v[74:75], v[30:31]
    v_pk_mul_f32 v[76:77], v[76:77], v[32:33]
    v_pk_mul_f32 v[78:79], v[78:79], v[34:35]
    v_cvt_pk_bf16_f32 v72, v72, v73
    v_cvt_pk_bf16_f32 v73, v74, v75
    v_cvt_pk_bf16_f32 v74, v76, v77
    v_cvt_pk_bf16_f32 v75, v78, v79
    buffer_store_dwordx4 v[72:75], v17, s[4:7], s34 offen offset:512 sc1
    v_pk_fma_f32 v[80:81], v[80:81], v[10:11], v[232:233] op_sel_hi:[1,0,1]
    v_pk_fma_f32 v[82:83], v[82:83], v[10:11], v[234:235] op_sel_hi:[1,0,1]
    v_pk_fma_f32 v[84:85], v[84:85], v[10:11], v[236:237] op_sel_hi:[1,0,1]
    v_pk_fma_f32 v[86:87], v[86:87], v[10:11], v[238:239] op_sel_hi:[1,0,1]
    v_pk_mul_f32 v[36:37], v[80:81], v[80:81]
    v_pk_mul_f32 v[38:39], v[82:83], v[82:83]
    v_pk_mul_f32 v[40:41], v[84:85], v[84:85]
    v_pk_mul_f32 v[42:43], v[86:87], v[86:87]
    v_pk_fma_f32 v[36:37], v[36:37], v[18:19], s[36:37] op_sel_hi:[1,0,1]
    v_pk_fma_f32 v[38:39], v[38:39], v[18:19], s[36:37] op_sel_hi:[1,0,1]
    v_pk_fma_f32 v[40:41], v[40:41], v[18:19], s[36:37] op_sel_hi:[1,0,1]
    v_pk_fma_f32 v[42:43], v[42:43], v[18:19], s[36:37] op_sel_hi:[1,0,1]
    v_pk_mul_f32 v[36:37], v[36:37], v[80:81]
    v_pk_mul_f32 v[38:39], v[38:39], v[82:83]
    v_pk_mul_f32 v[40:41], v[40:41], v[84:85]
    v_pk_mul_f32 v[42:43], v[42:43], v[86:87]
    v_exp_f32 v36, v36
    v_exp_f32 v37, v37
    v_exp_f32 v38, v38
    v_exp_f32 v39, v39
    v_exp_f32 v40, v40
    v_exp_f32 v41, v41
    v_exp_f32 v42, v42
    v_exp_f32 v43, v43
    v_pk_add_f32 v[36:37], v[36:37], 1.0 op_sel_hi:[1,0]
    v_pk_add_f32 v[38:39], v[38:39], 1.0 op_sel_hi:[1,0]
    v_pk_add_f32 v[40:41], v[40:41], 1.0 op_sel_hi:[1,0]
    v_pk_add_f32 v[42:43], v[42:43], 1.0 op_sel_hi:[1,0]
    v_rcp_f32 v36, v36
    v_rcp_f32 v37, v37
    v_rcp_f32 v38, v38
    v_rcp_f32 v39, v39
    v_rcp_f32 v40, v40
    v_rcp_f32 v41, v41
    v_rcp_f32 v42, v42
    v_rcp_f32 v43, v43
    v_pk_mul_f32 v[80:81], v[80:81], v[36:37]
    v_pk_mul_f32 v[82:83], v[82:83], v[38:39]
    v_pk_mul_f32 v[84:85], v[84:85], v[40:41]
    v_pk_mul_f32 v[86:87], v[86:87], v[42:43]
    v_cvt_pk_bf16_f32 v80, v80, v81
    v_cvt_pk_bf16_f32 v81, v82, v83
    v_cvt_pk_bf16_f32 v82, v84, v85
    v_cvt_pk_bf16_f32 v83, v86, v87
    buffer_store_dwordx4 v[80:83], v17, s[4:7], s34 offen offset:1024 sc1
    v_pk_fma_f32 v[88:89], v[88:89], v[10:11], v[240:241] op_sel_hi:[1,0,1]
    v_pk_fma_f32 v[90:91], v[90:91], v[10:11], v[242:243] op_sel_hi:[1,0,1]
    v_pk_fma_f32 v[92:93], v[92:93], v[10:11], v[244:245] op_sel_hi:[1,0,1]
    v_pk_fma_f32 v[94:95], v[94:95], v[10:11], v[246:247] op_sel_hi:[1,0,1]
    v_pk_mul_f32 v[20:21], v[88:89], v[88:89]
    v_pk_mul_f32 v[22:23], v[90:91], v[90:91]
    v_pk_mul_f32 v[24:25], v[92:93], v[92:93]
    v_pk_mul_f32 v[26:27], v[94:95], v[94:95]
    v_pk_fma_f32 v[20:21], v[20:21], v[18:19], s[36:37] op_sel_hi:[1,0,1]
    v_pk_fma_f32 v[22:23], v[22:23], v[18:19], s[36:37] op_sel_hi:[1,0,1]
    v_pk_fma_f32 v[24:25], v[24:25], v[18:19], s[36:37] op_sel_hi:[1,0,1]
    v_pk_fma_f32 v[26:27], v[26:27], v[18:19], s[36:37] op_sel_hi:[1,0,1]
    v_pk_mul_f32 v[20:21], v[20:21], v[88:89]
    v_pk_mul_f32 v[22:23], v[22:23], v[90:91]
    v_pk_mul_f32 v[24:25], v[24:25], v[92:93]
    v_pk_mul_f32 v[26:27], v[26:27], v[94:95]
    v_exp_f32 v20, v20
    v_exp_f32 v21, v21
    v_exp_f32 v22, v22
    v_exp_f32 v23, v23
    v_exp_f32 v24, v24
    v_exp_f32 v25, v25
    v_exp_f32 v26, v26
    v_exp_f32 v27, v27
    v_pk_add_f32 v[20:21], v[20:21], 1.0 op_sel_hi:[1,0]
    v_pk_add_f32 v[22:23], v[22:23], 1.0 op_sel_hi:[1,0]
    v_pk_add_f32 v[24:25], v[24:25], 1.0 op_sel_hi:[1,0]
    v_pk_add_f32 v[26:27], v[26:27], 1.0 op_sel_hi:[1,0]
    v_rcp_f32 v20, v20
    v_rcp_f32 v21, v21
    v_rcp_f32 v22, v22
    v_rcp_f32 v23, v23
    v_rcp_f32 v24, v24
    v_rcp_f32 v25, v25
    v_rcp_f32 v26, v26
    v_rcp_f32 v27, v27
    v_pk_mul_f32 v[88:89], v[88:89], v[20:21]
    v_pk_mul_f32 v[90:91], v[90:91], v[22:23]
    v_pk_mul_f32 v[92:93], v[92:93], v[24:25]
    v_pk_mul_f32 v[94:95], v[94:95], v[26:27]
    v_cvt_pk_bf16_f32 v88, v88, v89
    v_cvt_pk_bf16_f32 v89, v90, v91
    v_cvt_pk_bf16_f32 v90, v92, v93
    v_cvt_pk_bf16_f32 v91, v94, v95
    buffer_store_dwordx4 v[88:91], v17, s[4:7], s34 offen offset:1536 sc1
    v_pk_fma_f32 v[96:97], v[96:97], v[10:11], v[248:249] op_sel_hi:[1,0,1]
    v_pk_fma_f32 v[98:99], v[98:99], v[10:11], v[250:251] op_sel_hi:[1,0,1]
    v_pk_fma_f32 v[100:101], v[100:101], v[10:11], v[252:253] op_sel_hi:[1,0,1]
    v_pk_fma_f32 v[102:103], v[102:103], v[10:11], v[254:255] op_sel_hi:[1,0,1]
    v_pk_mul_f32 v[28:29], v[96:97], v[96:97]
    v_pk_mul_f32 v[30:31], v[98:99], v[98:99]
    v_pk_mul_f32 v[32:33], v[100:101], v[100:101]
    v_pk_mul_f32 v[34:35], v[102:103], v[102:103]
    v_pk_fma_f32 v[28:29], v[28:29], v[18:19], s[36:37] op_sel_hi:[1,0,1]
    v_pk_fma_f32 v[30:31], v[30:31], v[18:19], s[36:37] op_sel_hi:[1,0,1]
    v_pk_fma_f32 v[32:33], v[32:33], v[18:19], s[36:37] op_sel_hi:[1,0,1]
    v_pk_fma_f32 v[34:35], v[34:35], v[18:19], s[36:37] op_sel_hi:[1,0,1]
    v_pk_mul_f32 v[28:29], v[28:29], v[96:97]
    v_pk_mul_f32 v[30:31], v[30:31], v[98:99]
    v_pk_mul_f32 v[32:33], v[32:33], v[100:101]
    v_pk_mul_f32 v[34:35], v[34:35], v[102:103]
    v_exp_f32 v28, v28
    v_exp_f32 v29, v29
    v_exp_f32 v30, v30
    v_exp_f32 v31, v31
    v_exp_f32 v32, v32
    v_exp_f32 v33, v33
    v_exp_f32 v34, v34
    v_exp_f32 v35, v35
    v_pk_add_f32 v[28:29], v[28:29], 1.0 op_sel_hi:[1,0]
    v_pk_add_f32 v[30:31], v[30:31], 1.0 op_sel_hi:[1,0]
    v_pk_add_f32 v[32:33], v[32:33], 1.0 op_sel_hi:[1,0]
    v_pk_add_f32 v[34:35], v[34:35], 1.0 op_sel_hi:[1,0]
    v_rcp_f32 v28, v28
    v_rcp_f32 v29, v29
    v_rcp_f32 v30, v30
    v_rcp_f32 v31, v31
    v_rcp_f32 v32, v32
    v_rcp_f32 v33, v33
    v_rcp_f32 v34, v34
    v_rcp_f32 v35, v35
    v_pk_mul_f32 v[96:97], v[96:97], v[28:29]
    v_pk_mul_f32 v[98:99], v[98:99], v[30:31]
    v_pk_mul_f32 v[100:101], v[100:101], v[32:33]
    v_pk_mul_f32 v[102:103], v[102:103], v[34:35]
    v_cvt_pk_bf16_f32 v96, v96, v97
    v_cvt_pk_bf16_f32 v97, v98, v99
    v_cvt_pk_bf16_f32 v98, v100, v101
    v_cvt_pk_bf16_f32 v99, v102, v103
    buffer_store_dwordx4 v[96:99], v17, s[4:7], s34 offen offset:2048 sc1
    v_pk_fma_f32 v[104:105], v[104:105], v[10:11], v[152:153] op_sel_hi:[1,0,1]
    v_pk_fma_f32 v[106:107], v[106:107], v[10:11], v[154:155] op_sel_hi:[1,0,1]
    v_pk_fma_f32 v[108:109], v[108:109], v[10:11], v[156:157] op_sel_hi:[1,0,1]
    v_pk_fma_f32 v[110:111], v[110:111], v[10:11], v[158:159] op_sel_hi:[1,0,1]
    v_pk_mul_f32 v[36:37], v[104:105], v[104:105]
    v_pk_mul_f32 v[38:39], v[106:107], v[106:107]
    v_pk_mul_f32 v[40:41], v[108:109], v[108:109]
    v_pk_mul_f32 v[42:43], v[110:111], v[110:111]
    v_pk_fma_f32 v[36:37], v[36:37], v[18:19], s[36:37] op_sel_hi:[1,0,1]
    v_pk_fma_f32 v[38:39], v[38:39], v[18:19], s[36:37] op_sel_hi:[1,0,1]
    v_pk_fma_f32 v[40:41], v[40:41], v[18:19], s[36:37] op_sel_hi:[1,0,1]
    v_pk_fma_f32 v[42:43], v[42:43], v[18:19], s[36:37] op_sel_hi:[1,0,1]
    v_pk_mul_f32 v[36:37], v[36:37], v[104:105]
    v_pk_mul_f32 v[38:39], v[38:39], v[106:107]
    v_pk_mul_f32 v[40:41], v[40:41], v[108:109]
    v_pk_mul_f32 v[42:43], v[42:43], v[110:111]
    v_exp_f32 v36, v36
    v_exp_f32 v37, v37
    v_exp_f32 v38, v38
    v_exp_f32 v39, v39
    v_exp_f32 v40, v40
    v_exp_f32 v41, v41
    v_exp_f32 v42, v42
    v_exp_f32 v43, v43
    v_pk_add_f32 v[36:37], v[36:37], 1.0 op_sel_hi:[1,0]
    v_pk_add_f32 v[38:39], v[38:39], 1.0 op_sel_hi:[1,0]
    v_pk_add_f32 v[40:41], v[40:41], 1.0 op_sel_hi:[1,0]
    v_pk_add_f32 v[42:43], v[42:43], 1.0 op_sel_hi:[1,0]
    v_rcp_f32 v36, v36
    v_rcp_f32 v37, v37
    v_rcp_f32 v38, v38
    v_rcp_f32 v39, v39
    v_rcp_f32 v40, v40
    v_rcp_f32 v41, v41
    v_rcp_f32 v42, v42
    v_rcp_f32 v43, v43
    v_pk_mul_f32 v[104:105], v[104:105], v[36:37]
    v_pk_mul_f32 v[106:107], v[106:107], v[38:39]
    v_pk_mul_f32 v[108:109], v[108:109], v[40:41]
    v_pk_mul_f32 v[110:111], v[110:111], v[42:43]
    v_cvt_pk_bf16_f32 v104, v104, v105
    v_cvt_pk_bf16_f32 v105, v106, v107
    v_cvt_pk_bf16_f32 v106, v108, v109
    v_cvt_pk_bf16_f32 v107, v110, v111
    buffer_store_dwordx4 v[104:107], v17, s[4:7], s34 offen offset:2560 sc1
    s_lshl_b32 s100, s21, 3
    s_add_u32 s100, s100, s28
    s_lshl_b32 s100, s100, 6
    s_add_u32 s100, s100, s52
    s_add_u32 s100, s100, 20480
    s_lshl_b32 s23, s27, 2
    s_add_u32 s100, s100, s23
    s_lshr_b32 s22, s51, 3
    s_lshl_b32 s22, s22, 2
    s_and_b32 s23, s20, 1
    s_lshl_b32 s23, s23, 1
    s_add_u32 s22, s22, s23
    s_lshr_b32 s23, s20, 1
    s_add_u32 s34, s22, s23
    s_lshr_b32 s35, s34, 1
    s_mul_i32 s35, s35, 40960
    s_and_b32 s22, s34, 1
    s_lshl_b32 s22, s22, 8
    s_add_u32 s35, s35, s22
    s_and_b32 s23, s51, 7
    s_mul_i32 s22, s23, 5120
    s_add_u32 s35, s35, s22
    s_mul_i32 s22, s21, 327680
    s_add_u32 s35, s35, s22
    s_lshl_b32 s42, s21, 4
    s_add_u32 s42, s42, s34
    s_mul_i32 s42, s42, 20480
    s_mul_i32 s22, s23, 160
    s_add_u32 s42, s42, s22
    v_and_b32 v234, 15, v0
    v_lshrrev_b32 v235, 4, v0
    v_lshrrev_b32 v236, 5, v0
    v_lshlrev_b32 v236, 9, v236
    v_lshl_add_u32 v7, v234, 4, v236
    v_and_b32 v236, 1, v235
    v_lshl_add_u32 v7, v236, 3, v7
    v_mul_u32_u24 v15, 1280, v234
    v_lshl_add_u32 v15, v235, 3, v15
    s_and_b32 s27, s51, 7
    s_lshr_b32 s30, s20, 1
    s_xor_b32 s31, s34, 1
    s_lshl_b32 s22, s30, 10
    s_mul_i32 s23, s53, 491520
    s_add_u32 s22, s22, s23
    s_and_b32 s23, s53, 1
    s_mul_i32 s23, s23, 393216
    s_add_u32 s22, s22, 10321920
    s_sub_u32 s22, s22, s23
    s_mul_i32 s32, s34, 49152
    s_add_u32 s32, s32, s22
    s_mul_i32 s33, s31, 49152
    s_add_u32 s33, s33, s22
    s_mul_i32 s38, s30, 5120
    v_add_u32 v12, s38, v2
    v_add_u32 v13, 0x10000, v12
    v_add_u32 v14, 0x20000, v12
    s_mul_i32 s39, s20, 5120
    s_add_u32 s39, s39, 102400
    v_add_u32 v3, s39, v2
    s_xor_b32 s40, s20, 2
    s_mul_i32 s40, s40, 5120
    s_add_u32 s40, s40, 102400
    v_add_u32 v4, s40, v2
    s_add_u32 s37, s35, 4096
    s_lshl_b32 s43, s34, 10
    s_lshl_b32 s44, s27, 3
    s_add_u32 s43, s43, s44
    s_add_u32 s43, s43, s3
    s_add_u32 s43, s43, 327680
    s_lshr_b32 s45, s34, 1
    s_lshl_b32 s46, s27, 1
    s_add_u32 s46, s46, s30
    v_lshlrev_b32 v1, 6, v234
    v_and_b32 v236, 1, v235
    v_mul_u32_u24 v5, 1016, v236
    v_add_u32 v5, v5, v7
    v_mul_u32_u24 v6, 24, v236
    v_add_u32 v6, v6, v15
    s_waitcnt vmcnt(6)
    v_lshlrev_b32 v232, 16, v112
    v_and_b32 v233, 0xffff0000, v112
    v_lshlrev_b32 v10, 16, v52
    v_and_b32 v11, 0xffff0000, v52
    v_pk_add_f32 v[232:233], v[232:233], v[10:11]
    v_lshlrev_b32 v234, 16, v113
    v_and_b32 v235, 0xffff0000, v113
    v_lshlrev_b32 v10, 16, v53
    v_and_b32 v11, 0xffff0000, v53
    v_pk_add_f32 v[234:235], v[234:235], v[10:11]
    v_lshlrev_b32 v236, 16, v114
    v_and_b32 v237, 0xffff0000, v114
    v_lshlrev_b32 v10, 16, v54
    v_and_b32 v11, 0xffff0000, v54
    v_pk_add_f32 v[236:237], v[236:237], v[10:11]
    v_lshlrev_b32 v238, 16, v115
    v_and_b32 v239, 0xffff0000, v115
    v_lshlrev_b32 v10, 16, v55
    v_and_b32 v11, 0xffff0000, v55
    v_pk_add_f32 v[238:239], v[238:239], v[10:11]
    v_lshlrev_b32 v240, 16, v116
    v_and_b32 v241, 0xffff0000, v116
    v_lshlrev_b32 v10, 16, v56
    v_and_b32 v11, 0xffff0000, v56
    v_pk_add_f32 v[240:241], v[240:241], v[10:11]
    v_lshlrev_b32 v242, 16, v117
    v_and_b32 v243, 0xffff0000, v117
    v_lshlrev_b32 v10, 16, v57
    v_and_b32 v11, 0xffff0000, v57
    v_pk_add_f32 v[242:243], v[242:243], v[10:11]
    v_lshlrev_b32 v244, 16, v118
    v_and_b32 v245, 0xffff0000, v118
    v_lshlrev_b32 v10, 16, v58
    v_and_b32 v11, 0xffff0000, v58
    v_pk_add_f32 v[244:245], v[244:245], v[10:11]
    v_lshlrev_b32 v246, 16, v119
    v_and_b32 v247, 0xffff0000, v119
    v_lshlrev_b32 v10, 16, v59
    v_and_b32 v11, 0xffff0000, v59
    v_pk_add_f32 v[246:247], v[246:247], v[10:11]
    v_lshlrev_b32 v248, 16, v120
    v_and_b32 v249, 0xffff0000, v120
    v_lshlrev_b32 v10, 16, v60
    v_and_b32 v11, 0xffff0000, v60
    v_pk_add_f32 v[248:249], v[248:249], v[10:11]
    v_lshlrev_b32 v250, 16, v121
    v_and_b32 v251, 0xffff0000, v121
    v_lshlrev_b32 v10, 16, v61
    v_and_b32 v11, 0xffff0000, v61
    v_pk_add_f32 v[250:251], v[250:251], v[10:11]
    v_mov_b32 v8, 0
    v_mov_b32 v9, 1
    s_cmp_eq_u32 s54, 0
    s_mov_b64 exec, 1
    s_waitcnt vmcnt(0)
    s_cbranch_scc1 L_sigimp_64
    buffer_store_dword v9, v8, s[4:7], s100 offen
L_sigback_65:
    s_mov_b64 exec, -1
    s_lshl_b32 s22, s21, 3
    s_add_u32 s22, s22, s45
    s_lshl_b32 s22, s22, 6
    s_add_u32 s22, s22, s52
    s_add_u32 s22, s22, 20480
    s_mov_b32 s23, 200000
    v_lshlrev_b32 v9, 2, v0
    s_cmp_eq_u32 s54, 0
    s_cbranch_scc1 L_pollimp_68
    s_mov_b64 exec, 0xffff
L_poll_66:
    buffer_load_dword v10, v9, s[4:7], s22 offen sc1
    s_sub_u32 s23, s23, 1
    s_cbranch_scc1 L_polled_67
    s_waitcnt vmcnt(0)
    v_cmp_ne_u32 vcc, 1, v10
    s_cbranch_vccnz L_poll_66
L_polled_67:
    s_waitcnt lgkmcnt(0)
    s_mov_b64 exec, -1
    s_setprio 3
    s_add_u32 s24, s32, 0
    buffer_load_dwordx4 v[128:131], v2, s[4:7], s24 offen offset:0 sc1
    s_add_u32 s25, s33, 0
    buffer_load_dwordx4 v[132:135], v2, s[4:7], s25 offen offset:0 sc1
    s_setprio 2
    buffer_load_dwordx4 v[136:139], v2, s[4:7], s24 offen offset:2048 sc1
    buffer_load_dwordx4 v[140:143], v2, s[4:7], s25 offen offset:2048 sc1
    s_setprio 1
    s_add_u32 s24, s32, 4096
    buffer_load_dwordx4 v[144:147], v2, s[4:7], s24 offen offset:0 sc1
    s_add_u32 s25, s33, 4096
    buffer_load_dwordx4 v[148:151], v2, s[4:7], s25 offen offset:0 sc1
    buffer_load_dwordx4 v[152:155], v2, s[4:7], s24 offen offset:2048 sc1
    buffer_load_dwordx4 v[156:159], v2, s[4:7], s25 offen offset:2048 sc1
    s_setprio 0
    s_add_u32 s24, s32, 8192
    buffer_load_dwordx4 v[160:163], v2, s[4:7], s24 offen offset:0 sc1
    s_add_u32 s25, s33, 8192
    buffer_load_dwordx4 v[164:167], v2, s[4:7], s25 offen offset:0 sc1
    buffer_load_dwordx4 v[168:171], v2, s[4:7], s24 offen offset:2048 sc1
    buffer_load_dwordx4 v[172:175], v2, s[4:7], s25 offen offset:2048 sc1
    s_setprio 0
    s_barrier
    ds_read_b128 v[56:59], v12 offset:0
    ds_read_b128 v[60:63], v12 offset:1024
    ds_read_b128 v[64:67], v12 offset:2048
    ds_read_b128 v[68:71], v12 offset:3072
    ds_read_b128 v[72:75], v12 offset:4096
    v_mov_b32 v8, 0
    v_mov_b32 v9, 0
    v_mov_b32 v11, 0x3f803f80
    s_waitcnt vmcnt(11) lgkmcnt(4)
    v_mfma_f32_16x16x32_bf16 v[16:19], v[56:59], v[128:131], v[232:235]
    s_waitcnt vmcnt(10)
    v_mfma_f32_16x16x32_bf16 v[36:39], v[56:59], v[132:135], 0
    ds_read_b128 v[76:79], v12 offset:10240
    s_waitcnt lgkmcnt(4)
    v_mfma_f32_16x16x32_bf16 v[20:23], v[60:63], v[128:131], v[236:239]
    v_mfma_f32_16x16x32_bf16 v[40:43], v[60:63], v[132:135], 0
    ds_read_b128 v[80:83], v12 offset:11264
    s_add_u32 s24, s32, 12288
    buffer_load_dwordx4 v[176:179], v2, s[4:7], s24 offen offset:0 sc1
    s_waitcnt lgkmcnt(4)
    v_mfma_f32_16x16x32_bf16 v[24:27], v[64:67], v[128:131], v[240:243]
    v_mfma_f32_16x16x32_bf16 v[44:47], v[64:67], v[132:135], 0
    ds_read_b128 v[84:87], v12 offset:12288
    s_waitcnt lgkmcnt(4)
    v_mfma_f32_16x16x32_bf16 v[28:31], v[68:71], v[128:131], v[244:247]
    v_mfma_f32_16x16x32_bf16 v[48:51], v[68:71], v[132:135], 0
    ds_read_b128 v[88:91], v12 offset:13312
    s_add_u32 s25, s33, 12288
    buffer_load_dwordx4 v[180:183], v2, s[4:7], s25 offen offset:0 sc1
    s_waitcnt lgkmcnt(4)
    v_mfma_f32_16x16x32_bf16 v[32:35], v[72:75], v[128:131], v[248:251]
    v_mfma_f32_16x16x32_bf16 v[52:55], v[72:75], v[132:135], 0
    ds_read_b128 v[92:95], v12 offset:14336
    s_waitcnt vmcnt(11) lgkmcnt(4)
    v_mfma_f32_16x16x32_bf16 v[16:19], v[76:79], v[136:139], v[16:19]
    s_waitcnt vmcnt(10)
    v_mfma_f32_16x16x32_bf16 v[36:39], v[76:79], v[140:143], v[36:39]
    ds_read_b128 v[56:59], v12 offset:20480
    s_waitcnt lgkmcnt(4)
    v_mfma_f32_16x16x32_bf16 v[20:23], v[80:83], v[136:139], v[20:23]
    v_mfma_f32_16x16x32_bf16 v[40:43], v[80:83], v[140:143], v[40:43]
    ds_read_b128 v[60:63], v12 offset:21504
    buffer_load_dwordx4 v[184:187], v2, s[4:7], s24 offen offset:2048 sc1
    s_waitcnt lgkmcnt(4)
    v_mfma_f32_16x16x32_bf16 v[24:27], v[84:87], v[136:139], v[24:27]
    v_mfma_f32_16x16x32_bf16 v[44:47], v[84:87], v[140:143], v[44:47]
    ds_read_b128 v[64:67], v12 offset:22528
    s_waitcnt lgkmcnt(4)
    v_mfma_f32_16x16x32_bf16 v[28:31], v[88:91], v[136:139], v[28:31]
    v_mfma_f32_16x16x32_bf16 v[48:51], v[88:91], v[140:143], v[48:51]
    ds_read_b128 v[68:71], v12 offset:23552
    buffer_load_dwordx4 v[188:191], v2, s[4:7], s25 offen offset:2048 sc1
    s_waitcnt lgkmcnt(4)
    v_mfma_f32_16x16x32_bf16 v[32:35], v[92:95], v[136:139], v[32:35]
    v_mfma_f32_16x16x32_bf16 v[52:55], v[92:95], v[140:143], v[52:55]
    ds_read_b128 v[72:75], v12 offset:24576
    s_waitcnt vmcnt(11) lgkmcnt(4)
    v_mfma_f32_16x16x32_bf16 v[16:19], v[56:59], v[144:147], v[16:19]
    s_waitcnt vmcnt(10)
    v_mfma_f32_16x16x32_bf16 v[36:39], v[56:59], v[148:151], v[36:39]
    ds_read_b128 v[76:79], v12 offset:30720
    s_waitcnt lgkmcnt(4)
    v_mfma_f32_16x16x32_bf16 v[20:23], v[60:63], v[144:147], v[20:23]
    v_mfma_f32_16x16x32_bf16 v[40:43], v[60:63], v[148:151], v[40:43]
    ds_read_b128 v[80:83], v12 offset:31744
    s_add_u32 s24, s32, 16384
    buffer_load_dwordx4 v[192:195], v2, s[4:7], s24 offen offset:0 sc1
    s_waitcnt lgkmcnt(4)
    v_mfma_f32_16x16x32_bf16 v[24:27], v[64:67], v[144:147], v[24:27]
    v_mfma_f32_16x16x32_bf16 v[44:47], v[64:67], v[148:151], v[44:47]
    ds_read_b128 v[84:87], v12 offset:32768
    s_waitcnt lgkmcnt(4)
    v_mfma_f32_16x16x32_bf16 v[28:31], v[68:71], v[144:147], v[28:31]
    v_mfma_f32_16x16x32_bf16 v[48:51], v[68:71], v[148:151], v[48:51]
    ds_read_b128 v[88:91], v12 offset:33792
    s_add_u32 s25, s33, 16384
    buffer_load_dwordx4 v[196:199], v2, s[4:7], s25 offen offset:0 sc1
    s_waitcnt lgkmcnt(4)
    v_mfma_f32_16x16x32_bf16 v[32:35], v[72:75], v[144:147], v[32:35]
    v_mfma_f32_16x16x32_bf16 v[52:55], v[72:75], v[148:151], v[52:55]
    ds_read_b128 v[92:95], v12 offset:34816
    s_waitcnt vmcnt(11) lgkmcnt(4)
    v_mfma_f32_16x16x32_bf16 v[16:19], v[76:79], v[152:155], v[16:19]
    s_waitcnt vmcnt(10)
    v_mfma_f32_16x16x32_bf16 v[36:39], v[76:79], v[156:159], v[36:39]
    s_barrier
    ds_read_b128 v[56:59], v12 offset:40960
    s_waitcnt lgkmcnt(4)
    v_mfma_f32_16x16x32_bf16 v[20:23], v[80:83], v[152:155], v[20:23]
    v_mfma_f32_16x16x32_bf16 v[40:43], v[80:83], v[156:159], v[40:43]
    ds_read_b128 v[60:63], v12 offset:41984
    buffer_load_dwordx4 v[200:203], v2, s[4:7], s24 offen offset:2048 sc1
    s_waitcnt lgkmcnt(4)
    v_mfma_f32_16x16x32_bf16 v[24:27], v[84:87], v[152:155], v[24:27]
    v_mfma_f32_16x16x32_bf16 v[44:47], v[84:87], v[156:159], v[44:47]
    ds_read_b128 v[64:67], v12 offset:43008
    s_waitcnt lgkmcnt(4)
    v_mfma_f32_16x16x32_bf16 v[28:31], v[88:91], v[152:155], v[28:31]
    v_mfma_f32_16x16x32_bf16 v[48:51], v[88:91], v[156:159], v[48:51]
    ds_read_b128 v[68:71], v12 offset:44032
    buffer_load_dwordx4 v[204:207], v2, s[4:7], s25 offen offset:2048 sc1
    s_waitcnt lgkmcnt(4)
    v_mfma_f32_16x16x32_bf16 v[32:35], v[92:95], v[152:155], v[32:35]
    v_mfma_f32_16x16x32_bf16 v[52:55], v[92:95], v[156:159], v[52:55]
    ds_read_b128 v[72:75], v12 offset:45056
    s_waitcnt vmcnt(11) lgkmcnt(4)
    v_mfma_f32_16x16x32_bf16 v[16:19], v[56:59], v[160:163], v[16:19]
    s_waitcnt vmcnt(10)
    v_mfma_f32_16x16x32_bf16 v[36:39], v[56:59], v[164:167], v[36:39]
    ds_read_b128 v[76:79], v12 offset:51200
    s_waitcnt lgkmcnt(4)
    v_mfma_f32_16x16x32_bf16 v[20:23], v[60:63], v[160:163], v[20:23]
    v_mfma_f32_16x16x32_bf16 v[40:43], v[60:63], v[164:167], v[40:43]
    ds_read_b128 v[80:83], v12 offset:52224
    s_add_u32 s24, s32, 20480
    buffer_load_dwordx4 v[208:211], v2, s[4:7], s24 offen offset:0 sc1
    s_waitcnt lgkmcnt(4)
    v_mfma_f32_16x16x32_bf16 v[24:27], v[64:67], v[160:163], v[24:27]
    v_mfma_f32_16x16x32_bf16 v[44:47], v[64:67], v[164:167], v[44:47]
    ds_read_b128 v[84:87], v12 offset:53248
    s_waitcnt lgkmcnt(4)
    v_mfma_f32_16x16x32_bf16 v[28:31], v[68:71], v[160:163], v[28:31]
    v_mfma_f32_16x16x32_bf16 v[48:51], v[68:71], v[164:167], v[48:51]
    ds_read_b128 v[88:91], v12 offset:54272
    s_add_u32 s25, s33, 20480
    buffer_load_dwordx4 v[212:215], v2, s[4:7], s25 offen offset:0 sc1
    s_waitcnt lgkmcnt(4)
    v_mfma_f32_16x16x32_bf16 v[32:35], v[72:75], v[160:163], v[32:35]
    v_mfma_f32_16x16x32_bf16 v[52:55], v[72:75], v[164:167], v[52:55]
    ds_read_b128 v[92:95], v12 offset:55296
    s_waitcnt vmcnt(11) lgkmcnt(4)
    v_mfma_f32_16x16x32_bf16 v[16:19], v[76:79], v[168:171], v[16:19]
    s_waitcnt vmcnt(10)
    v_mfma_f32_16x16x32_bf16 v[36:39], v[76:79], v[172:175], v[36:39]
    ds_read_b128 v[56:59], v12 offset:61440
    s_waitcnt lgkmcnt(4)
    v_mfma_f32_16x16x32_bf16 v[20:23], v[80:83], v[168:171], v[20:23]
    v_mfma_f32_16x16x32_bf16 v[40:43], v[80:83], v[172:175], v[40:43]
    ds_read_b128 v[60:63], v12 offset:62464
    buffer_load_dwordx4 v[216:219], v2, s[4:7], s24 offen offset:2048 sc1
    s_waitcnt lgkmcnt(4)
    v_mfma_f32_16x16x32_bf16 v[24:27], v[84:87], v[168:171], v[24:27]
    v_mfma_f32_16x16x32_bf16 v[44:47], v[84:87], v[172:175], v[44:47]
    ds_read_b128 v[64:67], v12 offset:63488
    s_waitcnt lgkmcnt(4)
    v_mfma_f32_16x16x32_bf16 v[28:31], v[88:91], v[168:171], v[28:31]
    v_mfma_f32_16x16x32_bf16 v[48:51], v[88:91], v[172:175], v[48:51]
    ds_read_b128 v[68:71], v12 offset:64512
    buffer_load_dwordx4 v[220:223], v2, s[4:7], s25 offen offset:2048 sc1
    s_waitcnt lgkmcnt(4)
    v_mfma_f32_16x16x32_bf16 v[32:35], v[92:95], v[168:171], v[32:35]
    v_mfma_f32_16x16x32_bf16 v[52:55], v[92:95], v[172:175], v[52:55]
    ds_read_b128 v[72:75], v13 offset:0
    s_waitcnt vmcnt(11) lgkmcnt(4)
    v_mfma_f32_16x16x32_bf16 v[16:19], v[56:59], v[176:179], v[16:19]
    s_waitcnt vmcnt(10)
    v_mfma_f32_16x16x32_bf16 v[36:39], v[56:59], v[180:183], v[36:39]
    ds_read_b128 v[76:79], v13 offset:6144
    s_waitcnt lgkmcnt(4)
    v_mfma_f32_16x16x32_bf16 v[20:23], v[60:63], v[176:179], v[20:23]
    v_mfma_f32_16x16x32_bf16 v[40:43], v[60:63], v[180:183], v[40:43]
    ds_read_b128 v[80:83], v13 offset:7168
    s_add_u32 s24, s32, 24576
    buffer_load_dwordx4 v[224:227], v2, s[4:7], s24 offen offset:0 sc1
    s_waitcnt lgkmcnt(4)
    v_mfma_f32_16x16x32_bf16 v[24:27], v[64:67], v[176:179], v[24:27]
    v_mfma_f32_16x16x32_bf16 v[44:47], v[64:67], v[180:183], v[44:47]
    ds_read_b128 v[84:87], v13 offset:8192
    s_waitcnt lgkmcnt(4)
    v_mfma_f32_16x16x32_bf16 v[28:31], v[68:71], v[176:179], v[28:31]
    v_mfma_f32_16x16x32_bf16 v[48:51], v[68:71], v[180:183], v[48:51]
    ds_read_b128 v[88:91], v13 offset:9216
    s_add_u32 s25, s33, 24576
    buffer_load_dwordx4 v[228:231], v2, s[4:7], s25 offen offset:0 sc1
    s_waitcnt lgkmcnt(4)
    v_mfma_f32_16x16x32_bf16 v[32:35], v[72:75], v[176:179], v[32:35]
    v_mfma_f32_16x16x32_bf16 v[52:55], v[72:75], v[180:183], v[52:55]
    ds_read_b128 v[92:95], v13 offset:10240
    s_waitcnt vmcnt(11) lgkmcnt(4)
    v_mfma_f32_16x16x32_bf16 v[16:19], v[76:79], v[184:187], v[16:19]
    s_waitcnt vmcnt(10)
    v_mfma_f32_16x16x32_bf16 v[36:39], v[76:79], v[188:191], v[36:39]
    s_barrier
    ds_read_b128 v[56:59], v13 offset:16384
    s_waitcnt lgkmcnt(4)
    v_mfma_f32_16x16x32_bf16 v[20:23], v[80:83], v[184:187], v[20:23]
    v_mfma_f32_16x16x32_bf16 v[40:43], v[80:83], v[188:191], v[40:43]
    ds_read_b128 v[60:63], v13 offset:17408
    buffer_load_dwordx4 v[128:131], v2, s[4:7], s24 offen offset:2048 sc1
    s_waitcnt lgkmcnt(4)
    v_mfma_f32_16x16x32_bf16 v[24:27], v[84:87], v[184:187], v[24:27]
    v_mfma_f32_16x16x32_bf16 v[44:47], v[84:87], v[188:191], v[44:47]
    ds_read_b128 v[64:67], v13 offset:18432
    s_waitcnt lgkmcnt(4)
    v_mfma_f32_16x16x32_bf16 v[28:31], v[88:91], v[184:187], v[28:31]
    v_mfma_f32_16x16x32_bf16 v[48:51], v[88:91], v[188:191], v[48:51]
    ds_read_b128 v[68:71], v13 offset:19456
    buffer_load_dwordx4 v[132:135], v2, s[4:7], s25 offen offset:2048 sc1
    s_waitcnt lgkmcnt(4)
    v_mfma_f32_16x16x32_bf16 v[32:35], v[92:95], v[184:187], v[32:35]
    v_mfma_f32_16x16x32_bf16 v[52:55], v[92:95], v[188:191], v[52:55]
    ds_read_b128 v[72:75], v13 offset:20480
    s_waitcnt vmcnt(11) lgkmcnt(4)
    v_mfma_f32_16x16x32_bf16 v[16:19], v[56:59], v[192:195], v[16:19]
    s_waitcnt vmcnt(10)
    v_mfma_f32_16x16x32_bf16 v[36:39], v[56:59], v[196:199], v[36:39]
    ds_read_b128 v[76:79], v13 offset:26624
    s_waitcnt lgkmcnt(4)
    v_mfma_f32_16x16x32_bf16 v[20:23], v[60:63], v[192:195], v[20:23]
    v_mfma_f32_16x16x32_bf16 v[40:43], v[60:63], v[196:199], v[40:43]
    ds_read_b128 v[80:83], v13 offset:27648
    s_add_u32 s24, s32, 28672
    buffer_load_dwordx4 v[136:139], v2, s[4:7], s24 offen offset:0 sc1
    s_waitcnt lgkmcnt(4)
    v_mfma_f32_16x16x32_bf16 v[24:27], v[64:67], v[192:195], v[24:27]
    v_mfma_f32_16x16x32_bf16 v[44:47], v[64:67], v[196:199], v[44:47]
    ds_read_b128 v[84:87], v13 offset:28672
    s_waitcnt lgkmcnt(4)
    v_mfma_f32_16x16x32_bf16 v[28:31], v[68:71], v[192:195], v[28:31]
    v_mfma_f32_16x16x32_bf16 v[48:51], v[68:71], v[196:199], v[48:51]
    ds_read_b128 v[88:91], v13 offset:29696
    s_add_u32 s25, s33, 28672
    buffer_load_dwordx4 v[140:143], v2, s[4:7], s25 offen offset:0 sc1
    s_waitcnt lgkmcnt(4)
    v_mfma_f32_16x16x32_bf16 v[32:35], v[72:75], v[192:195], v[32:35]
    v_mfma_f32_16x16x32_bf16 v[52:55], v[72:75], v[196:199], v[52:55]
    ds_read_b128 v[92:95], v13 offset:30720
    s_waitcnt vmcnt(11) lgkmcnt(4)
    v_mfma_f32_16x16x32_bf16 v[16:19], v[76:79], v[200:203], v[16:19]
    s_waitcnt vmcnt(10)
    v_mfma_f32_16x16x32_bf16 v[36:39], v[76:79], v[204:207], v[36:39]
    ds_read_b128 v[56:59], v13 offset:36864
    s_waitcnt lgkmcnt(4)
    v_mfma_f32_16x16x32_bf16 v[20:23], v[80:83], v[200:203], v[20:23]
    v_mfma_f32_16x16x32_bf16 v[40:43], v[80:83], v[204:207], v[40:43]
    ds_read_b128 v[60:63], v13 offset:37888
    buffer_load_dwordx4 v[144:147], v2, s[4:7], s24 offen offset:2048 sc1
    s_waitcnt lgkmcnt(4)
    v_mfma_f32_16x16x32_bf16 v[24:27], v[84:87], v[200:203], v[24:27]
    v_mfma_f32_16x16x32_bf16 v[44:47], v[84:87], v[204:207], v[44:47]
    ds_read_b128 v[64:67], v13 offset:38912
    s_waitcnt lgkmcnt(4)
    v_mfma_f32_16x16x32_bf16 v[28:31], v[88:91], v[200:203], v[28:31]
    v_mfma_f32_16x16x32_bf16 v[48:51], v[88:91], v[204:207], v[48:51]
    ds_read_b128 v[68:71], v13 offset:39936
    buffer_load_dwordx4 v[148:151], v2, s[4:7], s25 offen offset:2048 sc1
    s_waitcnt lgkmcnt(4)
    v_mfma_f32_16x16x32_bf16 v[32:35], v[92:95], v[200:203], v[32:35]
    v_mfma_f32_16x16x32_bf16 v[52:55], v[92:95], v[204:207], v[52:55]
    ds_read_b128 v[72:75], v13 offset:40960
    s_waitcnt vmcnt(11) lgkmcnt(4)
    v_mfma_f32_16x16x32_bf16 v[16:19], v[56:59], v[208:211], v[16:19]
    s_waitcnt vmcnt(10)
    v_mfma_f32_16x16x32_bf16 v[36:39], v[56:59], v[212:215], v[36:39]
    ds_read_b128 v[76:79], v13 offset:47104
    s_waitcnt lgkmcnt(4)
    v_mfma_f32_16x16x32_bf16 v[20:23], v[60:63], v[208:211], v[20:23]
    v_mfma_f32_16x16x32_bf16 v[40:43], v[60:63], v[212:215], v[40:43]
    ds_read_b128 v[80:83], v13 offset:48128
    s_add_u32 s24, s32, 32768
    buffer_load_dwordx4 v[152:155], v2, s[4:7], s24 offen offset:0 sc1
    s_waitcnt lgkmcnt(4)
    v_mfma_f32_16x16x32_bf16 v[24:27], v[64:67], v[208:211], v[24:27]
    v_mfma_f32_16x16x32_bf16 v[44:47], v[64:67], v[212:215], v[44:47]
    ds_read_b128 v[84:87], v13 offset:49152
    s_waitcnt lgkmcnt(4)
    v_mfma_f32_16x16x32_bf16 v[28:31], v[68:71], v[208:211], v[28:31]
    v_mfma_f32_16x16x32_bf16 v[48:51], v[68:71], v[212:215], v[48:51]
    ds_read_b128 v[88:91], v13 offset:50176
    s_add_u32 s25, s33, 32768
    buffer_load_dwordx4 v[156:159], v2, s[4:7], s25 offen offset:0 sc1
    s_waitcnt lgkmcnt(4)
    v_mfma_f32_16x16x32_bf16 v[32:35], v[72:75], v[208:211], v[32:35]
    v_mfma_f32_16x16x32_bf16 v[52:55], v[72:75], v[212:215], v[52:55]
    ds_read_b128 v[92:95], v13 offset:51200
    s_waitcnt vmcnt(11) lgkmcnt(4)
    v_mfma_f32_16x16x32_bf16 v[16:19], v[76:79], v[216:219], v[16:19]
    s_waitcnt vmcnt(10)
    v_mfma_f32_16x16x32_bf16 v[36:39], v[76:79], v[220:223], v[36:39]
    s_barrier
    ds_read_b128 v[56:59], v13 offset:57344
    s_waitcnt lgkmcnt(4)
    v_mfma_f32_16x16x32_bf16 v[20:23], v[80:83], v[216:219], v[20:23]
    v_mfma_f32_16x16x32_bf16 v[40:43], v[80:83], v[220:223], v[40:43]
    ds_read_b128 v[60:63], v13 offset:58368
    buffer_load_dwordx4 v[160:163], v2, s[4:7], s24 offen offset:2048 sc1
    s_waitcnt lgkmcnt(4)
    v_mfma_f32_16x16x32_bf16 v[24:27], v[84:87], v[216:219], v[24:27]
    v_mfma_f32_16x16x32_bf16 v[44:47], v[84:87], v[220:223], v[44:47]
    ds_read_b128 v[64:67], v13 offset:59392
    s_waitcnt lgkmcnt(4)
    v_mfma_f32_16x16x32_bf16 v[28:31], v[88:91], v[216:219], v[28:31]
    v_mfma_f32_16x16x32_bf16 v[48:51], v[88:91], v[220:223], v[48:51]
    ds_read_b128 v[68:71], v13 offset:60416
    buffer_load_dwordx4 v[164:167], v2, s[4:7], s25 offen offset:2048 sc1
    s_waitcnt lgkmcnt(4)
    v_mfma_f32_16x16x32_bf16 v[32:35], v[92:95], v[216:219], v[32:35]
    v_mfma_f32_16x16x32_bf16 v[52:55], v[92:95], v[220:223], v[52:55]
    ds_read_b128 v[72:75], v13 offset:61440
    s_waitcnt vmcnt(11) lgkmcnt(4)
    v_mfma_f32_16x16x32_bf16 v[16:19], v[56:59], v[224:227], v[16:19]
    s_waitcnt vmcnt(10)
    v_mfma_f32_16x16x32_bf16 v[36:39], v[56:59], v[228:231], v[36:39]
    ds_read_b128 v[76:79], v14 offset:2048
    s_waitcnt lgkmcnt(4)
    v_mfma_f32_16x16x32_bf16 v[20:23], v[60:63], v[224:227], v[20:23]
    v_mfma_f32_16x16x32_bf16 v[40:43], v[60:63], v[228:231], v[40:43]
    ds_read_b128 v[80:83], v14 offset:3072
    s_add_u32 s24, s32, 36864
    buffer_load_dwordx4 v[168:171], v2, s[4:7], s24 offen offset:0 sc1
    s_waitcnt lgkmcnt(4)
    v_mfma_f32_16x16x32_bf16 v[24:27], v[64:67], v[224:227], v[24:27]
    v_mfma_f32_16x16x32_bf16 v[44:47], v[64:67], v[228:231], v[44:47]
    ds_read_b128 v[84:87], v14 offset:4096
    s_waitcnt lgkmcnt(4)
    v_mfma_f32_16x16x32_bf16 v[28:31], v[68:71], v[224:227], v[28:31]
    v_mfma_f32_16x16x32_bf16 v[48:51], v[68:71], v[228:231], v[48:51]
    ds_read_b128 v[88:91], v14 offset:5120
    s_add_u32 s25, s33, 36864
    buffer_load_dwordx4 v[172:175], v2, s[4:7], s25 offen offset:0 sc1
    s_waitcnt lgkmcnt(4)
    v_mfma_f32_16x16x32_bf16 v[32:35], v[72:75], v[224:227], v[32:35]
    v_mfma_f32_16x16x32_bf16 v[52:55], v[72:75], v[228:231], v[52:55]
    ds_read_b128 v[92:95], v14 offset:6144
    s_waitcnt vmcnt(11) lgkmcnt(4)
    v_mfma_f32_16x16x32_bf16 v[16:19], v[76:79], v[128:131], v[16:19]
    s_waitcnt vmcnt(10)
    v_mfma_f32_16x16x32_bf16 v[36:39], v[76:79], v[132:135], v[36:39]
    ds_read_b128 v[56:59], v12 offset:0
    s_waitcnt lgkmcnt(4)
    v_mfma_f32_16x16x32_bf16 v[20:23], v[80:83], v[128:131], v[20:23]
    v_mfma_f32_16x16x32_bf16 v[40:43], v[80:83], v[132:135], v[40:43]
    ds_read_b128 v[60:63], v12 offset:1024
    buffer_load_dwordx4 v[176:179], v2, s[4:7], s24 offen offset:2048 sc1
    s_waitcnt lgkmcnt(4)
    v_mfma_f32_16x16x32_bf16 v[24:27], v[84:87], v[128:131], v[24:27]
    v_mfma_f32_16x16x32_bf16 v[44:47], v[84:87], v[132:135], v[44:47]
    ds_read_b128 v[64:67], v12 offset:2048
    s_waitcnt lgkmcnt(4)
    v_mfma_f32_16x16x32_bf16 v[28:31], v[88:91], v[128:131], v[28:31]
    v_mfma_f32_16x16x32_bf16 v[48:51], v[88:91], v[132:135], v[48:51]
    ds_read_b128 v[68:71], v12 offset:3072
    buffer_load_dwordx4 v[180:183], v2, s[4:7], s25 offen offset:2048 sc1
    s_waitcnt lgkmcnt(4)
    v_mfma_f32_16x16x32_bf16 v[32:35], v[92:95], v[128:131], v[32:35]
    v_mfma_f32_16x16x32_bf16 v[52:55], v[92:95], v[132:135], v[52:55]
    ds_read_b128 v[72:75], v12 offset:4096
    s_waitcnt vmcnt(11) lgkmcnt(4)
    v_mfma_f32_16x16x32_bf16 v[16:19], v[56:59], v[136:139], v[16:19]
    s_waitcnt vmcnt(10)
    v_mfma_f32_16x16x32_bf16 v[36:39], v[56:59], v[140:143], v[36:39]
    ds_read_b128 v[76:79], v12 offset:10240
    s_waitcnt lgkmcnt(4)
    v_mfma_f32_16x16x32_bf16 v[20:23], v[60:63], v[136:139], v[20:23]
    v_mfma_f32_16x16x32_bf16 v[40:43], v[60:63], v[140:143], v[40:43]
    ds_read_b128 v[80:83], v12 offset:11264
    s_add_u32 s24, s32, 40960
    buffer_load_dwordx4 v[184:187], v2, s[4:7], s24 offen offset:0 sc1
    s_waitcnt lgkmcnt(4)
    v_mfma_f32_16x16x32_bf16 v[24:27], v[64:67], v[136:139], v[24:27]
    v_mfma_f32_16x16x32_bf16 v[44:47], v[64:67], v[140:143], v[44:47]
    ds_read_b128 v[84:87], v12 offset:12288
    s_waitcnt lgkmcnt(4)
    v_mfma_f32_16x16x32_bf16 v[28:31], v[68:71], v[136:139], v[28:31]
    v_mfma_f32_16x16x32_bf16 v[48:51], v[68:71], v[140:143], v[48:51]
    ds_read_b128 v[88:91], v12 offset:13312
    s_add_u32 s25, s33, 40960
    buffer_load_dwordx4 v[188:191], v2, s[4:7], s25 offen offset:0 sc1
    s_waitcnt lgkmcnt(4)
    v_mfma_f32_16x16x32_bf16 v[32:35], v[72:75], v[136:139], v[32:35]
    v_mfma_f32_16x16x32_bf16 v[52:55], v[72:75], v[140:143], v[52:55]
    ds_read_b128 v[92:95], v12 offset:14336
    s_waitcnt vmcnt(11) lgkmcnt(4)
    v_mfma_f32_16x16x32_bf16 v[16:19], v[76:79], v[144:147], v[16:19]
    s_waitcnt vmcnt(10)
    v_mfma_f32_16x16x32_bf16 v[36:39], v[76:79], v[148:151], v[36:39]
    s_barrier
    ds_read_b128 v[56:59], v12 offset:20480
    s_waitcnt lgkmcnt(4)
    v_mfma_f32_16x16x32_bf16 v[20:23], v[80:83], v[144:147], v[20:23]
    v_mfma_f32_16x16x32_bf16 v[40:43], v[80:83], v[148:151], v[40:43]
    ds_read_b128 v[60:63], v12 offset:21504
    buffer_load_dwordx4 v[192:195], v2, s[4:7], s24 offen offset:2048 sc1
    s_waitcnt lgkmcnt(4)
    v_mfma_f32_16x16x32_bf16 v[24:27], v[84:87], v[144:147], v[24:27]
    v_mfma_f32_16x16x32_bf16 v[44:47], v[84:87], v[148:151], v[44:47]
    ds_read_b128 v[64:67], v12 offset:22528
    s_waitcnt lgkmcnt(4)
    v_mfma_f32_16x16x32_bf16 v[28:31], v[88:91], v[144:147], v[28:31]
    v_mfma_f32_16x16x32_bf16 v[48:51], v[88:91], v[148:151], v[48:51]
    ds_read_b128 v[68:71], v12 offset:23552
    buffer_load_dwordx4 v[196:199], v2, s[4:7], s25 offen offset:2048 sc1
    s_waitcnt lgkmcnt(4)
    v_mfma_f32_16x16x32_bf16 v[32:35], v[92:95], v[144:147], v[32:35]
    v_mfma_f32_16x16x32_bf16 v[52:55], v[92:95], v[148:151], v[52:55]
    ds_read_b128 v[72:75], v12 offset:24576
    s_waitcnt vmcnt(11) lgkmcnt(4)
    v_mfma_f32_16x16x32_bf16 v[16:19], v[56:59], v[152:155], v[16:19]
    s_waitcnt vmcnt(10)
    v_mfma_f32_16x16x32_bf16 v[36:39], v[56:59], v[156:159], v[36:39]
    ds_read_b128 v[76:79], v12 offset:30720
    s_waitcnt lgkmcnt(4)
    v_mfma_f32_16x16x32_bf16 v[20:23], v[60:63], v[152:155], v[20:23]
    v_mfma_f32_16x16x32_bf16 v[40:43], v[60:63], v[156:159], v[40:43]
    ds_read_b128 v[80:83], v12 offset:31744
    s_add_u32 s24, s32, 45056
    buffer_load_dwordx4 v[200:203], v2, s[4:7], s24 offen offset:0 sc1
    s_waitcnt lgkmcnt(4)
    v_mfma_f32_16x16x32_bf16 v[24:27], v[64:67], v[152:155], v[24:27]
    v_mfma_f32_16x16x32_bf16 v[44:47], v[64:67], v[156:159], v[44:47]
    ds_read_b128 v[84:87], v12 offset:32768
    s_waitcnt lgkmcnt(4)
    v_mfma_f32_16x16x32_bf16 v[28:31], v[68:71], v[152:155], v[28:31]
    v_mfma_f32_16x16x32_bf16 v[48:51], v[68:71], v[156:159], v[48:51]
    ds_read_b128 v[88:91], v12 offset:33792
    s_add_u32 s25, s33, 45056
    buffer_load_dwordx4 v[204:207], v2, s[4:7], s25 offen offset:0 sc1
    s_waitcnt lgkmcnt(4)
    v_mfma_f32_16x16x32_bf16 v[32:35], v[72:75], v[152:155], v[32:35]
    v_mfma_f32_16x16x32_bf16 v[52:55], v[72:75], v[156:159], v[52:55]
    ds_read_b128 v[92:95], v12 offset:34816
    s_waitcnt vmcnt(11) lgkmcnt(4)
    v_mfma_f32_16x16x32_bf16 v[16:19], v[76:79], v[160:163], v[16:19]
    s_waitcnt vmcnt(10)
    v_mfma_f32_16x16x32_bf16 v[36:39], v[76:79], v[164:167], v[36:39]
    ds_read_b128 v[56:59], v12 offset:40960
    s_waitcnt lgkmcnt(4)
    v_mfma_f32_16x16x32_bf16 v[20:23], v[80:83], v[160:163], v[20:23]
    v_mfma_f32_16x16x32_bf16 v[40:43], v[80:83], v[164:167], v[40:43]
    ds_read_b128 v[60:63], v12 offset:41984
    buffer_load_dwordx4 v[208:211], v2, s[4:7], s24 offen offset:2048 sc1
    s_waitcnt lgkmcnt(4)
    v_mfma_f32_16x16x32_bf16 v[24:27], v[84:87], v[160:163], v[24:27]
    v_mfma_f32_16x16x32_bf16 v[44:47], v[84:87], v[164:167], v[44:47]
    ds_read_b128 v[64:67], v12 offset:43008
    s_waitcnt lgkmcnt(4)
    v_mfma_f32_16x16x32_bf16 v[28:31], v[88:91], v[160:163], v[28:31]
    v_mfma_f32_16x16x32_bf16 v[48:51], v[88:91], v[164:167], v[48:51]
    ds_read_b128 v[68:71], v12 offset:44032
    buffer_load_dwordx4 v[212:215], v2, s[4:7], s25 offen offset:2048 sc1
    s_waitcnt lgkmcnt(4)
    v_mfma_f32_16x16x32_bf16 v[32:35], v[92:95], v[160:163], v[32:35]
    v_mfma_f32_16x16x32_bf16 v[52:55], v[92:95], v[164:167], v[52:55]
    ds_read_b128 v[72:75], v12 offset:45056
    s_waitcnt vmcnt(11) lgkmcnt(4)
    v_mfma_f32_16x16x32_bf16 v[16:19], v[56:59], v[168:171], v[16:19]
    s_waitcnt vmcnt(10)
    v_mfma_f32_16x16x32_bf16 v[36:39], v[56:59], v[172:175], v[36:39]
    ds_read_b128 v[76:79], v12 offset:51200
    s_waitcnt lgkmcnt(4)
    v_mfma_f32_16x16x32_bf16 v[20:23], v[60:63], v[168:171], v[20:23]
    v_mfma_f32_16x16x32_bf16 v[40:43], v[60:63], v[172:175], v[40:43]
    ds_read_b128 v[80:83], v12 offset:52224
    s_waitcnt lgkmcnt(4)
    v_mfma_f32_16x16x32_bf16 v[24:27], v[64:67], v[168:171], v[24:27]
    v_mfma_f32_16x16x32_bf16 v[44:47], v[64:67], v[172:175], v[44:47]
    ds_read_b128 v[84:87], v12 offset:53248
    s_waitcnt lgkmcnt(4)
    v_mfma_f32_16x16x32_bf16 v[28:31], v[68:71], v[168:171], v[28:31]
    v_mfma_f32_16x16x32_bf16 v[48:51], v[68:71], v[172:175], v[48:51]
    ds_read_b128 v[88:91], v12 offset:54272
    s_waitcnt lgkmcnt(4)
    v_mfma_f32_16x16x32_bf16 v[32:35], v[72:75], v[168:171], v[32:35]
    v_mfma_f32_16x16x32_bf16 v[52:55], v[72:75], v[172:175], v[52:55]
    ds_read_b128 v[92:95], v12 offset:55296
    s_waitcnt vmcnt(9) lgkmcnt(4)
    v_mfma_f32_16x16x32_bf16 v[16:19], v[76:79], v[176:179], v[16:19]
    s_waitcnt vmcnt(8)
    v_mfma_f32_16x16x32_bf16 v[36:39], v[76:79], v[180:183], v[36:39]
    s_barrier
    ds_read_b128 v[56:59], v12 offset:61440
    s_waitcnt lgkmcnt(4)
    v_mfma_f32_16x16x32_bf16 v[20:23], v[80:83], v[176:179], v[20:23]
    v_mfma_f32_16x16x32_bf16 v[40:43], v[80:83], v[180:183], v[40:43]
    ds_read_b128 v[60:63], v12 offset:62464
    s_waitcnt lgkmcnt(4)
    v_mfma_f32_16x16x32_bf16 v[24:27], v[84:87], v[176:179], v[24:27]
    v_mfma_f32_16x16x32_bf16 v[44:47], v[84:87], v[180:183], v[44:47]
    ds_read_b128 v[64:67], v12 offset:63488
    s_waitcnt lgkmcnt(4)
    v_mfma_f32_16x16x32_bf16 v[28:31], v[88:91], v[176:179], v[28:31]
    v_mfma_f32_16x16x32_bf16 v[48:51], v[88:91], v[180:183], v[48:51]
    ds_read_b128 v[68:71], v12 offset:64512
    s_waitcnt lgkmcnt(4)
    v_mfma_f32_16x16x32_bf16 v[32:35], v[92:95], v[176:179], v[32:35]
    v_mfma_f32_16x16x32_bf16 v[52:55], v[92:95], v[180:183], v[52:55]
    ds_read_b128 v[72:75], v13 offset:0
    s_waitcnt vmcnt(7) lgkmcnt(4)
    v_mfma_f32_16x16x32_bf16 v[16:19], v[56:59], v[184:187], v[16:19]
    s_waitcnt vmcnt(6)
    v_mfma_f32_16x16x32_bf16 v[36:39], v[56:59], v[188:191], v[36:39]
    ds_read_b128 v[76:79], v13 offset:6144
    s_waitcnt lgkmcnt(4)
    v_mfma_f32_16x16x32_bf16 v[20:23], v[60:63], v[184:187], v[20:23]
    v_mfma_f32_16x16x32_bf16 v[40:43], v[60:63], v[188:191], v[40:43]
    ds_read_b128 v[80:83], v13 offset:7168
    s_waitcnt lgkmcnt(4)
    v_mfma_f32_16x16x32_bf16 v[24:27], v[64:67], v[184:187], v[24:27]
    v_mfma_f32_16x16x32_bf16 v[44:47], v[64:67], v[188:191], v[44:47]
    ds_read_b128 v[84:87], v13 offset:8192
    s_waitcnt lgkmcnt(4)
    v_mfma_f32_16x16x32_bf16 v[28:31], v[68:71], v[184:187], v[28:31]
    v_mfma_f32_16x16x32_bf16 v[48:51], v[68:71], v[188:191], v[48:51]
    ds_read_b128 v[88:91], v13 offset:9216
    s_waitcnt lgkmcnt(4)
    v_mfma_f32_16x16x32_bf16 v[32:35], v[72:75], v[184:187], v[32:35]
    v_mfma_f32_16x16x32_bf16 v[52:55], v[72:75], v[188:191], v[52:55]
    ds_read_b128 v[92:95], v13 offset:10240
    s_waitcnt vmcnt(5) lgkmcnt(4)
    v_mfma_f32_16x16x32_bf16 v[16:19], v[76:79], v[192:195], v[16:19]
    s_waitcnt vmcnt(4)
    v_mfma_f32_16x16x32_bf16 v[36:39], v[76:79], v[196:199], v[36:39]
    ds_read_b128 v[56:59], v13 offset:16384
    s_waitcnt lgkmcnt(4)
    v_mfma_f32_16x16x32_bf16 v[20:23], v[80:83], v[192:195], v[20:23]
    v_mfma_f32_16x16x32_bf16 v[40:43], v[80:83], v[196:199], v[40:43]
    ds_read_b128 v[60:63], v13 offset:17408
    s_waitcnt lgkmcnt(4)
    v_mfma_f32_16x16x32_bf16 v[24:27], v[84:87], v[192:195], v[24:27]
    v_mfma_f32_16x16x32_bf16 v[44:47], v[84:87], v[196:199], v[44:47]
    ds_read_b128 v[64:67], v13 offset:18432
    s_waitcnt lgkmcnt(4)
    v_mfma_f32_16x16x32_bf16 v[28:31], v[88:91], v[192:195], v[28:31]
    v_mfma_f32_16x16x32_bf16 v[48:51], v[88:91], v[196:199], v[48:51]
    ds_read_b128 v[68:71], v13 offset:19456
    s_waitcnt lgkmcnt(4)
    v_mfma_f32_16x16x32_bf16 v[32:35], v[92:95], v[192:195], v[32:35]
    v_mfma_f32_16x16x32_bf16 v[52:55], v[92:95], v[196:199], v[52:55]
    ds_read_b128 v[72:75], v13 offset:20480
    s_waitcnt vmcnt(3) lgkmcnt(4)
    v_mfma_f32_16x16x32_bf16 v[16:19], v[56:59], v[200:203], v[16:19]
    s_waitcnt vmcnt(2)
    v_mfma_f32_16x16x32_bf16 v[36:39], v[56:59], v[204:207], v[36:39]
    ds_read_b128 v[76:79], v13 offset:26624
    s_waitcnt lgkmcnt(4)
    v_mfma_f32_16x16x32_bf16 v[20:23], v[60:63], v[200:203], v[20:23]
    v_mfma_f32_16x16x32_bf16 v[40:43], v[60:63], v[204:207], v[40:43]
    ds_read_b128 v[80:83], v13 offset:27648
    s_waitcnt lgkmcnt(4)
    v_mfma_f32_16x16x32_bf16 v[24:27], v[64:67], v[200:203], v[24:27]
    v_mfma_f32_16x16x32_bf16 v[44:47], v[64:67], v[204:207], v[44:47]
    ds_read_b128 v[84:87], v13 offset:28672
    s_waitcnt lgkmcnt(4)
    v_mfma_f32_16x16x32_bf16 v[28:31], v[68:71], v[200:203], v[28:31]
    v_mfma_f32_16x16x32_bf16 v[48:51], v[68:71], v[204:207], v[48:51]
    ds_read_b128 v[88:91], v13 offset:29696
    s_waitcnt lgkmcnt(4)
    v_mfma_f32_16x16x32_bf16 v[32:35], v[72:75], v[200:203], v[32:35]
    v_mfma_f32_16x16x32_bf16 v[52:55], v[72:75], v[204:207], v[52:55]
    ds_read_b128 v[92:95], v13 offset:30720
    s_waitcnt vmcnt(0) lgkmcnt(4)
    v_mfma_f32_16x16x32_bf16 v[36:39], v[76:79], v[212:215], v[36:39]
    s_waitcnt lgkmcnt(3)
    v_mfma_f32_16x16x32_bf16 v[40:43], v[80:83], v[212:215], v[40:43]
    s_waitcnt lgkmcnt(2)
    v_mfma_f32_16x16x32_bf16 v[44:47], v[84:87], v[212:215], v[44:47]
    s_waitcnt lgkmcnt(1)
    v_mfma_f32_16x16x32_bf16 v[48:51], v[88:91], v[212:215], v[48:51]
    s_waitcnt lgkmcnt(0)
    v_mfma_f32_16x16x32_bf16 v[52:55], v[92:95], v[212:215], v[52:55]
    s_waitcnt vmcnt(1)
    v_mfma_f32_16x16x32_bf16 v[16:19], v[76:79], v[208:211], v[16:19]
    v_mfma_f32_16x16x32_bf16 v[20:23], v[80:83], v[208:211], v[20:23]
    v_mfma_f32_16x16x32_bf16 v[24:27], v[84:87], v[208:211], v[24:27]
    v_mfma_f32_16x16x32_bf16 v[28:31], v[88:91], v[208:211], v[28:31]
    v_mfma_f32_16x16x32_bf16 v[32:35], v[92:95], v[208:211], v[32:35]
    ds_write_b128 v3, v[36:39] offset:0
    ds_write_b128 v3, v[40:43] offset:1024
    ds_write_b128 v3, v[44:47] offset:2048
    ds_write_b128 v3, v[48:51] offset:3072
    ds_write_b128 v3, v[52:55] offset:4096
    s_waitcnt lgkmcnt(0)
    s_barrier
    ds_read_b128 v[56:59], v4 offset:0
    ds_read_b128 v[60:63], v4 offset:1024
    ds_read_b128 v[64:67], v4 offset:2048
    ds_read_b128 v[68:71], v4 offset:3072
    ds_read_b128 v[72:75], v4 offset:4096
    s_cmp_lg_u32 s50, 0
    s_cbranch_scc1 L_lastl_69
    s_waitcnt lgkmcnt(4)
    v_pk_add_f32 v[16:17], v[16:17], v[56:57]
    v_pk_add_f32 v[18:19], v[18:19], v[58:59]
    v_cvt_pk_bf16_f32 v112, v16, v17
    v_cvt_pk_bf16_f32 v113, v18, v19
    s_waitcnt lgkmcnt(3)
    v_pk_add_f32 v[20:21], v[20:21], v[60:61]
    v_pk_add_f32 v[22:23], v[22:23], v[62:63]
    v_cvt_pk_bf16_f32 v114, v20, v21
    v_cvt_pk_bf16_f32 v115, v22, v23
    v_pk_mov_b32 v[76:77], v[112:113], v[112:113] op_sel:[0,1]
    v_pk_mov_b32 v[78:79], v[114:115], v[114:115] op_sel:[0,1]
    s_nop 1
    v_permlane16_swap_b32 v76, v78
    v_permlane16_swap_b32 v77, v79
    buffer_store_dwordx4 v[76:79], v5, s[12:15], s35 offen offset:0
    s_waitcnt lgkmcnt(2)
    v_pk_add_f32 v[24:25], v[24:25], v[64:65]
    v_pk_add_f32 v[26:27], v[26:27], v[66:67]
    v_cvt_pk_bf16_f32 v116, v24, v25
    v_cvt_pk_bf16_f32 v117, v26, v27
    s_waitcnt lgkmcnt(1)
    v_pk_add_f32 v[28:29], v[28:29], v[68:69]
    v_pk_add_f32 v[30:31], v[30:31], v[70:71]
    v_cvt_pk_bf16_f32 v118, v28, v29
    v_cvt_pk_bf16_f32 v119, v30, v31
    v_pk_mov_b32 v[80:81], v[116:117], v[116:117] op_sel:[0,1]
    v_pk_mov_b32 v[82:83], v[118:119], v[118:119] op_sel:[0,1]
    s_nop 1
    v_permlane16_swap_b32 v80, v82
    v_permlane16_swap_b32 v81, v83
    buffer_store_dwordx4 v[80:83], v5, s[12:15], s35 offen offset:2048
    s_waitcnt lgkmcnt(0)
    v_pk_add_f32 v[32:33], v[32:33], v[72:73]
    v_pk_add_f32 v[34:35], v[34:35], v[74:75]
    v_cvt_pk_bf16_f32 v120, v32, v33
    v_cvt_pk_bf16_f32 v121, v34, v35
    buffer_store_dwordx2 v[120:121], v7, s[12:15], s37 offen
    v_dot2_f32_bf16 v8, v112, v11, v8
    v_dot2_f32_bf16 v9, v112, v112, v9
    v_dot2_f32_bf16 v8, v113, v11, v8
    v_dot2_f32_bf16 v9, v113, v113, v9
    v_dot2_f32_bf16 v8, v114, v11, v8
    v_dot2_f32_bf16 v9, v114, v114, v9
    v_dot2_f32_bf16 v8, v115, v11, v8
    v_dot2_f32_bf16 v9, v115, v115, v9
    v_dot2_f32_bf16 v8, v116, v11, v8
    v_dot2_f32_bf16 v9, v116, v116, v9
    v_dot2_f32_bf16 v8, v117, v11, v8
    v_dot2_f32_bf16 v9, v117, v117, v9
    v_dot2_f32_bf16 v8, v118, v11, v8
    v_dot2_f32_bf16 v9, v118, v118, v9
    v_dot2_f32_bf16 v8, v119, v11, v8
    v_dot2_f32_bf16 v9, v119, v119, v9
    v_dot2_f32_bf16 v8, v120, v11, v8
    v_dot2_f32_bf16 v9, v120, v120, v9
    v_dot2_f32_bf16 v8, v121, v11, v8
    v_dot2_f32_bf16 v9, v121, v121, v9
    s_nop 1
    v_mov_b32 v10, v8
    v_mov_b32 v11, v9
    s_nop 0
    v_permlane16_swap_b32 v8, v10
    v_permlane16_swap_b32 v9, v11
    v_pk_add_f32 v[8:9], v[8:9], v[10:11]
    v_pk_mov_b32 v[10:11], v[8:9], v[8:9] op_sel:[0,1]
    s_nop 1
    v_permlane32_swap_b32 v8, v10
    v_permlane32_swap_b32 v9, v11
    v_pk_add_f32 v[8:9], v[8:9], v[10:11]
    s_mov_b64 exec, 0xffff
    buffer_store_dwordx2 v[8:9], v1, s[4:7], s43 offen
    s_mov_b64 exec, -1
    s_and_b32 s27, s51, 15
    s_mov_b32 s26, s45
    s_mov_b32 s101, s46
    s_lshl_b32 s29, s53, 2
    s_add_u32 s29, s29, s20
    v_lshlrev_b32 v2, 4, v0
    v_and_b32 v5, 31, v0
    v_lshrrev_b32 v6, 5, v0
    s_and_b32 s28, s29, 7
    s_mul_i32 s30, s29, 40960
    v_add_u32 v3, 0x10000, v2
    v_add_u32 v4, 0x20000, v2
    v_lshlrev_b32 v7, 6, v5
    v_lshl_add_u32 v7, v6, 5, v7
    s_lshl_b32 s31, s28, 11
    s_add_u32 s31, s31, s3
    s_add_u32 s31, s31, 327680
    s_lshr_b32 s33, s20, 1
    s_mul_i32 s32, s53, 491520
    s_add_u32 s32, s32, 10321920
    s_and_b32 s34, s29, 1
    s_cmp_ge_u32 s27, 11
    s_cbranch_scc1 L_vpath_70
    v_lshlrev_b32 v16, 4, v6
    v_add_u32 v16, 156672, v16
    v_and_b32 v17, 0x13, v5
    v_bfe_u32 v18, v5, 2, 1
    v_lshl_add_u32 v17, v18, 3, v17
    v_bfe_u32 v18, v5, 3, 1
    v_lshl_add_u32 v17, v18, 2, v17
    v_lshlrev_b32 v32, 4, v17
    v_lshl_add_u32 v32, v6, 9, v32
    v_lshlrev_b32 v17, 3, v17
    s_mul_i32 s22, s33, 5120
    s_add_u32 s22, s22, s32
    s_sub_u32 s22, s22, 327680
    s_lshl_b32 s23, s34, 10
    s_add_u32 s35, s22, s23
    s_lshl_b32 s23, s34, 8
    s_add_u32 s36, s22, s23
    s_add_u32 s36, s36, 2048
    s_mul_i32 s37, s20, 1280
    s_add_u32 s37, s37, s32
    s_add_u32 s37, s37, 327680
    s_add_u32 s38, s37, 1024
    s_mul_i32 s22, s27, 6
    s_add_u32 s22, s22, 0
    s_movk_i32 s23, 5120
    s_cmp_ge_u32 s22, 32
    s_cselect_b32 s23, 10240, s23
    s_cselect_b32 s39, s35, s37
    s_cselect_b32 s41, s36, s38
    s_cselect_b32 s33, 1.0, 0x3ea52b5c
    s_mul_i32 s24, s22, s23
    s_cmp_ge_u32 s22, 64
    s_cselect_b32 s24, 0x80000000, s24
    s_add_u32 s39, s39, s24
    s_add_u32 s40, s39, s23
    s_add_u32 s41, s41, s24
    v_mad_u32_u24 v33, v6, s23, v17
    s_mul_i32 s22, s27, 6
    s_add_u32 s22, s22, 2
    s_movk_i32 s23, 5120
    s_cmp_ge_u32 s22, 32
    s_cselect_b32 s23, 10240, s23
    s_cselect_b32 s42, s35, s37
    s_cselect_b32 s44, s36, s38
    s_cselect_b32 s34, 1.0, 0x3ea52b5c
    s_mul_i32 s24, s22, s23
    s_cmp_ge_u32 s22, 64
    s_cselect_b32 s24, 0x80000000, s24
    s_add_u32 s42, s42, s24
    s_add_u32 s43, s42, s23
    s_add_u32 s44, s44, s24
    v_mad_u32_u24 v34, v6, s23, v17
    s_mul_i32 s22, s27, 6
    s_add_u32 s22, s22, 4
    s_movk_i32 s23, 5120
    s_cmp_ge_u32 s22, 32
    s_cselect_b32 s23, 10240, s23
    s_cselect_b32 s45, s35, s37
    s_cselect_b32 s47, s36, s38
    s_cselect_b32 s48, 1.0, 0x3ea52b5c
    s_mul_i32 s24, s22, s23
    s_cmp_ge_u32 s22, 64
    s_cselect_b32 s24, 0x80000000, s24
    s_add_u32 s45, s45, s24
    s_add_u32 s46, s45, s23
    s_add_u32 s47, s47, s24
    v_mad_u32_u24 v35, v6, s23, v17
    s_lshl_b32 s100, s21, 3
    s_add_u32 s100, s100, s26
    s_lshl_b32 s100, s100, 6
    s_add_u32 s100, s100, s52
    s_add_u32 s100, s100, 28672
    s_lshl_b32 s23, s101, 2
    s_add_u32 s100, s100, s23
    v_mov_b32 v8, 0
    v_mov_b32 v9, 1
    s_cmp_eq_u32 s54, 0
    s_mov_b64 exec, 1
    s_waitcnt vmcnt(0)
    s_cbranch_scc1 L_sigimp_71
    buffer_store_dword v9, v8, s[4:7], s100 offen
L_sigback_72:
    s_mov_b64 exec, -1
    s_lshl_b32 s22, s21, 3
    s_add_u32 s22, s22, s28
    s_lshl_b32 s22, s22, 6
    s_add_u32 s22, s22, s52
    s_add_u32 s22, s22, 28672
    s_mov_b32 s23, 200000
    v_lshlrev_b32 v9, 2, v0
    s_cmp_eq_u32 s54, 0
    s_cbranch_scc1 L_pollimp_75
    s_mov_b64 exec, 0xffff
L_poll_73:
    buffer_load_dword v10, v9, s[4:7], s22 offen sc1
    s_sub_u32 s23, s23, 1
    s_cbranch_scc1 L_polled_74
    s_waitcnt vmcnt(0)
    v_cmp_ne_u32 vcc, 1, v10
    s_cbranch_vccnz L_poll_73
L_polled_74:
    s_waitcnt lgkmcnt(0)
    s_mov_b64 exec, -1
    s_setprio 3
    s_add_u32 s25, s30, 0
    buffer_load_dwordx4 v[160:163], v2, s[12:15], s25 offen offset:0 sc1
    buffer_load_dwordx4 v[164:167], v2, s[12:15], s25 offen offset:1024 sc1
    s_setprio 2
    buffer_load_dwordx4 v[168:171], v2, s[12:15], s25 offen offset:2048 sc1
    buffer_load_dwordx4 v[172:175], v2, s[12:15], s25 offen offset:3072 sc1
    s_setprio 1
    s_add_u32 s25, s30, 4096
    buffer_load_dwordx4 v[176:179], v2, s[12:15], s25 offen offset:0 sc1
    buffer_load_dwordx4 v[180:183], v2, s[12:15], s25 offen offset:1024 sc1
    buffer_load_dwordx4 v[184:187], v2, s[12:15], s25 offen offset:2048 sc1
    s_setprio 0
    buffer_load_dwordx4 v[188:191], v2, s[12:15], s25 offen offset:3072 sc1
    s_add_u32 s25, s30, 8192
    buffer_load_dwordx4 v[192:195], v2, s[12:15], s25 offen offset:0 sc1
    buffer_load_dwordx4 v[196:199], v2, s[12:15], s25 offen offset:1024 sc1
    buffer_load_dwordx4 v[200:203], v2, s[12:15], s25 offen offset:2048 sc1
    buffer_load_dwordx4 v[204:207], v2, s[12:15], s25 offen offset:3072 sc1
    s_setprio 0
    buffer_load_dwordx4 v[8:11], v7, s[4:7], s31 offen sc1
    buffer_load_dwordx4 v[12:15], v7, s[4:7], s31 offen offset:16 sc1
    s_barrier
    ds_read_b128 v[128:131], v2 offset:0
    ds_read_b128 v[132:135], v2 offset:1024
    ds_read_b128 v[136:139], v2 offset:2048
    ds_read_b128 v[140:143], v2 offset:3072
    s_waitcnt vmcnt(13) lgkmcnt(3)
    v_mfma_f32_32x32x16_bf16 v[64:79], v[128:131], v[160:163], 0
    ds_read_b128 v[144:147], v2 offset:4096
    s_waitcnt lgkmcnt(3)
    v_mfma_f32_32x32x16_bf16 v[80:95], v[132:135], v[160:163], 0
    ds_read_b128 v[148:151], v2 offset:5120
    s_waitcnt lgkmcnt(3)
    v_mfma_f32_32x32x16_bf16 v[96:111], v[136:139], v[160:163], 0
    ds_read_b128 v[152:155], v2 offset:6144
    s_waitcnt lgkmcnt(3)
    v_mfma_f32_32x32x16_bf16 v[112:127], v[140:143], v[160:163], 0
    ds_read_b128 v[156:159], v2 offset:7168
    s_add_u32 s25, s30, 12288
    buffer_load_dwordx4 v[208:211], v2, s[12:15], s25 offen offset:0 sc1
    s_waitcnt vmcnt(13) lgkmcnt(3)
    v_mfma_f32_32x32x16_bf16 v[64:79], v[144:147], v[164:167], v[64:79]
    ds_read_b128 v[128:131], v2 offset:8192
    ds_read_b128 v[216:219], v16 offset:0
    s_waitcnt lgkmcnt(4)
    v_mfma_f32_32x32x16_bf16 v[80:95], v[148:151], v[164:167], v[80:95]
    ds_read_b128 v[132:135], v2 offset:9216
    ds_read_b128 v[220:223], v16 offset:32
    s_waitcnt lgkmcnt(5)
    v_mfma_f32_32x32x16_bf16 v[96:111], v[152:155], v[164:167], v[96:111]
    ds_read_b128 v[136:139], v2 offset:10240
    ds_read_b128 v[224:227], v16 offset:64
    s_waitcnt lgkmcnt(6)
    v_mfma_f32_32x32x16_bf16 v[112:127], v[156:159], v[164:167], v[112:127]
    ds_read_b128 v[140:143], v2 offset:11264
    buffer_load_dwordx4 v[212:215], v2, s[12:15], s25 offen offset:1024 sc1
    ds_read_b128 v[228:231], v16 offset:96
    s_waitcnt vmcnt(13) lgkmcnt(7)
    v_mfma_f32_32x32x16_bf16 v[64:79], v[128:131], v[168:171], v[64:79]
    ds_read_b128 v[144:147], v2 offset:12288
    ds_read_b128 v[232:235], v16 offset:128
    s_waitcnt lgkmcnt(7)
    v_mfma_f32_32x32x16_bf16 v[80:95], v[132:135], v[168:171], v[80:95]
    ds_read_b128 v[148:151], v2 offset:13312
    ds_read_b128 v[236:239], v16 offset:160
    s_waitcnt lgkmcnt(7)
    v_mfma_f32_32x32x16_bf16 v[96:111], v[136:139], v[168:171], v[96:111]
    ds_read_b128 v[152:155], v2 offset:14336
    ds_read_b128 v[240:243], v16 offset:192
    s_waitcnt lgkmcnt(7)
    v_mfma_f32_32x32x16_bf16 v[112:127], v[140:143], v[168:171], v[112:127]
    ds_read_b128 v[156:159], v2 offset:15360
    buffer_load_dwordx4 v[160:163], v2, s[12:15], s25 offen offset:2048 sc1
    ds_read_b128 v[244:247], v16 offset:224
    s_waitcnt vmcnt(13) lgkmcnt(7)
    v_mfma_f32_32x32x16_bf16 v[64:79], v[144:147], v[172:175], v[64:79]
    s_barrier
    ds_read_b128 v[128:131], v2 offset:16384
    ds_read_b128 v[248:251], v16 offset:256
    s_waitcnt lgkmcnt(7)
    v_mfma_f32_32x32x16_bf16 v[80:95], v[148:151], v[172:175], v[80:95]
    ds_read_b128 v[132:135], v2 offset:17408
    ds_read_b128 v[252:255], v16 offset:288
    s_waitcnt lgkmcnt(7)
    v_mfma_f32_32x32x16_bf16 v[96:111], v[152:155], v[172:175], v[96:111]
    ds_read_b128 v[136:139], v2 offset:18432
    ds_read_b128 v[48:51], v16 offset:320
    s_waitcnt lgkmcnt(7)
    v_mfma_f32_32x32x16_bf16 v[112:127], v[156:159], v[172:175], v[112:127]
    ds_read_b128 v[140:143], v2 offset:19456
    buffer_load_dwordx4 v[164:167], v2, s[12:15], s25 offen offset:3072 sc1
    ds_read_b128 v[52:55], v16 offset:352
    s_waitcnt vmcnt(13) lgkmcnt(7)
    v_mfma_f32_32x32x16_bf16 v[64:79], v[128:131], v[176:179], v[64:79]
    ds_read_b128 v[144:147], v2 offset:20480
    ds_read_b128 v[56:59], v16 offset:384
    s_waitcnt lgkmcnt(7)
    v_mfma_f32_32x32x16_bf16 v[80:95], v[132:135], v[176:179], v[80:95]
    ds_read_b128 v[148:151], v2 offset:21504
    ds_read_b128 v[60:63], v16 offset:416
    s_waitcnt lgkmcnt(7)
    v_mfma_f32_32x32x16_bf16 v[96:111], v[136:139], v[176:179], v[96:111]
    ds_read_b128 v[152:155], v2 offset:22528
    ds_read_b128 v[24:27], v16 offset:448
    s_waitcnt lgkmcnt(7)
    v_mfma_f32_32x32x16_bf16 v[112:127], v[140:143], v[176:179], v[112:127]
    ds_read_b128 v[156:159], v2 offset:23552
    s_add_u32 s25, s30, 16384
    buffer_load_dwordx4 v[168:171], v2, s[12:15], s25 offen offset:0 sc1
    s_waitcnt vmcnt(13) lgkmcnt(6)
    v_mfma_f32_32x32x16_bf16 v[64:79], v[144:147], v[180:183], v[64:79]
    ds_read_b128 v[128:131], v2 offset:24576
    s_waitcnt lgkmcnt(5)
    v_mfma_f32_32x32x16_bf16 v[80:95], v[148:151], v[180:183], v[80:95]
    ds_read_b128 v[132:135], v2 offset:25600
    s_waitcnt lgkmcnt(4)
    v_mfma_f32_32x32x16_bf16 v[96:111], v[152:155], v[180:183], v[96:111]
    ds_read_b128 v[136:139], v2 offset:26624
    s_waitcnt lgkmcnt(3)
    v_mfma_f32_32x32x16_bf16 v[112:127], v[156:159], v[180:183], v[112:127]
    ds_read_b128 v[140:143], v2 offset:27648
    buffer_load_dwordx4 v[172:175], v2, s[12:15], s25 offen offset:1024 sc1
    s_waitcnt vmcnt(13) lgkmcnt(3)
    v_mfma_f32_32x32x16_bf16 v[64:79], v[128:131], v[184:187], v[64:79]
    ds_read_b128 v[144:147], v2 offset:28672
    s_waitcnt lgkmcnt(3)
    v_mfma_f32_32x32x16_bf16 v[80:95], v[132:135], v[184:187], v[80:95]
    ds_read_b128 v[148:151], v2 offset:29696
    s_waitcnt lgkmcnt(3)
    v_mfma_f32_32x32x16_bf16 v[96:111], v[136:139], v[184:187], v[96:111]
    ds_read_b128 v[152:155], v2 offset:30720
    s_waitcnt lgkmcnt(3)
    v_mfma_f32_32x32x16_bf16 v[112:127], v[140:143], v[184:187], v[112:127]
    ds_read_b128 v[156:159], v2 offset:31744
    buffer_load_dwordx4 v[176:179], v2, s[12:15], s25 offen offset:2048 sc1
    s_waitcnt vmcnt(13) lgkmcnt(3)
    v_mfma_f32_32x32x16_bf16 v[64:79], v[144:147], v[188:191], v[64:79]
    s_barrier
    ds_read_b128 v[128:131], v2 offset:32768
    s_waitcnt lgkmcnt(3)
    v_mfma_f32_32x32x16_bf16 v[80:95], v[148:151], v[188:191], v[80:95]
    ds_read_b128 v[132:135], v2 offset:33792
    s_waitcnt lgkmcnt(3)
    v_mfma_f32_32x32x16_bf16 v[96:111], v[152:155], v[188:191], v[96:111]
    ds_read_b128 v[136:139], v2 offset:34816
    s_waitcnt lgkmcnt(3)
    v_mfma_f32_32x32x16_bf16 v[112:127], v[156:159], v[188:191], v[112:127]
    ds_read_b128 v[140:143], v2 offset:35840
    buffer_load_dwordx4 v[180:183], v2, s[12:15], s25 offen offset:3072 sc1
    s_waitcnt vmcnt(13) lgkmcnt(3)
    v_mfma_f32_32x32x16_bf16 v[64:79], v[128:131], v[192:195], v[64:79]
    ds_read_b128 v[144:147], v2 offset:36864
    s_waitcnt lgkmcnt(3)
    v_mfma_f32_32x32x16_bf16 v[80:95], v[132:135], v[192:195], v[80:95]
    ds_read_b128 v[148:151], v2 offset:37888
    s_waitcnt lgkmcnt(3)
    v_mfma_f32_32x32x16_bf16 v[96:111], v[136:139], v[192:195], v[96:111]
    ds_read_b128 v[152:155], v2 offset:38912
    s_waitcnt lgkmcnt(3)
    v_mfma_f32_32x32x16_bf16 v[112:127], v[140:143], v[192:195], v[112:127]
    ds_read_b128 v[156:159], v2 offset:39936
    s_add_u32 s25, s30, 20480
    buffer_load_dwordx4 v[184:187], v2, s[12:15], s25 offen offset:0 sc1
    s_waitcnt vmcnt(13) lgkmcnt(3)
    v_mfma_f32_32x32x16_bf16 v[64:79], v[144:147], v[196:199], v[64:79]
    ds_read_b128 v[128:131], v2 offset:40960
    s_waitcnt lgkmcnt(3)
    v_mfma_f32_32x32x16_bf16 v[80:95], v[148:151], v[196:199], v[80:95]
    ds_read_b128 v[132:135], v2 offset:41984
    s_waitcnt lgkmcnt(3)
    v_mfma_f32_32x32x16_bf16 v[96:111], v[152:155], v[196:199], v[96:111]
    ds_read_b128 v[136:139], v2 offset:43008
    s_waitcnt lgkmcnt(3)
    v_mfma_f32_32x32x16_bf16 v[112:127], v[156:159], v[196:199], v[112:127]
    ds_read_b128 v[140:143], v2 offset:44032
    buffer_load_dwordx4 v[188:191], v2, s[12:15], s25 offen offset:1024 sc1
    s_waitcnt vmcnt(13) lgkmcnt(3)
    v_mfma_f32_32x32x16_bf16 v[64:79], v[128:131], v[200:203], v[64:79]
    ds_read_b128 v[144:147], v2 offset:45056
    s_waitcnt lgkmcnt(3)
    v_mfma_f32_32x32x16_bf16 v[80:95], v[132:135], v[200:203], v[80:95]
    ds_read_b128 v[148:151], v2 offset:46080
    s_waitcnt lgkmcnt(3)
    v_mfma_f32_32x32x16_bf16 v[96:111], v[136:139], v[200:203], v[96:111]
    ds_read_b128 v[152:155], v2 offset:47104
    s_waitcnt lgkmcnt(3)
    v_mfma_f32_32x32x16_bf16 v[112:127], v[140:143], v[200:203], v[112:127]
    ds_read_b128 v[156:159], v2 offset:48128
    buffer_load_dwordx4 v[192:195], v2, s[12:15], s25 offen offset:2048 sc1
    s_waitcnt vmcnt(13) lgkmcnt(3)
    v_mfma_f32_32x32x16_bf16 v[64:79], v[144:147], v[204:207], v[64:79]
    s_barrier
    ds_read_b128 v[128:131], v2 offset:49152
    s_waitcnt lgkmcnt(3)
    v_mfma_f32_32x32x16_bf16 v[80:95], v[148:151], v[204:207], v[80:95]
    ds_read_b128 v[132:135], v2 offset:50176
    s_waitcnt lgkmcnt(3)
    v_mfma_f32_32x32x16_bf16 v[96:111], v[152:155], v[204:207], v[96:111]
    ds_read_b128 v[136:139], v2 offset:51200
    s_waitcnt lgkmcnt(3)
    v_mfma_f32_32x32x16_bf16 v[112:127], v[156:159], v[204:207], v[112:127]
    ds_read_b128 v[140:143], v2 offset:52224
    buffer_load_dwordx4 v[196:199], v2, s[12:15], s25 offen offset:3072 sc1
    s_waitcnt vmcnt(11) lgkmcnt(3)
    v_mfma_f32_32x32x16_bf16 v[64:79], v[128:131], v[208:211], v[64:79]
    ds_read_b128 v[144:147], v2 offset:53248
    v_add_f32 v8, v8, v10
    v_add_f32 v9, v9, v11
    s_waitcnt lgkmcnt(3)
    v_mfma_f32_32x32x16_bf16 v[80:95], v[132:135], v[208:211], v[80:95]
    ds_read_b128 v[148:151], v2 offset:54272
    v_add_f32 v12, v12, v14
    v_add_f32 v13, v13, v15
    s_waitcnt lgkmcnt(3)
    v_mfma_f32_32x32x16_bf16 v[96:111], v[136:139], v[208:211], v[96:111]
    ds_read_b128 v[152:155], v2 offset:55296
    v_add_f32 v8, v8, v12
    v_add_f32 v9, v9, v13
    s_waitcnt lgkmcnt(3)
    v_mfma_f32_32x32x16_bf16 v[112:127], v[140:143], v[208:211], v[112:127]
    ds_read_b128 v[156:159], v2 offset:56320
    s_add_u32 s25, s30, 24576
    buffer_load_dwordx4 v[200:203], v2, s[12:15], s25 offen offset:0 sc1
    v_mov_b32 v10, v8
    s_nop 1
    s_waitcnt vmcnt(11) lgkmcnt(3)
    v_mfma_f32_32x32x16_bf16 v[64:79], v[144:147], v[212:215], v[64:79]
    ds_read_b128 v[128:131], v2 offset:57344
    v_permlane32_swap_b32 v8, v10
    v_add_f32 v8, v8, v10
    s_waitcnt lgkmcnt(3)
    v_mfma_f32_32x32x16_bf16 v[80:95], v[148:151], v[212:215], v[80:95]
    ds_read_b128 v[132:135], v2 offset:58368
    v_mov_b32 v11, v9
    s_nop 1
    s_waitcnt lgkmcnt(3)
    v_mfma_f32_32x32x16_bf16 v[96:111], v[152:155], v[212:215], v[96:111]
    ds_read_b128 v[136:139], v2 offset:59392
    v_permlane32_swap_b32 v9, v11
    v_add_f32 v9, v9, v11
    s_waitcnt lgkmcnt(3)
    v_mfma_f32_32x32x16_bf16 v[112:127], v[156:159], v[212:215], v[112:127]
    ds_read_b128 v[140:143], v2 offset:60416
    buffer_load_dwordx4 v[204:207], v2, s[12:15], s25 offen offset:1024 sc1
    v_mul_f32 v8, 0x3acccccd, v8
    v_mul_f32 v9, 0x3acccccd, v9
    s_waitcnt vmcnt(11) lgkmcnt(3)
    v_mfma_f32_32x32x16_bf16 v[64:79], v[128:131], v[160:163], v[64:79]
    ds_read_b128 v[144:147], v2 offset:61440
    v_fma_f32 v9, -v8, v8, v9
    v_max_f32 v9, 0, v9
    s_waitcnt lgkmcnt(3)
    v_mfma_f32_32x32x16_bf16 v[80:95], v[132:135], v[160:163], v[80:95]
    ds_read_b128 v[148:151], v2 offset:62464
    v_add_f32 v10, 0x3727c5ac, v9
    v_rsq_f32 v10, v10
    s_waitcnt lgkmcnt(3)
    v_mfma_f32_32x32x16_bf16 v[96:111], v[136:139], v[160:163], v[96:111]
    ds_read_b128 v[152:155], v2 offset:63488
    s_nop 0
    v_mov_b32 v9, v10
    s_waitcnt lgkmcnt(3)
    v_mfma_f32_32x32x16_bf16 v[112:127], v[140:143], v[160:163], v[112:127]
    ds_read_b128 v[156:159], v2 offset:64512
    buffer_load_dwordx4 v[208:211], v2, s[12:15], s25 offen offset:2048 sc1
    v_mul_f32 v36, s33, v9
    v_mul_f32 v42, -v8, v36
    s_waitcnt vmcnt(11) lgkmcnt(3)
    v_mfma_f32_32x32x16_bf16 v[64:79], v[144:147], v[164:167], v[64:79]
    s_barrier
    ds_read_b128 v[128:131], v3 offset:0
    v_mul_f32 v38, s34, v9
    v_mul_f32 v44, -v8, v38
    s_waitcnt lgkmcnt(3)
    v_mfma_f32_32x32x16_bf16 v[80:95], v[148:151], v[164:167], v[80:95]
    ds_read_b128 v[132:135], v3 offset:1024
    v_mul_f32 v40, s48, v9
    v_mul_f32 v46, -v8, v40
    s_waitcnt lgkmcnt(3)
    v_mfma_f32_32x32x16_bf16 v[96:111], v[152:155], v[164:167], v[96:111]
    ds_read_b128 v[136:139], v3 offset:2048
    v_mul_f32 v216, v42, v216
    v_mul_f32 v217, v42, v217
    s_waitcnt lgkmcnt(3)
    v_mfma_f32_32x32x16_bf16 v[112:127], v[156:159], v[164:167], v[112:127]
    ds_read_b128 v[140:143], v3 offset:3072
    buffer_load_dwordx4 v[212:215], v2, s[12:15], s25 offen offset:3072 sc1
    v_mul_f32 v218, v42, v218
    v_mul_f32 v219, v42, v219
    s_waitcnt vmcnt(11) lgkmcnt(3)
    v_mfma_f32_32x32x16_bf16 v[64:79], v[128:131], v[168:171], v[64:79]
    ds_read_b128 v[144:147], v3 offset:4096
    v_mul_f32 v220, v42, v220
    v_mul_f32 v221, v42, v221
    s_waitcnt lgkmcnt(3)
    v_mfma_f32_32x32x16_bf16 v[80:95], v[132:135], v[168:171], v[80:95]
    ds_read_b128 v[148:151], v3 offset:5120
    v_mul_f32 v222, v42, v222
    v_mul_f32 v223, v42, v223
    s_waitcnt lgkmcnt(3)
    v_mfma_f32_32x32x16_bf16 v[96:111], v[136:139], v[168:171], v[96:111]
    ds_read_b128 v[152:155], v3 offset:6144
    v_mul_f32 v224, v42, v224
    v_mul_f32 v225, v42, v225
    s_waitcnt lgkmcnt(3)
    v_mfma_f32_32x32x16_bf16 v[112:127], v[140:143], v[168:171], v[112:127]
    ds_read_b128 v[156:159], v3 offset:7168
    s_add_u32 s25, s30, 28672
    buffer_load_dwordx4 v[160:163], v2, s[12:15], s25 offen offset:0 sc1
    v_mul_f32 v226, v42, v226
    v_mul_f32 v227, v42, v227
    s_waitcnt vmcnt(11) lgkmcnt(3)
    v_mfma_f32_32x32x16_bf16 v[64:79], v[144:147], v[172:175], v[64:79]
    ds_read_b128 v[128:131], v3 offset:8192
    v_mul_f32 v228, v42, v228
    v_mul_f32 v229, v42, v229
    s_waitcnt lgkmcnt(3)
    v_mfma_f32_32x32x16_bf16 v[80:95], v[148:151], v[172:175], v[80:95]
    ds_read_b128 v[132:135], v3 offset:9216
    v_mul_f32 v230, v42, v230
    v_mul_f32 v231, v42, v231
    s_waitcnt lgkmcnt(3)
    v_mfma_f32_32x32x16_bf16 v[96:111], v[152:155], v[172:175], v[96:111]
    ds_read_b128 v[136:139], v3 offset:10240
    v_mul_f32 v232, v44, v232
    v_mul_f32 v233, v44, v233
    s_waitcnt lgkmcnt(3)
    v_mfma_f32_32x32x16_bf16 v[112:127], v[156:159], v[172:175], v[112:127]
    ds_read_b128 v[140:143], v3 offset:11264
    buffer_load_dwordx4 v[164:167], v2, s[12:15], s25 offen offset:1024 sc1
    v_mul_f32 v234, v44, v234
    v_mul_f32 v235, v44, v235
    s_waitcnt vmcnt(11) lgkmcnt(3)
    v_mfma_f32_32x32x16_bf16 v[64:79], v[128:131], v[176:179], v[64:79]
    ds_read_b128 v[144:147], v3 offset:12288
    v_mul_f32 v236, v44, v236
    v_mul_f32 v237, v44, v237
    s_waitcnt lgkmcnt(3)
    v_mfma_f32_32x32x16_bf16 v[80:95], v[132:135], v[176:179], v[80:95]
    ds_read_b128 v[148:151], v3 offset:13312
    v_mul_f32 v238, v44, v238
    v_mul_f32 v239, v44, v239
    s_waitcnt lgkmcnt(3)
    v_mfma_f32_32x32x16_bf16 v[96:111], v[136:139], v[176:179], v[96:111]
    ds_read_b128 v[152:155], v3 offset:14336
    v_mul_f32 v240, v44, v240
    v_mul_f32 v241, v44, v241
    s_waitcnt lgkmcnt(3)
    v_mfma_f32_32x32x16_bf16 v[112:127], v[140:143], v[176:179], v[112:127]
    ds_read_b128 v[156:159], v3 offset:15360
    buffer_load_dwordx4 v[168:171], v2, s[12:15], s25 offen offset:2048 sc1
    v_mul_f32 v242, v44, v242
    v_mul_f32 v243, v44, v243
    s_waitcnt vmcnt(11) lgkmcnt(3)
    v_mfma_f32_32x32x16_bf16 v[64:79], v[144:147], v[180:183], v[64:79]
    s_barrier
    ds_read_b128 v[128:131], v3 offset:16384
    v_mul_f32 v244, v44, v244
    v_mul_f32 v245, v44, v245
    s_waitcnt lgkmcnt(3)
    v_mfma_f32_32x32x16_bf16 v[80:95], v[148:151], v[180:183], v[80:95]
    ds_read_b128 v[132:135], v3 offset:17408
    v_mul_f32 v246, v44, v246
    v_mul_f32 v247, v44, v247
    s_waitcnt lgkmcnt(3)
    v_mfma_f32_32x32x16_bf16 v[96:111], v[152:155], v[180:183], v[96:111]
    ds_read_b128 v[136:139], v3 offset:18432
    v_mul_f32 v248, v46, v248
    v_mul_f32 v249, v46, v249
    s_waitcnt lgkmcnt(3)
    v_mfma_f32_32x32x16_bf16 v[112:127], v[156:159], v[180:183], v[112:127]
    ds_read_b128 v[140:143], v3 offset:19456
    buffer_load_dwordx4 v[172:175], v2, s[12:15], s25 offen offset:3072 sc1
    v_mul_f32 v250, v46, v250
    v_mul_f32 v251, v46, v251
    s_waitcnt vmcnt(11) lgkmcnt(3)
    v_mfma_f32_32x32x16_bf16 v[64:79], v[128:131], v[184:187], v[64:79]
    ds_read_b128 v[144:147], v3 offset:20480
    v_mul_f32 v252, v46, v252
    v_mul_f32 v253, v46, v253
    s_waitcnt lgkmcnt(3)
    v_mfma_f32_32x32x16_bf16 v[80:95], v[132:135], v[184:187], v[80:95]
    ds_read_b128 v[148:151], v3 offset:21504
    v_mul_f32 v254, v46, v254
    v_mul_f32 v255, v46, v255
    s_waitcnt lgkmcnt(3)
    v_mfma_f32_32x32x16_bf16 v[96:111], v[136:139], v[184:187], v[96:111]
    ds_read_b128 v[152:155], v3 offset:22528
    v_mul_f32 v48, v46, v48
    v_mul_f32 v49, v46, v49
    s_waitcnt lgkmcnt(3)
    v_mfma_f32_32x32x16_bf16 v[112:127], v[140:143], v[184:187], v[112:127]
    ds_read_b128 v[156:159], v3 offset:23552
    s_add_u32 s25, s30, 32768
    buffer_load_dwordx4 v[176:179], v2, s[12:15], s25 offen offset:0 sc1
    v_mul_f32 v50, v46, v50
    v_mul_f32 v51, v46, v51
    s_waitcnt vmcnt(11) lgkmcnt(3)
    v_mfma_f32_32x32x16_bf16 v[64:79], v[144:147], v[188:191], v[64:79]
    ds_read_b128 v[128:131], v3 offset:24576
    v_mul_f32 v52, v46, v52
    v_mul_f32 v53, v46, v53
    s_waitcnt lgkmcnt(3)
    v_mfma_f32_32x32x16_bf16 v[80:95], v[148:151], v[188:191], v[80:95]
    ds_read_b128 v[132:135], v3 offset:25600
    v_mul_f32 v54, v46, v54
    v_mul_f32 v55, v46, v55
    s_waitcnt lgkmcnt(3)
    v_mfma_f32_32x32x16_bf16 v[96:111], v[152:155], v[188:191], v[96:111]
    ds_read_b128 v[136:139], v3 offset:26624
    v_mul_f32 v56, v42, v56
    v_mul_f32 v57, v42, v57
    s_waitcnt lgkmcnt(3)
    v_mfma_f32_32x32x16_bf16 v[112:127], v[156:159], v[188:191], v[112:127]
    ds_read_b128 v[140:143], v3 offset:27648
    buffer_load_dwordx4 v[180:183], v2, s[12:15], s25 offen offset:1024 sc1
    v_mul_f32 v58, v42, v58
    v_mul_f32 v59, v42, v59
    s_waitcnt vmcnt(11) lgkmcnt(3)
    v_mfma_f32_32x32x16_bf16 v[64:79], v[128:131], v[192:195], v[64:79]
    ds_read_b128 v[144:147], v3 offset:28672
    v_mul_f32 v60, v44, v60
    v_mul_f32 v61, v44, v61
    s_waitcnt lgkmcnt(3)
    v_mfma_f32_32x32x16_bf16 v[80:95], v[132:135], v[192:195], v[80:95]
    ds_read_b128 v[148:151], v3 offset:29696
    v_mul_f32 v62, v44, v62
    v_mul_f32 v63, v44, v63
    s_waitcnt lgkmcnt(3)
    v_mfma_f32_32x32x16_bf16 v[96:111], v[136:139], v[192:195], v[96:111]
    ds_read_b128 v[152:155], v3 offset:30720
    v_mul_f32 v24, v46, v24
    v_mul_f32 v25, v46, v25
    s_waitcnt lgkmcnt(3)
    v_mfma_f32_32x32x16_bf16 v[112:127], v[140:143], v[192:195], v[112:127]
    ds_read_b128 v[156:159], v3 offset:31744
    buffer_load_dwordx4 v[184:187], v2, s[12:15], s25 offen offset:2048 sc1
    v_mul_f32 v26, v46, v26
    v_mul_f32 v27, v46, v27
    s_waitcnt vmcnt(11) lgkmcnt(3)
    v_mfma_f32_32x32x16_bf16 v[64:79], v[144:147], v[196:199], v[64:79]
    s_barrier
    ds_read_b128 v[128:131], v3 offset:57344
    s_waitcnt lgkmcnt(3)
    v_mfma_f32_32x32x16_bf16 v[80:95], v[148:151], v[196:199], v[80:95]
    ds_read_b128 v[132:135], v3 offset:58368
    s_waitcnt lgkmcnt(3)
    v_mfma_f32_32x32x16_bf16 v[96:111], v[152:155], v[196:199], v[96:111]
    ds_read_b128 v[136:139], v3 offset:59392
    s_waitcnt lgkmcnt(3)
    v_mfma_f32_32x32x16_bf16 v[112:127], v[156:159], v[196:199], v[112:127]
    ds_read_b128 v[140:143], v3 offset:60416
    buffer_load_dwordx4 v[188:191], v2, s[12:15], s25 offen offset:3072 sc1
    s_waitcnt vmcnt(11) lgkmcnt(3)
    v_mfma_f32_32x32x16_bf16 v[64:79], v[128:131], v[200:203], v[64:79]
    ds_read_b128 v[144:147], v3 offset:61440
    s_waitcnt lgkmcnt(3)
    v_mfma_f32_32x32x16_bf16 v[80:95], v[132:135], v[200:203], v[80:95]
    ds_read_b128 v[148:151], v3 offset:62464
    s_waitcnt lgkmcnt(3)
    v_mfma_f32_32x32x16_bf16 v[96:111], v[136:139], v[200:203], v[96:111]
    ds_read_b128 v[152:155], v3 offset:63488
    s_waitcnt lgkmcnt(3)
    v_mfma_f32_32x32x16_bf16 v[112:127], v[140:143], v[200:203], v[112:127]
    ds_read_b128 v[156:159], v3 offset:64512
    s_add_u32 s25, s30, 36864
    buffer_load_dwordx4 v[192:195], v2, s[12:15], s25 offen offset:0 sc1
    s_waitcnt vmcnt(11) lgkmcnt(3)
    v_mfma_f32_32x32x16_bf16 v[64:79], v[144:147], v[204:207], v[64:79]
    ds_read_b128 v[128:131], v4 offset:0
    s_waitcnt lgkmcnt(3)
    v_mfma_f32_32x32x16_bf16 v[80:95], v[148:151], v[204:207], v[80:95]
    ds_read_b128 v[132:135], v4 offset:1024
    s_waitcnt lgkmcnt(3)
    v_mfma_f32_32x32x16_bf16 v[96:111], v[152:155], v[204:207], v[96:111]
    ds_read_b128 v[136:139], v4 offset:2048
    s_waitcnt lgkmcnt(3)
    v_mfma_f32_32x32x16_bf16 v[112:127], v[156:159], v[204:207], v[112:127]
    ds_read_b128 v[140:143], v4 offset:3072
    buffer_load_dwordx4 v[196:199], v2, s[12:15], s25 offen offset:1024 sc1
    s_waitcnt vmcnt(11) lgkmcnt(3)
    v_mfma_f32_32x32x16_bf16 v[64:79], v[128:131], v[208:211], v[64:79]
    ds_read_b128 v[144:147], v4 offset:4096
    s_waitcnt lgkmcnt(3)
    v_mfma_f32_32x32x16_bf16 v[80:95], v[132:135], v[208:211], v[80:95]
    ds_read_b128 v[148:151], v4 offset:5120
    s_waitcnt lgkmcnt(3)
    v_mfma_f32_32x32x16_bf16 v[96:111], v[136:139], v[208:211], v[96:111]
    ds_read_b128 v[152:155], v4 offset:6144
    s_waitcnt lgkmcnt(3)
    v_mfma_f32_32x32x16_bf16 v[112:127], v[140:143], v[208:211], v[112:127]
    ds_read_b128 v[156:159], v4 offset:7168
    buffer_load_dwordx4 v[200:203], v2, s[12:15], s25 offen offset:2048 sc1
    s_waitcnt vmcnt(11) lgkmcnt(3)
    v_mfma_f32_32x32x16_bf16 v[64:79], v[144:147], v[212:215], v[64:79]
    s_barrier
    ds_read_b128 v[128:131], v4 offset:8192
    s_waitcnt lgkmcnt(3)
    v_mfma_f32_32x32x16_bf16 v[80:95], v[148:151], v[212:215], v[80:95]
    ds_read_b128 v[132:135], v4 offset:9216
    s_waitcnt lgkmcnt(3)
    v_mfma_f32_32x32x16_bf16 v[96:111], v[152:155], v[212:215], v[96:111]
    ds_read_b128 v[136:139], v4 offset:10240
    s_waitcnt lgkmcnt(3)
    v_mfma_f32_32x32x16_bf16 v[112:127], v[156:159], v[212:215], v[112:127]
    ds_read_b128 v[140:143], v4 offset:11264
    buffer_load_dwordx4 v[204:207], v2, s[12:15], s25 offen offset:3072 sc1
    s_waitcnt vmcnt(11) lgkmcnt(3)
    v_mfma_f32_32x32x16_bf16 v[64:79], v[128:131], v[160:163], v[64:79]
    ds_read_b128 v[144:147], v4 offset:12288
    s_waitcnt lgkmcnt(3)
    v_mfma_f32_32x32x16_bf16 v[80:95], v[132:135], v[160:163], v[80:95]
    ds_read_b128 v[148:151], v4 offset:13312
    s_waitcnt lgkmcnt(3)
    v_mfma_f32_32x32x16_bf16 v[96:111], v[136:139], v[160:163], v[96:111]
    ds_read_b128 v[152:155], v4 offset:14336
    s_waitcnt lgkmcnt(3)
    v_mfma_f32_32x32x16_bf16 v[112:127], v[140:143], v[160:163], v[112:127]
    ds_read_b128 v[156:159], v4 offset:15360
    s_waitcnt vmcnt(10) lgkmcnt(3)
    v_mfma_f32_32x32x16_bf16 v[64:79], v[144:147], v[164:167], v[64:79]
    ds_read_b128 v[128:131], v4 offset:16384
    s_waitcnt lgkmcnt(3)
    v_mfma_f32_32x32x16_bf16 v[80:95], v[148:151], v[164:167], v[80:95]
    ds_read_b128 v[132:135], v4 offset:17408
    s_waitcnt lgkmcnt(3)
    v_mfma_f32_32x32x16_bf16 v[96:111], v[152:155], v[164:167], v[96:111]
    ds_read_b128 v[136:139], v4 offset:18432
    s_waitcnt lgkmcnt(3)
    v_mfma_f32_32x32x16_bf16 v[112:127], v[156:159], v[164:167], v[112:127]
    ds_read_b128 v[140:143], v4 offset:19456
    s_waitcnt vmcnt(9) lgkmcnt(3)
    v_mfma_f32_32x32x16_bf16 v[64:79], v[128:131], v[168:171], v[64:79]
    ds_read_b128 v[144:147], v4 offset:20480
    s_waitcnt lgkmcnt(3)
    v_mfma_f32_32x32x16_bf16 v[80:95], v[132:135], v[168:171], v[80:95]
    ds_read_b128 v[148:151], v4 offset:21504
    s_waitcnt lgkmcnt(3)
    v_mfma_f32_32x32x16_bf16 v[96:111], v[136:139], v[168:171], v[96:111]
    ds_read_b128 v[152:155], v4 offset:22528
    s_waitcnt lgkmcnt(3)
    v_mfma_f32_32x32x16_bf16 v[112:127], v[140:143], v[168:171], v[112:127]
    ds_read_b128 v[156:159], v4 offset:23552
    s_waitcnt vmcnt(8) lgkmcnt(3)
    v_mfma_f32_32x32x16_bf16 v[64:79], v[144:147], v[172:175], v[64:79]
    s_barrier
    ds_read_b128 v[128:131], v3 offset:36864
    s_waitcnt lgkmcnt(3)
    v_mfma_f32_32x32x16_bf16 v[80:95], v[148:151], v[172:175], v[80:95]
    ds_read_b128 v[132:135], v3 offset:37888
    s_waitcnt lgkmcnt(3)
    v_mfma_f32_32x32x16_bf16 v[96:111], v[152:155], v[172:175], v[96:111]
    ds_read_b128 v[136:139], v3 offset:38912
    s_waitcnt lgkmcnt(3)
    v_mfma_f32_32x32x16_bf16 v[112:127], v[156:159], v[172:175], v[112:127]
    ds_read_b128 v[140:143], v3 offset:39936
    s_waitcnt vmcnt(7) lgkmcnt(3)
    v_mfma_f32_32x32x16_bf16 v[64:79], v[128:131], v[176:179], v[64:79]
    ds_read_b128 v[144:147], v3 offset:40960
    s_waitcnt lgkmcnt(3)
    v_mfma_f32_32x32x16_bf16 v[80:95], v[132:135], v[176:179], v[80:95]
    ds_read_b128 v[148:151], v3 offset:41984
    s_waitcnt lgkmcnt(3)
    v_mfma_f32_32x32x16_bf16 v[96:111], v[136:139], v[176:179], v[96:111]
    ds_read_b128 v[152:155], v3 offset:43008
    s_waitcnt lgkmcnt(3)
    v_mfma_f32_32x32x16_bf16 v[112:127], v[140:143], v[176:179], v[112:127]
    ds_read_b128 v[156:159], v3 offset:44032
    s_waitcnt vmcnt(6) lgkmcnt(3)
    v_mfma_f32_32x32x16_bf16 v[64:79], v[144:147], v[180:183], v[64:79]
    ds_read_b128 v[128:131], v3 offset:45056
    s_waitcnt lgkmcnt(3)
    v_mfma_f32_32x32x16_bf16 v[80:95], v[148:151], v[180:183], v[80:95]
    ds_read_b128 v[132:135], v3 offset:46080
    s_waitcnt lgkmcnt(3)
    v_mfma_f32_32x32x16_bf16 v[96:111], v[152:155], v[180:183], v[96:111]
    ds_read_b128 v[136:139], v3 offset:47104
    s_waitcnt lgkmcnt(3)
    v_mfma_f32_32x32x16_bf16 v[112:127], v[156:159], v[180:183], v[112:127]
    ds_read_b128 v[140:143], v3 offset:48128
    s_waitcnt vmcnt(5) lgkmcnt(3)
    v_mfma_f32_32x32x16_bf16 v[64:79], v[128:131], v[184:187], v[64:79]
    ds_read_b128 v[144:147], v3 offset:49152
    s_waitcnt lgkmcnt(3)
    v_mfma_f32_32x32x16_bf16 v[80:95], v[132:135], v[184:187], v[80:95]
    ds_read_b128 v[148:151], v3 offset:50176
    s_waitcnt lgkmcnt(3)
    v_mfma_f32_32x32x16_bf16 v[96:111], v[136:139], v[184:187], v[96:111]
    ds_read_b128 v[152:155], v3 offset:51200
    s_waitcnt lgkmcnt(3)
    v_mfma_f32_32x32x16_bf16 v[112:127], v[140:143], v[184:187], v[112:127]
    ds_read_b128 v[156:159], v3 offset:52224
    s_waitcnt vmcnt(4) lgkmcnt(3)
    v_mfma_f32_32x32x16_bf16 v[64:79], v[144:147], v[188:191], v[64:79]
    s_barrier
    ds_read_b128 v[128:131], v2 offset:0
    s_waitcnt lgkmcnt(3)
    v_mfma_f32_32x32x16_bf16 v[80:95], v[148:151], v[188:191], v[80:95]
    ds_read_b128 v[132:135], v2 offset:1024
    s_waitcnt lgkmcnt(3)
    v_mfma_f32_32x32x16_bf16 v[96:111], v[152:155], v[188:191], v[96:111]
    ds_read_b128 v[136:139], v2 offset:2048
    s_waitcnt lgkmcnt(3)
    v_mfma_f32_32x32x16_bf16 v[112:127], v[156:159], v[188:191], v[112:127]
    ds_read_b128 v[140:143], v2 offset:3072
    s_waitcnt vmcnt(3) lgkmcnt(3)
    v_mfma_f32_32x32x16_bf16 v[64:79], v[128:131], v[192:195], v[64:79]
    ds_read_b128 v[144:147], v2 offset:4096
    s_waitcnt lgkmcnt(3)
    v_mfma_f32_32x32x16_bf16 v[80:95], v[132:135], v[192:195], v[80:95]
    ds_read_b128 v[148:151], v2 offset:5120
    s_waitcnt lgkmcnt(3)
    v_mfma_f32_32x32x16_bf16 v[96:111], v[136:139], v[192:195], v[96:111]
    ds_read_b128 v[152:155], v2 offset:6144
    s_waitcnt lgkmcnt(3)
    v_mfma_f32_32x32x16_bf16 v[112:127], v[140:143], v[192:195], v[112:127]
    ds_read_b128 v[156:159], v2 offset:7168
    s_waitcnt vmcnt(2) lgkmcnt(3)
    v_mfma_f32_32x32x16_bf16 v[64:79], v[144:147], v[196:199], v[64:79]
    ds_read_b128 v[128:131], v2 offset:8192
    s_waitcnt lgkmcnt(3)
    v_mfma_f32_32x32x16_bf16 v[80:95], v[148:151], v[196:199], v[80:95]
    ds_read_b128 v[132:135], v2 offset:9216
    s_waitcnt lgkmcnt(3)
    v_mfma_f32_32x32x16_bf16 v[96:111], v[152:155], v[196:199], v[96:111]
    ds_read_b128 v[136:139], v2 offset:10240
    s_waitcnt lgkmcnt(3)
    v_mfma_f32_32x32x16_bf16 v[112:127], v[156:159], v[196:199], v[112:127]
    ds_read_b128 v[140:143], v2 offset:11264
    s_waitcnt vmcnt(1) lgkmcnt(3)
    v_mfma_f32_32x32x16_bf16 v[64:79], v[128:131], v[200:203], v[64:79]
    ds_read_b128 v[144:147], v2 offset:12288
    s_waitcnt lgkmcnt(3)
    v_mfma_f32_32x32x16_bf16 v[80:95], v[132:135], v[200:203], v[80:95]
    ds_read_b128 v[148:151], v2 offset:13312
    s_waitcnt lgkmcnt(3)
    v_mfma_f32_32x32x16_bf16 v[96:111], v[136:139], v[200:203], v[96:111]
    ds_read_b128 v[152:155], v2 offset:14336
    s_waitcnt lgkmcnt(3)
    v_mfma_f32_32x32x16_bf16 v[112:127], v[140:143], v[200:203], v[112:127]
    ds_read_b128 v[156:159], v2 offset:15360
    s_waitcnt vmcnt(0) lgkmcnt(3)
    v_mfma_f32_32x32x16_bf16 v[64:79], v[144:147], v[204:207], v[64:79]
    s_waitcnt lgkmcnt(2)
    v_mfma_f32_32x32x16_bf16 v[80:95], v[148:151], v[204:207], v[80:95]
    s_waitcnt lgkmcnt(1)
    v_mfma_f32_32x32x16_bf16 v[96:111], v[152:155], v[204:207], v[96:111]
    s_waitcnt lgkmcnt(0)
    v_mfma_f32_32x32x16_bf16 v[112:127], v[156:159], v[204:207], v[112:127]
    s_nop 7
    v_pk_fma_f32 v[64:65], v[64:65], v[36:37], v[216:217] op_sel_hi:[1,0,1]
    v_pk_fma_f32 v[66:67], v[66:67], v[36:37], v[218:219] op_sel_hi:[1,0,1]
    v_cvt_pk_bf16_f32 v64, v64, v65
    v_cvt_pk_bf16_f32 v65, v66, v67
    v_pk_fma_f32 v[68:69], v[68:69], v[36:37], v[220:221] op_sel_hi:[1,0,1]
    v_pk_fma_f32 v[70:71], v[70:71], v[36:37], v[222:223] op_sel_hi:[1,0,1]
    v_cvt_pk_bf16_f32 v66, v68, v69
    v_cvt_pk_bf16_f32 v67, v70, v71
    buffer_store_dwordx4 v[64:67], v32, s[4:7], s39 offen sc1
    v_pk_fma_f32 v[72:73], v[72:73], v[36:37], v[224:225] op_sel_hi:[1,0,1]
    v_pk_fma_f32 v[74:75], v[74:75], v[36:37], v[226:227] op_sel_hi:[1,0,1]
    v_cvt_pk_bf16_f32 v72, v72, v73
    v_cvt_pk_bf16_f32 v73, v74, v75
    v_pk_fma_f32 v[76:77], v[76:77], v[36:37], v[228:229] op_sel_hi:[1,0,1]
    v_pk_fma_f32 v[78:79], v[78:79], v[36:37], v[230:231] op_sel_hi:[1,0,1]
    v_cvt_pk_bf16_f32 v74, v76, v77
    v_cvt_pk_bf16_f32 v75, v78, v79
    buffer_store_dwordx4 v[72:75], v32, s[4:7], s40 offen sc1
    v_pk_fma_f32 v[80:81], v[80:81], v[38:39], v[232:233] op_sel_hi:[1,0,1]
    v_pk_fma_f32 v[82:83], v[82:83], v[38:39], v[234:235] op_sel_hi:[1,0,1]
    v_cvt_pk_bf16_f32 v80, v80, v81
    v_cvt_pk_bf16_f32 v81, v82, v83
    v_pk_fma_f32 v[84:85], v[84:85], v[38:39], v[236:237] op_sel_hi:[1,0,1]
    v_pk_fma_f32 v[86:87], v[86:87], v[38:39], v[238:239] op_sel_hi:[1,0,1]
    v_cvt_pk_bf16_f32 v82, v84, v85
    v_cvt_pk_bf16_f32 v83, v86, v87
    buffer_store_dwordx4 v[80:83], v32, s[4:7], s42 offen sc1
    v_pk_fma_f32 v[88:89], v[88:89], v[38:39], v[240:241] op_sel_hi:[1,0,1]
    v_pk_fma_f32 v[90:91], v[90:91], v[38:39], v[242:243] op_sel_hi:[1,0,1]
    v_cvt_pk_bf16_f32 v88, v88, v89
    v_cvt_pk_bf16_f32 v89, v90, v91
    v_pk_fma_f32 v[92:93], v[92:93], v[38:39], v[244:245] op_sel_hi:[1,0,1]
    v_pk_fma_f32 v[94:95], v[94:95], v[38:39], v[246:247] op_sel_hi:[1,0,1]
    v_cvt_pk_bf16_f32 v90, v92, v93
    v_cvt_pk_bf16_f32 v91, v94, v95
    buffer_store_dwordx4 v[88:91], v32, s[4:7], s43 offen sc1
    v_pk_fma_f32 v[96:97], v[96:97], v[40:41], v[248:249] op_sel_hi:[1,0,1]
    v_pk_fma_f32 v[98:99], v[98:99], v[40:41], v[250:251] op_sel_hi:[1,0,1]
    v_cvt_pk_bf16_f32 v96, v96, v97
    v_cvt_pk_bf16_f32 v97, v98, v99
    v_pk_fma_f32 v[100:101], v[100:101], v[40:41], v[252:253] op_sel_hi:[1,0,1]
    v_pk_fma_f32 v[102:103], v[102:103], v[40:41], v[254:255] op_sel_hi:[1,0,1]
    v_cvt_pk_bf16_f32 v98, v100, v101
    v_cvt_pk_bf16_f32 v99, v102, v103
    buffer_store_dwordx4 v[96:99], v32, s[4:7], s45 offen sc1
    v_pk_fma_f32 v[104:105], v[104:105], v[40:41], v[48:49] op_sel_hi:[1,0,1]
    v_pk_fma_f32 v[106:107], v[106:107], v[40:41], v[50:51] op_sel_hi:[1,0,1]
    v_cvt_pk_bf16_f32 v104, v104, v105
    v_cvt_pk_bf16_f32 v105, v106, v107
    v_pk_fma_f32 v[108:109], v[108:109], v[40:41], v[52:53] op_sel_hi:[1,0,1]
    v_pk_fma_f32 v[110:111], v[110:111], v[40:41], v[54:55] op_sel_hi:[1,0,1]
    v_cvt_pk_bf16_f32 v106, v108, v109
    v_cvt_pk_bf16_f32 v107, v110, v111
    buffer_store_dwordx4 v[104:107], v32, s[4:7], s46 offen sc1
    v_pk_fma_f32 v[112:113], v[112:113], v[36:37], v[56:57] op_sel_hi:[1,0,1]
    v_pk_fma_f32 v[114:115], v[114:115], v[36:37], v[58:59] op_sel_hi:[1,0,1]
    v_cvt_pk_bf16_f32 v112, v112, v113
    v_cvt_pk_bf16_f32 v113, v114, v115
    buffer_store_dwordx2 v[112:113], v33, s[4:7], s41 offen sc1
    v_pk_fma_f32 v[116:117], v[116:117], v[38:39], v[60:61] op_sel_hi:[1,0,1]
    v_pk_fma_f32 v[118:119], v[118:119], v[38:39], v[62:63] op_sel_hi:[1,0,1]
    v_cvt_pk_bf16_f32 v116, v116, v117
    v_cvt_pk_bf16_f32 v117, v118, v119
    buffer_store_dwordx2 v[116:117], v34, s[4:7], s44 offen sc1
    v_pk_fma_f32 v[120:121], v[120:121], v[40:41], v[24:25] op_sel_hi:[1,0,1]
    v_pk_fma_f32 v[122:123], v[122:123], v[40:41], v[26:27] op_sel_hi:[1,0,1]
    v_cvt_pk_bf16_f32 v120, v120, v121
    v_cvt_pk_bf16_f32 v121, v122, v123
    buffer_store_dwordx2 v[120:121], v35, s[4:7], s47 offen sc1
    s_branch L_next
L_vpath_70:
    v_lshlrev_b32 v16, 2, v5
    v_add_u32 v23, 156672, v16
    s_sub_u32 s35, s27, 11
    s_lshl_b32 s46, s35, 7
    s_mul_i32 s42, s33, 5120
    s_mul_i32 s43, s34, 1280
    s_add_u32 s42, s42, s43
    s_add_u32 s42, s42, s32
    s_add_u32 s42, s42, 2560
    s_mov_b32 s47, 52429
    s_movk_i32 s36, 10240
    v_mul_u32_u24 v17, 320, v6
    s_add_u32 s48, s46, 0
    v_add_u32 v20, s48, v5
    v_mul_u32_u24 v21, s47, v20
    v_lshrrev_b32 v21, 20, v21
    v_mul_u32_u24 v22, 20, v21
    v_sub_u32 v22, v20, v22
    v_mul_u32_u24 v21, s36, v21
    v_lshl_add_u32 v21, v22, 4, v21
    v_add_u32 v32, v21, v17
    s_add_u32 s48, s46, 32
    v_add_u32 v20, s48, v5
    v_mul_u32_u24 v21, s47, v20
    v_lshrrev_b32 v21, 20, v21
    v_mul_u32_u24 v22, 20, v21
    v_sub_u32 v22, v20, v22
    v_mul_u32_u24 v21, s36, v21
    v_lshl_add_u32 v21, v22, 4, v21
    v_add_u32 v33, v21, v17
    s_add_u32 s48, s46, 64
    v_add_u32 v20, s48, v5
    v_mul_u32_u24 v21, s47, v20
    v_lshrrev_b32 v21, 20, v21
    v_mul_u32_u24 v22, 20, v21
    v_sub_u32 v22, v20, v22
    v_mul_u32_u24 v21, s36, v21
    v_lshl_add_u32 v21, v22, 4, v21
    v_add_u32 v34, v21, v17
    s_add_u32 s48, s46, 96
    v_add_u32 v20, s48, v5
    v_mul_u32_u24 v21, s47, v20
    v_lshrrev_b32 v21, 20, v21
    v_mul_u32_u24 v22, 20, v21
    v_sub_u32 v22, v20, v22
    v_mul_u32_u24 v21, s36, v21
    v_lshl_add_u32 v21, v22, 4, v21
    v_add_u32 v35, v21, v17
    s_lshl_b32 s49, s20, 8
    s_add_u32 s49, s49, 155648
    v_add_u32 v18, s49, v16
    v_lshlrev_b32 v19, 4, v6
    v_add_u32 v19, s49, v19
    s_lshl_b32 s100, s21, 3
    s_add_u32 s100, s100, s26
    s_lshl_b32 s100, s100, 6
    s_add_u32 s100, s100, s52
    s_add_u32 s100, s100, 28672
    s_lshl_b32 s23, s101, 2
    s_add_u32 s100, s100, s23
    v_mov_b32 v8, 0
    v_mov_b32 v9, 1
    s_cmp_eq_u32 s54, 0
    s_mov_b64 exec, 1
    s_waitcnt vmcnt(0)
    s_cbranch_scc1 L_sigimp_76
    buffer_store_dword v9, v8, s[4:7], s100 offen
L_sigback_77:
    s_mov_b64 exec, -1
    s_lshl_b32 s22, s21, 3
    s_add_u32 s22, s22, s28
    s_lshl_b32 s22, s22, 6
    s_add_u32 s22, s22, s52
    s_add_u32 s22, s22, 28672
    s_mov_b32 s23, 200000
    v_lshlrev_b32 v9, 2, v0
    s_cmp_eq_u32 s54, 0
    s_cbranch_scc1 L_pollimp_80
    s_mov_b64 exec, 0xffff
L_poll_78:
    buffer_load_dword v10, v9, s[4:7], s22 offen sc1
    s_sub_u32 s23, s23, 1
    s_cbranch_scc1 L_polled_79
    s_waitcnt vmcnt(0)
    v_cmp_ne_u32 vcc, 1, v10
    s_cbranch_vccnz L_poll_78
L_polled_79:
    s_waitcnt lgkmcnt(0)
    s_mov_b64 exec, -1
    s_setprio 3
    s_add_u32 s25, s30, 0
    buffer_load_dwordx4 v[160:163], v2, s[12:15], s25 offen offset:0 sc1
    buffer_load_dwordx4 v[164:167], v2, s[12:15], s25 offen offset:1024 sc1
    s_setprio 2
    buffer_load_dwordx4 v[168:171], v2, s[12:15], s25 offen offset:2048 sc1
    buffer_load_dwordx4 v[172:175], v2, s[12:15], s25 offen offset:3072 sc1
    s_setprio 1
    s_add_u32 s25, s30, 4096
    buffer_load_dwordx4 v[176:179], v2, s[12:15], s25 offen offset:0 sc1
    buffer_load_dwordx4 v[180:183], v2, s[12:15], s25 offen offset:1024 sc1
    buffer_load_dwordx4 v[184:187], v2, s[12:15], s25 offen offset:2048 sc1
    s_setprio 0
    buffer_load_dwordx4 v[188:191], v2, s[12:15], s25 offen offset:3072 sc1
    s_add_u32 s25, s30, 8192
    buffer_load_dwordx4 v[192:195], v2, s[12:15], s25 offen offset:0 sc1
    buffer_load_dwordx4 v[196:199], v2, s[12:15], s25 offen offset:1024 sc1
    buffer_load_dwordx4 v[200:203], v2, s[12:15], s25 offen offset:2048 sc1
    buffer_load_dwordx4 v[204:207], v2, s[12:15], s25 offen offset:3072 sc1
    s_setprio 0
    buffer_load_dwordx4 v[8:11], v7, s[4:7], s31 offen sc1
    buffer_load_dwordx4 v[12:15], v7, s[4:7], s31 offen offset:16 sc1
    s_barrier
    ds_read_b128 v[128:131], v2 offset:0
    ds_read_b128 v[132:135], v2 offset:1024
    ds_read_b128 v[136:139], v2 offset:2048
    ds_read_b128 v[140:143], v2 offset:3072
    s_waitcnt vmcnt(13) lgkmcnt(3)
    v_mfma_f32_32x32x16_bf16 v[64:79], v[160:163], v[128:131], 0
    ds_read_b128 v[144:147], v2 offset:4096
    s_waitcnt lgkmcnt(3)
    v_mfma_f32_32x32x16_bf16 v[80:95], v[160:163], v[132:135], 0
    ds_read_b128 v[148:151], v2 offset:5120
    s_waitcnt lgkmcnt(3)
    v_mfma_f32_32x32x16_bf16 v[96:111], v[160:163], v[136:139], 0
    ds_read_b128 v[152:155], v2 offset:6144
    s_waitcnt lgkmcnt(3)
    v_mfma_f32_32x32x16_bf16 v[112:127], v[160:163], v[140:143], 0
    ds_read_b128 v[156:159], v2 offset:7168
    s_add_u32 s25, s30, 12288
    buffer_load_dwordx4 v[208:211], v2, s[12:15], s25 offen offset:0 sc1
    s_waitcnt vmcnt(13) lgkmcnt(3)
    v_mfma_f32_32x32x16_bf16 v[64:79], v[164:167], v[144:147], v[64:79]
    ds_read_b128 v[128:131], v2 offset:8192
    ds_read_b32 v40, v23 offset:0
    s_waitcnt lgkmcnt(4)
    v_mfma_f32_32x32x16_bf16 v[80:95], v[164:167], v[148:151], v[80:95]
    ds_read_b128 v[132:135], v2 offset:9216
    ds_read_b32 v42, v23 offset:128
    s_waitcnt lgkmcnt(5)
    v_mfma_f32_32x32x16_bf16 v[96:111], v[164:167], v[152:155], v[96:111]
    ds_read_b128 v[136:139], v2 offset:10240
    ds_read_b32 v44, v23 offset:256
    s_waitcnt lgkmcnt(6)
    v_mfma_f32_32x32x16_bf16 v[112:127], v[164:167], v[156:159], v[112:127]
    ds_read_b128 v[140:143], v2 offset:11264
    buffer_load_dwordx4 v[212:215], v2, s[12:15], s25 offen offset:1024 sc1
    ds_read_b32 v46, v23 offset:384
    s_waitcnt vmcnt(13) lgkmcnt(7)
    v_mfma_f32_32x32x16_bf16 v[64:79], v[168:171], v[128:131], v[64:79]
    ds_read_b128 v[144:147], v2 offset:12288
    s_waitcnt lgkmcnt(6)
    v_mfma_f32_32x32x16_bf16 v[80:95], v[168:171], v[132:135], v[80:95]
    ds_read_b128 v[148:151], v2 offset:13312
    s_waitcnt lgkmcnt(5)
    v_mfma_f32_32x32x16_bf16 v[96:111], v[168:171], v[136:139], v[96:111]
    ds_read_b128 v[152:155], v2 offset:14336
    s_waitcnt lgkmcnt(4)
    v_mfma_f32_32x32x16_bf16 v[112:127], v[168:171], v[140:143], v[112:127]
    ds_read_b128 v[156:159], v2 offset:15360
    buffer_load_dwordx4 v[160:163], v2, s[12:15], s25 offen offset:2048 sc1
    s_waitcnt vmcnt(13) lgkmcnt(3)
    v_mfma_f32_32x32x16_bf16 v[64:79], v[172:175], v[144:147], v[64:79]
    s_barrier
    ds_read_b128 v[128:131], v2 offset:16384
    s_waitcnt lgkmcnt(3)
    v_mfma_f32_32x32x16_bf16 v[80:95], v[172:175], v[148:151], v[80:95]
    ds_read_b128 v[132:135], v2 offset:17408
    s_waitcnt lgkmcnt(3)
    v_mfma_f32_32x32x16_bf16 v[96:111], v[172:175], v[152:155], v[96:111]
    ds_read_b128 v[136:139], v2 offset:18432
    s_waitcnt lgkmcnt(3)
    v_mfma_f32_32x32x16_bf16 v[112:127], v[172:175], v[156:159], v[112:127]
    ds_read_b128 v[140:143], v2 offset:19456
    buffer_load_dwordx4 v[164:167], v2, s[12:15], s25 offen offset:3072 sc1
    s_waitcnt vmcnt(13) lgkmcnt(3)
    v_mfma_f32_32x32x16_bf16 v[64:79], v[176:179], v[128:131], v[64:79]
    ds_read_b128 v[144:147], v2 offset:20480
    s_waitcnt lgkmcnt(3)
    v_mfma_f32_32x32x16_bf16 v[80:95], v[176:179], v[132:135], v[80:95]
    ds_read_b128 v[148:151], v2 offset:21504
    s_waitcnt lgkmcnt(3)
    v_mfma_f32_32x32x16_bf16 v[96:111], v[176:179], v[136:139], v[96:111]
    ds_read_b128 v[152:155], v2 offset:22528
    s_waitcnt lgkmcnt(3)
    v_mfma_f32_32x32x16_bf16 v[112:127], v[176:179], v[140:143], v[112:127]
    ds_read_b128 v[156:159], v2 offset:23552
    s_add_u32 s25, s30, 16384
    buffer_load_dwordx4 v[168:171], v2, s[12:15], s25 offen offset:0 sc1
    s_waitcnt vmcnt(13) lgkmcnt(3)
    v_mfma_f32_32x32x16_bf16 v[64:79], v[180:183], v[144:147], v[64:79]
    ds_read_b128 v[128:131], v2 offset:24576
    s_waitcnt lgkmcnt(3)
    v_mfma_f32_32x32x16_bf16 v[80:95], v[180:183], v[148:151], v[80:95]
    ds_read_b128 v[132:135], v2 offset:25600
    s_waitcnt lgkmcnt(3)
    v_mfma_f32_32x32x16_bf16 v[96:111], v[180:183], v[152:155], v[96:111]
    ds_read_b128 v[136:139], v2 offset:26624
    s_waitcnt lgkmcnt(3)
    v_mfma_f32_32x32x16_bf16 v[112:127], v[180:183], v[156:159], v[112:127]
    ds_read_b128 v[140:143], v2 offset:27648
    buffer_load_dwordx4 v[172:175], v2, s[12:15], s25 offen offset:1024 sc1
    s_waitcnt vmcnt(13) lgkmcnt(3)
    v_mfma_f32_32x32x16_bf16 v[64:79], v[184:187], v[128:131], v[64:79]
    ds_read_b128 v[144:147], v2 offset:28672
    s_waitcnt lgkmcnt(3)
    v_mfma_f32_32x32x16_bf16 v[80:95], v[184:187], v[132:135], v[80:95]
    ds_read_b128 v[148:151], v2 offset:29696
    s_waitcnt lgkmcnt(3)
    v_mfma_f32_32x32x16_bf16 v[96:111], v[184:187], v[136:139], v[96:111]
    ds_read_b128 v[152:155], v2 offset:30720
    s_waitcnt lgkmcnt(3)
    v_mfma_f32_32x32x16_bf16 v[112:127], v[184:187], v[140:143], v[112:127]
    ds_read_b128 v[156:159], v2 offset:31744
    buffer_load_dwordx4 v[176:179], v2, s[12:15], s25 offen offset:2048 sc1
    s_waitcnt vmcnt(13) lgkmcnt(3)
    v_mfma_f32_32x32x16_bf16 v[64:79], v[188:191], v[144:147], v[64:79]
    s_barrier
    ds_read_b128 v[128:131], v2 offset:32768
    s_waitcnt lgkmcnt(3)
    v_mfma_f32_32x32x16_bf16 v[80:95], v[188:191], v[148:151], v[80:95]
    ds_read_b128 v[132:135], v2 offset:33792
    s_waitcnt lgkmcnt(3)
    v_mfma_f32_32x32x16_bf16 v[96:111], v[188:191], v[152:155], v[96:111]
    ds_read_b128 v[136:139], v2 offset:34816
    s_waitcnt lgkmcnt(3)
    v_mfma_f32_32x32x16_bf16 v[112:127], v[188:191], v[156:159], v[112:127]
    ds_read_b128 v[140:143], v2 offset:35840
    buffer_load_dwordx4 v[180:183], v2, s[12:15], s25 offen offset:3072 sc1
    s_waitcnt vmcnt(13) lgkmcnt(3)
    v_mfma_f32_32x32x16_bf16 v[64:79], v[192:195], v[128:131], v[64:79]
    ds_read_b128 v[144:147], v2 offset:36864
    s_waitcnt lgkmcnt(3)
    v_mfma_f32_32x32x16_bf16 v[80:95], v[192:195], v[132:135], v[80:95]
    ds_read_b128 v[148:151], v2 offset:37888
    s_waitcnt lgkmcnt(3)
    v_mfma_f32_32x32x16_bf16 v[96:111], v[192:195], v[136:139], v[96:111]
    ds_read_b128 v[152:155], v2 offset:38912
    s_waitcnt lgkmcnt(3)
    v_mfma_f32_32x32x16_bf16 v[112:127], v[192:195], v[140:143], v[112:127]
    ds_read_b128 v[156:159], v2 offset:39936
    s_add_u32 s25, s30, 20480
    buffer_load_dwordx4 v[184:187], v2, s[12:15], s25 offen offset:0 sc1
    s_waitcnt vmcnt(13) lgkmcnt(3)
    v_mfma_f32_32x32x16_bf16 v[64:79], v[196:199], v[144:147], v[64:79]
    ds_read_b128 v[128:131], v2 offset:40960
    s_waitcnt lgkmcnt(3)
    v_mfma_f32_32x32x16_bf16 v[80:95], v[196:199], v[148:151], v[80:95]
    ds_read_b128 v[132:135], v2 offset:41984
    s_waitcnt lgkmcnt(3)
    v_mfma_f32_32x32x16_bf16 v[96:111], v[196:199], v[152:155], v[96:111]
    ds_read_b128 v[136:139], v2 offset:43008
    s_waitcnt lgkmcnt(3)
    v_mfma_f32_32x32x16_bf16 v[112:127], v[196:199], v[156:159], v[112:127]
    ds_read_b128 v[140:143], v2 offset:44032
    buffer_load_dwordx4 v[188:191], v2, s[12:15], s25 offen offset:1024 sc1
    s_waitcnt vmcnt(13) lgkmcnt(3)
    v_mfma_f32_32x32x16_bf16 v[64:79], v[200:203], v[128:131], v[64:79]
    ds_read_b128 v[144:147], v2 offset:45056
    s_waitcnt lgkmcnt(3)
    v_mfma_f32_32x32x16_bf16 v[80:95], v[200:203], v[132:135], v[80:95]
    ds_read_b128 v[148:151], v2 offset:46080
    s_waitcnt lgkmcnt(3)
    v_mfma_f32_32x32x16_bf16 v[96:111], v[200:203], v[136:139], v[96:111]
    ds_read_b128 v[152:155], v2 offset:47104
    s_waitcnt lgkmcnt(3)
    v_mfma_f32_32x32x16_bf16 v[112:127], v[200:203], v[140:143], v[112:127]
    ds_read_b128 v[156:159], v2 offset:48128
    buffer_load_dwordx4 v[192:195], v2, s[12:15], s25 offen offset:2048 sc1
    s_waitcnt vmcnt(13) lgkmcnt(3)
    v_mfma_f32_32x32x16_bf16 v[64:79], v[204:207], v[144:147], v[64:79]
    s_barrier
    ds_read_b128 v[128:131], v2 offset:49152
    s_waitcnt lgkmcnt(3)
    v_mfma_f32_32x32x16_bf16 v[80:95], v[204:207], v[148:151], v[80:95]
    ds_read_b128 v[132:135], v2 offset:50176
    s_waitcnt lgkmcnt(3)
    v_mfma_f32_32x32x16_bf16 v[96:111], v[204:207], v[152:155], v[96:111]
    ds_read_b128 v[136:139], v2 offset:51200
    s_waitcnt lgkmcnt(3)
    v_mfma_f32_32x32x16_bf16 v[112:127], v[204:207], v[156:159], v[112:127]
    ds_read_b128 v[140:143], v2 offset:52224
    buffer_load_dwordx4 v[196:199], v2, s[12:15], s25 offen offset:3072 sc1
    s_waitcnt vmcnt(11) lgkmcnt(3)
    v_mfma_f32_32x32x16_bf16 v[64:79], v[208:211], v[128:131], v[64:79]
    ds_read_b128 v[144:147], v2 offset:53248
    v_add_f32 v8, v8, v10
    s_waitcnt lgkmcnt(3)
    v_mfma_f32_32x32x16_bf16 v[80:95], v[208:211], v[132:135], v[80:95]
    ds_read_b128 v[148:151], v2 offset:54272
    v_add_f32 v9, v9, v11
    s_waitcnt lgkmcnt(3)
    v_mfma_f32_32x32x16_bf16 v[96:111], v[208:211], v[136:139], v[96:111]
    ds_read_b128 v[152:155], v2 offset:55296
    v_add_f32 v12, v12, v14
    s_waitcnt lgkmcnt(3)
    v_mfma_f32_32x32x16_bf16 v[112:127], v[208:211], v[140:143], v[112:127]
    ds_read_b128 v[156:159], v2 offset:56320
    s_add_u32 s25, s30, 24576
    buffer_load_dwordx4 v[200:203], v2, s[12:15], s25 offen offset:0 sc1
    v_add_f32 v13, v13, v15
    s_waitcnt vmcnt(11) lgkmcnt(3)
    v_mfma_f32_32x32x16_bf16 v[64:79], v[212:215], v[144:147], v[64:79]
    ds_read_b128 v[128:131], v2 offset:57344
    v_add_f32 v8, v8, v12
    s_waitcnt lgkmcnt(3)
    v_mfma_f32_32x32x16_bf16 v[80:95], v[212:215], v[148:151], v[80:95]
    ds_read_b128 v[132:135], v2 offset:58368
    v_add_f32 v9, v9, v13
    s_waitcnt lgkmcnt(3)
    v_mfma_f32_32x32x16_bf16 v[96:111], v[212:215], v[152:155], v[96:111]
    ds_read_b128 v[136:139], v2 offset:59392
    v_mov_b32 v10, v8
    s_waitcnt lgkmcnt(3)
    v_mfma_f32_32x32x16_bf16 v[112:127], v[212:215], v[156:159], v[112:127]
    ds_read_b128 v[140:143], v2 offset:60416
    buffer_load_dwordx4 v[204:207], v2, s[12:15], s25 offen offset:1024 sc1
    s_nop 1
    s_waitcnt vmcnt(11) lgkmcnt(3)
    v_mfma_f32_32x32x16_bf16 v[64:79], v[160:163], v[128:131], v[64:79]
    ds_read_b128 v[144:147], v2 offset:61440
    v_permlane32_swap_b32 v8, v10
    s_waitcnt lgkmcnt(3)
    v_mfma_f32_32x32x16_bf16 v[80:95], v[160:163], v[132:135], v[80:95]
    ds_read_b128 v[148:151], v2 offset:62464
    v_add_f32 v8, v8, v10
    s_waitcnt lgkmcnt(3)
    v_mfma_f32_32x32x16_bf16 v[96:111], v[160:163], v[136:139], v[96:111]
    ds_read_b128 v[152:155], v2 offset:63488
    v_mov_b32 v11, v9
    s_waitcnt lgkmcnt(3)
    v_mfma_f32_32x32x16_bf16 v[112:127], v[160:163], v[140:143], v[112:127]
    ds_read_b128 v[156:159], v2 offset:64512
    buffer_load_dwordx4 v[208:211], v2, s[12:15], s25 offen offset:2048 sc1
    s_nop 1
    s_waitcnt vmcnt(11) lgkmcnt(3)
    v_mfma_f32_32x32x16_bf16 v[64:79], v[164:167], v[144:147], v[64:79]
    s_barrier
    ds_read_b128 v[128:131], v3 offset:0
    v_permlane32_swap_b32 v9, v11
    s_waitcnt lgkmcnt(3)
    v_mfma_f32_32x32x16_bf16 v[80:95], v[164:167], v[148:151], v[80:95]
    ds_read_b128 v[132:135], v3 offset:1024
    v_add_f32 v9, v9, v11
    s_waitcnt lgkmcnt(3)
    v_mfma_f32_32x32x16_bf16 v[96:111], v[164:167], v[152:155], v[96:111]
    ds_read_b128 v[136:139], v3 offset:2048
    v_mul_f32 v8, 0x3acccccd, v8
    s_waitcnt lgkmcnt(3)
    v_mfma_f32_32x32x16_bf16 v[112:127], v[164:167], v[156:159], v[112:127]
    ds_read_b128 v[140:143], v3 offset:3072
    buffer_load_dwordx4 v[212:215], v2, s[12:15], s25 offen offset:3072 sc1
    v_mul_f32 v9, 0x3acccccd, v9
    s_waitcnt vmcnt(11) lgkmcnt(3)
    v_mfma_f32_32x32x16_bf16 v[64:79], v[168:171], v[128:131], v[64:79]
    ds_read_b128 v[144:147], v3 offset:4096
    v_fma_f32 v9, -v8, v8, v9
    s_waitcnt lgkmcnt(3)
    v_mfma_f32_32x32x16_bf16 v[80:95], v[168:171], v[132:135], v[80:95]
    ds_read_b128 v[148:151], v3 offset:5120
    v_max_f32 v9, 0, v9
    s_waitcnt lgkmcnt(3)
    v_mfma_f32_32x32x16_bf16 v[96:111], v[168:171], v[136:139], v[96:111]
    ds_read_b128 v[152:155], v3 offset:6144
    v_add_f32 v10, 0x3727c5ac, v9
    s_waitcnt lgkmcnt(3)
    v_mfma_f32_32x32x16_bf16 v[112:127], v[168:171], v[140:143], v[112:127]
    ds_read_b128 v[156:159], v3 offset:7168
    s_add_u32 s25, s30, 28672
    buffer_load_dwordx4 v[160:163], v2, s[12:15], s25 offen offset:0 sc1
    v_rsq_f32 v10, v10
    s_waitcnt vmcnt(11) lgkmcnt(3)
    v_mfma_f32_32x32x16_bf16 v[64:79], v[172:175], v[144:147], v[64:79]
    ds_read_b128 v[128:131], v3 offset:8192
    s_nop 0
    s_waitcnt lgkmcnt(3)
    v_mfma_f32_32x32x16_bf16 v[80:95], v[172:175], v[148:151], v[80:95]
    ds_read_b128 v[132:135], v3 offset:9216
    v_mov_b32 v9, v10
    s_waitcnt lgkmcnt(3)
    v_mfma_f32_32x32x16_bf16 v[96:111], v[172:175], v[152:155], v[96:111]
    ds_read_b128 v[136:139], v3 offset:10240
    v_mul_f32 v8, -v8, v9
    s_waitcnt lgkmcnt(3)
    v_mfma_f32_32x32x16_bf16 v[112:127], v[172:175], v[156:159], v[112:127]
    ds_read_b128 v[140:143], v3 offset:11264
    buffer_load_dwordx4 v[164:167], v2, s[12:15], s25 offen offset:1024 sc1
    ds_write_b32 v18, v9
    s_waitcnt vmcnt(11) lgkmcnt(4)
    v_mfma_f32_32x32x16_bf16 v[64:79], v[176:179], v[128:131], v[64:79]
    ds_read_b128 v[144:147], v3 offset:12288
    ds_write_b32 v18, v8 offset:128
    s_waitcnt lgkmcnt(5)
    v_mfma_f32_32x32x16_bf16 v[80:95], v[176:179], v[132:135], v[80:95]
    ds_read_b128 v[148:151], v3 offset:13312
    ds_read_b128 v[216:219], v19 offset:0
    s_waitcnt lgkmcnt(6)
    v_mfma_f32_32x32x16_bf16 v[96:111], v[176:179], v[136:139], v[96:111]
    ds_read_b128 v[152:155], v3 offset:14336
    ds_read_b128 v[232:235], v19 offset:128
    s_waitcnt lgkmcnt(7)
    v_mfma_f32_32x32x16_bf16 v[112:127], v[176:179], v[140:143], v[112:127]
    ds_read_b128 v[156:159], v3 offset:15360
    buffer_load_dwordx4 v[168:171], v2, s[12:15], s25 offen offset:2048 sc1
    ds_read_b128 v[220:223], v19 offset:32
    s_waitcnt vmcnt(11) lgkmcnt(7)
    v_mfma_f32_32x32x16_bf16 v[64:79], v[180:183], v[144:147], v[64:79]
    s_barrier
    ds_read_b128 v[128:131], v3 offset:16384
    ds_read_b128 v[236:239], v19 offset:160
    s_waitcnt lgkmcnt(7)
    v_mfma_f32_32x32x16_bf16 v[80:95], v[180:183], v[148:151], v[80:95]
    ds_read_b128 v[132:135], v3 offset:17408
    ds_read_b128 v[224:227], v19 offset:64
    s_waitcnt lgkmcnt(7)
    v_mfma_f32_32x32x16_bf16 v[96:111], v[180:183], v[152:155], v[96:111]
    ds_read_b128 v[136:139], v3 offset:18432
    ds_read_b128 v[240:243], v19 offset:192
    s_waitcnt lgkmcnt(7)
    v_mfma_f32_32x32x16_bf16 v[112:127], v[180:183], v[156:159], v[112:127]
    ds_read_b128 v[140:143], v3 offset:19456
    buffer_load_dwordx4 v[172:175], v2, s[12:15], s25 offen offset:3072 sc1
    ds_read_b128 v[228:231], v19 offset:96
    s_waitcnt vmcnt(11) lgkmcnt(7)
    v_mfma_f32_32x32x16_bf16 v[64:79], v[184:187], v[128:131], v[64:79]
    ds_read_b128 v[144:147], v3 offset:20480
    ds_read_b128 v[244:247], v19 offset:224
    s_waitcnt lgkmcnt(7)
    v_mfma_f32_32x32x16_bf16 v[80:95], v[184:187], v[132:135], v[80:95]
    ds_read_b128 v[148:151], v3 offset:21504
    s_waitcnt lgkmcnt(6)
    v_mfma_f32_32x32x16_bf16 v[96:111], v[184:187], v[136:139], v[96:111]
    ds_read_b128 v[152:155], v3 offset:22528
    s_waitcnt lgkmcnt(5)
    v_mfma_f32_32x32x16_bf16 v[112:127], v[184:187], v[140:143], v[112:127]
    ds_read_b128 v[156:159], v3 offset:23552
    s_add_u32 s25, s30, 32768
    buffer_load_dwordx4 v[176:179], v2, s[12:15], s25 offen offset:0 sc1
    s_waitcnt vmcnt(11) lgkmcnt(4)
    v_mfma_f32_32x32x16_bf16 v[64:79], v[188:191], v[144:147], v[64:79]
    ds_read_b128 v[128:131], v3 offset:24576
    s_waitcnt lgkmcnt(3)
    v_mfma_f32_32x32x16_bf16 v[80:95], v[188:191], v[148:151], v[80:95]
    ds_read_b128 v[132:135], v3 offset:25600
    s_waitcnt lgkmcnt(3)
    v_mfma_f32_32x32x16_bf16 v[96:111], v[188:191], v[152:155], v[96:111]
    ds_read_b128 v[136:139], v3 offset:26624
    s_waitcnt lgkmcnt(3)
    v_mfma_f32_32x32x16_bf16 v[112:127], v[188:191], v[156:159], v[112:127]
    ds_read_b128 v[140:143], v3 offset:27648
    buffer_load_dwordx4 v[180:183], v2, s[12:15], s25 offen offset:1024 sc1
    s_waitcnt vmcnt(11) lgkmcnt(3)
    v_mfma_f32_32x32x16_bf16 v[64:79], v[192:195], v[128:131], v[64:79]
    ds_read_b128 v[144:147], v3 offset:28672
    s_waitcnt lgkmcnt(3)
    v_mfma_f32_32x32x16_bf16 v[80:95], v[192:195], v[132:135], v[80:95]
    ds_read_b128 v[148:151], v3 offset:29696
    s_waitcnt lgkmcnt(3)
    v_mfma_f32_32x32x16_bf16 v[96:111], v[192:195], v[136:139], v[96:111]
    ds_read_b128 v[152:155], v3 offset:30720
    s_waitcnt lgkmcnt(3)
    v_mfma_f32_32x32x16_bf16 v[112:127], v[192:195], v[140:143], v[112:127]
    ds_read_b128 v[156:159], v3 offset:31744
    buffer_load_dwordx4 v[184:187], v2, s[12:15], s25 offen offset:2048 sc1
    s_waitcnt vmcnt(11) lgkmcnt(3)
    v_mfma_f32_32x32x16_bf16 v[64:79], v[196:199], v[144:147], v[64:79]
    s_barrier
    ds_read_b128 v[128:131], v3 offset:57344
    s_waitcnt lgkmcnt(3)
    v_mfma_f32_32x32x16_bf16 v[80:95], v[196:199], v[148:151], v[80:95]
    ds_read_b128 v[132:135], v3 offset:58368
    s_waitcnt lgkmcnt(3)
    v_mfma_f32_32x32x16_bf16 v[96:111], v[196:199], v[152:155], v[96:111]
    ds_read_b128 v[136:139], v3 offset:59392
    s_waitcnt lgkmcnt(3)
    v_mfma_f32_32x32x16_bf16 v[112:127], v[196:199], v[156:159], v[112:127]
    ds_read_b128 v[140:143], v3 offset:60416
    buffer_load_dwordx4 v[188:191], v2, s[12:15], s25 offen offset:3072 sc1
    s_waitcnt vmcnt(11) lgkmcnt(3)
    v_mfma_f32_32x32x16_bf16 v[64:79], v[200:203], v[128:131], v[64:79]
    ds_read_b128 v[144:147], v3 offset:61440
    s_waitcnt lgkmcnt(3)
    v_mfma_f32_32x32x16_bf16 v[80:95], v[200:203], v[132:135], v[80:95]
    ds_read_b128 v[148:151], v3 offset:62464
    s_waitcnt lgkmcnt(3)
    v_mfma_f32_32x32x16_bf16 v[96:111], v[200:203], v[136:139], v[96:111]
    ds_read_b128 v[152:155], v3 offset:63488
    s_waitcnt lgkmcnt(3)
    v_mfma_f32_32x32x16_bf16 v[112:127], v[200:203], v[140:143], v[112:127]
    ds_read_b128 v[156:159], v3 offset:64512
    s_add_u32 s25, s30, 36864
    buffer_load_dwordx4 v[192:195], v2, s[12:15], s25 offen offset:0 sc1
    s_waitcnt vmcnt(11) lgkmcnt(3)
    v_mfma_f32_32x32x16_bf16 v[64:79], v[204:207], v[144:147], v[64:79]
    ds_read_b128 v[128:131], v4 offset:0
    s_waitcnt lgkmcnt(3)
    v_mfma_f32_32x32x16_bf16 v[80:95], v[204:207], v[148:151], v[80:95]
    ds_read_b128 v[132:135], v4 offset:1024
    s_waitcnt lgkmcnt(3)
    v_mfma_f32_32x32x16_bf16 v[96:111], v[204:207], v[152:155], v[96:111]
    ds_read_b128 v[136:139], v4 offset:2048
    s_waitcnt lgkmcnt(3)
    v_mfma_f32_32x32x16_bf16 v[112:127], v[204:207], v[156:159], v[112:127]
    ds_read_b128 v[140:143], v4 offset:3072
    buffer_load_dwordx4 v[196:199], v2, s[12:15], s25 offen offset:1024 sc1
    s_waitcnt vmcnt(11) lgkmcnt(3)
    v_mfma_f32_32x32x16_bf16 v[64:79], v[208:211], v[128:131], v[64:79]
    ds_read_b128 v[144:147], v4 offset:4096
    s_waitcnt lgkmcnt(3)
    v_mfma_f32_32x32x16_bf16 v[80:95], v[208:211], v[132:135], v[80:95]
    ds_read_b128 v[148:151], v4 offset:5120
    s_waitcnt lgkmcnt(3)
    v_mfma_f32_32x32x16_bf16 v[96:111], v[208:211], v[136:139], v[96:111]
    ds_read_b128 v[152:155], v4 offset:6144
    s_waitcnt lgkmcnt(3)
    v_mfma_f32_32x32x16_bf16 v[112:127], v[208:211], v[140:143], v[112:127]
    ds_read_b128 v[156:159], v4 offset:7168
    buffer_load_dwordx4 v[200:203], v2, s[12:15], s25 offen offset:2048 sc1
    s_waitcnt vmcnt(11) lgkmcnt(3)
    v_mfma_f32_32x32x16_bf16 v[64:79], v[212:215], v[144:147], v[64:79]
    s_barrier
    ds_read_b128 v[128:131], v4 offset:8192
    s_waitcnt lgkmcnt(3)
    v_mfma_f32_32x32x16_bf16 v[80:95], v[212:215], v[148:151], v[80:95]
    ds_read_b128 v[132:135], v4 offset:9216
    s_waitcnt lgkmcnt(3)
    v_mfma_f32_32x32x16_bf16 v[96:111], v[212:215], v[152:155], v[96:111]
    ds_read_b128 v[136:139], v4 offset:10240
    s_waitcnt lgkmcnt(3)
    v_mfma_f32_32x32x16_bf16 v[112:127], v[212:215], v[156:159], v[112:127]
    ds_read_b128 v[140:143], v4 offset:11264
    buffer_load_dwordx4 v[204:207], v2, s[12:15], s25 offen offset:3072 sc1
    s_waitcnt vmcnt(11) lgkmcnt(3)
    v_mfma_f32_32x32x16_bf16 v[64:79], v[160:163], v[128:131], v[64:79]
    ds_read_b128 v[144:147], v4 offset:12288
    s_waitcnt lgkmcnt(3)
    v_mfma_f32_32x32x16_bf16 v[80:95], v[160:163], v[132:135], v[80:95]
    ds_read_b128 v[148:151], v4 offset:13312
    s_waitcnt lgkmcnt(3)
    v_mfma_f32_32x32x16_bf16 v[96:111], v[160:163], v[136:139], v[96:111]
    ds_read_b128 v[152:155], v4 offset:14336
    s_waitcnt lgkmcnt(3)
    v_mfma_f32_32x32x16_bf16 v[112:127], v[160:163], v[140:143], v[112:127]
    ds_read_b128 v[156:159], v4 offset:15360
    s_waitcnt vmcnt(10) lgkmcnt(3)
    v_mfma_f32_32x32x16_bf16 v[64:79], v[164:167], v[144:147], v[64:79]
    ds_read_b128 v[128:131], v4 offset:16384
    s_waitcnt lgkmcnt(3)
    v_mfma_f32_32x32x16_bf16 v[80:95], v[164:167], v[148:151], v[80:95]
    ds_read_b128 v[132:135], v4 offset:17408
    s_waitcnt lgkmcnt(3)
    v_mfma_f32_32x32x16_bf16 v[96:111], v[164:167], v[152:155], v[96:111]
    ds_read_b128 v[136:139], v4 offset:18432
    s_waitcnt lgkmcnt(3)
    v_mfma_f32_32x32x16_bf16 v[112:127], v[164:167], v[156:159], v[112:127]
    ds_read_b128 v[140:143], v4 offset:19456
    s_waitcnt vmcnt(9) lgkmcnt(3)
    v_mfma_f32_32x32x16_bf16 v[64:79], v[168:171], v[128:131], v[64:79]
    ds_read_b128 v[144:147], v4 offset:20480
    s_waitcnt lgkmcnt(3)
    v_mfma_f32_32x32x16_bf16 v[80:95], v[168:171], v[132:135], v[80:95]
    ds_read_b128 v[148:151], v4 offset:21504
    s_waitcnt lgkmcnt(3)
    v_mfma_f32_32x32x16_bf16 v[96:111], v[168:171], v[136:139], v[96:111]
    ds_read_b128 v[152:155], v4 offset:22528
    s_waitcnt lgkmcnt(3)
    v_mfma_f32_32x32x16_bf16 v[112:127], v[168:171], v[140:143], v[112:127]
    ds_read_b128 v[156:159], v4 offset:23552
    s_waitcnt vmcnt(8) lgkmcnt(3)
    v_mfma_f32_32x32x16_bf16 v[64:79], v[172:175], v[144:147], v[64:79]
    s_barrier
    ds_read_b128 v[128:131], v3 offset:36864
    s_waitcnt lgkmcnt(3)
    v_mfma_f32_32x32x16_bf16 v[80:95], v[172:175], v[148:151], v[80:95]
    ds_read_b128 v[132:135], v3 offset:37888
    s_waitcnt lgkmcnt(3)
    v_mfma_f32_32x32x16_bf16 v[96:111], v[172:175], v[152:155], v[96:111]
    ds_read_b128 v[136:139], v3 offset:38912
    s_waitcnt lgkmcnt(3)
    v_mfma_f32_32x32x16_bf16 v[112:127], v[172:175], v[156:159], v[112:127]
    ds_read_b128 v[140:143], v3 offset:39936
    s_waitcnt vmcnt(7) lgkmcnt(3)
    v_mfma_f32_32x32x16_bf16 v[64:79], v[176:179], v[128:131], v[64:79]
    ds_read_b128 v[144:147], v3 offset:40960
    s_waitcnt lgkmcnt(3)
    v_mfma_f32_32x32x16_bf16 v[80:95], v[176:179], v[132:135], v[80:95]
    ds_read_b128 v[148:151], v3 offset:41984
    s_waitcnt lgkmcnt(3)
    v_mfma_f32_32x32x16_bf16 v[96:111], v[176:179], v[136:139], v[96:111]
    ds_read_b128 v[152:155], v3 offset:43008
    s_waitcnt lgkmcnt(3)
    v_mfma_f32_32x32x16_bf16 v[112:127], v[176:179], v[140:143], v[112:127]
    ds_read_b128 v[156:159], v3 offset:44032
    s_waitcnt vmcnt(6) lgkmcnt(3)
    v_mfma_f32_32x32x16_bf16 v[64:79], v[180:183], v[144:147], v[64:79]
    ds_read_b128 v[128:131], v3 offset:45056
    s_waitcnt lgkmcnt(3)
    v_mfma_f32_32x32x16_bf16 v[80:95], v[180:183], v[148:151], v[80:95]
    ds_read_b128 v[132:135], v3 offset:46080
    s_waitcnt lgkmcnt(3)
    v_mfma_f32_32x32x16_bf16 v[96:111], v[180:183], v[152:155], v[96:111]
    ds_read_b128 v[136:139], v3 offset:47104
    s_waitcnt lgkmcnt(3)
    v_mfma_f32_32x32x16_bf16 v[112:127], v[180:183], v[156:159], v[112:127]
    ds_read_b128 v[140:143], v3 offset:48128
    s_waitcnt vmcnt(5) lgkmcnt(3)
    v_mfma_f32_32x32x16_bf16 v[64:79], v[184:187], v[128:131], v[64:79]
    ds_read_b128 v[144:147], v3 offset:49152
    s_waitcnt lgkmcnt(3)
    v_mfma_f32_32x32x16_bf16 v[80:95], v[184:187], v[132:135], v[80:95]
    ds_read_b128 v[148:151], v3 offset:50176
    s_waitcnt lgkmcnt(3)
    v_mfma_f32_32x32x16_bf16 v[96:111], v[184:187], v[136:139], v[96:111]
    ds_read_b128 v[152:155], v3 offset:51200
    s_waitcnt lgkmcnt(3)
    v_mfma_f32_32x32x16_bf16 v[112:127], v[184:187], v[140:143], v[112:127]
    ds_read_b128 v[156:159], v3 offset:52224
    s_waitcnt vmcnt(4) lgkmcnt(3)
    v_mfma_f32_32x32x16_bf16 v[64:79], v[188:191], v[144:147], v[64:79]
    s_barrier
    ds_read_b128 v[128:131], v2 offset:0
    s_waitcnt lgkmcnt(3)
    v_mfma_f32_32x32x16_bf16 v[80:95], v[188:191], v[148:151], v[80:95]
    ds_read_b128 v[132:135], v2 offset:1024
    s_waitcnt lgkmcnt(3)
    v_mfma_f32_32x32x16_bf16 v[96:111], v[188:191], v[152:155], v[96:111]
    ds_read_b128 v[136:139], v2 offset:2048
    s_waitcnt lgkmcnt(3)
    v_mfma_f32_32x32x16_bf16 v[112:127], v[188:191], v[156:159], v[112:127]
    ds_read_b128 v[140:143], v2 offset:3072
    s_waitcnt vmcnt(3) lgkmcnt(3)
    v_mfma_f32_32x32x16_bf16 v[64:79], v[192:195], v[128:131], v[64:79]
    ds_read_b128 v[144:147], v2 offset:4096
    s_waitcnt lgkmcnt(3)
    v_mfma_f32_32x32x16_bf16 v[80:95], v[192:195], v[132:135], v[80:95]
    ds_read_b128 v[148:151], v2 offset:5120
    s_waitcnt lgkmcnt(3)
    v_mfma_f32_32x32x16_bf16 v[96:111], v[192:195], v[136:139], v[96:111]
    ds_read_b128 v[152:155], v2 offset:6144
    s_waitcnt lgkmcnt(3)
    v_mfma_f32_32x32x16_bf16 v[112:127], v[192:195], v[140:143], v[112:127]
    ds_read_b128 v[156:159], v2 offset:7168
    s_waitcnt vmcnt(2) lgkmcnt(3)
    v_mfma_f32_32x32x16_bf16 v[64:79], v[196:199], v[144:147], v[64:79]
    ds_read_b128 v[128:131], v2 offset:8192
    s_waitcnt lgkmcnt(3)
    v_mfma_f32_32x32x16_bf16 v[80:95], v[196:199], v[148:151], v[80:95]
    ds_read_b128 v[132:135], v2 offset:9216
    s_waitcnt lgkmcnt(3)
    v_mfma_f32_32x32x16_bf16 v[96:111], v[196:199], v[152:155], v[96:111]
    ds_read_b128 v[136:139], v2 offset:10240
    s_waitcnt lgkmcnt(3)
    v_mfma_f32_32x32x16_bf16 v[112:127], v[196:199], v[156:159], v[112:127]
    ds_read_b128 v[140:143], v2 offset:11264
    s_waitcnt vmcnt(1) lgkmcnt(3)
    v_mfma_f32_32x32x16_bf16 v[64:79], v[200:203], v[128:131], v[64:79]
    ds_read_b128 v[144:147], v2 offset:12288
    s_waitcnt lgkmcnt(3)
    v_mfma_f32_32x32x16_bf16 v[80:95], v[200:203], v[132:135], v[80:95]
    ds_read_b128 v[148:151], v2 offset:13312
    s_waitcnt lgkmcnt(3)
    v_mfma_f32_32x32x16_bf16 v[96:111], v[200:203], v[136:139], v[96:111]
    ds_read_b128 v[152:155], v2 offset:14336
    s_waitcnt lgkmcnt(3)
    v_mfma_f32_32x32x16_bf16 v[112:127], v[200:203], v[140:143], v[112:127]
    ds_read_b128 v[156:159], v2 offset:15360
    s_waitcnt vmcnt(0) lgkmcnt(3)
    v_mfma_f32_32x32x16_bf16 v[64:79], v[204:207], v[144:147], v[64:79]
    s_waitcnt lgkmcnt(2)
    v_mfma_f32_32x32x16_bf16 v[80:95], v[204:207], v[148:151], v[80:95]
    s_waitcnt lgkmcnt(1)
    v_mfma_f32_32x32x16_bf16 v[96:111], v[204:207], v[152:155], v[96:111]
    s_waitcnt lgkmcnt(0)
    v_mfma_f32_32x32x16_bf16 v[112:127], v[204:207], v[156:159], v[112:127]
    s_nop 7
    v_pk_mul_f32 v[64:65], v[64:65], v[216:217]
    v_pk_mul_f32 v[66:67], v[66:67], v[218:219]
    v_pk_mul_f32 v[68:69], v[68:69], v[220:221]
    v_pk_mul_f32 v[70:71], v[70:71], v[222:223]
    v_pk_mul_f32 v[72:73], v[72:73], v[224:225]
    v_pk_mul_f32 v[74:75], v[74:75], v[226:227]
    v_pk_mul_f32 v[76:77], v[76:77], v[228:229]
    v_pk_mul_f32 v[78:79], v[78:79], v[230:231]
    v_pk_fma_f32 v[64:65], v[232:233], v[40:41], v[64:65] op_sel_hi:[1,0,1]
    v_pk_fma_f32 v[66:67], v[234:235], v[40:41], v[66:67] op_sel_hi:[1,0,1]
    v_pk_fma_f32 v[68:69], v[236:237], v[40:41], v[68:69] op_sel_hi:[1,0,1]
    v_pk_fma_f32 v[70:71], v[238:239], v[40:41], v[70:71] op_sel_hi:[1,0,1]
    v_pk_fma_f32 v[72:73], v[240:241], v[40:41], v[72:73] op_sel_hi:[1,0,1]
    v_pk_fma_f32 v[74:75], v[242:243], v[40:41], v[74:75] op_sel_hi:[1,0,1]
    v_pk_fma_f32 v[76:77], v[244:245], v[40:41], v[76:77] op_sel_hi:[1,0,1]
    v_pk_fma_f32 v[78:79], v[246:247], v[40:41], v[78:79] op_sel_hi:[1,0,1]
    v_cvt_pk_bf16_f32 v64, v64, v65
    v_cvt_pk_bf16_f32 v65, v66, v67
    v_cvt_pk_bf16_f32 v66, v68, v69
    v_cvt_pk_bf16_f32 v67, v70, v71
    v_cvt_pk_bf16_f32 v68, v72, v73
    v_cvt_pk_bf16_f32 v69, v74, v75
    v_cvt_pk_bf16_f32 v70, v76, v77
    v_cvt_pk_bf16_f32 v71, v78, v79
    buffer_store_dwordx4 v[64:67], v32, s[4:7], s42 offen sc1
    buffer_store_dwordx4 v[68:71], v32, s[4:7], s42 offen offset:640 sc1
    v_pk_mul_f32 v[80:81], v[80:81], v[216:217]
    v_pk_mul_f32 v[82:83], v[82:83], v[218:219]
    v_pk_mul_f32 v[84:85], v[84:85], v[220:221]
    v_pk_mul_f32 v[86:87], v[86:87], v[222:223]
    v_pk_mul_f32 v[88:89], v[88:89], v[224:225]
    v_pk_mul_f32 v[90:91], v[90:91], v[226:227]
    v_pk_mul_f32 v[92:93], v[92:93], v[228:229]
    v_pk_mul_f32 v[94:95], v[94:95], v[230:231]
    v_pk_fma_f32 v[80:81], v[232:233], v[42:43], v[80:81] op_sel_hi:[1,0,1]
    v_pk_fma_f32 v[82:83], v[234:235], v[42:43], v[82:83] op_sel_hi:[1,0,1]
    v_pk_fma_f32 v[84:85], v[236:237], v[42:43], v[84:85] op_sel_hi:[1,0,1]
    v_pk_fma_f32 v[86:87], v[238:239], v[42:43], v[86:87] op_sel_hi:[1,0,1]
    v_pk_fma_f32 v[88:89], v[240:241], v[42:43], v[88:89] op_sel_hi:[1,0,1]
    v_pk_fma_f32 v[90:91], v[242:243], v[42:43], v[90:91] op_sel_hi:[1,0,1]
    v_pk_fma_f32 v[92:93], v[244:245], v[42:43], v[92:93] op_sel_hi:[1,0,1]
    v_pk_fma_f32 v[94:95], v[246:247], v[42:43], v[94:95] op_sel_hi:[1,0,1]
    v_cvt_pk_bf16_f32 v80, v80, v81
    v_cvt_pk_bf16_f32 v81, v82, v83
    v_cvt_pk_bf16_f32 v82, v84, v85
    v_cvt_pk_bf16_f32 v83, v86, v87
    v_cvt_pk_bf16_f32 v84, v88, v89
    v_cvt_pk_bf16_f32 v85, v90, v91
    v_cvt_pk_bf16_f32 v86, v92, v93
    v_cvt_pk_bf16_f32 v87, v94, v95
    buffer_store_dwordx4 v[80:83], v33, s[4:7], s42 offen sc1
    buffer_store_dwordx4 v[84:87], v33, s[4:7], s42 offen offset:640 sc1
    v_pk_mul_f32 v[96:97], v[96:97], v[216:217]
    v_pk_mul_f32 v[98:99], v[98:99], v[218:219]
    v_pk_mul_f32 v[100:101], v[100:101], v[220:221]
    v_pk_mul_f32 v[102:103], v[102:103], v[222:223]
    v_pk_mul_f32 v[104:105], v[104:105], v[224:225]
    v_pk_mul_f32 v[106:107], v[106:107], v[226:227]
    v_pk_mul_f32 v[108:109], v[108:109], v[228:229]
    v_pk_mul_f32 v[110:111], v[110:111], v[230:231]
    v_pk_fma_f32 v[96:97], v[232:233], v[44:45], v[96:97] op_sel_hi:[1,0,1]
    v_pk_fma_f32 v[98:99], v[234:235], v[44:45], v[98:99] op_sel_hi:[1,0,1]
    v_pk_fma_f32 v[100:101], v[236:237], v[44:45], v[100:101] op_sel_hi:[1,0,1]
    v_pk_fma_f32 v[102:103], v[238:239], v[44:45], v[102:103] op_sel_hi:[1,0,1]
    v_pk_fma_f32 v[104:105], v[240:241], v[44:45], v[104:105] op_sel_hi:[1,0,1]
    v_pk_fma_f32 v[106:107], v[242:243], v[44:45], v[106:107] op_sel_hi:[1,0,1]
    v_pk_fma_f32 v[108:109], v[244:245], v[44:45], v[108:109] op_sel_hi:[1,0,1]
    v_pk_fma_f32 v[110:111], v[246:247], v[44:45], v[110:111] op_sel_hi:[1,0,1]
    v_cvt_pk_bf16_f32 v96, v96, v97
    v_cvt_pk_bf16_f32 v97, v98, v99
    v_cvt_pk_bf16_f32 v98, v100, v101
    v_cvt_pk_bf16_f32 v99, v102, v103
    v_cvt_pk_bf16_f32 v100, v104, v105
    v_cvt_pk_bf16_f32 v101, v106, v107
    v_cvt_pk_bf16_f32 v102, v108, v109
    v_cvt_pk_bf16_f32 v103, v110, v111
    buffer_store_dwordx4 v[96:99], v34, s[4:7], s42 offen sc1
    buffer_store_dwordx4 v[100:103], v34, s[4:7], s42 offen offset:640 sc1
    v_pk_mul_f32 v[112:113], v[112:113], v[216:217]
    v_pk_mul_f32 v[114:115], v[114:115], v[218:219]
    v_pk_mul_f32 v[116:117], v[116:117], v[220:221]
    v_pk_mul_f32 v[118:119], v[118:119], v[222:223]
    v_pk_mul_f32 v[120:121], v[120:121], v[224:225]
    v_pk_mul_f32 v[122:123], v[122:123], v[226:227]
    v_pk_mul_f32 v[124:125], v[124:125], v[228:229]
    v_pk_mul_f32 v[126:127], v[126:127], v[230:231]
    v_pk_fma_f32 v[112:113], v[232:233], v[46:47], v[112:113] op_sel_hi:[1,0,1]
    v_pk_fma_f32 v[114:115], v[234:235], v[46:47], v[114:115] op_sel_hi:[1,0,1]
    v_pk_fma_f32 v[116:117], v[236:237], v[46:47], v[116:117] op_sel_hi:[1,0,1]
    v_pk_fma_f32 v[118:119], v[238:239], v[46:47], v[118:119] op_sel_hi:[1,0,1]
    v_pk_fma_f32 v[120:121], v[240:241], v[46:47], v[120:121] op_sel_hi:[1,0,1]
    v_pk_fma_f32 v[122:123], v[242:243], v[46:47], v[122:123] op_sel_hi:[1,0,1]
    v_pk_fma_f32 v[124:125], v[244:245], v[46:47], v[124:125] op_sel_hi:[1,0,1]
    v_pk_fma_f32 v[126:127], v[246:247], v[46:47], v[126:127] op_sel_hi:[1,0,1]
    v_cvt_pk_bf16_f32 v112, v112, v113
    v_cvt_pk_bf16_f32 v113, v114, v115
    v_cvt_pk_bf16_f32 v114, v116, v117
    v_cvt_pk_bf16_f32 v115, v118, v119
    v_cvt_pk_bf16_f32 v116, v120, v121
    v_cvt_pk_bf16_f32 v117, v122, v123
    v_cvt_pk_bf16_f32 v118, v124, v125
    v_cvt_pk_bf16_f32 v119, v126, v127
    buffer_store_dwordx4 v[112:115], v35, s[4:7], s42 offen sc1
    buffer_store_dwordx4 v[116:119], v35, s[4:7], s42 offen offset:640 sc1
L_next:
    s_mov_b32 s50, 1
    s_mov_b32 s52, 7536640
    s_branch L_layer
L_lastl_69:
    s_waitcnt lgkmcnt(4)
    v_pk_add_f32 v[16:17], v[16:17], v[56:57]
    v_pk_add_f32 v[18:19], v[18:19], v[58:59]
    v_cvt_pk_bf16_f32 v112, v16, v17
    v_cvt_pk_bf16_f32 v113, v18, v19
    s_waitcnt lgkmcnt(3)
    v_pk_add_f32 v[20:21], v[20:21], v[60:61]
    v_pk_add_f32 v[22:23], v[22:23], v[62:63]
    v_cvt_pk_bf16_f32 v114, v20, v21
    v_cvt_pk_bf16_f32 v115, v22, v23
    v_pk_mov_b32 v[76:77], v[112:113], v[112:113] op_sel:[0,1]
    v_pk_mov_b32 v[78:79], v[114:115], v[114:115] op_sel:[0,1]
    s_nop 1
    v_permlane16_swap_b32 v76, v78
    v_permlane16_swap_b32 v77, v79
    buffer_store_dwordx4 v[76:79], v6, s[12:15], s42 offen offset:0
    s_waitcnt lgkmcnt(2)
    v_pk_add_f32 v[24:25], v[24:25], v[64:65]
    v_pk_add_f32 v[26:27], v[26:27], v[66:67]
    v_cvt_pk_bf16_f32 v116, v24, v25
    v_cvt_pk_bf16_f32 v117, v26, v27
    s_waitcnt lgkmcnt(1)
    v_pk_add_f32 v[28:29], v[28:29], v[68:69]
    v_pk_add_f32 v[30:31], v[30:31], v[70:71]
    v_cvt_pk_bf16_f32 v118, v28, v29
    v_cvt_pk_bf16_f32 v119, v30, v31
    v_pk_mov_b32 v[80:81], v[116:117], v[116:117] op_sel:[0,1]
    v_pk_mov_b32 v[82:83], v[118:119], v[118:119] op_sel:[0,1]
    s_nop 1
    v_permlane16_swap_b32 v80, v82
    v_permlane16_swap_b32 v81, v83
    buffer_store_dwordx4 v[80:83], v6, s[12:15], s42 offen offset:64
    s_waitcnt lgkmcnt(0)
    v_pk_add_f32 v[32:33], v[32:33], v[72:73]
    v_pk_add_f32 v[34:35], v[34:35], v[74:75]
    v_cvt_pk_bf16_f32 v120, v32, v33
    v_cvt_pk_bf16_f32 v121, v34, v35
    buffer_store_dwordx2 v[120:121], v15, s[12:15], s42 offen offset:128
    s_branch L_fin_47
L_sigimp_59:
    v_mov_b32 v8, 162816
    s_lshl_b32 s22, s53, 8
    s_add_u32 s22, s22, s52
    s_add_u32 s22, s22, 8192
    ds_add_rtn_u32 v10, v8, v9
    v_mov_b32 v8, 0
    s_waitcnt lgkmcnt(0)
    v_cmp_ne_u32 vcc, 11, v10
    s_cbranch_vccnz L_sigback_60
    buffer_wbl2 sc1
    s_waitcnt vmcnt(0)
    buffer_atomic_add v9, v8, s[4:7], s22 offen sc1
    s_branch L_sigback_60
L_pollimp_63:
    s_lshl_b32 s22, s53, 8
    s_add_u32 s22, s22, s52
    s_add_u32 s22, s22, 8192
    s_mov_b64 exec, 1
L_poll2_81:
    buffer_load_dword v10, v9, s[4:7], s22 offen sc1
    s_sub_u32 s23, s23, 1
    s_cbranch_scc1 L_polled2_82
    s_waitcnt vmcnt(0)
    v_cmp_gt_u32 vcc, 16, v10
    s_cbranch_vccnz L_poll2_81
L_polled2_82:
    s_waitcnt vmcnt(0)
    buffer_inv sc1
    s_waitcnt vmcnt(0)
    s_branch L_polled_62
L_sigimp_64:
    v_mov_b32 v8, 162816
    s_lshl_b32 s22, s53, 8
    s_add_u32 s22, s22, s52
    s_add_u32 s22, s22, 16384
    ds_add_rtn_u32 v10, v8, v9
    v_mov_b32 v8, 0
    s_waitcnt lgkmcnt(0)
    v_cmp_ne_u32 vcc, 15, v10
    s_cbranch_vccnz L_sigback_65
    buffer_wbl2 sc1
    s_waitcnt vmcnt(0)
    buffer_atomic_add v9, v8, s[4:7], s22 offen sc1
    s_branch L_sigback_65
L_pollimp_68:
    s_lshl_b32 s22, s53, 8
    s_add_u32 s22, s22, s52
    s_add_u32 s22, s22, 16384
    s_mov_b64 exec, 1
L_poll2_83:
    buffer_load_dword v10, v9, s[4:7], s22 offen sc1
    s_sub_u32 s23, s23, 1
    s_cbranch_scc1 L_polled2_84
    s_waitcnt vmcnt(0)
    v_cmp_gt_u32 vcc, 16, v10
    s_cbranch_vccnz L_poll2_83
L_polled2_84:
    s_waitcnt vmcnt(0)
    buffer_inv sc1
    s_waitcnt vmcnt(0)
    s_branch L_polled_67
L_sigimp_71:
    v_mov_b32 v8, 162816
    s_lshl_b32 s22, s53, 8
    s_add_u32 s22, s22, s52
    s_add_u32 s22, s22, 24576
    ds_add_rtn_u32 v10, v8, v9
    v_mov_b32 v8, 0
    s_waitcnt lgkmcnt(0)
    v_cmp_ne_u32 vcc, 19, v10
    s_cbranch_vccnz L_sigback_72
    buffer_wbl2 sc1
    s_waitcnt vmcnt(0)
    buffer_atomic_add v9, v8, s[4:7], s22 offen sc1
    s_branch L_sigback_72
L_pollimp_75:
    s_lshl_b32 s22, s53, 8
    s_add_u32 s22, s22, s52
    s_add_u32 s22, s22, 24576
    s_mov_b64 exec, 1
L_poll2_85:
    buffer_load_dword v10, v9, s[4:7], s22 offen sc1
    s_sub_u32 s23, s23, 1
    s_cbranch_scc1 L_polled2_86
    s_waitcnt vmcnt(0)
    v_cmp_gt_u32 vcc, 16, v10
    s_cbranch_vccnz L_poll2_85
L_polled2_86:
    s_waitcnt vmcnt(0)
    buffer_inv sc1
    s_waitcnt vmcnt(0)
    s_branch L_polled_74
L_sigimp_76:
    v_mov_b32 v8, 162816
    s_lshl_b32 s22, s53, 8
    s_add_u32 s22, s22, s52
    s_add_u32 s22, s22, 24576
    ds_add_rtn_u32 v10, v8, v9
    v_mov_b32 v8, 0
    s_waitcnt lgkmcnt(0)
    v_cmp_ne_u32 vcc, 19, v10
    s_cbranch_vccnz L_sigback_77
    buffer_wbl2 sc1
    s_waitcnt vmcnt(0)
    buffer_atomic_add v9, v8, s[4:7], s22 offen sc1
    s_branch L_sigback_77
L_pollimp_80:
    s_lshl_b32 s22, s53, 8
    s_add_u32 s22, s22, s52
    s_add_u32 s22, s22, 24576
    s_mov_b64 exec, 1
L_poll2_87:
    buffer_load_dword v10, v9, s[4:7], s22 offen sc1
    s_sub_u32 s23, s23, 1
    s_cbranch_scc1 L_polled2_88
    s_waitcnt vmcnt(0)
    v_cmp_gt_u32 vcc, 16, v10
    s_cbranch_vccnz L_poll2_87
L_polled2_88:
    s_waitcnt vmcnt(0)
    buffer_inv sc1
    s_waitcnt vmcnt(0)
    s_branch L_polled_79
L_fin_47:
L_end_chain:
    s_endpgm
L_text_end:
.section .rodata,"a"
.p2align 6
.amdhsa_kernel first_kernel
  .amdhsa_next_free_vgpr 256
  .amdhsa_next_free_sgpr 102
  .amdhsa_accum_offset 256
  .amdhsa_group_segment_fixed_size 0
  .amdhsa_kernarg_size 88
  .amdhsa_user_sgpr_count 2
  .amdhsa_user_sgpr_kernarg_segment_ptr 1
  .amdhsa_system_sgpr_workgroup_id_x 1
  .amdhsa_float_denorm_mode_32 3
  .amdhsa_float_denorm_mode_16_64 3
.end_amdhsa_kernel
.p2align 6
.amdhsa_kernel chain_kernel
  .amdhsa_next_free_vgpr 256
  .amdhsa_next_free_sgpr 102
  .amdhsa_accum_offset 256
  .amdhsa_group_segment_fixed_size 0
  .amdhsa_kernarg_size 88
  .amdhsa_user_sgpr_count 2
  .amdhsa_user_sgpr_kernarg_segment_ptr 1
  .amdhsa_system_sgpr_workgroup_id_x 1
  .amdhsa_float_denorm_mode_32 3
  .amdhsa_float_denorm_mode_16_64 3
.end_amdhsa_kernel
```
